```python
import torch

def _softmax(x, axis=-1):
    return torch.softmax(x, dim=axis)

def _gelu(x):
    return torch.nn.functional.gelu(x, approximate='tanh')

def _silu(x):
    return torch.nn.functional.silu(x)

def _sigmoid(x):
    return torch.sigmoid(x)

def _layernorm(x, axis=-1, eps=1e-05):
    m = x.mean(dim=axis, keepdim=True)
    v = x.var(dim=axis, keepdim=True, unbiased=False)
    return (x - m) / torch.sqrt(v + eps)

def _scatter_add(tgt, idx, src, axis=0):
    return tgt.clone().index_add_(axis, idx, src)

def _segment_sum(src, seg, n):
    out = torch.zeros((n,) + src.shape[1:], dtype=src.dtype)
    return out.index_add_(0, seg, src)

def _pad(x, pw):
    flat = tuple((v for pair in reversed(pw) for v in pair))
    return torch.nn.functional.pad(x, flat)
kernel_name = 'sequential_preLN__memory_aug_recurrent_mem_tr__swiglu_ffn__prompt'

def setup_inputs():

    _w = lambda a: (lambda t: t.to(torch.bfloat16) if t.is_floating_point() else t)(torch.as_tensor(a))

    def _A_setup():
        B, S, Dm = (1, 2048, 576)
        H, Dh = (32, 128)
        M, seg = (8, 32)
        seg = min(seg, S)
        S = S // seg * seg
        return {'x': _w((lambda *s: torch.randn(*s, dtype=torch.bfloat16) * 0.05)(B, S, Dm)), 'mem0': _w((lambda *s: torch.randn(*s, dtype=torch.bfloat16) * 0.2)(B, M, Dm)), 'Wq': _w((lambda *s: torch.randn(*s, dtype=torch.bfloat16) * 1.6)(Dm, H, Dh) * Dm ** (-0.5)), 'Wk': _w((lambda *s: torch.randn(*s, dtype=torch.bfloat16) * 1.6)(Dm, H, Dh) * Dm ** (-0.5)), 'Wv': _w((lambda *s: torch.randn(*s, dtype=torch.bfloat16) * 0.2)(Dm, H, Dh) * Dm ** (-0.5)), 'Wo': _w((lambda *s: torch.randn(*s, dtype=torch.bfloat16) * 0.2)(H, Dh, Dm) * (H * Dh) ** (-0.5)), 'seg_len': seg}
    _A_in = _A_setup()

    def _B_setup():
        B, S, D, F = (1, 2048, 576, 4608)
        return {'x': _w((lambda *s: torch.randn(*s, dtype=torch.bfloat16) * 0.05)(B, S, D)), 'w_gate': _w((lambda *s: torch.randn(*s, dtype=torch.bfloat16) * 0.05)(D, F)), 'w_up': _w((lambda *s: torch.randn(*s, dtype=torch.bfloat16) * 0.05)(D, F)), 'w_down': _w((lambda *s: torch.randn(*s, dtype=torch.bfloat16) * 0.05)(F, D))}
    _B_in = _B_setup()
    return {'A_x': _A_in['x'], 'A_mem0': _A_in['mem0'], 'A_Wq': _A_in['Wq'], 'A_Wk': _A_in['Wk'], 'A_Wv': _A_in['Wv'], 'A_Wo': _A_in['Wo'], 'A_seg_len': _A_in['seg_len'], 'B_x': _B_in['x'], 'B_w_gate': _B_in['w_gate'], 'B_w_up': _B_in['w_up'], 'B_w_down': _B_in['w_down']}

def reference(A_x, A_mem0, A_Wq, A_Wk, A_Wv, A_Wo, A_seg_len, B_x, B_w_gate, B_w_up, B_w_down):

    def _A_ref(x, mem0, Wq, Wk, Wv, Wo, seg_len):
        B, S, Dm = x.shape
        H, Dh = (Wq.shape[1], Wq.shape[2])
        M = mem0.shape[1]
        scale = Dh ** (-0.5)
        n_seg = S // seg_len
        L = M + seg_len
        idx = torch.arange(L)
        mask = (idx[:, None] < M) | (idx[:, None] >= idx[None, :])
        mem = mem0
        outs = []
        for s in range(n_seg):
            xs = x[:, s * seg_len:(s + 1) * seg_len, :].clone()
            h = torch.concatenate([mem, xs], axis=1)
            q = torch.einsum('btd,dhe->bhte', h, Wq)
            k = torch.einsum('btd,dhe->bhte', h, Wk)
            v = torch.einsum('btd,dhe->bhte', h, Wv)
            scores = torch.einsum('bhqe,bhke->bhqk', q, k) * scale
            scores = torch.where(mask[None, None], scores, -1000000000.0)
            p = _softmax(scores, axis=-1)
            o = torch.einsum('bhqk,bhke->bhqe', p, v)
            o = torch.einsum('bhte,hed->btd', o, Wo)
            mem = o[:, :M, :].clone()
            outs.append(o[:, M:, :])
        return torch.concatenate(outs, axis=1)

    def _B_ref(x, w_gate, w_up, w_down):
        g = _silu(x @ w_gate)
        u = x @ w_up
        return g * u @ w_down
    x = A_x
    h = x + _A_ref(_layernorm(x, axis=-1), A_mem0, A_Wq, A_Wk, A_Wv, A_Wo, A_seg_len)
    h2 = h + _B_ref(_layernorm(h, axis=-1), B_w_gate, B_w_up, B_w_down)
    return h2
```

```asm
; @launch grid=(256,1,1) block=(256,1,1) lds=163840
.amdgcn_target "amdgcn-amd-amdhsa--gfx950"
.text
.globl sequential_preLN__memory_aug_recurrent_mem_tr__swiglu_ffn__prompt_kernel
.p2align 8
.type sequential_preLN__memory_aug_recurrent_mem_tr__swiglu_ffn__prompt_kernel,@function
sequential_preLN__memory_aug_recurrent_mem_tr__swiglu_ffn__prompt_kernel:
    s_cmp_ge_u32 s2, 256
    s_cbranch_scc1 EXIT
    s_load_dwordx16 s[64:79], s[0:1], 0
    s_load_dwordx8 s[80:87], s[0:1], 64
    s_load_dwordx4 s[88:91], s[0:1], 96
    v_and_b32 v1, 63, v0
    v_lshrrev_b32 v3, 6, v0
    s_nop 0
    v_readfirstlane_b32 s24, v3
    s_getreg_b32 s28, hwreg(HW_REG_XCC_ID, 0, 4)
    s_xor_b32 s28, s28, 1
    s_and_b32 s28, s28, 7
    s_waitcnt lgkmcnt(0)
    s_mov_b32 s4, s90
    s_mov_b32 s5, s91
    s_mov_b32 s6, 0x10000000
    s_mov_b32 s7, 0x20000
    s_mov_b32 s8, s88
    s_mov_b32 s9, s89
    s_mov_b32 s10, 0x100
    s_mov_b32 s11, 0x20000
    s_cmp_lg_u32 s24, 0
    s_cbranch_scc1 P_WAIT
    s_mov_b32 s29, s28
    s_mov_b32 s30, 0
P_TRY:
    s_lshl_b32 s31, s29, 5
    v_mov_b32 v3, s31
    v_mov_b32 v4, 1
    s_mov_b64 exec, 1
    buffer_atomic_add v4, v3, s[8:11], 0 offen sc0 sc1
    s_waitcnt vmcnt(0)
    s_mov_b64 exec, -1
    v_readfirstlane_b32 s26, v4
    s_cmp_lt_u32 s26, 32
    s_cbranch_scc1 P_GOT
    s_add_u32 s29, s29, 1
    s_and_b32 s29, s29, 7
    s_add_u32 s30, s30, 1
    s_cmp_lt_u32 s30, 8
    s_cbranch_scc1 P_TRY
    s_mov_b32 s29, 8
P_GOT:
    s_lshl_b32 s31, s29, 8
    s_add_u32 s31, s31, s26
    v_mov_b32 v3, 0
    v_mov_b32 v4, s31
    ds_write_b32 v3, v4
    s_waitcnt lgkmcnt(0)
    s_branch P_JOIN
P_WAIT:
    s_cmp_ge_u32 s2, 18
    s_cbranch_scc1 P_JOIN
    s_cmp_lg_u32 s24, 1
    s_cbranch_scc1 P_JOIN
    v_mov_b32 v4, 0
    v_mov_b32 v5, 0
    v_mov_b32 v6, 0
    v_mov_b32 v7, 0
    v_lshlrev_b32 v3, 7, v1
    s_lshl_b32 s31, s2, 13
    s_add_u32 s31, s31, 0x60000
    buffer_store_dwordx4 v[4:7], v3, s[4:7], s31 offen sc1
    v_mov_b32 v3, 244
    v_mov_b32 v8, 1
    s_waitcnt vmcnt(0)
    s_mov_b64 exec, 1
    buffer_atomic_add v8, v3, s[8:11], 0 offen sc1
    s_mov_b64 exec, -1
P_JOIN:
    s_barrier
    v_mov_b32 v3, 0
    ds_read_b32 v4, v3
    s_waitcnt lgkmcnt(0)
    v_readfirstlane_b32 s31, v4
    s_lshr_b32 s25, s31, 8
    s_and_b32 s26, s31, 255
    s_barrier
    s_cmp_eq_u32 s25, 0
    s_cbranch_scc1 R_CHAIN
    s_cmp_gt_u32 s25, 7
    s_cbranch_scc1 EXIT
    s_mov_b32 s56, 0
    s_cmp_eq_u32 s25, 1
    s_cbranch_scc1 R_LN
    s_sub_u32 s32, s25, 2
    s_cmp_lt_u32 s26, 6
    s_cbranch_scc1 R_TRIP
    s_and_b32 s37, s26, 1
    s_lshr_b32 s33, s26, 1
    s_mul_i32 s34, s32, 5
    s_add_u32 s36, s34, s33
    s_sub_u32 s36, s36, 3
    s_cmp_lt_u32 s26, 16
    s_cbranch_scc1 R_QKV
    s_lshl_b32 s36, s32, 2
    s_add_u32 s36, s36, s33
    s_sub_u32 s36, s36, 8
    s_cmp_lt_u32 s26, 24
    s_cbranch_scc1 R_F1
    s_add_u32 s35, s34, s26
    s_sub_u32 s35, s35, 24
    s_cmp_lt_u32 s26, 29
    s_cbranch_scc1 R_AM
    s_cmp_lt_u32 s32, 4
    s_cbranch_scc1 R_TRIP1
    s_add_u32 s35, s32, 26
    s_mov_b32 s36, s35
    s_cmp_eq_u32 s26, 31
    s_cbranch_scc1 R_AM
    s_branch R_QKV
R_F1:
    s_lshl_b32 s30, s36, 1
    s_add_u32 s30, s30, s37
    s_mov_b32 s12, s80
    s_mov_b32 s13, s81
    s_mov_b32 s14, 0x510000
    s_mov_b32 s15, 0x20000
    s_mov_b32 s16, s82
    s_mov_b32 s17, s83
    s_mov_b32 s18, 0x510000
    s_mov_b32 s19, 0x20000
    v_lshrrev_b32 v7, 2, v1
    v_mul_u32_u24 v8, 9216, v7
    v_and_b32 v6, 3, v1
    v_lshl_add_u32 v8, v6, 4, v8
    v_lshrrev_b32 v5, 4, v1
    v_and_b32 v7, 3, v7
    v_lshl_add_u32 v7, v5, 3, v7
    v_lshlrev_b32 v10, 6, v7
    v_lshl_add_u32 v10, v6, 4, v10
    s_mul_i32 s30, s24, 40960
    v_add_u32 v10, s30, v10
    s_mul_i32 s33, s36, 384
    s_lshr_b32 s34, s24, 1
    s_lshl_b32 s34, s34, 6
    s_add_u32 s34, s34, s33
    v_add_u32 v9, s34, v8
    s_lshl_b32 s34, s24, 6
    s_add_u32 s34, s34, s33
    v_add_u32 v8, s34, v8
    s_and_b32 s34, s24, 1
    s_lshl_b32 s34, s34, 5
    v_lshlrev_b32 v6, 3, v6
    v_sub_u32 v11, v10, v6
    v_add_u32 v11, s34, v11
    s_mul_i32 s30, s24, 40960
    s_add_u32 m0, s30, 0
    s_mov_b32 s31, 0
    buffer_load_dwordx4 v8, s[12:15], s31 offen lds
    s_add_u32 m0, s30, 1024
    s_mov_b32 s31, 147456
    buffer_load_dwordx4 v8, s[12:15], s31 offen lds
    s_add_u32 m0, s30, 2048
    s_mov_b32 s31, 256
    buffer_load_dwordx4 v9, s[12:15], s31 offen lds
    s_add_u32 m0, s30, 3072
    s_mov_b32 s31, 147712
    buffer_load_dwordx4 v9, s[12:15], s31 offen lds
    s_add_u32 m0, s30, 4096
    s_mov_b32 s31, 0
    buffer_load_dwordx4 v8, s[16:19], s31 offen lds
    s_add_u32 m0, s30, 5120
    s_mov_b32 s31, 147456
    buffer_load_dwordx4 v8, s[16:19], s31 offen lds
    s_add_u32 m0, s30, 6144
    s_mov_b32 s31, 256
    buffer_load_dwordx4 v9, s[16:19], s31 offen lds
    s_add_u32 m0, s30, 7168
    s_mov_b32 s31, 147712
    buffer_load_dwordx4 v9, s[16:19], s31 offen lds
    s_add_u32 m0, s30, 8192
    s_mov_b32 s31, 294912
    buffer_load_dwordx4 v8, s[12:15], s31 offen lds
    s_add_u32 m0, s30, 9216
    s_mov_b32 s31, 442368
    buffer_load_dwordx4 v8, s[12:15], s31 offen lds
    s_add_u32 m0, s30, 10240
    s_mov_b32 s31, 295168
    buffer_load_dwordx4 v9, s[12:15], s31 offen lds
    s_add_u32 m0, s30, 11264
    s_mov_b32 s31, 442624
    buffer_load_dwordx4 v9, s[12:15], s31 offen lds
    s_add_u32 m0, s30, 12288
    s_mov_b32 s31, 294912
    buffer_load_dwordx4 v8, s[16:19], s31 offen lds
    s_add_u32 m0, s30, 13312
    s_mov_b32 s31, 442368
    buffer_load_dwordx4 v8, s[16:19], s31 offen lds
    s_add_u32 m0, s30, 14336
    s_mov_b32 s31, 295168
    buffer_load_dwordx4 v9, s[16:19], s31 offen lds
    s_add_u32 m0, s30, 15360
    s_mov_b32 s31, 442624
    buffer_load_dwordx4 v9, s[16:19], s31 offen lds
    s_add_u32 m0, s30, 16384
    s_mov_b32 s31, 589824
    buffer_load_dwordx4 v8, s[12:15], s31 offen lds
    s_add_u32 m0, s30, 17408
    s_mov_b32 s31, 737280
    buffer_load_dwordx4 v8, s[12:15], s31 offen lds
    s_add_u32 m0, s30, 18432
    s_mov_b32 s31, 590080
    buffer_load_dwordx4 v9, s[12:15], s31 offen lds
    s_add_u32 m0, s30, 19456
    s_mov_b32 s31, 737536
    buffer_load_dwordx4 v9, s[12:15], s31 offen lds
    s_add_u32 m0, s30, 20480
    s_mov_b32 s31, 589824
    buffer_load_dwordx4 v8, s[16:19], s31 offen lds
    s_add_u32 m0, s30, 21504
    s_mov_b32 s31, 737280
    buffer_load_dwordx4 v8, s[16:19], s31 offen lds
    s_add_u32 m0, s30, 22528
    s_mov_b32 s31, 590080
    buffer_load_dwordx4 v9, s[16:19], s31 offen lds
    s_add_u32 m0, s30, 23552
    s_mov_b32 s31, 737536
    buffer_load_dwordx4 v9, s[16:19], s31 offen lds
    s_add_u32 m0, s30, 24576
    s_mov_b32 s31, 884736
    buffer_load_dwordx4 v8, s[12:15], s31 offen lds
    s_add_u32 m0, s30, 25600
    s_mov_b32 s31, 1032192
    buffer_load_dwordx4 v8, s[12:15], s31 offen lds
    s_add_u32 m0, s30, 26624
    s_mov_b32 s31, 884992
    buffer_load_dwordx4 v9, s[12:15], s31 offen lds
    s_add_u32 m0, s30, 27648
    s_mov_b32 s31, 1032448
    buffer_load_dwordx4 v9, s[12:15], s31 offen lds
    s_add_u32 m0, s30, 28672
    s_mov_b32 s31, 884736
    buffer_load_dwordx4 v8, s[16:19], s31 offen lds
    s_add_u32 m0, s30, 29696
    s_mov_b32 s31, 1032192
    buffer_load_dwordx4 v8, s[16:19], s31 offen lds
    s_add_u32 m0, s30, 30720
    s_mov_b32 s31, 884992
    buffer_load_dwordx4 v9, s[16:19], s31 offen lds
    s_add_u32 m0, s30, 31744
    s_mov_b32 s31, 1032448
    buffer_load_dwordx4 v9, s[16:19], s31 offen lds
    s_add_u32 m0, s30, 32768
    s_mov_b32 s31, 1179648
    buffer_load_dwordx4 v8, s[12:15], s31 offen lds
    s_add_u32 m0, s30, 33792
    s_mov_b32 s31, 1327104
    buffer_load_dwordx4 v8, s[12:15], s31 offen lds
    s_add_u32 m0, s30, 34816
    s_mov_b32 s31, 1179904
    buffer_load_dwordx4 v9, s[12:15], s31 offen lds
    s_add_u32 m0, s30, 35840
    s_mov_b32 s31, 1327360
    buffer_load_dwordx4 v9, s[12:15], s31 offen lds
    s_add_u32 m0, s30, 36864
    s_mov_b32 s31, 1179648
    buffer_load_dwordx4 v8, s[16:19], s31 offen lds
    s_add_u32 m0, s30, 37888
    s_mov_b32 s31, 1327104
    buffer_load_dwordx4 v8, s[16:19], s31 offen lds
    s_add_u32 m0, s30, 38912
    s_mov_b32 s31, 1179904
    buffer_load_dwordx4 v9, s[16:19], s31 offen lds
    s_add_u32 m0, s30, 39936
    s_mov_b32 s31, 1327360
    buffer_load_dwordx4 v9, s[16:19], s31 offen lds
    s_waitcnt vmcnt(34)
    ds_read_b64_tr_b16 a[0:1], v10 offset:0
    ds_read_b64_tr_b16 a[2:3], v10 offset:256
    ds_read_b64_tr_b16 a[4:5], v10 offset:8
    ds_read_b64_tr_b16 a[6:7], v10 offset:264
    ds_read_b64_tr_b16 a[8:9], v11 offset:2048
    ds_read_b64_tr_b16 a[10:11], v11 offset:2304
    ds_read_b64_tr_b16 a[12:13], v10 offset:4096
    ds_read_b64_tr_b16 a[14:15], v10 offset:4352
    ds_read_b64_tr_b16 a[16:17], v10 offset:4104
    ds_read_b64_tr_b16 a[18:19], v10 offset:4360
    s_waitcnt lgkmcnt(0)
    s_add_u32 m0, s30, 0
    s_mov_b32 s31, 1474560
    buffer_load_dwordx4 v8, s[12:15], s31 offen lds
    s_add_u32 m0, s30, 1024
    s_mov_b32 s31, 1622016
    buffer_load_dwordx4 v8, s[12:15], s31 offen lds
    s_add_u32 m0, s30, 2048
    s_mov_b32 s31, 1474816
    buffer_load_dwordx4 v9, s[12:15], s31 offen lds
    s_add_u32 m0, s30, 3072
    s_mov_b32 s31, 1622272
    buffer_load_dwordx4 v9, s[12:15], s31 offen lds
    s_add_u32 m0, s30, 4096
    s_mov_b32 s31, 1474560
    buffer_load_dwordx4 v8, s[16:19], s31 offen lds
    s_add_u32 m0, s30, 5120
    s_mov_b32 s31, 1622016
    buffer_load_dwordx4 v8, s[16:19], s31 offen lds
    s_waitcnt vmcnt(34)
    ds_read_b64_tr_b16 a[20:21], v11 offset:6144
    ds_read_b64_tr_b16 a[22:23], v11 offset:6400
    ds_read_b64_tr_b16 a[24:25], v10 offset:8192
    ds_read_b64_tr_b16 a[26:27], v10 offset:8448
    ds_read_b64_tr_b16 a[28:29], v10 offset:8200
    ds_read_b64_tr_b16 a[30:31], v10 offset:8456
    ds_read_b64_tr_b16 a[32:33], v11 offset:10240
    ds_read_b64_tr_b16 a[34:35], v11 offset:10496
    s_waitcnt lgkmcnt(0)
    s_add_u32 m0, s30, 6144
    s_mov_b32 s31, 1474816
    buffer_load_dwordx4 v9, s[16:19], s31 offen lds
    s_add_u32 m0, s30, 7168
    s_mov_b32 s31, 1622272
    buffer_load_dwordx4 v9, s[16:19], s31 offen lds
    s_add_u32 m0, s30, 8192
    s_mov_b32 s31, 1769472
    buffer_load_dwordx4 v8, s[12:15], s31 offen lds
    s_add_u32 m0, s30, 9216
    s_mov_b32 s31, 1916928
    buffer_load_dwordx4 v8, s[12:15], s31 offen lds
    s_add_u32 m0, s30, 10240
    s_mov_b32 s31, 1769728
    buffer_load_dwordx4 v9, s[12:15], s31 offen lds
    s_add_u32 m0, s30, 11264
    s_mov_b32 s31, 1917184
    buffer_load_dwordx4 v9, s[12:15], s31 offen lds
    s_waitcnt vmcnt(34)
    ds_read_b64_tr_b16 a[36:37], v10 offset:12288
    ds_read_b64_tr_b16 a[38:39], v10 offset:12544
    ds_read_b64_tr_b16 a[40:41], v10 offset:12296
    ds_read_b64_tr_b16 a[42:43], v10 offset:12552
    ds_read_b64_tr_b16 a[44:45], v11 offset:14336
    ds_read_b64_tr_b16 a[46:47], v11 offset:14592
    ds_read_b64_tr_b16 a[48:49], v10 offset:16384
    ds_read_b64_tr_b16 a[50:51], v10 offset:16640
    ds_read_b64_tr_b16 a[52:53], v10 offset:16392
    ds_read_b64_tr_b16 a[54:55], v10 offset:16648
    s_waitcnt lgkmcnt(0)
    s_add_u32 m0, s30, 12288
    s_mov_b32 s31, 1769472
    buffer_load_dwordx4 v8, s[16:19], s31 offen lds
    s_add_u32 m0, s30, 13312
    s_mov_b32 s31, 1916928
    buffer_load_dwordx4 v8, s[16:19], s31 offen lds
    s_add_u32 m0, s30, 14336
    s_mov_b32 s31, 1769728
    buffer_load_dwordx4 v9, s[16:19], s31 offen lds
    s_add_u32 m0, s30, 15360
    s_mov_b32 s31, 1917184
    buffer_load_dwordx4 v9, s[16:19], s31 offen lds
    s_add_u32 m0, s30, 16384
    s_mov_b32 s31, 2064384
    buffer_load_dwordx4 v8, s[12:15], s31 offen lds
    s_add_u32 m0, s30, 17408
    s_mov_b32 s31, 2211840
    buffer_load_dwordx4 v8, s[12:15], s31 offen lds
    s_waitcnt vmcnt(34)
    ds_read_b64_tr_b16 a[56:57], v11 offset:18432
    ds_read_b64_tr_b16 a[58:59], v11 offset:18688
    ds_read_b64_tr_b16 a[60:61], v10 offset:20480
    ds_read_b64_tr_b16 a[62:63], v10 offset:20736
    ds_read_b64_tr_b16 a[64:65], v10 offset:20488
    ds_read_b64_tr_b16 a[66:67], v10 offset:20744
    ds_read_b64_tr_b16 a[68:69], v11 offset:22528
    ds_read_b64_tr_b16 a[70:71], v11 offset:22784
    s_waitcnt lgkmcnt(0)
    s_add_u32 m0, s30, 18432
    s_mov_b32 s31, 2064640
    buffer_load_dwordx4 v9, s[12:15], s31 offen lds
    s_add_u32 m0, s30, 19456
    s_mov_b32 s31, 2212096
    buffer_load_dwordx4 v9, s[12:15], s31 offen lds
    s_add_u32 m0, s30, 20480
    s_mov_b32 s31, 2064384
    buffer_load_dwordx4 v8, s[16:19], s31 offen lds
    s_add_u32 m0, s30, 21504
    s_mov_b32 s31, 2211840
    buffer_load_dwordx4 v8, s[16:19], s31 offen lds
    s_add_u32 m0, s30, 22528
    s_mov_b32 s31, 2064640
    buffer_load_dwordx4 v9, s[16:19], s31 offen lds
    s_add_u32 m0, s30, 23552
    s_mov_b32 s31, 2212096
    buffer_load_dwordx4 v9, s[16:19], s31 offen lds
    s_waitcnt vmcnt(34)
    ds_read_b64_tr_b16 a[72:73], v10 offset:24576
    ds_read_b64_tr_b16 a[74:75], v10 offset:24832
    ds_read_b64_tr_b16 a[76:77], v10 offset:24584
    ds_read_b64_tr_b16 a[78:79], v10 offset:24840
    ds_read_b64_tr_b16 a[80:81], v11 offset:26624
    ds_read_b64_tr_b16 a[82:83], v11 offset:26880
    ds_read_b64_tr_b16 a[84:85], v10 offset:28672
    ds_read_b64_tr_b16 a[86:87], v10 offset:28928
    ds_read_b64_tr_b16 a[88:89], v10 offset:28680
    ds_read_b64_tr_b16 a[90:91], v10 offset:28936
    s_waitcnt lgkmcnt(0)
    s_add_u32 m0, s30, 24576
    s_mov_b32 s31, 2359296
    buffer_load_dwordx4 v8, s[12:15], s31 offen lds
    s_add_u32 m0, s30, 25600
    s_mov_b32 s31, 2506752
    buffer_load_dwordx4 v8, s[12:15], s31 offen lds
    s_add_u32 m0, s30, 26624
    s_mov_b32 s31, 2359552
    buffer_load_dwordx4 v9, s[12:15], s31 offen lds
    s_add_u32 m0, s30, 27648
    s_mov_b32 s31, 2507008
    buffer_load_dwordx4 v9, s[12:15], s31 offen lds
    s_add_u32 m0, s30, 28672
    s_mov_b32 s31, 2359296
    buffer_load_dwordx4 v8, s[16:19], s31 offen lds
    s_add_u32 m0, s30, 29696
    s_mov_b32 s31, 2506752
    buffer_load_dwordx4 v8, s[16:19], s31 offen lds
    s_waitcnt vmcnt(34)
    ds_read_b64_tr_b16 a[92:93], v11 offset:30720
    ds_read_b64_tr_b16 a[94:95], v11 offset:30976
    ds_read_b64_tr_b16 a[96:97], v10 offset:32768
    ds_read_b64_tr_b16 a[98:99], v10 offset:33024
    ds_read_b64_tr_b16 a[100:101], v10 offset:32776
    ds_read_b64_tr_b16 a[102:103], v10 offset:33032
    ds_read_b64_tr_b16 a[104:105], v11 offset:34816
    ds_read_b64_tr_b16 a[106:107], v11 offset:35072
    s_waitcnt lgkmcnt(0)
    s_add_u32 m0, s30, 30720
    s_mov_b32 s31, 2359552
    buffer_load_dwordx4 v9, s[16:19], s31 offen lds
    s_add_u32 m0, s30, 31744
    s_mov_b32 s31, 2507008
    buffer_load_dwordx4 v9, s[16:19], s31 offen lds
    s_add_u32 m0, s30, 32768
    s_mov_b32 s31, 2654208
    buffer_load_dwordx4 v8, s[12:15], s31 offen lds
    s_add_u32 m0, s30, 33792
    s_mov_b32 s31, 2801664
    buffer_load_dwordx4 v8, s[12:15], s31 offen lds
    s_add_u32 m0, s30, 34816
    s_mov_b32 s31, 2654464
    buffer_load_dwordx4 v9, s[12:15], s31 offen lds
    s_add_u32 m0, s30, 35840
    s_mov_b32 s31, 2801920
    buffer_load_dwordx4 v9, s[12:15], s31 offen lds
    s_waitcnt vmcnt(34)
    ds_read_b64_tr_b16 a[108:109], v10 offset:36864
    ds_read_b64_tr_b16 a[110:111], v10 offset:37120
    ds_read_b64_tr_b16 a[112:113], v10 offset:36872
    ds_read_b64_tr_b16 a[114:115], v10 offset:37128
    ds_read_b64_tr_b16 a[116:117], v11 offset:38912
    ds_read_b64_tr_b16 a[118:119], v11 offset:39168
    ds_read_b64_tr_b16 a[120:121], v10 offset:0
    ds_read_b64_tr_b16 a[122:123], v10 offset:256
    ds_read_b64_tr_b16 a[124:125], v10 offset:8
    ds_read_b64_tr_b16 a[126:127], v10 offset:264
    s_waitcnt lgkmcnt(0)
    s_add_u32 m0, s30, 36864
    s_mov_b32 s31, 2654208
    buffer_load_dwordx4 v8, s[16:19], s31 offen lds
    s_add_u32 m0, s30, 37888
    s_mov_b32 s31, 2801664
    buffer_load_dwordx4 v8, s[16:19], s31 offen lds
    s_add_u32 m0, s30, 38912
    s_mov_b32 s31, 2654464
    buffer_load_dwordx4 v9, s[16:19], s31 offen lds
    s_add_u32 m0, s30, 39936
    s_mov_b32 s31, 2801920
    buffer_load_dwordx4 v9, s[16:19], s31 offen lds
    s_add_u32 m0, s30, 0
    s_mov_b32 s31, 2949120
    buffer_load_dwordx4 v8, s[12:15], s31 offen lds
    s_add_u32 m0, s30, 1024
    s_mov_b32 s31, 3096576
    buffer_load_dwordx4 v8, s[12:15], s31 offen lds
    s_waitcnt vmcnt(34)
    ds_read_b64_tr_b16 a[128:129], v11 offset:2048
    ds_read_b64_tr_b16 a[130:131], v11 offset:2304
    ds_read_b64_tr_b16 a[132:133], v10 offset:4096
    ds_read_b64_tr_b16 a[134:135], v10 offset:4352
    ds_read_b64_tr_b16 a[136:137], v10 offset:4104
    ds_read_b64_tr_b16 a[138:139], v10 offset:4360
    ds_read_b64_tr_b16 a[140:141], v11 offset:6144
    ds_read_b64_tr_b16 a[142:143], v11 offset:6400
    s_waitcnt lgkmcnt(0)
    s_add_u32 m0, s30, 2048
    s_mov_b32 s31, 2949376
    buffer_load_dwordx4 v9, s[12:15], s31 offen lds
    s_add_u32 m0, s30, 3072
    s_mov_b32 s31, 3096832
    buffer_load_dwordx4 v9, s[12:15], s31 offen lds
    s_add_u32 m0, s30, 4096
    s_mov_b32 s31, 2949120
    buffer_load_dwordx4 v8, s[16:19], s31 offen lds
    s_add_u32 m0, s30, 5120
    s_mov_b32 s31, 3096576
    buffer_load_dwordx4 v8, s[16:19], s31 offen lds
    s_add_u32 m0, s30, 6144
    s_mov_b32 s31, 2949376
    buffer_load_dwordx4 v9, s[16:19], s31 offen lds
    s_add_u32 m0, s30, 7168
    s_mov_b32 s31, 3096832
    buffer_load_dwordx4 v9, s[16:19], s31 offen lds
    s_waitcnt vmcnt(34)
    ds_read_b64_tr_b16 a[144:145], v10 offset:8192
    ds_read_b64_tr_b16 a[146:147], v10 offset:8448
    ds_read_b64_tr_b16 a[148:149], v10 offset:8200
    ds_read_b64_tr_b16 a[150:151], v10 offset:8456
    ds_read_b64_tr_b16 a[152:153], v11 offset:10240
    ds_read_b64_tr_b16 a[154:155], v11 offset:10496
    ds_read_b64_tr_b16 a[156:157], v10 offset:12288
    ds_read_b64_tr_b16 a[158:159], v10 offset:12544
    ds_read_b64_tr_b16 a[160:161], v10 offset:12296
    ds_read_b64_tr_b16 a[162:163], v10 offset:12552
    s_waitcnt lgkmcnt(0)
    s_add_u32 m0, s30, 8192
    s_mov_b32 s31, 3244032
    buffer_load_dwordx4 v8, s[12:15], s31 offen lds
    s_add_u32 m0, s30, 9216
    s_mov_b32 s31, 3391488
    buffer_load_dwordx4 v8, s[12:15], s31 offen lds
    s_add_u32 m0, s30, 10240
    s_mov_b32 s31, 3244288
    buffer_load_dwordx4 v9, s[12:15], s31 offen lds
    s_add_u32 m0, s30, 11264
    s_mov_b32 s31, 3391744
    buffer_load_dwordx4 v9, s[12:15], s31 offen lds
    s_add_u32 m0, s30, 12288
    s_mov_b32 s31, 3244032
    buffer_load_dwordx4 v8, s[16:19], s31 offen lds
    s_add_u32 m0, s30, 13312
    s_mov_b32 s31, 3391488
    buffer_load_dwordx4 v8, s[16:19], s31 offen lds
    s_waitcnt vmcnt(34)
    ds_read_b64_tr_b16 a[164:165], v11 offset:14336
    ds_read_b64_tr_b16 a[166:167], v11 offset:14592
    ds_read_b64_tr_b16 a[168:169], v10 offset:16384
    ds_read_b64_tr_b16 a[170:171], v10 offset:16640
    ds_read_b64_tr_b16 a[172:173], v10 offset:16392
    ds_read_b64_tr_b16 a[174:175], v10 offset:16648
    ds_read_b64_tr_b16 a[176:177], v11 offset:18432
    ds_read_b64_tr_b16 a[178:179], v11 offset:18688
    s_waitcnt lgkmcnt(0)
    s_add_u32 m0, s30, 14336
    s_mov_b32 s31, 3244288
    buffer_load_dwordx4 v9, s[16:19], s31 offen lds
    s_add_u32 m0, s30, 15360
    s_mov_b32 s31, 3391744
    buffer_load_dwordx4 v9, s[16:19], s31 offen lds
    s_add_u32 m0, s30, 16384
    s_mov_b32 s31, 3538944
    buffer_load_dwordx4 v8, s[12:15], s31 offen lds
    s_add_u32 m0, s30, 17408
    s_mov_b32 s31, 3686400
    buffer_load_dwordx4 v8, s[12:15], s31 offen lds
    s_add_u32 m0, s30, 18432
    s_mov_b32 s31, 3539200
    buffer_load_dwordx4 v9, s[12:15], s31 offen lds
    s_add_u32 m0, s30, 19456
    s_mov_b32 s31, 3686656
    buffer_load_dwordx4 v9, s[12:15], s31 offen lds
    s_waitcnt vmcnt(34)
    ds_read_b64_tr_b16 a[180:181], v10 offset:20480
    ds_read_b64_tr_b16 a[182:183], v10 offset:20736
    ds_read_b64_tr_b16 a[184:185], v10 offset:20488
    ds_read_b64_tr_b16 a[186:187], v10 offset:20744
    ds_read_b64_tr_b16 a[188:189], v11 offset:22528
    ds_read_b64_tr_b16 a[190:191], v11 offset:22784
    ds_read_b64_tr_b16 a[192:193], v10 offset:24576
    ds_read_b64_tr_b16 a[194:195], v10 offset:24832
    ds_read_b64_tr_b16 a[196:197], v10 offset:24584
    ds_read_b64_tr_b16 a[198:199], v10 offset:24840
    s_waitcnt lgkmcnt(0)
    s_add_u32 m0, s30, 20480
    s_mov_b32 s31, 3538944
    buffer_load_dwordx4 v8, s[16:19], s31 offen lds
    s_add_u32 m0, s30, 21504
    s_mov_b32 s31, 3686400
    buffer_load_dwordx4 v8, s[16:19], s31 offen lds
    s_add_u32 m0, s30, 22528
    s_mov_b32 s31, 3539200
    buffer_load_dwordx4 v9, s[16:19], s31 offen lds
    s_add_u32 m0, s30, 23552
    s_mov_b32 s31, 3686656
    buffer_load_dwordx4 v9, s[16:19], s31 offen lds
    s_add_u32 m0, s30, 24576
    s_mov_b32 s31, 3833856
    buffer_load_dwordx4 v8, s[12:15], s31 offen lds
    s_add_u32 m0, s30, 25600
    s_mov_b32 s31, 3981312
    buffer_load_dwordx4 v8, s[12:15], s31 offen lds
    s_waitcnt vmcnt(34)
    ds_read_b64_tr_b16 a[200:201], v11 offset:26624
    ds_read_b64_tr_b16 a[202:203], v11 offset:26880
    ds_read_b64_tr_b16 a[204:205], v10 offset:28672
    ds_read_b64_tr_b16 a[206:207], v10 offset:28928
    ds_read_b64_tr_b16 a[208:209], v10 offset:28680
    ds_read_b64_tr_b16 a[210:211], v10 offset:28936
    ds_read_b64_tr_b16 a[212:213], v11 offset:30720
    ds_read_b64_tr_b16 a[214:215], v11 offset:30976
    s_waitcnt lgkmcnt(0)
    s_add_u32 m0, s30, 26624
    s_mov_b32 s31, 3834112
    buffer_load_dwordx4 v9, s[12:15], s31 offen lds
    s_add_u32 m0, s30, 27648
    s_mov_b32 s31, 3981568
    buffer_load_dwordx4 v9, s[12:15], s31 offen lds
    s_add_u32 m0, s30, 28672
    s_mov_b32 s31, 3833856
    buffer_load_dwordx4 v8, s[16:19], s31 offen lds
    s_add_u32 m0, s30, 29696
    s_mov_b32 s31, 3981312
    buffer_load_dwordx4 v8, s[16:19], s31 offen lds
    s_add_u32 m0, s30, 30720
    s_mov_b32 s31, 3834112
    buffer_load_dwordx4 v9, s[16:19], s31 offen lds
    s_add_u32 m0, s30, 31744
    s_mov_b32 s31, 3981568
    buffer_load_dwordx4 v9, s[16:19], s31 offen lds
    s_waitcnt vmcnt(34)
    ds_read_b64_tr_b16 a[216:217], v10 offset:32768
    ds_read_b64_tr_b16 a[218:219], v10 offset:33024
    ds_read_b64_tr_b16 a[220:221], v10 offset:32776
    ds_read_b64_tr_b16 a[222:223], v10 offset:33032
    ds_read_b64_tr_b16 a[224:225], v11 offset:34816
    ds_read_b64_tr_b16 a[226:227], v11 offset:35072
    ds_read_b64_tr_b16 a[228:229], v10 offset:36864
    ds_read_b64_tr_b16 a[230:231], v10 offset:37120
    ds_read_b64_tr_b16 a[232:233], v10 offset:36872
    ds_read_b64_tr_b16 a[234:235], v10 offset:37128
    s_waitcnt lgkmcnt(0)
    s_add_u32 m0, s30, 32768
    s_mov_b32 s31, 4128768
    buffer_load_dwordx4 v8, s[12:15], s31 offen lds
    s_add_u32 m0, s30, 33792
    s_mov_b32 s31, 4276224
    buffer_load_dwordx4 v8, s[12:15], s31 offen lds
    s_add_u32 m0, s30, 34816
    s_mov_b32 s31, 4129024
    buffer_load_dwordx4 v9, s[12:15], s31 offen lds
    s_add_u32 m0, s30, 35840
    s_mov_b32 s31, 4276480
    buffer_load_dwordx4 v9, s[12:15], s31 offen lds
    s_add_u32 m0, s30, 36864
    s_mov_b32 s31, 4128768
    buffer_load_dwordx4 v8, s[16:19], s31 offen lds
    s_add_u32 m0, s30, 37888
    s_mov_b32 s31, 4276224
    buffer_load_dwordx4 v8, s[16:19], s31 offen lds
    s_waitcnt vmcnt(34)
    ds_read_b64_tr_b16 a[236:237], v11 offset:38912
    ds_read_b64_tr_b16 a[238:239], v11 offset:39168
    ds_read_b64_tr_b16 a[240:241], v10 offset:0
    ds_read_b64_tr_b16 a[242:243], v10 offset:256
    ds_read_b64_tr_b16 a[244:245], v10 offset:8
    ds_read_b64_tr_b16 a[246:247], v10 offset:264
    ds_read_b64_tr_b16 a[248:249], v11 offset:2048
    ds_read_b64_tr_b16 a[250:251], v11 offset:2304
    s_waitcnt lgkmcnt(0)
    s_add_u32 m0, s30, 38912
    s_mov_b32 s31, 4129024
    buffer_load_dwordx4 v9, s[16:19], s31 offen lds
    s_add_u32 m0, s30, 39936
    s_mov_b32 s31, 4276480
    buffer_load_dwordx4 v9, s[16:19], s31 offen lds
    s_add_u32 m0, s30, 0
    s_mov_b32 s31, 4423680
    buffer_load_dwordx4 v8, s[12:15], s31 offen lds
    s_add_u32 m0, s30, 1024
    s_mov_b32 s31, 4571136
    buffer_load_dwordx4 v8, s[12:15], s31 offen lds
    s_add_u32 m0, s30, 2048
    s_mov_b32 s31, 4423936
    buffer_load_dwordx4 v9, s[12:15], s31 offen lds
    s_add_u32 m0, s30, 3072
    s_mov_b32 s31, 4571392
    buffer_load_dwordx4 v9, s[12:15], s31 offen lds
    s_waitcnt vmcnt(34)
    ds_read_b64_tr_b16 a[252:253], v10 offset:4096
    ds_read_b64_tr_b16 a[254:255], v10 offset:4352
    ds_read_b64_tr_b16 v[80:81], v10 offset:4104
    ds_read_b64_tr_b16 v[82:83], v10 offset:4360
    ds_read_b64_tr_b16 v[84:85], v11 offset:6144
    ds_read_b64_tr_b16 v[86:87], v11 offset:6400
    ds_read_b64_tr_b16 v[88:89], v10 offset:8192
    ds_read_b64_tr_b16 v[90:91], v10 offset:8448
    ds_read_b64_tr_b16 v[92:93], v10 offset:8200
    ds_read_b64_tr_b16 v[94:95], v10 offset:8456
    s_waitcnt lgkmcnt(0)
    s_add_u32 m0, s30, 4096
    s_mov_b32 s31, 4423680
    buffer_load_dwordx4 v8, s[16:19], s31 offen lds
    s_add_u32 m0, s30, 5120
    s_mov_b32 s31, 4571136
    buffer_load_dwordx4 v8, s[16:19], s31 offen lds
    s_add_u32 m0, s30, 6144
    s_mov_b32 s31, 4423936
    buffer_load_dwordx4 v9, s[16:19], s31 offen lds
    s_add_u32 m0, s30, 7168
    s_mov_b32 s31, 4571392
    buffer_load_dwordx4 v9, s[16:19], s31 offen lds
    s_add_u32 m0, s30, 8192
    s_mov_b32 s31, 4718592
    buffer_load_dwordx4 v8, s[12:15], s31 offen lds
    s_add_u32 m0, s30, 9216
    s_mov_b32 s31, 4866048
    buffer_load_dwordx4 v8, s[12:15], s31 offen lds
    s_waitcnt vmcnt(34)
    ds_read_b64_tr_b16 v[96:97], v11 offset:10240
    ds_read_b64_tr_b16 v[98:99], v11 offset:10496
    ds_read_b64_tr_b16 v[100:101], v10 offset:12288
    ds_read_b64_tr_b16 v[102:103], v10 offset:12544
    ds_read_b64_tr_b16 v[104:105], v10 offset:12296
    ds_read_b64_tr_b16 v[106:107], v10 offset:12552
    ds_read_b64_tr_b16 v[108:109], v11 offset:14336
    ds_read_b64_tr_b16 v[110:111], v11 offset:14592
    s_waitcnt lgkmcnt(0)
    s_add_u32 m0, s30, 10240
    s_mov_b32 s31, 4718848
    buffer_load_dwordx4 v9, s[12:15], s31 offen lds
    s_add_u32 m0, s30, 11264
    s_mov_b32 s31, 4866304
    buffer_load_dwordx4 v9, s[12:15], s31 offen lds
    s_add_u32 m0, s30, 12288
    s_mov_b32 s31, 4718592
    buffer_load_dwordx4 v8, s[16:19], s31 offen lds
    s_add_u32 m0, s30, 13312
    s_mov_b32 s31, 4866048
    buffer_load_dwordx4 v8, s[16:19], s31 offen lds
    s_add_u32 m0, s30, 14336
    s_mov_b32 s31, 4718848
    buffer_load_dwordx4 v9, s[16:19], s31 offen lds
    s_add_u32 m0, s30, 15360
    s_mov_b32 s31, 4866304
    buffer_load_dwordx4 v9, s[16:19], s31 offen lds
    s_waitcnt vmcnt(34)
    ds_read_b64_tr_b16 v[112:113], v10 offset:16384
    ds_read_b64_tr_b16 v[114:115], v10 offset:16640
    ds_read_b64_tr_b16 v[116:117], v10 offset:16392
    ds_read_b64_tr_b16 v[118:119], v10 offset:16648
    ds_read_b64_tr_b16 v[120:121], v11 offset:18432
    ds_read_b64_tr_b16 v[122:123], v11 offset:18688
    ds_read_b64_tr_b16 v[124:125], v10 offset:20480
    ds_read_b64_tr_b16 v[126:127], v10 offset:20736
    ds_read_b64_tr_b16 v[128:129], v10 offset:20488
    ds_read_b64_tr_b16 v[130:131], v10 offset:20744
    s_waitcnt lgkmcnt(0)
    s_add_u32 m0, s30, 16384
    s_mov_b32 s31, 5013504
    buffer_load_dwordx4 v8, s[12:15], s31 offen lds
    s_add_u32 m0, s30, 17408
    s_mov_b32 s31, 5160960
    buffer_load_dwordx4 v8, s[12:15], s31 offen lds
    s_add_u32 m0, s30, 18432
    s_mov_b32 s31, 5013760
    buffer_load_dwordx4 v9, s[12:15], s31 offen lds
    s_add_u32 m0, s30, 19456
    s_mov_b32 s31, 5161216
    buffer_load_dwordx4 v9, s[12:15], s31 offen lds
    s_add_u32 m0, s30, 20480
    s_mov_b32 s31, 5013504
    buffer_load_dwordx4 v8, s[16:19], s31 offen lds
    s_add_u32 m0, s30, 21504
    s_mov_b32 s31, 5160960
    buffer_load_dwordx4 v8, s[16:19], s31 offen lds
    s_waitcnt vmcnt(34)
    ds_read_b64_tr_b16 v[132:133], v11 offset:22528
    ds_read_b64_tr_b16 v[134:135], v11 offset:22784
    ds_read_b64_tr_b16 v[136:137], v10 offset:24576
    ds_read_b64_tr_b16 v[138:139], v10 offset:24832
    ds_read_b64_tr_b16 v[140:141], v10 offset:24584
    ds_read_b64_tr_b16 v[142:143], v10 offset:24840
    ds_read_b64_tr_b16 v[144:145], v11 offset:26624
    ds_read_b64_tr_b16 v[146:147], v11 offset:26880
    s_waitcnt lgkmcnt(0)
    s_add_u32 m0, s30, 22528
    s_mov_b32 s31, 5013760
    buffer_load_dwordx4 v9, s[16:19], s31 offen lds
    s_add_u32 m0, s30, 23552
    s_mov_b32 s31, 5161216
    buffer_load_dwordx4 v9, s[16:19], s31 offen lds
    s_waitcnt vmcnt(30)
    ds_read_b64_tr_b16 v[148:149], v10 offset:28672
    ds_read_b64_tr_b16 v[150:151], v10 offset:28928
    ds_read_b64_tr_b16 v[152:153], v10 offset:28680
    ds_read_b64_tr_b16 v[154:155], v10 offset:28936
    ds_read_b64_tr_b16 v[156:157], v11 offset:30720
    ds_read_b64_tr_b16 v[158:159], v11 offset:30976
    ds_read_b64_tr_b16 v[160:161], v10 offset:32768
    ds_read_b64_tr_b16 v[162:163], v10 offset:33024
    ds_read_b64_tr_b16 v[164:165], v10 offset:32776
    ds_read_b64_tr_b16 v[166:167], v10 offset:33032
    s_waitcnt vmcnt(24) lgkmcnt(0)
    ds_read_b64_tr_b16 v[168:169], v11 offset:34816
    ds_read_b64_tr_b16 v[170:171], v11 offset:35072
    ds_read_b64_tr_b16 v[172:173], v10 offset:36864
    ds_read_b64_tr_b16 v[174:175], v10 offset:37120
    ds_read_b64_tr_b16 v[176:177], v10 offset:36872
    ds_read_b64_tr_b16 v[178:179], v10 offset:37128
    ds_read_b64_tr_b16 v[180:181], v11 offset:38912
    ds_read_b64_tr_b16 v[182:183], v11 offset:39168
    s_waitcnt vmcnt(18) lgkmcnt(0)
    ds_read_b64_tr_b16 v[184:185], v10 offset:0
    ds_read_b64_tr_b16 v[186:187], v10 offset:256
    ds_read_b64_tr_b16 v[188:189], v10 offset:8
    ds_read_b64_tr_b16 v[190:191], v10 offset:264
    ds_read_b64_tr_b16 v[192:193], v11 offset:2048
    ds_read_b64_tr_b16 v[194:195], v11 offset:2304
    ds_read_b64_tr_b16 v[196:197], v10 offset:4096
    ds_read_b64_tr_b16 v[198:199], v10 offset:4352
    ds_read_b64_tr_b16 v[200:201], v10 offset:4104
    ds_read_b64_tr_b16 v[202:203], v10 offset:4360
    s_waitcnt vmcnt(12) lgkmcnt(0)
    ds_read_b64_tr_b16 v[204:205], v11 offset:6144
    ds_read_b64_tr_b16 v[206:207], v11 offset:6400
    ds_read_b64_tr_b16 v[208:209], v10 offset:8192
    ds_read_b64_tr_b16 v[210:211], v10 offset:8448
    ds_read_b64_tr_b16 v[212:213], v10 offset:8200
    ds_read_b64_tr_b16 v[214:215], v10 offset:8456
    ds_read_b64_tr_b16 v[216:217], v11 offset:10240
    ds_read_b64_tr_b16 v[218:219], v11 offset:10496
    s_waitcnt vmcnt(6) lgkmcnt(0)
    ds_read_b64_tr_b16 v[220:221], v10 offset:12288
    ds_read_b64_tr_b16 v[222:223], v10 offset:12544
    ds_read_b64_tr_b16 v[224:225], v10 offset:12296
    ds_read_b64_tr_b16 v[226:227], v10 offset:12552
    ds_read_b64_tr_b16 v[228:229], v11 offset:14336
    ds_read_b64_tr_b16 v[230:231], v11 offset:14592
    ds_read_b64_tr_b16 v[232:233], v10 offset:16384
    ds_read_b64_tr_b16 v[234:235], v10 offset:16640
    ds_read_b64_tr_b16 v[236:237], v10 offset:16392
    ds_read_b64_tr_b16 v[238:239], v10 offset:16648
    s_waitcnt vmcnt(0) lgkmcnt(0)
    ds_read_b64_tr_b16 v[240:241], v11 offset:18432
    ds_read_b64_tr_b16 v[242:243], v11 offset:18688
    ds_read_b64_tr_b16 v[244:245], v10 offset:20480
    ds_read_b64_tr_b16 v[246:247], v10 offset:20736
    ds_read_b64_tr_b16 v[248:249], v10 offset:20488
    ds_read_b64_tr_b16 v[250:251], v10 offset:20744
    ds_read_b64_tr_b16 v[252:253], v11 offset:22528
    ds_read_b64_tr_b16 v[254:255], v11 offset:22784
    s_waitcnt lgkmcnt(0)
    v_mov_b32 v6, 244
    s_mov_b32 s27, 0
SP_1:
    buffer_load_dword v7, v6, s[8:11], 0 offen sc1
    s_waitcnt vmcnt(0)
    v_cmp_gt_u32 vcc, 18, v7
    s_cbranch_vccz SD_2
    s_add_u32 s27, s27, 1
    s_cmp_lt_u32 s27, 400000
    s_cbranch_scc1 SP_1
    s_movk_i32 s27, 1
    s_branch FAIL
SD_2:
    s_mov_b32 s40, 0
    s_mul_i32 s41, s37, 144
    s_mul_i32 s34, s36, 6
    s_add_u32 s34, s34, s24
    s_add_u32 s41, s41, s34
    s_lshl_b32 s34, s24, 9
    s_sub_u32 s34, 4096, s34
    v_and_b32 v6, 15, v1
    v_lshlrev_b32 v6, 4, v6
    v_lshrrev_b32 v5, 5, v1
    v_lshl_add_u32 v6, v5, 8, v6
    v_bfe_u32 v5, v1, 4, 1
    v_lshl_add_u32 v6, v5, 3, v6
    v_add_u32 v6, s34, v6
    s_lshl_b32 s34, s36, 2
    s_add_u32 s34, s34, s24
    s_lshl_b32 s41, s41, 10
    s_add_u32 s41, s41, 0x6000000
    s_mul_i32 s42, s37, 18432
    s_mul_i32 s33, s24, 4480
    s_add_u32 s42, s42, s33
    s_add_u32 s42, s42, 0xc00000
    s_mul_i32 s45, s37, 160
    s_add_u32 s45, s45, s34
    s_add_u32 s45, s45, 3712
    s_lshl_b32 s45, s45, 7
    s_lshl_b32 s33, s37, 5
    s_add_u32 s33, s33, 3648
    v_min_u32 v4, 11, v1
    v_add_u32 v4, s33, v4
    v_lshlrev_b32 v4, 7, v4
    s_mov_b32 s50, 0xbfb8aa3b
    s_mov_b32 s51, s50
    v_lshlrev_b32 v0, 4, v1
    v_mov_b32 v3, v0
    v_mov_b32 v5, 0
    s_mul_i32 s43, s24, 4480
    s_mov_b32 s46, 0
    v_and_b32 v76, 3, v1
    v_cmp_eq_u32 s[54:55], s24, v76
    v_lshlrev_b32 v76, 2, v76
    v_add_u32 v76, 0x20000, v76
    s_barrier
    ds_write_b32 v76, v5
F1_S:
    s_add_u32 s48, s40, 1
    s_mov_b32 s27, 0
SP_3:
    buffer_load_dword v5, v4, s[4:7], 0 offen sc1
    s_waitcnt vmcnt(0)
    v_cmp_gt_u32 vcc, s48, v5
    s_cbranch_vccz SD_4
    s_add_u32 s27, s27, 1
    s_cmp_lt_u32 s27, 400000
    s_cbranch_scc1 SP_3
    s_movk_i32 s27, 20
    s_branch FAIL
SD_4:
F1_D:
    s_add_u32 m0, s43, 0
    s_nop 0
    buffer_load_dwordx4 v0, s[4:7], s42 offen offset:0 sc1 lds
    buffer_load_dwordx4 v0, s[4:7], s42 offen offset:1024 sc1 lds
    buffer_load_dwordx4 v0, s[4:7], s42 offen offset:2048 sc1 lds
    buffer_load_dwordx4 v0, s[4:7], s42 offen offset:3072 sc1 lds
    s_add_u32 m0, s43, 4096
    s_add_u32 s47, s42, 4096
    buffer_load_dwordx4 v0, s[4:7], s47 offen offset:0 sc1 lds
    s_add_u32 s42, s42, 36864
    s_xor_b32 s43, s43, 32768
    s_waitcnt vmcnt(0)
F1_L:
    s_barrier
    ds_read_b128 v[32:35], v3 offset:0
    ds_read_b128 v[36:39], v3 offset:1024
    ds_read_b128 v[40:43], v3 offset:2048
    ds_read_b128 v[44:47], v3 offset:3072
    s_add_u32 s44, s40, 1
    s_cmp_lt_u32 s44, 64
    s_cselect_b32 s44, s44, -1
    v_cmp_ge_u32 vcc, s44, v5
    s_cbranch_vccz F1_V0
    buffer_load_dword v5, v4, s[4:7], 0 offen sc1
    s_waitcnt lgkmcnt(3)
    v_mfma_f32_16x16x32_bf16 v[8:11], a[0:3], v[32:35], 0
    ds_read_b128 v[48:51], v3 offset:4096
    v_mfma_f32_16x16x32_bf16 v[12:15], a[4:7], v[32:35], 0
    v_mfma_f32_16x16x32_bf16 v[16:19], a[8:11], v[32:35], 0
    v_mfma_f32_16x16x32_bf16 v[20:23], a[12:15], v[32:35], 0
    v_mfma_f32_16x16x32_bf16 v[24:27], a[16:19], v[32:35], 0
    v_mfma_f32_16x16x32_bf16 v[28:31], a[20:23], v[32:35], 0
    s_waitcnt lgkmcnt(3)
    v_mfma_f32_16x16x32_bf16 v[8:11], a[24:27], v[36:39], v[8:11]
    ds_read_b128 v[52:55], v3 offset:5120
    v_mfma_f32_16x16x32_bf16 v[12:15], a[28:31], v[36:39], v[12:15]
    v_mfma_f32_16x16x32_bf16 v[16:19], a[32:35], v[36:39], v[16:19]
    v_mfma_f32_16x16x32_bf16 v[20:23], a[36:39], v[36:39], v[20:23]
    v_mfma_f32_16x16x32_bf16 v[24:27], a[40:43], v[36:39], v[24:27]
    v_mfma_f32_16x16x32_bf16 v[28:31], a[44:47], v[36:39], v[28:31]
    s_waitcnt lgkmcnt(3)
    v_mfma_f32_16x16x32_bf16 v[8:11], a[48:51], v[40:43], v[8:11]
    ds_read_b128 v[56:59], v3 offset:6144
    v_mfma_f32_16x16x32_bf16 v[12:15], a[52:55], v[40:43], v[12:15]
    v_mfma_f32_16x16x32_bf16 v[16:19], a[56:59], v[40:43], v[16:19]
    v_mfma_f32_16x16x32_bf16 v[20:23], a[60:63], v[40:43], v[20:23]
    v_mfma_f32_16x16x32_bf16 v[24:27], a[64:67], v[40:43], v[24:27]
    v_mfma_f32_16x16x32_bf16 v[28:31], a[68:71], v[40:43], v[28:31]
    s_waitcnt lgkmcnt(3)
    v_mfma_f32_16x16x32_bf16 v[8:11], a[72:75], v[44:47], v[8:11]
    ds_read_b128 v[60:63], v3 offset:7168
    v_mfma_f32_16x16x32_bf16 v[12:15], a[76:79], v[44:47], v[12:15]
    v_mfma_f32_16x16x32_bf16 v[16:19], a[80:83], v[44:47], v[16:19]
    v_mfma_f32_16x16x32_bf16 v[20:23], a[84:87], v[44:47], v[20:23]
    v_mfma_f32_16x16x32_bf16 v[24:27], a[88:91], v[44:47], v[24:27]
    v_mfma_f32_16x16x32_bf16 v[28:31], a[92:95], v[44:47], v[28:31]
    s_waitcnt lgkmcnt(3)
    v_mfma_f32_16x16x32_bf16 v[8:11], a[96:99], v[48:51], v[8:11]
    ds_read_b128 v[32:35], v3 offset:8192
    v_mfma_f32_16x16x32_bf16 v[12:15], a[100:103], v[48:51], v[12:15]
    v_cmp_ge_u32 vcc, s44, v5
    v_mfma_f32_16x16x32_bf16 v[16:19], a[104:107], v[48:51], v[16:19]
    v_mfma_f32_16x16x32_bf16 v[20:23], a[108:111], v[48:51], v[20:23]
    v_mfma_f32_16x16x32_bf16 v[24:27], a[112:115], v[48:51], v[24:27]
    v_mfma_f32_16x16x32_bf16 v[28:31], a[116:119], v[48:51], v[28:31]
    s_cbranch_vccz F1_V5
    buffer_load_dword v5, v4, s[4:7], 0 offen sc1
    s_waitcnt lgkmcnt(3)
    v_mfma_f32_16x16x32_bf16 v[8:11], a[120:123], v[52:55], v[8:11]
    ds_read_b128 v[36:39], v3 offset:9216
    v_mfma_f32_16x16x32_bf16 v[12:15], a[124:127], v[52:55], v[12:15]
    s_cmp_eq_u32 s46, 0
    s_cbranch_scc1 NP_5
    s_waitcnt vmcnt(2)
    v_mov_b32 v7, s40
    s_mov_b64 exec, 1
    buffer_store_dword v7, off, s[4:7], s45 sc1
    s_mov_b64 exec, -1
    s_mov_b32 s46, 0
NP_5:
    v_mfma_f32_16x16x32_bf16 v[16:19], a[128:131], v[52:55], v[16:19]
    v_mfma_f32_16x16x32_bf16 v[20:23], a[132:135], v[52:55], v[20:23]
    v_mfma_f32_16x16x32_bf16 v[24:27], a[136:139], v[52:55], v[24:27]
    v_mfma_f32_16x16x32_bf16 v[28:31], a[140:143], v[52:55], v[28:31]
    s_waitcnt lgkmcnt(3)
    v_mfma_f32_16x16x32_bf16 v[8:11], a[144:147], v[56:59], v[8:11]
    ds_read_b128 v[40:43], v3 offset:10240
    v_mfma_f32_16x16x32_bf16 v[12:15], a[148:151], v[56:59], v[12:15]
    v_mfma_f32_16x16x32_bf16 v[16:19], a[152:155], v[56:59], v[16:19]
    v_mfma_f32_16x16x32_bf16 v[20:23], a[156:159], v[56:59], v[20:23]
    v_mfma_f32_16x16x32_bf16 v[24:27], a[160:163], v[56:59], v[24:27]
    v_mfma_f32_16x16x32_bf16 v[28:31], a[164:167], v[56:59], v[28:31]
    s_waitcnt lgkmcnt(3)
    v_mfma_f32_16x16x32_bf16 v[8:11], a[168:171], v[60:63], v[8:11]
    ds_read_b128 v[44:47], v3 offset:11264
    v_mfma_f32_16x16x32_bf16 v[12:15], a[172:175], v[60:63], v[12:15]
    v_mfma_f32_16x16x32_bf16 v[16:19], a[176:179], v[60:63], v[16:19]
    v_mfma_f32_16x16x32_bf16 v[20:23], a[180:183], v[60:63], v[20:23]
    v_mfma_f32_16x16x32_bf16 v[24:27], a[184:187], v[60:63], v[24:27]
    v_mfma_f32_16x16x32_bf16 v[28:31], a[188:191], v[60:63], v[28:31]
    s_waitcnt lgkmcnt(3)
    v_mfma_f32_16x16x32_bf16 v[8:11], a[192:195], v[32:35], v[8:11]
    ds_read_b128 v[48:51], v3 offset:12288
    v_mfma_f32_16x16x32_bf16 v[12:15], a[196:199], v[32:35], v[12:15]
    v_mfma_f32_16x16x32_bf16 v[16:19], a[200:203], v[32:35], v[16:19]
    v_mfma_f32_16x16x32_bf16 v[20:23], a[204:207], v[32:35], v[20:23]
    v_mfma_f32_16x16x32_bf16 v[24:27], a[208:211], v[32:35], v[24:27]
    v_mfma_f32_16x16x32_bf16 v[28:31], a[212:215], v[32:35], v[28:31]
    s_waitcnt lgkmcnt(3)
    v_mfma_f32_16x16x32_bf16 v[8:11], a[216:219], v[36:39], v[8:11]
    ds_read_b128 v[52:55], v3 offset:13312
    v_mfma_f32_16x16x32_bf16 v[12:15], a[220:223], v[36:39], v[12:15]
    v_cmp_ge_u32 vcc, s44, v5
    v_mfma_f32_16x16x32_bf16 v[16:19], a[224:227], v[36:39], v[16:19]
    v_mfma_f32_16x16x32_bf16 v[20:23], a[228:231], v[36:39], v[20:23]
    v_mfma_f32_16x16x32_bf16 v[24:27], a[232:235], v[36:39], v[24:27]
    v_mfma_f32_16x16x32_bf16 v[28:31], a[236:239], v[36:39], v[28:31]
    s_cbranch_vccz F1_V10
    buffer_load_dword v5, v4, s[4:7], 0 offen sc1
    s_waitcnt lgkmcnt(3)
    v_mfma_f32_16x16x32_bf16 v[8:11], a[240:243], v[40:43], v[8:11]
    ds_read_b128 v[56:59], v3 offset:14336
    v_mfma_f32_16x16x32_bf16 v[12:15], a[244:247], v[40:43], v[12:15]
    v_mfma_f32_16x16x32_bf16 v[16:19], a[248:251], v[40:43], v[16:19]
    s_waitcnt lgkmcnt(3)
    v_mfma_f32_16x16x32_bf16 v[8:11], v[88:91], v[44:47], v[8:11]
    ds_read_b128 v[60:63], v3 offset:15360
    v_mfma_f32_16x16x32_bf16 v[12:15], v[92:95], v[44:47], v[12:15]
    v_mfma_f32_16x16x32_bf16 v[16:19], v[96:99], v[44:47], v[16:19]
    s_waitcnt lgkmcnt(3)
    v_mfma_f32_16x16x32_bf16 v[8:11], v[112:115], v[48:51], v[8:11]
    ds_read_b128 v[32:35], v3 offset:16384
    v_mfma_f32_16x16x32_bf16 v[12:15], v[116:119], v[48:51], v[12:15]
    v_mfma_f32_16x16x32_bf16 v[16:19], v[120:123], v[48:51], v[16:19]
    s_waitcnt lgkmcnt(3)
    v_mfma_f32_16x16x32_bf16 v[8:11], v[136:139], v[52:55], v[8:11]
    ds_read_b128 v[36:39], v3 offset:17408
    v_mfma_f32_16x16x32_bf16 v[12:15], v[140:143], v[52:55], v[12:15]
    v_mfma_f32_16x16x32_bf16 v[16:19], v[144:147], v[52:55], v[16:19]
    s_waitcnt lgkmcnt(3)
    v_mfma_f32_16x16x32_bf16 v[8:11], v[160:163], v[56:59], v[8:11]
    v_mfma_f32_16x16x32_bf16 v[12:15], v[164:167], v[56:59], v[12:15]
    v_mfma_f32_16x16x32_bf16 v[16:19], v[168:171], v[56:59], v[16:19]
    s_waitcnt lgkmcnt(2)
    v_mfma_f32_16x16x32_bf16 v[8:11], v[184:187], v[60:63], v[8:11]
    v_mfma_f32_16x16x32_bf16 v[12:15], v[188:191], v[60:63], v[12:15]
    v_mfma_f32_16x16x32_bf16 v[16:19], v[192:195], v[60:63], v[16:19]
    s_waitcnt lgkmcnt(1)
    v_mfma_f32_16x16x32_bf16 v[8:11], v[208:211], v[32:35], v[8:11]
    v_mfma_f32_16x16x32_bf16 v[12:15], v[212:215], v[32:35], v[12:15]
    v_mfma_f32_16x16x32_bf16 v[16:19], v[216:219], v[32:35], v[16:19]
    s_waitcnt lgkmcnt(0)
    v_mfma_f32_16x16x32_bf16 v[8:11], v[232:235], v[36:39], v[8:11]
    v_cmp_ge_u32 vcc, s44, v5
    v_mfma_f32_16x16x32_bf16 v[12:15], v[236:239], v[36:39], v[12:15]
    v_mfma_f32_16x16x32_bf16 v[16:19], v[240:243], v[36:39], v[16:19]
    s_cbranch_vccz F1_V18
    buffer_load_dword v5, v4, s[4:7], 0 offen sc1
    v_mfma_f32_16x16x32_bf16 v[20:23], a[252:255], v[40:43], v[20:23]
    v_mfma_f32_16x16x32_bf16 v[24:27], v[80:83], v[40:43], v[24:27]
    v_pk_mul_f32 v[64:65], v[8:9], s[50:51]
    v_mfma_f32_16x16x32_bf16 v[28:31], v[84:87], v[40:43], v[28:31]
    v_exp_f32 v64, v64
    v_pk_mul_f32 v[66:67], v[10:11], s[50:51]
    v_mfma_f32_16x16x32_bf16 v[20:23], v[100:103], v[44:47], v[20:23]
    v_exp_f32 v65, v65
    v_mfma_f32_16x16x32_bf16 v[24:27], v[104:107], v[44:47], v[24:27]
    v_exp_f32 v66, v66
    v_pk_add_f32 v[64:65], v[64:65], 1.0 op_sel_hi:[1,0]
    v_mfma_f32_16x16x32_bf16 v[28:31], v[108:111], v[44:47], v[28:31]
    v_exp_f32 v67, v67
    v_mfma_f32_16x16x32_bf16 v[20:23], v[124:127], v[48:51], v[20:23]
    v_rcp_f32 v64, v64
    v_pk_add_f32 v[66:67], v[66:67], 1.0 op_sel_hi:[1,0]
    v_pk_mul_f32 v[68:69], v[12:13], s[50:51]
    v_mfma_f32_16x16x32_bf16 v[24:27], v[128:131], v[48:51], v[24:27]
    v_rcp_f32 v65, v65
    v_mfma_f32_16x16x32_bf16 v[28:31], v[132:135], v[48:51], v[28:31]
    v_exp_f32 v68, v68
    v_pk_mul_f32 v[70:71], v[14:15], s[50:51]
    v_pk_mul_f32 v[8:9], v[8:9], v[64:65]
    v_mfma_f32_16x16x32_bf16 v[20:23], v[148:151], v[52:55], v[20:23]
    buffer_load_dword v5, v4, s[4:7], 0 offen sc1
    v_exp_f32 v69, v69
    v_mfma_f32_16x16x32_bf16 v[24:27], v[152:155], v[52:55], v[24:27]
    v_exp_f32 v70, v70
    v_pk_add_f32 v[68:69], v[68:69], 1.0 op_sel_hi:[1,0]
    v_mfma_f32_16x16x32_bf16 v[28:31], v[156:159], v[52:55], v[28:31]
    v_exp_f32 v71, v71
    v_mfma_f32_16x16x32_bf16 v[20:23], v[172:175], v[56:59], v[20:23]
    v_rcp_f32 v66, v66
    v_pk_add_f32 v[70:71], v[70:71], 1.0 op_sel_hi:[1,0]
    v_pk_mul_f32 v[72:73], v[16:17], s[50:51]
    v_mfma_f32_16x16x32_bf16 v[24:27], v[176:179], v[56:59], v[24:27]
    v_rcp_f32 v67, v67
    v_mfma_f32_16x16x32_bf16 v[28:31], v[180:183], v[56:59], v[28:31]
    v_exp_f32 v72, v72
    v_pk_mul_f32 v[74:75], v[18:19], s[50:51]
    v_pk_mul_f32 v[10:11], v[10:11], v[66:67]
    v_mfma_f32_16x16x32_bf16 v[20:23], v[196:199], v[60:63], v[20:23]
    v_exp_f32 v73, v73
    v_mfma_f32_16x16x32_bf16 v[24:27], v[200:203], v[60:63], v[24:27]
    v_exp_f32 v74, v74
    v_pk_add_f32 v[72:73], v[72:73], 1.0 op_sel_hi:[1,0]
    v_mfma_f32_16x16x32_bf16 v[28:31], v[204:207], v[60:63], v[28:31]
    v_exp_f32 v75, v75
    v_mfma_f32_16x16x32_bf16 v[20:23], v[220:223], v[32:35], v[20:23]
    v_rcp_f32 v68, v68
    v_pk_add_f32 v[74:75], v[74:75], 1.0 op_sel_hi:[1,0]
    v_mfma_f32_16x16x32_bf16 v[24:27], v[224:227], v[32:35], v[24:27]
    v_rcp_f32 v70, v70
    v_rcp_f32 v69, v69
    v_mfma_f32_16x16x32_bf16 v[28:31], v[228:231], v[32:35], v[28:31]
    v_rcp_f32 v72, v72
    v_rcp_f32 v71, v71
    v_pk_mul_f32 v[12:13], v[12:13], v[68:69]
    v_mfma_f32_16x16x32_bf16 v[20:23], v[244:247], v[36:39], v[20:23]
    v_rcp_f32 v73, v73
    v_pk_mul_f32 v[14:15], v[14:15], v[70:71]
    v_mfma_f32_16x16x32_bf16 v[24:27], v[248:251], v[36:39], v[24:27]
    v_rcp_f32 v75, v75
    v_rcp_f32 v74, v74
    v_pk_mul_f32 v[16:17], v[16:17], v[72:73]
    v_mfma_f32_16x16x32_bf16 v[28:31], v[252:255], v[36:39], v[28:31]
    v_pk_mul_f32 v[18:19], v[18:19], v[74:75]
    v_xor_b32 v3, 32768, v3
    v_pk_mul_f32 v[8:9], v[8:9], v[20:21]
    v_pk_mul_f32 v[10:11], v[10:11], v[22:23]
    v_pk_mul_f32 v[12:13], v[12:13], v[24:25]
    v_pk_mul_f32 v[14:15], v[14:15], v[26:27]
    v_cvt_pk_bf16_f32 v64, v8, v9
    v_cvt_pk_bf16_f32 v65, v10, v11
    v_cvt_pk_bf16_f32 v66, v12, v13
    v_cvt_pk_bf16_f32 v67, v14, v15
    buffer_store_dwordx4 v[64:67], v0, s[4:7], s41 offen sc1
    v_pk_mul_f32 v[16:17], v[16:17], v[28:29]
    v_pk_mul_f32 v[18:19], v[18:19], v[30:31]
    v_cvt_pk_bf16_f32 v72, v16, v17
    v_cvt_pk_bf16_f32 v73, v18, v19
    buffer_store_dwordx2 v[72:73], v6, s[4:7], s41 offen sc1
    s_add_u32 s41, s41, 294912
    s_add_u32 s40, s40, 1
    v_cmp_ge_u32 vcc, s44, v5
    s_cbranch_vccz F1_E1
    buffer_load_dword v5, v4, s[4:7], 0 offen sc1
    s_waitcnt vmcnt(1)
    v_mov_b32 v7, s40
    s_mov_b64 exec, 1
    buffer_store_dword v7, off, s[4:7], s45 sc1
    s_mov_b64 exec, -1
    s_waitcnt vmcnt(1)
    v_cmp_ge_u32 vcc, s44, v5
    s_cbranch_vccz F1_D
    s_cmp_ge_u32 s40, 64
    s_cbranch_scc1 F1_E
    s_branch F1_S
F1_E1:
    s_add_u32 m0, s43, 0
    s_nop 0
    buffer_load_dwordx4 v0, s[4:7], s42 offen offset:0 sc1 lds
    buffer_load_dwordx4 v0, s[4:7], s42 offen offset:1024 sc1 lds
    buffer_load_dwordx4 v0, s[4:7], s42 offen offset:2048 sc1 lds
    buffer_load_dwordx4 v0, s[4:7], s42 offen offset:3072 sc1 lds
    s_add_u32 m0, s43, 4096
    s_add_u32 s47, s42, 4096
    buffer_load_dwordx4 v0, s[4:7], s47 offen offset:0 sc1 lds
    s_add_u32 s42, s42, 36864
    s_xor_b32 s43, s43, 32768
    s_waitcnt vmcnt(5)
    v_mov_b32 v7, s40
    s_mov_b64 exec, 1
    buffer_store_dword v7, off, s[4:7], s45 sc1
    s_mov_b64 exec, -1
    s_waitcnt vmcnt(1)
    s_branch F1_L
F1_P:
    s_waitcnt vmcnt(0)
    v_mov_b32 v7, s40
    s_mov_b64 exec, 1
    buffer_store_dword v7, off, s[4:7], s45 sc1
    s_mov_b64 exec, -1
    s_branch F1_L
F1_V0:
    s_waitcnt lgkmcnt(3)
    v_mfma_f32_16x16x32_bf16 v[8:11], a[0:3], v[32:35], 0
    v_mov_b32 v77, s44
    s_mov_b64 exec, s[54:55]
    ds_write_b32 v76, v77
    s_mov_b64 exec, -1
    v_mfma_f32_16x16x32_bf16 v[12:15], a[4:7], v[32:35], 0
    ds_read_b128 v[48:51], v3 offset:4096
    v_mfma_f32_16x16x32_bf16 v[16:19], a[8:11], v[32:35], 0
    s_add_u32 m0, s43, 0
    s_nop 0
    buffer_load_dwordx4 v0, s[4:7], s42 offen offset:0 sc1 lds
    v_mfma_f32_16x16x32_bf16 v[20:23], a[12:15], v[32:35], 0
    v_mfma_f32_16x16x32_bf16 v[24:27], a[16:19], v[32:35], 0
    v_mfma_f32_16x16x32_bf16 v[28:31], a[20:23], v[32:35], 0
    s_waitcnt lgkmcnt(4)
    v_mfma_f32_16x16x32_bf16 v[8:11], a[24:27], v[36:39], v[8:11]
    ds_read_b128 v[52:55], v3 offset:5120
    v_mfma_f32_16x16x32_bf16 v[12:15], a[28:31], v[36:39], v[12:15]
    v_mfma_f32_16x16x32_bf16 v[16:19], a[32:35], v[36:39], v[16:19]
    v_mfma_f32_16x16x32_bf16 v[20:23], a[36:39], v[36:39], v[20:23]
    v_mfma_f32_16x16x32_bf16 v[24:27], a[40:43], v[36:39], v[24:27]
    v_mfma_f32_16x16x32_bf16 v[28:31], a[44:47], v[36:39], v[28:31]
    s_waitcnt lgkmcnt(4)
    v_mfma_f32_16x16x32_bf16 v[8:11], a[48:51], v[40:43], v[8:11]
    ds_read_b128 v[56:59], v3 offset:6144
    v_mfma_f32_16x16x32_bf16 v[12:15], a[52:55], v[40:43], v[12:15]
    v_mfma_f32_16x16x32_bf16 v[16:19], a[56:59], v[40:43], v[16:19]
    v_mfma_f32_16x16x32_bf16 v[20:23], a[60:63], v[40:43], v[20:23]
    v_mfma_f32_16x16x32_bf16 v[24:27], a[64:67], v[40:43], v[24:27]
    v_mfma_f32_16x16x32_bf16 v[28:31], a[68:71], v[40:43], v[28:31]
    s_waitcnt lgkmcnt(4)
    v_mfma_f32_16x16x32_bf16 v[8:11], a[72:75], v[44:47], v[8:11]
    ds_read_b128 v[60:63], v3 offset:7168
    v_mfma_f32_16x16x32_bf16 v[12:15], a[76:79], v[44:47], v[12:15]
    buffer_load_dwordx4 v0, s[4:7], s42 offen offset:1024 sc1 lds
    v_mfma_f32_16x16x32_bf16 v[16:19], a[80:83], v[44:47], v[16:19]
    v_mfma_f32_16x16x32_bf16 v[20:23], a[84:87], v[44:47], v[20:23]
    v_mfma_f32_16x16x32_bf16 v[24:27], a[88:91], v[44:47], v[24:27]
    v_mfma_f32_16x16x32_bf16 v[28:31], a[92:95], v[44:47], v[28:31]
    s_waitcnt lgkmcnt(3)
    v_mfma_f32_16x16x32_bf16 v[8:11], a[96:99], v[48:51], v[8:11]
    ds_read_b128 v[32:35], v3 offset:8192
    v_mfma_f32_16x16x32_bf16 v[12:15], a[100:103], v[48:51], v[12:15]
    v_mfma_f32_16x16x32_bf16 v[16:19], a[104:107], v[48:51], v[16:19]
    v_mfma_f32_16x16x32_bf16 v[20:23], a[108:111], v[48:51], v[20:23]
    v_mfma_f32_16x16x32_bf16 v[24:27], a[112:115], v[48:51], v[24:27]
    v_mfma_f32_16x16x32_bf16 v[28:31], a[116:119], v[48:51], v[28:31]
    s_waitcnt lgkmcnt(3)
    v_mfma_f32_16x16x32_bf16 v[8:11], a[120:123], v[52:55], v[8:11]
    ds_read_b128 v[36:39], v3 offset:9216
    v_mfma_f32_16x16x32_bf16 v[12:15], a[124:127], v[52:55], v[12:15]
    s_cmp_eq_u32 s46, 0
    s_cbranch_scc1 NP_6
    s_waitcnt vmcnt(2)
    v_mov_b32 v7, s40
    s_mov_b64 exec, 1
    buffer_store_dword v7, off, s[4:7], s45 sc1
    s_mov_b64 exec, -1
    s_mov_b32 s46, 0
NP_6:
    v_mfma_f32_16x16x32_bf16 v[16:19], a[128:131], v[52:55], v[16:19]
    v_mfma_f32_16x16x32_bf16 v[20:23], a[132:135], v[52:55], v[20:23]
    v_mfma_f32_16x16x32_bf16 v[24:27], a[136:139], v[52:55], v[24:27]
    v_mfma_f32_16x16x32_bf16 v[28:31], a[140:143], v[52:55], v[28:31]
    s_waitcnt lgkmcnt(3)
    v_mfma_f32_16x16x32_bf16 v[8:11], a[144:147], v[56:59], v[8:11]
    ds_read_b128 v[40:43], v3 offset:10240
    v_mfma_f32_16x16x32_bf16 v[12:15], a[148:151], v[56:59], v[12:15]
    buffer_load_dwordx4 v0, s[4:7], s42 offen offset:2048 sc1 lds
    v_mfma_f32_16x16x32_bf16 v[16:19], a[152:155], v[56:59], v[16:19]
    v_mfma_f32_16x16x32_bf16 v[20:23], a[156:159], v[56:59], v[20:23]
    v_mfma_f32_16x16x32_bf16 v[24:27], a[160:163], v[56:59], v[24:27]
    v_mfma_f32_16x16x32_bf16 v[28:31], a[164:167], v[56:59], v[28:31]
    s_waitcnt lgkmcnt(3)
    v_mfma_f32_16x16x32_bf16 v[8:11], a[168:171], v[60:63], v[8:11]
    ds_read_b128 v[44:47], v3 offset:11264
    v_mfma_f32_16x16x32_bf16 v[12:15], a[172:175], v[60:63], v[12:15]
    v_mfma_f32_16x16x32_bf16 v[16:19], a[176:179], v[60:63], v[16:19]
    v_mfma_f32_16x16x32_bf16 v[20:23], a[180:183], v[60:63], v[20:23]
    v_mfma_f32_16x16x32_bf16 v[24:27], a[184:187], v[60:63], v[24:27]
    v_mfma_f32_16x16x32_bf16 v[28:31], a[188:191], v[60:63], v[28:31]
    s_waitcnt lgkmcnt(3)
    v_mfma_f32_16x16x32_bf16 v[8:11], a[192:195], v[32:35], v[8:11]
    ds_read_b128 v[48:51], v3 offset:12288
    v_mfma_f32_16x16x32_bf16 v[12:15], a[196:199], v[32:35], v[12:15]
    v_mfma_f32_16x16x32_bf16 v[16:19], a[200:203], v[32:35], v[16:19]
    v_mfma_f32_16x16x32_bf16 v[20:23], a[204:207], v[32:35], v[20:23]
    v_mfma_f32_16x16x32_bf16 v[24:27], a[208:211], v[32:35], v[24:27]
    v_mfma_f32_16x16x32_bf16 v[28:31], a[212:215], v[32:35], v[28:31]
    s_waitcnt lgkmcnt(3)
    v_mfma_f32_16x16x32_bf16 v[8:11], a[216:219], v[36:39], v[8:11]
    ds_read_b128 v[52:55], v3 offset:13312
    v_mfma_f32_16x16x32_bf16 v[12:15], a[220:223], v[36:39], v[12:15]
    buffer_load_dwordx4 v0, s[4:7], s42 offen offset:3072 sc1 lds
    v_mfma_f32_16x16x32_bf16 v[16:19], a[224:227], v[36:39], v[16:19]
    v_mfma_f32_16x16x32_bf16 v[20:23], a[228:231], v[36:39], v[20:23]
    v_mfma_f32_16x16x32_bf16 v[24:27], a[232:235], v[36:39], v[24:27]
    v_mfma_f32_16x16x32_bf16 v[28:31], a[236:239], v[36:39], v[28:31]
    s_waitcnt lgkmcnt(3)
    v_mfma_f32_16x16x32_bf16 v[8:11], a[240:243], v[40:43], v[8:11]
    ds_read_b128 v[56:59], v3 offset:14336
    v_mfma_f32_16x16x32_bf16 v[12:15], a[244:247], v[40:43], v[12:15]
    v_mfma_f32_16x16x32_bf16 v[16:19], a[248:251], v[40:43], v[16:19]
    s_waitcnt lgkmcnt(3)
    v_mfma_f32_16x16x32_bf16 v[8:11], v[88:91], v[44:47], v[8:11]
    ds_read_b128 v[60:63], v3 offset:15360
    v_mfma_f32_16x16x32_bf16 v[12:15], v[92:95], v[44:47], v[12:15]
    v_mfma_f32_16x16x32_bf16 v[16:19], v[96:99], v[44:47], v[16:19]
    s_waitcnt lgkmcnt(3)
    v_mfma_f32_16x16x32_bf16 v[8:11], v[112:115], v[48:51], v[8:11]
    ds_read_b128 v[32:35], v3 offset:16384
    v_mfma_f32_16x16x32_bf16 v[12:15], v[116:119], v[48:51], v[12:15]
    s_add_u32 m0, s43, 4096
    s_add_u32 s47, s42, 4096
    buffer_load_dwordx4 v0, s[4:7], s47 offen offset:0 sc1 lds
    s_add_u32 s42, s42, 36864
    s_xor_b32 s43, s43, 32768
    v_mfma_f32_16x16x32_bf16 v[16:19], v[120:123], v[48:51], v[16:19]
    s_waitcnt lgkmcnt(3)
    v_mfma_f32_16x16x32_bf16 v[8:11], v[136:139], v[52:55], v[8:11]
    ds_read_b128 v[36:39], v3 offset:17408
    v_mfma_f32_16x16x32_bf16 v[12:15], v[140:143], v[52:55], v[12:15]
    buffer_load_dword v5, v4, s[4:7], 0 offen sc1
    v_mfma_f32_16x16x32_bf16 v[16:19], v[144:147], v[52:55], v[16:19]
    s_waitcnt lgkmcnt(3)
    v_mfma_f32_16x16x32_bf16 v[8:11], v[160:163], v[56:59], v[8:11]
    v_mfma_f32_16x16x32_bf16 v[12:15], v[164:167], v[56:59], v[12:15]
    v_mfma_f32_16x16x32_bf16 v[16:19], v[168:171], v[56:59], v[16:19]
    s_waitcnt lgkmcnt(2)
    v_mfma_f32_16x16x32_bf16 v[8:11], v[184:187], v[60:63], v[8:11]
    v_mfma_f32_16x16x32_bf16 v[12:15], v[188:191], v[60:63], v[12:15]
    v_mfma_f32_16x16x32_bf16 v[16:19], v[192:195], v[60:63], v[16:19]
    s_waitcnt lgkmcnt(1)
    v_mfma_f32_16x16x32_bf16 v[8:11], v[208:211], v[32:35], v[8:11]
    v_mfma_f32_16x16x32_bf16 v[12:15], v[212:215], v[32:35], v[12:15]
    v_mfma_f32_16x16x32_bf16 v[16:19], v[216:219], v[32:35], v[16:19]
    s_waitcnt lgkmcnt(0)
    v_mfma_f32_16x16x32_bf16 v[8:11], v[232:235], v[36:39], v[8:11]
    v_mfma_f32_16x16x32_bf16 v[12:15], v[236:239], v[36:39], v[12:15]
    v_mfma_f32_16x16x32_bf16 v[16:19], v[240:243], v[36:39], v[16:19]
    v_mfma_f32_16x16x32_bf16 v[20:23], a[252:255], v[40:43], v[20:23]
    v_mfma_f32_16x16x32_bf16 v[24:27], v[80:83], v[40:43], v[24:27]
    v_pk_mul_f32 v[64:65], v[8:9], s[50:51]
    v_mfma_f32_16x16x32_bf16 v[28:31], v[84:87], v[40:43], v[28:31]
    v_exp_f32 v64, v64
    v_pk_mul_f32 v[66:67], v[10:11], s[50:51]
    v_mfma_f32_16x16x32_bf16 v[20:23], v[100:103], v[44:47], v[20:23]
    v_exp_f32 v65, v65
    v_mfma_f32_16x16x32_bf16 v[24:27], v[104:107], v[44:47], v[24:27]
    v_exp_f32 v66, v66
    v_pk_add_f32 v[64:65], v[64:65], 1.0 op_sel_hi:[1,0]
    v_mfma_f32_16x16x32_bf16 v[28:31], v[108:111], v[44:47], v[28:31]
    v_exp_f32 v67, v67
    v_mfma_f32_16x16x32_bf16 v[20:23], v[124:127], v[48:51], v[20:23]
    v_rcp_f32 v64, v64
    v_pk_add_f32 v[66:67], v[66:67], 1.0 op_sel_hi:[1,0]
    v_pk_mul_f32 v[68:69], v[12:13], s[50:51]
    v_mfma_f32_16x16x32_bf16 v[24:27], v[128:131], v[48:51], v[24:27]
    v_rcp_f32 v65, v65
    v_mfma_f32_16x16x32_bf16 v[28:31], v[132:135], v[48:51], v[28:31]
    v_exp_f32 v68, v68
    v_pk_mul_f32 v[70:71], v[14:15], s[50:51]
    v_pk_mul_f32 v[8:9], v[8:9], v[64:65]
    v_mfma_f32_16x16x32_bf16 v[20:23], v[148:151], v[52:55], v[20:23]
    v_exp_f32 v69, v69
    v_mfma_f32_16x16x32_bf16 v[24:27], v[152:155], v[52:55], v[24:27]
    v_exp_f32 v70, v70
    v_pk_add_f32 v[68:69], v[68:69], 1.0 op_sel_hi:[1,0]
    v_mfma_f32_16x16x32_bf16 v[28:31], v[156:159], v[52:55], v[28:31]
    v_exp_f32 v71, v71
    v_mfma_f32_16x16x32_bf16 v[20:23], v[172:175], v[56:59], v[20:23]
    v_rcp_f32 v66, v66
    v_pk_add_f32 v[70:71], v[70:71], 1.0 op_sel_hi:[1,0]
    v_pk_mul_f32 v[72:73], v[16:17], s[50:51]
    v_mfma_f32_16x16x32_bf16 v[24:27], v[176:179], v[56:59], v[24:27]
    v_rcp_f32 v67, v67
    v_mfma_f32_16x16x32_bf16 v[28:31], v[180:183], v[56:59], v[28:31]
    v_exp_f32 v72, v72
    v_pk_mul_f32 v[74:75], v[18:19], s[50:51]
    v_pk_mul_f32 v[10:11], v[10:11], v[66:67]
    v_mfma_f32_16x16x32_bf16 v[20:23], v[196:199], v[60:63], v[20:23]
    v_exp_f32 v73, v73
    v_mfma_f32_16x16x32_bf16 v[24:27], v[200:203], v[60:63], v[24:27]
    v_exp_f32 v74, v74
    v_pk_add_f32 v[72:73], v[72:73], 1.0 op_sel_hi:[1,0]
    v_mfma_f32_16x16x32_bf16 v[28:31], v[204:207], v[60:63], v[28:31]
    v_exp_f32 v75, v75
    v_mfma_f32_16x16x32_bf16 v[20:23], v[220:223], v[32:35], v[20:23]
    v_rcp_f32 v68, v68
    v_pk_add_f32 v[74:75], v[74:75], 1.0 op_sel_hi:[1,0]
    v_mfma_f32_16x16x32_bf16 v[24:27], v[224:227], v[32:35], v[24:27]
    v_rcp_f32 v70, v70
    v_rcp_f32 v69, v69
    v_mfma_f32_16x16x32_bf16 v[28:31], v[228:231], v[32:35], v[28:31]
    v_rcp_f32 v72, v72
    v_rcp_f32 v71, v71
    v_pk_mul_f32 v[12:13], v[12:13], v[68:69]
    v_mfma_f32_16x16x32_bf16 v[20:23], v[244:247], v[36:39], v[20:23]
    ds_read_b32 v77, v76
    v_rcp_f32 v73, v73
    v_pk_mul_f32 v[14:15], v[14:15], v[70:71]
    v_mfma_f32_16x16x32_bf16 v[24:27], v[248:251], v[36:39], v[24:27]
    v_rcp_f32 v75, v75
    v_rcp_f32 v74, v74
    v_pk_mul_f32 v[16:17], v[16:17], v[72:73]
    v_mfma_f32_16x16x32_bf16 v[28:31], v[252:255], v[36:39], v[28:31]
    v_pk_mul_f32 v[18:19], v[18:19], v[74:75]
    v_xor_b32 v3, 32768, v3
    v_pk_mul_f32 v[8:9], v[8:9], v[20:21]
    v_pk_mul_f32 v[10:11], v[10:11], v[22:23]
    v_pk_mul_f32 v[12:13], v[12:13], v[24:25]
    v_pk_mul_f32 v[14:15], v[14:15], v[26:27]
    v_cvt_pk_bf16_f32 v64, v8, v9
    v_cvt_pk_bf16_f32 v65, v10, v11
    v_cvt_pk_bf16_f32 v66, v12, v13
    v_cvt_pk_bf16_f32 v67, v14, v15
    buffer_store_dwordx4 v[64:67], v0, s[4:7], s41 offen sc1
    v_pk_mul_f32 v[16:17], v[16:17], v[28:29]
    v_pk_mul_f32 v[18:19], v[18:19], v[30:31]
    v_cvt_pk_bf16_f32 v72, v16, v17
    v_cvt_pk_bf16_f32 v73, v18, v19
    buffer_store_dwordx2 v[72:73], v6, s[4:7], s41 offen sc1
    s_add_u32 s41, s41, 294912
    s_add_u32 s40, s40, 1
    s_waitcnt lgkmcnt(0)
    v_cmp_ne_u32 vcc, s40, v77
    s_cbranch_vccnz F1_P
    s_waitcnt vmcnt(3)
    s_mov_b32 s46, 1
    s_branch F1_L
F1_V5:
    s_waitcnt lgkmcnt(3)
    v_mfma_f32_16x16x32_bf16 v[8:11], a[120:123], v[52:55], v[8:11]
    v_mov_b32 v77, s44
    s_mov_b64 exec, s[54:55]
    ds_write_b32 v76, v77
    s_mov_b64 exec, -1
    v_mfma_f32_16x16x32_bf16 v[12:15], a[124:127], v[52:55], v[12:15]
    ds_read_b128 v[36:39], v3 offset:9216
    v_mfma_f32_16x16x32_bf16 v[16:19], a[128:131], v[52:55], v[16:19]
    s_add_u32 m0, s43, 0
    s_nop 0
    buffer_load_dwordx4 v0, s[4:7], s42 offen offset:0 sc1 lds
    v_mfma_f32_16x16x32_bf16 v[20:23], a[132:135], v[52:55], v[20:23]
    s_cmp_eq_u32 s46, 0
    s_cbranch_scc1 NP_7
    s_waitcnt vmcnt(2)
    v_mov_b32 v7, s40
    s_mov_b64 exec, 1
    buffer_store_dword v7, off, s[4:7], s45 sc1
    s_mov_b64 exec, -1
    s_mov_b32 s46, 0
NP_7:
    v_mfma_f32_16x16x32_bf16 v[24:27], a[136:139], v[52:55], v[24:27]
    v_mfma_f32_16x16x32_bf16 v[28:31], a[140:143], v[52:55], v[28:31]
    s_waitcnt lgkmcnt(4)
    v_mfma_f32_16x16x32_bf16 v[8:11], a[144:147], v[56:59], v[8:11]
    ds_read_b128 v[40:43], v3 offset:10240
    v_mfma_f32_16x16x32_bf16 v[12:15], a[148:151], v[56:59], v[12:15]
    v_mfma_f32_16x16x32_bf16 v[16:19], a[152:155], v[56:59], v[16:19]
    v_mfma_f32_16x16x32_bf16 v[20:23], a[156:159], v[56:59], v[20:23]
    v_mfma_f32_16x16x32_bf16 v[24:27], a[160:163], v[56:59], v[24:27]
    v_mfma_f32_16x16x32_bf16 v[28:31], a[164:167], v[56:59], v[28:31]
    s_waitcnt lgkmcnt(4)
    v_mfma_f32_16x16x32_bf16 v[8:11], a[168:171], v[60:63], v[8:11]
    ds_read_b128 v[44:47], v3 offset:11264
    v_mfma_f32_16x16x32_bf16 v[12:15], a[172:175], v[60:63], v[12:15]
    v_mfma_f32_16x16x32_bf16 v[16:19], a[176:179], v[60:63], v[16:19]
    v_mfma_f32_16x16x32_bf16 v[20:23], a[180:183], v[60:63], v[20:23]
    v_mfma_f32_16x16x32_bf16 v[24:27], a[184:187], v[60:63], v[24:27]
    v_mfma_f32_16x16x32_bf16 v[28:31], a[188:191], v[60:63], v[28:31]
    s_waitcnt lgkmcnt(4)
    v_mfma_f32_16x16x32_bf16 v[8:11], a[192:195], v[32:35], v[8:11]
    ds_read_b128 v[48:51], v3 offset:12288
    v_mfma_f32_16x16x32_bf16 v[12:15], a[196:199], v[32:35], v[12:15]
    buffer_load_dwordx4 v0, s[4:7], s42 offen offset:1024 sc1 lds
    v_mfma_f32_16x16x32_bf16 v[16:19], a[200:203], v[32:35], v[16:19]
    v_mfma_f32_16x16x32_bf16 v[20:23], a[204:207], v[32:35], v[20:23]
    v_mfma_f32_16x16x32_bf16 v[24:27], a[208:211], v[32:35], v[24:27]
    v_mfma_f32_16x16x32_bf16 v[28:31], a[212:215], v[32:35], v[28:31]
    s_waitcnt lgkmcnt(3)
    v_mfma_f32_16x16x32_bf16 v[8:11], a[216:219], v[36:39], v[8:11]
    ds_read_b128 v[52:55], v3 offset:13312
    v_mfma_f32_16x16x32_bf16 v[12:15], a[220:223], v[36:39], v[12:15]
    v_mfma_f32_16x16x32_bf16 v[16:19], a[224:227], v[36:39], v[16:19]
    v_mfma_f32_16x16x32_bf16 v[20:23], a[228:231], v[36:39], v[20:23]
    v_mfma_f32_16x16x32_bf16 v[24:27], a[232:235], v[36:39], v[24:27]
    v_mfma_f32_16x16x32_bf16 v[28:31], a[236:239], v[36:39], v[28:31]
    s_waitcnt lgkmcnt(3)
    v_mfma_f32_16x16x32_bf16 v[8:11], a[240:243], v[40:43], v[8:11]
    ds_read_b128 v[56:59], v3 offset:14336
    v_mfma_f32_16x16x32_bf16 v[12:15], a[244:247], v[40:43], v[12:15]
    v_mfma_f32_16x16x32_bf16 v[16:19], a[248:251], v[40:43], v[16:19]
    s_waitcnt lgkmcnt(3)
    v_mfma_f32_16x16x32_bf16 v[8:11], v[88:91], v[44:47], v[8:11]
    ds_read_b128 v[60:63], v3 offset:15360
    v_mfma_f32_16x16x32_bf16 v[12:15], v[92:95], v[44:47], v[12:15]
    buffer_load_dwordx4 v0, s[4:7], s42 offen offset:2048 sc1 lds
    v_mfma_f32_16x16x32_bf16 v[16:19], v[96:99], v[44:47], v[16:19]
    s_waitcnt lgkmcnt(3)
    v_mfma_f32_16x16x32_bf16 v[8:11], v[112:115], v[48:51], v[8:11]
    ds_read_b128 v[32:35], v3 offset:16384
    v_mfma_f32_16x16x32_bf16 v[12:15], v[116:119], v[48:51], v[12:15]
    v_mfma_f32_16x16x32_bf16 v[16:19], v[120:123], v[48:51], v[16:19]
    s_waitcnt lgkmcnt(3)
    v_mfma_f32_16x16x32_bf16 v[8:11], v[136:139], v[52:55], v[8:11]
    ds_read_b128 v[36:39], v3 offset:17408
    v_mfma_f32_16x16x32_bf16 v[12:15], v[140:143], v[52:55], v[12:15]
    v_mfma_f32_16x16x32_bf16 v[16:19], v[144:147], v[52:55], v[16:19]
    s_waitcnt lgkmcnt(3)
    v_mfma_f32_16x16x32_bf16 v[8:11], v[160:163], v[56:59], v[8:11]
    buffer_load_dwordx4 v0, s[4:7], s42 offen offset:3072 sc1 lds
    v_mfma_f32_16x16x32_bf16 v[12:15], v[164:167], v[56:59], v[12:15]
    v_mfma_f32_16x16x32_bf16 v[16:19], v[168:171], v[56:59], v[16:19]
    s_waitcnt lgkmcnt(2)
    v_mfma_f32_16x16x32_bf16 v[8:11], v[184:187], v[60:63], v[8:11]
    v_mfma_f32_16x16x32_bf16 v[12:15], v[188:191], v[60:63], v[12:15]
    v_mfma_f32_16x16x32_bf16 v[16:19], v[192:195], v[60:63], v[16:19]
    s_waitcnt lgkmcnt(1)
    v_mfma_f32_16x16x32_bf16 v[8:11], v[208:211], v[32:35], v[8:11]
    v_mfma_f32_16x16x32_bf16 v[12:15], v[212:215], v[32:35], v[12:15]
    v_mfma_f32_16x16x32_bf16 v[16:19], v[216:219], v[32:35], v[16:19]
    s_waitcnt lgkmcnt(0)
    v_mfma_f32_16x16x32_bf16 v[8:11], v[232:235], v[36:39], v[8:11]
    s_add_u32 m0, s43, 4096
    s_add_u32 s47, s42, 4096
    buffer_load_dwordx4 v0, s[4:7], s47 offen offset:0 sc1 lds
    s_add_u32 s42, s42, 36864
    s_xor_b32 s43, s43, 32768
    v_mfma_f32_16x16x32_bf16 v[12:15], v[236:239], v[36:39], v[12:15]
    v_mfma_f32_16x16x32_bf16 v[16:19], v[240:243], v[36:39], v[16:19]
    v_mfma_f32_16x16x32_bf16 v[20:23], a[252:255], v[40:43], v[20:23]
    buffer_load_dword v5, v4, s[4:7], 0 offen sc1
    v_mfma_f32_16x16x32_bf16 v[24:27], v[80:83], v[40:43], v[24:27]
    v_pk_mul_f32 v[64:65], v[8:9], s[50:51]
    v_mfma_f32_16x16x32_bf16 v[28:31], v[84:87], v[40:43], v[28:31]
    v_exp_f32 v64, v64
    v_pk_mul_f32 v[66:67], v[10:11], s[50:51]
    v_mfma_f32_16x16x32_bf16 v[20:23], v[100:103], v[44:47], v[20:23]
    v_exp_f32 v65, v65
    v_mfma_f32_16x16x32_bf16 v[24:27], v[104:107], v[44:47], v[24:27]
    v_exp_f32 v66, v66
    v_pk_add_f32 v[64:65], v[64:65], 1.0 op_sel_hi:[1,0]
    v_mfma_f32_16x16x32_bf16 v[28:31], v[108:111], v[44:47], v[28:31]
    v_exp_f32 v67, v67
    v_mfma_f32_16x16x32_bf16 v[20:23], v[124:127], v[48:51], v[20:23]
    v_rcp_f32 v64, v64
    v_pk_add_f32 v[66:67], v[66:67], 1.0 op_sel_hi:[1,0]
    v_pk_mul_f32 v[68:69], v[12:13], s[50:51]
    v_mfma_f32_16x16x32_bf16 v[24:27], v[128:131], v[48:51], v[24:27]
    v_rcp_f32 v65, v65
    v_mfma_f32_16x16x32_bf16 v[28:31], v[132:135], v[48:51], v[28:31]
    v_exp_f32 v68, v68
    v_pk_mul_f32 v[70:71], v[14:15], s[50:51]
    v_pk_mul_f32 v[8:9], v[8:9], v[64:65]
    v_mfma_f32_16x16x32_bf16 v[20:23], v[148:151], v[52:55], v[20:23]
    v_exp_f32 v69, v69
    v_mfma_f32_16x16x32_bf16 v[24:27], v[152:155], v[52:55], v[24:27]
    v_exp_f32 v70, v70
    v_pk_add_f32 v[68:69], v[68:69], 1.0 op_sel_hi:[1,0]
    v_mfma_f32_16x16x32_bf16 v[28:31], v[156:159], v[52:55], v[28:31]
    v_exp_f32 v71, v71
    v_mfma_f32_16x16x32_bf16 v[20:23], v[172:175], v[56:59], v[20:23]
    v_rcp_f32 v66, v66
    v_pk_add_f32 v[70:71], v[70:71], 1.0 op_sel_hi:[1,0]
    v_pk_mul_f32 v[72:73], v[16:17], s[50:51]
    v_mfma_f32_16x16x32_bf16 v[24:27], v[176:179], v[56:59], v[24:27]
    v_rcp_f32 v67, v67
    v_mfma_f32_16x16x32_bf16 v[28:31], v[180:183], v[56:59], v[28:31]
    v_exp_f32 v72, v72
    v_pk_mul_f32 v[74:75], v[18:19], s[50:51]
    v_pk_mul_f32 v[10:11], v[10:11], v[66:67]
    v_mfma_f32_16x16x32_bf16 v[20:23], v[196:199], v[60:63], v[20:23]
    v_exp_f32 v73, v73
    v_mfma_f32_16x16x32_bf16 v[24:27], v[200:203], v[60:63], v[24:27]
    v_exp_f32 v74, v74
    v_pk_add_f32 v[72:73], v[72:73], 1.0 op_sel_hi:[1,0]
    v_mfma_f32_16x16x32_bf16 v[28:31], v[204:207], v[60:63], v[28:31]
    v_exp_f32 v75, v75
    v_mfma_f32_16x16x32_bf16 v[20:23], v[220:223], v[32:35], v[20:23]
    v_rcp_f32 v68, v68
    v_pk_add_f32 v[74:75], v[74:75], 1.0 op_sel_hi:[1,0]
    v_mfma_f32_16x16x32_bf16 v[24:27], v[224:227], v[32:35], v[24:27]
    v_rcp_f32 v70, v70
    v_rcp_f32 v69, v69
    v_mfma_f32_16x16x32_bf16 v[28:31], v[228:231], v[32:35], v[28:31]
    v_rcp_f32 v72, v72
    v_rcp_f32 v71, v71
    v_pk_mul_f32 v[12:13], v[12:13], v[68:69]
    v_mfma_f32_16x16x32_bf16 v[20:23], v[244:247], v[36:39], v[20:23]
    ds_read_b32 v77, v76
    v_rcp_f32 v73, v73
    v_pk_mul_f32 v[14:15], v[14:15], v[70:71]
    v_mfma_f32_16x16x32_bf16 v[24:27], v[248:251], v[36:39], v[24:27]
    v_rcp_f32 v75, v75
    v_rcp_f32 v74, v74
    v_pk_mul_f32 v[16:17], v[16:17], v[72:73]
    v_mfma_f32_16x16x32_bf16 v[28:31], v[252:255], v[36:39], v[28:31]
    v_pk_mul_f32 v[18:19], v[18:19], v[74:75]
    v_xor_b32 v3, 32768, v3
    v_pk_mul_f32 v[8:9], v[8:9], v[20:21]
    v_pk_mul_f32 v[10:11], v[10:11], v[22:23]
    v_pk_mul_f32 v[12:13], v[12:13], v[24:25]
    v_pk_mul_f32 v[14:15], v[14:15], v[26:27]
    v_cvt_pk_bf16_f32 v64, v8, v9
    v_cvt_pk_bf16_f32 v65, v10, v11
    v_cvt_pk_bf16_f32 v66, v12, v13
    v_cvt_pk_bf16_f32 v67, v14, v15
    buffer_store_dwordx4 v[64:67], v0, s[4:7], s41 offen sc1
    v_pk_mul_f32 v[16:17], v[16:17], v[28:29]
    v_pk_mul_f32 v[18:19], v[18:19], v[30:31]
    v_cvt_pk_bf16_f32 v72, v16, v17
    v_cvt_pk_bf16_f32 v73, v18, v19
    buffer_store_dwordx2 v[72:73], v6, s[4:7], s41 offen sc1
    s_add_u32 s41, s41, 294912
    s_add_u32 s40, s40, 1
    s_waitcnt lgkmcnt(0)
    v_cmp_ne_u32 vcc, s40, v77
    s_cbranch_vccnz F1_P
    s_waitcnt vmcnt(3)
    s_mov_b32 s46, 1
    s_branch F1_L
F1_V10:
    s_waitcnt lgkmcnt(3)
    v_mfma_f32_16x16x32_bf16 v[8:11], a[240:243], v[40:43], v[8:11]
    v_mov_b32 v77, s44
    s_mov_b64 exec, s[54:55]
    ds_write_b32 v76, v77
    s_mov_b64 exec, -1
    v_mfma_f32_16x16x32_bf16 v[12:15], a[244:247], v[40:43], v[12:15]
    ds_read_b128 v[56:59], v3 offset:14336
    v_mfma_f32_16x16x32_bf16 v[16:19], a[248:251], v[40:43], v[16:19]
    s_add_u32 m0, s43, 0
    s_nop 0
    buffer_load_dwordx4 v0, s[4:7], s42 offen offset:0 sc1 lds
    s_waitcnt lgkmcnt(4)
    v_mfma_f32_16x16x32_bf16 v[8:11], v[88:91], v[44:47], v[8:11]
    ds_read_b128 v[60:63], v3 offset:15360
    v_mfma_f32_16x16x32_bf16 v[12:15], v[92:95], v[44:47], v[12:15]
    v_mfma_f32_16x16x32_bf16 v[16:19], v[96:99], v[44:47], v[16:19]
    s_waitcnt lgkmcnt(4)
    v_mfma_f32_16x16x32_bf16 v[8:11], v[112:115], v[48:51], v[8:11]
    ds_read_b128 v[32:35], v3 offset:16384
    v_mfma_f32_16x16x32_bf16 v[12:15], v[116:119], v[48:51], v[12:15]
    v_mfma_f32_16x16x32_bf16 v[16:19], v[120:123], v[48:51], v[16:19]
    s_waitcnt lgkmcnt(4)
    v_mfma_f32_16x16x32_bf16 v[8:11], v[136:139], v[52:55], v[8:11]
    ds_read_b128 v[36:39], v3 offset:17408
    v_mfma_f32_16x16x32_bf16 v[12:15], v[140:143], v[52:55], v[12:15]
    buffer_load_dwordx4 v0, s[4:7], s42 offen offset:1024 sc1 lds
    v_mfma_f32_16x16x32_bf16 v[16:19], v[144:147], v[52:55], v[16:19]
    s_waitcnt lgkmcnt(3)
    v_mfma_f32_16x16x32_bf16 v[8:11], v[160:163], v[56:59], v[8:11]
    v_mfma_f32_16x16x32_bf16 v[12:15], v[164:167], v[56:59], v[12:15]
    v_mfma_f32_16x16x32_bf16 v[16:19], v[168:171], v[56:59], v[16:19]
    s_waitcnt lgkmcnt(2)
    v_mfma_f32_16x16x32_bf16 v[8:11], v[184:187], v[60:63], v[8:11]
    v_mfma_f32_16x16x32_bf16 v[12:15], v[188:191], v[60:63], v[12:15]
    v_mfma_f32_16x16x32_bf16 v[16:19], v[192:195], v[60:63], v[16:19]
    s_waitcnt lgkmcnt(1)
    v_mfma_f32_16x16x32_bf16 v[8:11], v[208:211], v[32:35], v[8:11]
    buffer_load_dwordx4 v0, s[4:7], s42 offen offset:2048 sc1 lds
    v_mfma_f32_16x16x32_bf16 v[12:15], v[212:215], v[32:35], v[12:15]
    v_mfma_f32_16x16x32_bf16 v[16:19], v[216:219], v[32:35], v[16:19]
    s_waitcnt lgkmcnt(0)
    v_mfma_f32_16x16x32_bf16 v[8:11], v[232:235], v[36:39], v[8:11]
    v_mfma_f32_16x16x32_bf16 v[12:15], v[236:239], v[36:39], v[12:15]
    v_mfma_f32_16x16x32_bf16 v[16:19], v[240:243], v[36:39], v[16:19]
    v_mfma_f32_16x16x32_bf16 v[20:23], a[252:255], v[40:43], v[20:23]
    v_mfma_f32_16x16x32_bf16 v[24:27], v[80:83], v[40:43], v[24:27]
    v_pk_mul_f32 v[64:65], v[8:9], s[50:51]
    v_mfma_f32_16x16x32_bf16 v[28:31], v[84:87], v[40:43], v[28:31]
    v_exp_f32 v64, v64
    v_pk_mul_f32 v[66:67], v[10:11], s[50:51]
    v_mfma_f32_16x16x32_bf16 v[20:23], v[100:103], v[44:47], v[20:23]
    buffer_load_dwordx4 v0, s[4:7], s42 offen offset:3072 sc1 lds
    v_exp_f32 v65, v65
    v_mfma_f32_16x16x32_bf16 v[24:27], v[104:107], v[44:47], v[24:27]
    v_exp_f32 v66, v66
    v_pk_add_f32 v[64:65], v[64:65], 1.0 op_sel_hi:[1,0]
    v_mfma_f32_16x16x32_bf16 v[28:31], v[108:111], v[44:47], v[28:31]
    v_exp_f32 v67, v67
    v_mfma_f32_16x16x32_bf16 v[20:23], v[124:127], v[48:51], v[20:23]
    v_rcp_f32 v64, v64
    v_pk_add_f32 v[66:67], v[66:67], 1.0 op_sel_hi:[1,0]
    v_pk_mul_f32 v[68:69], v[12:13], s[50:51]
    v_mfma_f32_16x16x32_bf16 v[24:27], v[128:131], v[48:51], v[24:27]
    v_rcp_f32 v65, v65
    v_mfma_f32_16x16x32_bf16 v[28:31], v[132:135], v[48:51], v[28:31]
    v_exp_f32 v68, v68
    v_pk_mul_f32 v[70:71], v[14:15], s[50:51]
    v_pk_mul_f32 v[8:9], v[8:9], v[64:65]
    v_mfma_f32_16x16x32_bf16 v[20:23], v[148:151], v[52:55], v[20:23]
    v_exp_f32 v69, v69
    v_mfma_f32_16x16x32_bf16 v[24:27], v[152:155], v[52:55], v[24:27]
    v_exp_f32 v70, v70
    v_pk_add_f32 v[68:69], v[68:69], 1.0 op_sel_hi:[1,0]
    v_mfma_f32_16x16x32_bf16 v[28:31], v[156:159], v[52:55], v[28:31]
    v_exp_f32 v71, v71
    v_mfma_f32_16x16x32_bf16 v[20:23], v[172:175], v[56:59], v[20:23]
    s_add_u32 m0, s43, 4096
    s_add_u32 s47, s42, 4096
    buffer_load_dwordx4 v0, s[4:7], s47 offen offset:0 sc1 lds
    s_add_u32 s42, s42, 36864
    s_xor_b32 s43, s43, 32768
    v_rcp_f32 v66, v66
    v_pk_add_f32 v[70:71], v[70:71], 1.0 op_sel_hi:[1,0]
    v_pk_mul_f32 v[72:73], v[16:17], s[50:51]
    v_mfma_f32_16x16x32_bf16 v[24:27], v[176:179], v[56:59], v[24:27]
    v_rcp_f32 v67, v67
    v_mfma_f32_16x16x32_bf16 v[28:31], v[180:183], v[56:59], v[28:31]
    v_exp_f32 v72, v72
    v_pk_mul_f32 v[74:75], v[18:19], s[50:51]
    v_pk_mul_f32 v[10:11], v[10:11], v[66:67]
    v_mfma_f32_16x16x32_bf16 v[20:23], v[196:199], v[60:63], v[20:23]
    buffer_load_dword v5, v4, s[4:7], 0 offen sc1
    v_exp_f32 v73, v73
    v_mfma_f32_16x16x32_bf16 v[24:27], v[200:203], v[60:63], v[24:27]
    v_exp_f32 v74, v74
    v_pk_add_f32 v[72:73], v[72:73], 1.0 op_sel_hi:[1,0]
    v_mfma_f32_16x16x32_bf16 v[28:31], v[204:207], v[60:63], v[28:31]
    v_exp_f32 v75, v75
    v_mfma_f32_16x16x32_bf16 v[20:23], v[220:223], v[32:35], v[20:23]
    v_rcp_f32 v68, v68
    v_pk_add_f32 v[74:75], v[74:75], 1.0 op_sel_hi:[1,0]
    v_mfma_f32_16x16x32_bf16 v[24:27], v[224:227], v[32:35], v[24:27]
    v_rcp_f32 v70, v70
    v_rcp_f32 v69, v69
    v_mfma_f32_16x16x32_bf16 v[28:31], v[228:231], v[32:35], v[28:31]
    v_rcp_f32 v72, v72
    v_rcp_f32 v71, v71
    v_pk_mul_f32 v[12:13], v[12:13], v[68:69]
    v_mfma_f32_16x16x32_bf16 v[20:23], v[244:247], v[36:39], v[20:23]
    ds_read_b32 v77, v76
    v_rcp_f32 v73, v73
    v_pk_mul_f32 v[14:15], v[14:15], v[70:71]
    v_mfma_f32_16x16x32_bf16 v[24:27], v[248:251], v[36:39], v[24:27]
    v_rcp_f32 v75, v75
    v_rcp_f32 v74, v74
    v_pk_mul_f32 v[16:17], v[16:17], v[72:73]
    v_mfma_f32_16x16x32_bf16 v[28:31], v[252:255], v[36:39], v[28:31]
    v_pk_mul_f32 v[18:19], v[18:19], v[74:75]
    v_xor_b32 v3, 32768, v3
    v_pk_mul_f32 v[8:9], v[8:9], v[20:21]
    v_pk_mul_f32 v[10:11], v[10:11], v[22:23]
    v_pk_mul_f32 v[12:13], v[12:13], v[24:25]
    v_pk_mul_f32 v[14:15], v[14:15], v[26:27]
    v_cvt_pk_bf16_f32 v64, v8, v9
    v_cvt_pk_bf16_f32 v65, v10, v11
    v_cvt_pk_bf16_f32 v66, v12, v13
    v_cvt_pk_bf16_f32 v67, v14, v15
    buffer_store_dwordx4 v[64:67], v0, s[4:7], s41 offen sc1
    v_pk_mul_f32 v[16:17], v[16:17], v[28:29]
    v_pk_mul_f32 v[18:19], v[18:19], v[30:31]
    v_cvt_pk_bf16_f32 v72, v16, v17
    v_cvt_pk_bf16_f32 v73, v18, v19
    buffer_store_dwordx2 v[72:73], v6, s[4:7], s41 offen sc1
    s_add_u32 s41, s41, 294912
    s_add_u32 s40, s40, 1
    s_waitcnt lgkmcnt(0)
    v_cmp_ne_u32 vcc, s40, v77
    s_cbranch_vccnz F1_P
    s_waitcnt vmcnt(3)
    s_mov_b32 s46, 1
    s_branch F1_L
F1_V18:
    v_mfma_f32_16x16x32_bf16 v[20:23], a[252:255], v[40:43], v[20:23]
    v_mov_b32 v77, s44
    s_mov_b64 exec, s[54:55]
    ds_write_b32 v76, v77
    s_mov_b64 exec, -1
    v_mfma_f32_16x16x32_bf16 v[24:27], v[80:83], v[40:43], v[24:27]
    s_add_u32 m0, s43, 0
    s_nop 0
    buffer_load_dwordx4 v0, s[4:7], s42 offen offset:0 sc1 lds
    v_pk_mul_f32 v[64:65], v[8:9], s[50:51]
    v_mfma_f32_16x16x32_bf16 v[28:31], v[84:87], v[40:43], v[28:31]
    v_exp_f32 v64, v64
    v_pk_mul_f32 v[66:67], v[10:11], s[50:51]
    v_mfma_f32_16x16x32_bf16 v[20:23], v[100:103], v[44:47], v[20:23]
    buffer_load_dwordx4 v0, s[4:7], s42 offen offset:1024 sc1 lds
    v_exp_f32 v65, v65
    v_mfma_f32_16x16x32_bf16 v[24:27], v[104:107], v[44:47], v[24:27]
    v_exp_f32 v66, v66
    v_pk_add_f32 v[64:65], v[64:65], 1.0 op_sel_hi:[1,0]
    v_mfma_f32_16x16x32_bf16 v[28:31], v[108:111], v[44:47], v[28:31]
    v_exp_f32 v67, v67
    v_mfma_f32_16x16x32_bf16 v[20:23], v[124:127], v[48:51], v[20:23]
    buffer_load_dwordx4 v0, s[4:7], s42 offen offset:2048 sc1 lds
    v_rcp_f32 v64, v64
    v_pk_add_f32 v[66:67], v[66:67], 1.0 op_sel_hi:[1,0]
    v_pk_mul_f32 v[68:69], v[12:13], s[50:51]
    v_mfma_f32_16x16x32_bf16 v[24:27], v[128:131], v[48:51], v[24:27]
    v_rcp_f32 v65, v65
    v_mfma_f32_16x16x32_bf16 v[28:31], v[132:135], v[48:51], v[28:31]
    v_exp_f32 v68, v68
    v_pk_mul_f32 v[70:71], v[14:15], s[50:51]
    v_pk_mul_f32 v[8:9], v[8:9], v[64:65]
    v_mfma_f32_16x16x32_bf16 v[20:23], v[148:151], v[52:55], v[20:23]
    buffer_load_dwordx4 v0, s[4:7], s42 offen offset:3072 sc1 lds
    v_exp_f32 v69, v69
    v_mfma_f32_16x16x32_bf16 v[24:27], v[152:155], v[52:55], v[24:27]
    v_exp_f32 v70, v70
    v_pk_add_f32 v[68:69], v[68:69], 1.0 op_sel_hi:[1,0]
    v_mfma_f32_16x16x32_bf16 v[28:31], v[156:159], v[52:55], v[28:31]
    v_exp_f32 v71, v71
    v_mfma_f32_16x16x32_bf16 v[20:23], v[172:175], v[56:59], v[20:23]
    s_add_u32 m0, s43, 4096
    s_add_u32 s47, s42, 4096
    buffer_load_dwordx4 v0, s[4:7], s47 offen offset:0 sc1 lds
    s_add_u32 s42, s42, 36864
    s_xor_b32 s43, s43, 32768
    v_rcp_f32 v66, v66
    v_pk_add_f32 v[70:71], v[70:71], 1.0 op_sel_hi:[1,0]
    v_pk_mul_f32 v[72:73], v[16:17], s[50:51]
    v_mfma_f32_16x16x32_bf16 v[24:27], v[176:179], v[56:59], v[24:27]
    v_rcp_f32 v67, v67
    v_mfma_f32_16x16x32_bf16 v[28:31], v[180:183], v[56:59], v[28:31]
    v_exp_f32 v72, v72
    v_pk_mul_f32 v[74:75], v[18:19], s[50:51]
    v_pk_mul_f32 v[10:11], v[10:11], v[66:67]
    v_mfma_f32_16x16x32_bf16 v[20:23], v[196:199], v[60:63], v[20:23]
    buffer_load_dword v5, v4, s[4:7], 0 offen sc1
    v_exp_f32 v73, v73
    v_mfma_f32_16x16x32_bf16 v[24:27], v[200:203], v[60:63], v[24:27]
    v_exp_f32 v74, v74
    v_pk_add_f32 v[72:73], v[72:73], 1.0 op_sel_hi:[1,0]
    v_mfma_f32_16x16x32_bf16 v[28:31], v[204:207], v[60:63], v[28:31]
    v_exp_f32 v75, v75
    v_mfma_f32_16x16x32_bf16 v[20:23], v[220:223], v[32:35], v[20:23]
    v_rcp_f32 v68, v68
    v_pk_add_f32 v[74:75], v[74:75], 1.0 op_sel_hi:[1,0]
    v_mfma_f32_16x16x32_bf16 v[24:27], v[224:227], v[32:35], v[24:27]
    v_rcp_f32 v70, v70
    v_rcp_f32 v69, v69
    v_mfma_f32_16x16x32_bf16 v[28:31], v[228:231], v[32:35], v[28:31]
    v_rcp_f32 v72, v72
    v_rcp_f32 v71, v71
    v_pk_mul_f32 v[12:13], v[12:13], v[68:69]
    v_mfma_f32_16x16x32_bf16 v[20:23], v[244:247], v[36:39], v[20:23]
    ds_read_b32 v77, v76
    v_rcp_f32 v73, v73
    v_pk_mul_f32 v[14:15], v[14:15], v[70:71]
    v_mfma_f32_16x16x32_bf16 v[24:27], v[248:251], v[36:39], v[24:27]
    v_rcp_f32 v75, v75
    v_rcp_f32 v74, v74
    v_pk_mul_f32 v[16:17], v[16:17], v[72:73]
    v_mfma_f32_16x16x32_bf16 v[28:31], v[252:255], v[36:39], v[28:31]
    v_pk_mul_f32 v[18:19], v[18:19], v[74:75]
    v_xor_b32 v3, 32768, v3
    v_pk_mul_f32 v[8:9], v[8:9], v[20:21]
    v_pk_mul_f32 v[10:11], v[10:11], v[22:23]
    v_pk_mul_f32 v[12:13], v[12:13], v[24:25]
    v_pk_mul_f32 v[14:15], v[14:15], v[26:27]
    v_cvt_pk_bf16_f32 v64, v8, v9
    v_cvt_pk_bf16_f32 v65, v10, v11
    v_cvt_pk_bf16_f32 v66, v12, v13
    v_cvt_pk_bf16_f32 v67, v14, v15
    buffer_store_dwordx4 v[64:67], v0, s[4:7], s41 offen sc1
    v_pk_mul_f32 v[16:17], v[16:17], v[28:29]
    v_pk_mul_f32 v[18:19], v[18:19], v[30:31]
    v_cvt_pk_bf16_f32 v72, v16, v17
    v_cvt_pk_bf16_f32 v73, v18, v19
    buffer_store_dwordx2 v[72:73], v6, s[4:7], s41 offen sc1
    s_add_u32 s41, s41, 294912
    s_add_u32 s40, s40, 1
    s_waitcnt lgkmcnt(0)
    v_cmp_ne_u32 vcc, s40, v77
    s_cbranch_vccnz F1_P
    s_waitcnt vmcnt(3)
    s_mov_b32 s46, 1
    s_branch F1_L
F1_E:
    s_endpgm
R_TRIP1:
    s_sub_u32 s38, s26, 29
    s_and_b32 s33, s32, 1
    s_lshr_b32 s32, s32, 1
    s_add_u32 s32, s32, 6
    s_branch R_TRIP2
R_TRIP:
    s_cmp_ge_u32 s26, 3
    s_cselect_b32 s33, 1, 0
    s_cselect_b32 s38, 3, 0
    s_sub_u32 s38, s26, s38
R_TRIP2:
    s_and_b32 s34, s32, 6
    s_add_u32 s34, s34, s33
    s_lshl_b32 s34, s34, 1
    s_and_b32 s32, s32, 1
    s_add_u32 s34, s34, s32
    s_mul_i32 s30, s34, 3
    s_add_u32 s30, s30, s38
    s_add_u32 s30, s30, 48
    s_cmp_eq_u32 s38, 1
    s_cselect_b32 s12, s70, s68
    s_cselect_b32 s13, s71, s69
    s_cmp_eq_u32 s38, 2
    s_cselect_b32 s12, s72, s12
    s_cselect_b32 s13, s73, s13
    s_mov_b32 s14, 4718592
    s_mov_b32 s15, 0x20000
    v_lshrrev_b32 v5, 4, v1
    v_and_b32 v6, 15, v1
    v_lshlrev_b32 v6, 4, v6
    v_lshl_add_u32 v7, v5, 10, v6
    v_lshl_add_u32 v6, v5, 13, v6
    s_lshl_b32 s30, s34, 2
    s_add_u32 s30, s30, s24
    s_mul_i32 s30, s30, 73728
    s_add_u32 s31, s30, 4096
    buffer_load_dwordx4 v[12:15], v7, s[12:15], s30 offen offset:256
    s_add_u32 s30, s30, 4096
    buffer_load_dwordx4 v[16:19], v7, s[12:15], s30 offen offset:256
    s_add_u32 s30, s30, 4096
    buffer_load_dwordx4 v[20:23], v7, s[12:15], s30 offen offset:256
    s_add_u32 s30, s30, 4096
    buffer_load_dwordx4 v[24:27], v7, s[12:15], s30 offen offset:256
    s_add_u32 s30, s30, 4096
    buffer_load_dwordx4 v[28:31], v7, s[12:15], s30 offen offset:256
    s_add_u32 s30, s30, 4096
    buffer_load_dwordx4 v[32:35], v7, s[12:15], s30 offen offset:256
    s_add_u32 s30, s30, 4096
    buffer_load_dwordx4 v[36:39], v7, s[12:15], s30 offen offset:256
    s_add_u32 s30, s30, 4096
    buffer_load_dwordx4 v[40:43], v7, s[12:15], s30 offen offset:256
    s_add_u32 s30, s30, 4096
    buffer_load_dwordx4 v[44:47], v7, s[12:15], s30 offen offset:256
    s_add_u32 s30, s30, 4096
    buffer_load_dwordx4 v[48:51], v7, s[12:15], s30 offen offset:256
    s_add_u32 s30, s30, 4096
    buffer_load_dwordx4 v[52:55], v7, s[12:15], s30 offen offset:256
    s_add_u32 s30, s30, 4096
    buffer_load_dwordx4 v[56:59], v7, s[12:15], s30 offen offset:256
    s_add_u32 s30, s30, 4096
    buffer_load_dwordx4 v[60:63], v7, s[12:15], s30 offen offset:256
    s_add_u32 s30, s30, 4096
    buffer_load_dwordx4 v[64:67], v7, s[12:15], s30 offen offset:256
    s_add_u32 s30, s30, 4096
    buffer_load_dwordx4 v[68:71], v7, s[12:15], s30 offen offset:256
    s_add_u32 s30, s30, 4096
    buffer_load_dwordx4 v[72:75], v7, s[12:15], s30 offen offset:256
    s_add_u32 s30, s30, 4096
    buffer_load_dwordx4 v[76:79], v7, s[12:15], s30 offen offset:256
    s_add_u32 s30, s30, 4096
    buffer_load_dwordx4 v[80:83], v7, s[12:15], s30 offen offset:256
    s_add_u32 s30, s30, 4096
    buffer_load_dwordx4 v[84:87], v6, s[12:15], s31 offen offset:3840
    s_add_u32 s31, s31, 24576
    buffer_load_dwordx4 v[88:91], v6, s[12:15], s31 offen offset:3840
    s_add_u32 s31, s31, 24576
    buffer_load_dwordx4 v[92:95], v6, s[12:15], s31 offen offset:3840
    s_add_u32 s31, s31, 24576
    s_waitcnt vmcnt(0)
    s_bfe_u32 s37, s34, 0x10001
    s_lshr_b32 s36, s34, 2
    s_bitcmp1_b32 s34, 0
    s_cbranch_scc1 R_WO
R_F2:
    s_mov_b32 s12, s84
    s_mov_b32 s13, s85
    s_mov_b32 s14, 0x510000
    s_mov_b32 s15, 0x20000
    v_lshrrev_b32 v7, 2, v1
    v_mul_u32_u24 v8, 1152, v7
    v_and_b32 v6, 3, v1
    v_lshl_add_u32 v8, v6, 4, v8
    v_lshrrev_b32 v5, 4, v1
    v_and_b32 v7, 3, v7
    v_lshl_add_u32 v7, v5, 3, v7
    v_lshlrev_b32 v10, 6, v7
    v_lshl_add_u32 v10, v6, 4, v10
    s_mul_i32 s30, s24, 40960
    v_add_u32 v10, s30, v10
    s_mul_i32 s33, s36, 1327104
    s_mul_i32 s34, s38, 384
    s_add_u32 s33, s33, s34
    s_lshr_b32 s34, s24, 1
    s_lshl_b32 s34, s34, 6
    s_add_u32 s34, s34, s33
    v_add_u32 v9, s34, v8
    s_lshl_b32 s34, s24, 6
    s_add_u32 s34, s34, s33
    v_add_u32 v8, s34, v8
    s_and_b32 s34, s24, 1
    s_lshl_b32 s34, s34, 3
    v_add_u32 v11, s34, v10
    s_mul_i32 s30, s24, 40960
    s_add_u32 m0, s30, 0
    s_mov_b32 s31, 0
    buffer_load_dwordx4 v8, s[12:15], s31 offen lds
    s_add_u32 m0, s30, 1024
    s_mov_b32 s31, 18432
    buffer_load_dwordx4 v8, s[12:15], s31 offen lds
    s_add_u32 m0, s30, 2048
    s_mov_b32 s31, 256
    buffer_load_dwordx4 v9, s[12:15], s31 offen lds
    s_add_u32 m0, s30, 3072
    s_mov_b32 s31, 18688
    buffer_load_dwordx4 v9, s[12:15], s31 offen lds
    s_add_u32 m0, s30, 4096
    s_mov_b32 s31, 36864
    buffer_load_dwordx4 v8, s[12:15], s31 offen lds
    s_add_u32 m0, s30, 5120
    s_mov_b32 s31, 55296
    buffer_load_dwordx4 v8, s[12:15], s31 offen lds
    s_add_u32 m0, s30, 6144
    s_mov_b32 s31, 37120
    buffer_load_dwordx4 v9, s[12:15], s31 offen lds
    s_add_u32 m0, s30, 7168
    s_mov_b32 s31, 55552
    buffer_load_dwordx4 v9, s[12:15], s31 offen lds
    s_add_u32 m0, s30, 8192
    s_mov_b32 s31, 73728
    buffer_load_dwordx4 v8, s[12:15], s31 offen lds
    s_add_u32 m0, s30, 9216
    s_mov_b32 s31, 92160
    buffer_load_dwordx4 v8, s[12:15], s31 offen lds
    s_add_u32 m0, s30, 10240
    s_mov_b32 s31, 73984
    buffer_load_dwordx4 v9, s[12:15], s31 offen lds
    s_add_u32 m0, s30, 11264
    s_mov_b32 s31, 92416
    buffer_load_dwordx4 v9, s[12:15], s31 offen lds
    s_add_u32 m0, s30, 12288
    s_mov_b32 s31, 110592
    buffer_load_dwordx4 v8, s[12:15], s31 offen lds
    s_add_u32 m0, s30, 13312
    s_mov_b32 s31, 129024
    buffer_load_dwordx4 v8, s[12:15], s31 offen lds
    s_add_u32 m0, s30, 14336
    s_mov_b32 s31, 110848
    buffer_load_dwordx4 v9, s[12:15], s31 offen lds
    s_add_u32 m0, s30, 15360
    s_mov_b32 s31, 129280
    buffer_load_dwordx4 v9, s[12:15], s31 offen lds
    s_add_u32 m0, s30, 16384
    s_mov_b32 s31, 147456
    buffer_load_dwordx4 v8, s[12:15], s31 offen lds
    s_add_u32 m0, s30, 17408
    s_mov_b32 s31, 165888
    buffer_load_dwordx4 v8, s[12:15], s31 offen lds
    s_add_u32 m0, s30, 18432
    s_mov_b32 s31, 147712
    buffer_load_dwordx4 v9, s[12:15], s31 offen lds
    s_add_u32 m0, s30, 19456
    s_mov_b32 s31, 166144
    buffer_load_dwordx4 v9, s[12:15], s31 offen lds
    s_add_u32 m0, s30, 20480
    s_mov_b32 s31, 184320
    buffer_load_dwordx4 v8, s[12:15], s31 offen lds
    s_add_u32 m0, s30, 21504
    s_mov_b32 s31, 202752
    buffer_load_dwordx4 v8, s[12:15], s31 offen lds
    s_add_u32 m0, s30, 22528
    s_mov_b32 s31, 184576
    buffer_load_dwordx4 v9, s[12:15], s31 offen lds
    s_add_u32 m0, s30, 23552
    s_mov_b32 s31, 203008
    buffer_load_dwordx4 v9, s[12:15], s31 offen lds
    s_add_u32 m0, s30, 24576
    s_mov_b32 s31, 221184
    buffer_load_dwordx4 v8, s[12:15], s31 offen lds
    s_add_u32 m0, s30, 25600
    s_mov_b32 s31, 239616
    buffer_load_dwordx4 v8, s[12:15], s31 offen lds
    s_add_u32 m0, s30, 26624
    s_mov_b32 s31, 221440
    buffer_load_dwordx4 v9, s[12:15], s31 offen lds
    s_add_u32 m0, s30, 27648
    s_mov_b32 s31, 239872
    buffer_load_dwordx4 v9, s[12:15], s31 offen lds
    s_add_u32 m0, s30, 28672
    s_mov_b32 s31, 258048
    buffer_load_dwordx4 v8, s[12:15], s31 offen lds
    s_add_u32 m0, s30, 29696
    s_mov_b32 s31, 276480
    buffer_load_dwordx4 v8, s[12:15], s31 offen lds
    s_add_u32 m0, s30, 30720
    s_mov_b32 s31, 258304
    buffer_load_dwordx4 v9, s[12:15], s31 offen lds
    s_add_u32 m0, s30, 31744
    s_mov_b32 s31, 276736
    buffer_load_dwordx4 v9, s[12:15], s31 offen lds
    s_add_u32 m0, s30, 32768
    s_mov_b32 s31, 294912
    buffer_load_dwordx4 v8, s[12:15], s31 offen lds
    s_add_u32 m0, s30, 33792
    s_mov_b32 s31, 313344
    buffer_load_dwordx4 v8, s[12:15], s31 offen lds
    s_add_u32 m0, s30, 34816
    s_mov_b32 s31, 295168
    buffer_load_dwordx4 v9, s[12:15], s31 offen lds
    s_add_u32 m0, s30, 35840
    s_mov_b32 s31, 313600
    buffer_load_dwordx4 v9, s[12:15], s31 offen lds
    s_add_u32 m0, s30, 36864
    s_mov_b32 s31, 331776
    buffer_load_dwordx4 v8, s[12:15], s31 offen lds
    s_add_u32 m0, s30, 37888
    s_mov_b32 s31, 350208
    buffer_load_dwordx4 v8, s[12:15], s31 offen lds
    s_add_u32 m0, s30, 38912
    s_mov_b32 s31, 332032
    buffer_load_dwordx4 v9, s[12:15], s31 offen lds
    s_add_u32 m0, s30, 39936
    s_mov_b32 s31, 350464
    buffer_load_dwordx4 v9, s[12:15], s31 offen lds
    s_waitcnt vmcnt(34)
    ds_read_b64_tr_b16 a[0:1], v10 offset:0
    ds_read_b64_tr_b16 a[2:3], v10 offset:256
    ds_read_b64_tr_b16 a[4:5], v10 offset:8
    ds_read_b64_tr_b16 a[6:7], v10 offset:264
    ds_read_b64_tr_b16 a[8:9], v11 offset:2048
    ds_read_b64_tr_b16 a[10:11], v11 offset:2304
    ds_read_b64_tr_b16 a[12:13], v10 offset:4096
    ds_read_b64_tr_b16 a[14:15], v10 offset:4352
    ds_read_b64_tr_b16 a[16:17], v10 offset:4104
    ds_read_b64_tr_b16 a[18:19], v10 offset:4360
    s_waitcnt lgkmcnt(0)
    s_add_u32 m0, s30, 0
    s_mov_b32 s31, 368640
    buffer_load_dwordx4 v8, s[12:15], s31 offen lds
    s_add_u32 m0, s30, 1024
    s_mov_b32 s31, 387072
    buffer_load_dwordx4 v8, s[12:15], s31 offen lds
    s_add_u32 m0, s30, 2048
    s_mov_b32 s31, 368896
    buffer_load_dwordx4 v9, s[12:15], s31 offen lds
    s_add_u32 m0, s30, 3072
    s_mov_b32 s31, 387328
    buffer_load_dwordx4 v9, s[12:15], s31 offen lds
    s_add_u32 m0, s30, 4096
    s_mov_b32 s31, 405504
    buffer_load_dwordx4 v8, s[12:15], s31 offen lds
    s_add_u32 m0, s30, 5120
    s_mov_b32 s31, 423936
    buffer_load_dwordx4 v8, s[12:15], s31 offen lds
    s_waitcnt vmcnt(34)
    ds_read_b64_tr_b16 a[20:21], v11 offset:6144
    ds_read_b64_tr_b16 a[22:23], v11 offset:6400
    ds_read_b64_tr_b16 a[24:25], v10 offset:8192
    ds_read_b64_tr_b16 a[26:27], v10 offset:8448
    ds_read_b64_tr_b16 a[28:29], v10 offset:8200
    ds_read_b64_tr_b16 a[30:31], v10 offset:8456
    ds_read_b64_tr_b16 a[32:33], v11 offset:10240
    ds_read_b64_tr_b16 a[34:35], v11 offset:10496
    s_waitcnt lgkmcnt(0)
    s_add_u32 m0, s30, 6144
    s_mov_b32 s31, 405760
    buffer_load_dwordx4 v9, s[12:15], s31 offen lds
    s_add_u32 m0, s30, 7168
    s_mov_b32 s31, 424192
    buffer_load_dwordx4 v9, s[12:15], s31 offen lds
    s_add_u32 m0, s30, 8192
    s_mov_b32 s31, 442368
    buffer_load_dwordx4 v8, s[12:15], s31 offen lds
    s_add_u32 m0, s30, 9216
    s_mov_b32 s31, 460800
    buffer_load_dwordx4 v8, s[12:15], s31 offen lds
    s_add_u32 m0, s30, 10240
    s_mov_b32 s31, 442624
    buffer_load_dwordx4 v9, s[12:15], s31 offen lds
    s_add_u32 m0, s30, 11264
    s_mov_b32 s31, 461056
    buffer_load_dwordx4 v9, s[12:15], s31 offen lds
    s_waitcnt vmcnt(34)
    ds_read_b64_tr_b16 a[36:37], v10 offset:12288
    ds_read_b64_tr_b16 a[38:39], v10 offset:12544
    ds_read_b64_tr_b16 a[40:41], v10 offset:12296
    ds_read_b64_tr_b16 a[42:43], v10 offset:12552
    ds_read_b64_tr_b16 a[44:45], v11 offset:14336
    ds_read_b64_tr_b16 a[46:47], v11 offset:14592
    ds_read_b64_tr_b16 a[48:49], v10 offset:16384
    ds_read_b64_tr_b16 a[50:51], v10 offset:16640
    ds_read_b64_tr_b16 a[52:53], v10 offset:16392
    ds_read_b64_tr_b16 a[54:55], v10 offset:16648
    s_waitcnt lgkmcnt(0)
    s_add_u32 m0, s30, 12288
    s_mov_b32 s31, 479232
    buffer_load_dwordx4 v8, s[12:15], s31 offen lds
    s_add_u32 m0, s30, 13312
    s_mov_b32 s31, 497664
    buffer_load_dwordx4 v8, s[12:15], s31 offen lds
    s_add_u32 m0, s30, 14336
    s_mov_b32 s31, 479488
    buffer_load_dwordx4 v9, s[12:15], s31 offen lds
    s_add_u32 m0, s30, 15360
    s_mov_b32 s31, 497920
    buffer_load_dwordx4 v9, s[12:15], s31 offen lds
    s_add_u32 m0, s30, 16384
    s_mov_b32 s31, 516096
    buffer_load_dwordx4 v8, s[12:15], s31 offen lds
    s_add_u32 m0, s30, 17408
    s_mov_b32 s31, 534528
    buffer_load_dwordx4 v8, s[12:15], s31 offen lds
    s_waitcnt vmcnt(34)
    ds_read_b64_tr_b16 a[56:57], v11 offset:18432
    ds_read_b64_tr_b16 a[58:59], v11 offset:18688
    ds_read_b64_tr_b16 a[60:61], v10 offset:20480
    ds_read_b64_tr_b16 a[62:63], v10 offset:20736
    ds_read_b64_tr_b16 a[64:65], v10 offset:20488
    ds_read_b64_tr_b16 a[66:67], v10 offset:20744
    ds_read_b64_tr_b16 a[68:69], v11 offset:22528
    ds_read_b64_tr_b16 a[70:71], v11 offset:22784
    s_waitcnt lgkmcnt(0)
    s_add_u32 m0, s30, 18432
    s_mov_b32 s31, 516352
    buffer_load_dwordx4 v9, s[12:15], s31 offen lds
    s_add_u32 m0, s30, 19456
    s_mov_b32 s31, 534784
    buffer_load_dwordx4 v9, s[12:15], s31 offen lds
    s_add_u32 m0, s30, 20480
    s_mov_b32 s31, 552960
    buffer_load_dwordx4 v8, s[12:15], s31 offen lds
    s_add_u32 m0, s30, 21504
    s_mov_b32 s31, 571392
    buffer_load_dwordx4 v8, s[12:15], s31 offen lds
    s_add_u32 m0, s30, 22528
    s_mov_b32 s31, 553216
    buffer_load_dwordx4 v9, s[12:15], s31 offen lds
    s_add_u32 m0, s30, 23552
    s_mov_b32 s31, 571648
    buffer_load_dwordx4 v9, s[12:15], s31 offen lds
    s_waitcnt vmcnt(34)
    ds_read_b64_tr_b16 a[72:73], v10 offset:24576
    ds_read_b64_tr_b16 a[74:75], v10 offset:24832
    ds_read_b64_tr_b16 a[76:77], v10 offset:24584
    ds_read_b64_tr_b16 a[78:79], v10 offset:24840
    ds_read_b64_tr_b16 a[80:81], v11 offset:26624
    ds_read_b64_tr_b16 a[82:83], v11 offset:26880
    ds_read_b64_tr_b16 a[84:85], v10 offset:28672
    ds_read_b64_tr_b16 a[86:87], v10 offset:28928
    ds_read_b64_tr_b16 a[88:89], v10 offset:28680
    ds_read_b64_tr_b16 a[90:91], v10 offset:28936
    s_waitcnt lgkmcnt(0)
    s_add_u32 m0, s30, 24576
    s_mov_b32 s31, 589824
    buffer_load_dwordx4 v8, s[12:15], s31 offen lds
    s_add_u32 m0, s30, 25600
    s_mov_b32 s31, 608256
    buffer_load_dwordx4 v8, s[12:15], s31 offen lds
    s_add_u32 m0, s30, 26624
    s_mov_b32 s31, 590080
    buffer_load_dwordx4 v9, s[12:15], s31 offen lds
    s_add_u32 m0, s30, 27648
    s_mov_b32 s31, 608512
    buffer_load_dwordx4 v9, s[12:15], s31 offen lds
    s_add_u32 m0, s30, 28672
    s_mov_b32 s31, 626688
    buffer_load_dwordx4 v8, s[12:15], s31 offen lds
    s_add_u32 m0, s30, 29696
    s_mov_b32 s31, 645120
    buffer_load_dwordx4 v8, s[12:15], s31 offen lds
    s_waitcnt vmcnt(34)
    ds_read_b64_tr_b16 a[92:93], v11 offset:30720
    ds_read_b64_tr_b16 a[94:95], v11 offset:30976
    ds_read_b64_tr_b16 a[96:97], v10 offset:32768
    ds_read_b64_tr_b16 a[98:99], v10 offset:33024
    ds_read_b64_tr_b16 a[100:101], v10 offset:32776
    ds_read_b64_tr_b16 a[102:103], v10 offset:33032
    ds_read_b64_tr_b16 a[104:105], v11 offset:34816
    ds_read_b64_tr_b16 a[106:107], v11 offset:35072
    s_waitcnt lgkmcnt(0)
    s_add_u32 m0, s30, 30720
    s_mov_b32 s31, 626944
    buffer_load_dwordx4 v9, s[12:15], s31 offen lds
    s_add_u32 m0, s30, 31744
    s_mov_b32 s31, 645376
    buffer_load_dwordx4 v9, s[12:15], s31 offen lds
    s_add_u32 m0, s30, 32768
    s_mov_b32 s31, 663552
    buffer_load_dwordx4 v8, s[12:15], s31 offen lds
    s_add_u32 m0, s30, 33792
    s_mov_b32 s31, 681984
    buffer_load_dwordx4 v8, s[12:15], s31 offen lds
    s_add_u32 m0, s30, 34816
    s_mov_b32 s31, 663808
    buffer_load_dwordx4 v9, s[12:15], s31 offen lds
    s_add_u32 m0, s30, 35840
    s_mov_b32 s31, 682240
    buffer_load_dwordx4 v9, s[12:15], s31 offen lds
    s_waitcnt vmcnt(34)
    ds_read_b64_tr_b16 a[108:109], v10 offset:36864
    ds_read_b64_tr_b16 a[110:111], v10 offset:37120
    ds_read_b64_tr_b16 a[112:113], v10 offset:36872
    ds_read_b64_tr_b16 a[114:115], v10 offset:37128
    ds_read_b64_tr_b16 a[116:117], v11 offset:38912
    ds_read_b64_tr_b16 a[118:119], v11 offset:39168
    ds_read_b64_tr_b16 a[120:121], v10 offset:0
    ds_read_b64_tr_b16 a[122:123], v10 offset:256
    ds_read_b64_tr_b16 a[124:125], v10 offset:8
    ds_read_b64_tr_b16 a[126:127], v10 offset:264
    s_waitcnt lgkmcnt(0)
    s_add_u32 m0, s30, 36864
    s_mov_b32 s31, 700416
    buffer_load_dwordx4 v8, s[12:15], s31 offen lds
    s_add_u32 m0, s30, 37888
    s_mov_b32 s31, 718848
    buffer_load_dwordx4 v8, s[12:15], s31 offen lds
    s_add_u32 m0, s30, 38912
    s_mov_b32 s31, 700672
    buffer_load_dwordx4 v9, s[12:15], s31 offen lds
    s_add_u32 m0, s30, 39936
    s_mov_b32 s31, 719104
    buffer_load_dwordx4 v9, s[12:15], s31 offen lds
    s_add_u32 m0, s30, 0
    s_mov_b32 s31, 737280
    buffer_load_dwordx4 v8, s[12:15], s31 offen lds
    s_add_u32 m0, s30, 1024
    s_mov_b32 s31, 755712
    buffer_load_dwordx4 v8, s[12:15], s31 offen lds
    s_waitcnt vmcnt(34)
    ds_read_b64_tr_b16 a[128:129], v11 offset:2048
    ds_read_b64_tr_b16 a[130:131], v11 offset:2304
    ds_read_b64_tr_b16 a[132:133], v10 offset:4096
    ds_read_b64_tr_b16 a[134:135], v10 offset:4352
    ds_read_b64_tr_b16 a[136:137], v10 offset:4104
    ds_read_b64_tr_b16 a[138:139], v10 offset:4360
    ds_read_b64_tr_b16 a[140:141], v11 offset:6144
    ds_read_b64_tr_b16 a[142:143], v11 offset:6400
    s_waitcnt lgkmcnt(0)
    s_add_u32 m0, s30, 2048
    s_mov_b32 s31, 737536
    buffer_load_dwordx4 v9, s[12:15], s31 offen lds
    s_add_u32 m0, s30, 3072
    s_mov_b32 s31, 755968
    buffer_load_dwordx4 v9, s[12:15], s31 offen lds
    s_add_u32 m0, s30, 4096
    s_mov_b32 s31, 774144
    buffer_load_dwordx4 v8, s[12:15], s31 offen lds
    s_add_u32 m0, s30, 5120
    s_mov_b32 s31, 792576
    buffer_load_dwordx4 v8, s[12:15], s31 offen lds
    s_add_u32 m0, s30, 6144
    s_mov_b32 s31, 774400
    buffer_load_dwordx4 v9, s[12:15], s31 offen lds
    s_add_u32 m0, s30, 7168
    s_mov_b32 s31, 792832
    buffer_load_dwordx4 v9, s[12:15], s31 offen lds
    s_waitcnt vmcnt(34)
    ds_read_b64_tr_b16 a[144:145], v10 offset:8192
    ds_read_b64_tr_b16 a[146:147], v10 offset:8448
    ds_read_b64_tr_b16 a[148:149], v10 offset:8200
    ds_read_b64_tr_b16 a[150:151], v10 offset:8456
    ds_read_b64_tr_b16 a[152:153], v11 offset:10240
    ds_read_b64_tr_b16 a[154:155], v11 offset:10496
    ds_read_b64_tr_b16 a[156:157], v10 offset:12288
    ds_read_b64_tr_b16 a[158:159], v10 offset:12544
    ds_read_b64_tr_b16 a[160:161], v10 offset:12296
    ds_read_b64_tr_b16 a[162:163], v10 offset:12552
    s_waitcnt lgkmcnt(0)
    s_add_u32 m0, s30, 8192
    s_mov_b32 s31, 811008
    buffer_load_dwordx4 v8, s[12:15], s31 offen lds
    s_add_u32 m0, s30, 9216
    s_mov_b32 s31, 829440
    buffer_load_dwordx4 v8, s[12:15], s31 offen lds
    s_add_u32 m0, s30, 10240
    s_mov_b32 s31, 811264
    buffer_load_dwordx4 v9, s[12:15], s31 offen lds
    s_add_u32 m0, s30, 11264
    s_mov_b32 s31, 829696
    buffer_load_dwordx4 v9, s[12:15], s31 offen lds
    s_add_u32 m0, s30, 12288
    s_mov_b32 s31, 847872
    buffer_load_dwordx4 v8, s[12:15], s31 offen lds
    s_add_u32 m0, s30, 13312
    s_mov_b32 s31, 866304
    buffer_load_dwordx4 v8, s[12:15], s31 offen lds
    s_waitcnt vmcnt(34)
    ds_read_b64_tr_b16 a[164:165], v11 offset:14336
    ds_read_b64_tr_b16 a[166:167], v11 offset:14592
    ds_read_b64_tr_b16 a[168:169], v10 offset:16384
    ds_read_b64_tr_b16 a[170:171], v10 offset:16640
    ds_read_b64_tr_b16 a[172:173], v10 offset:16392
    ds_read_b64_tr_b16 a[174:175], v10 offset:16648
    ds_read_b64_tr_b16 a[176:177], v11 offset:18432
    ds_read_b64_tr_b16 a[178:179], v11 offset:18688
    s_waitcnt lgkmcnt(0)
    s_add_u32 m0, s30, 14336
    s_mov_b32 s31, 848128
    buffer_load_dwordx4 v9, s[12:15], s31 offen lds
    s_add_u32 m0, s30, 15360
    s_mov_b32 s31, 866560
    buffer_load_dwordx4 v9, s[12:15], s31 offen lds
    s_add_u32 m0, s30, 16384
    s_mov_b32 s31, 884736
    buffer_load_dwordx4 v8, s[12:15], s31 offen lds
    s_add_u32 m0, s30, 17408
    s_mov_b32 s31, 903168
    buffer_load_dwordx4 v8, s[12:15], s31 offen lds
    s_add_u32 m0, s30, 18432
    s_mov_b32 s31, 884992
    buffer_load_dwordx4 v9, s[12:15], s31 offen lds
    s_add_u32 m0, s30, 19456
    s_mov_b32 s31, 903424
    buffer_load_dwordx4 v9, s[12:15], s31 offen lds
    s_waitcnt vmcnt(34)
    ds_read_b64_tr_b16 a[180:181], v10 offset:20480
    ds_read_b64_tr_b16 a[182:183], v10 offset:20736
    ds_read_b64_tr_b16 a[184:185], v10 offset:20488
    ds_read_b64_tr_b16 a[186:187], v10 offset:20744
    ds_read_b64_tr_b16 a[188:189], v11 offset:22528
    ds_read_b64_tr_b16 a[190:191], v11 offset:22784
    ds_read_b64_tr_b16 a[192:193], v10 offset:24576
    ds_read_b64_tr_b16 a[194:195], v10 offset:24832
    ds_read_b64_tr_b16 a[196:197], v10 offset:24584
    ds_read_b64_tr_b16 a[198:199], v10 offset:24840
    s_waitcnt lgkmcnt(0)
    s_add_u32 m0, s30, 20480
    s_mov_b32 s31, 921600
    buffer_load_dwordx4 v8, s[12:15], s31 offen lds
    s_add_u32 m0, s30, 21504
    s_mov_b32 s31, 940032
    buffer_load_dwordx4 v8, s[12:15], s31 offen lds
    s_add_u32 m0, s30, 22528
    s_mov_b32 s31, 921856
    buffer_load_dwordx4 v9, s[12:15], s31 offen lds
    s_add_u32 m0, s30, 23552
    s_mov_b32 s31, 940288
    buffer_load_dwordx4 v9, s[12:15], s31 offen lds
    s_add_u32 m0, s30, 24576
    s_mov_b32 s31, 958464
    buffer_load_dwordx4 v8, s[12:15], s31 offen lds
    s_add_u32 m0, s30, 25600
    s_mov_b32 s31, 976896
    buffer_load_dwordx4 v8, s[12:15], s31 offen lds
    s_waitcnt vmcnt(34)
    ds_read_b64_tr_b16 a[200:201], v11 offset:26624
    ds_read_b64_tr_b16 a[202:203], v11 offset:26880
    ds_read_b64_tr_b16 a[204:205], v10 offset:28672
    ds_read_b64_tr_b16 a[206:207], v10 offset:28928
    ds_read_b64_tr_b16 a[208:209], v10 offset:28680
    ds_read_b64_tr_b16 a[210:211], v10 offset:28936
    ds_read_b64_tr_b16 a[212:213], v11 offset:30720
    ds_read_b64_tr_b16 a[214:215], v11 offset:30976
    s_waitcnt lgkmcnt(0)
    s_add_u32 m0, s30, 26624
    s_mov_b32 s31, 958720
    buffer_load_dwordx4 v9, s[12:15], s31 offen lds
    s_add_u32 m0, s30, 27648
    s_mov_b32 s31, 977152
    buffer_load_dwordx4 v9, s[12:15], s31 offen lds
    s_add_u32 m0, s30, 28672
    s_mov_b32 s31, 995328
    buffer_load_dwordx4 v8, s[12:15], s31 offen lds
    s_add_u32 m0, s30, 29696
    s_mov_b32 s31, 1013760
    buffer_load_dwordx4 v8, s[12:15], s31 offen lds
    s_add_u32 m0, s30, 30720
    s_mov_b32 s31, 995584
    buffer_load_dwordx4 v9, s[12:15], s31 offen lds
    s_add_u32 m0, s30, 31744
    s_mov_b32 s31, 1014016
    buffer_load_dwordx4 v9, s[12:15], s31 offen lds
    s_waitcnt vmcnt(34)
    ds_read_b64_tr_b16 a[216:217], v10 offset:32768
    ds_read_b64_tr_b16 a[218:219], v10 offset:33024
    ds_read_b64_tr_b16 a[220:221], v10 offset:32776
    ds_read_b64_tr_b16 a[222:223], v10 offset:33032
    ds_read_b64_tr_b16 a[224:225], v11 offset:34816
    ds_read_b64_tr_b16 a[226:227], v11 offset:35072
    ds_read_b64_tr_b16 a[228:229], v10 offset:36864
    ds_read_b64_tr_b16 a[230:231], v10 offset:37120
    ds_read_b64_tr_b16 a[232:233], v10 offset:36872
    ds_read_b64_tr_b16 a[234:235], v10 offset:37128
    s_waitcnt lgkmcnt(0)
    s_add_u32 m0, s30, 32768
    s_mov_b32 s31, 1032192
    buffer_load_dwordx4 v8, s[12:15], s31 offen lds
    s_add_u32 m0, s30, 33792
    s_mov_b32 s31, 1050624
    buffer_load_dwordx4 v8, s[12:15], s31 offen lds
    s_add_u32 m0, s30, 34816
    s_mov_b32 s31, 1032448
    buffer_load_dwordx4 v9, s[12:15], s31 offen lds
    s_add_u32 m0, s30, 35840
    s_mov_b32 s31, 1050880
    buffer_load_dwordx4 v9, s[12:15], s31 offen lds
    s_add_u32 m0, s30, 36864
    s_mov_b32 s31, 1069056
    buffer_load_dwordx4 v8, s[12:15], s31 offen lds
    s_add_u32 m0, s30, 37888
    s_mov_b32 s31, 1087488
    buffer_load_dwordx4 v8, s[12:15], s31 offen lds
    s_waitcnt vmcnt(34)
    ds_read_b64_tr_b16 a[236:237], v11 offset:38912
    ds_read_b64_tr_b16 a[238:239], v11 offset:39168
    ds_read_b64_tr_b16 a[240:241], v10 offset:0
    ds_read_b64_tr_b16 a[242:243], v10 offset:256
    ds_read_b64_tr_b16 a[244:245], v10 offset:8
    ds_read_b64_tr_b16 a[246:247], v10 offset:264
    ds_read_b64_tr_b16 a[248:249], v11 offset:2048
    ds_read_b64_tr_b16 a[250:251], v11 offset:2304
    s_waitcnt lgkmcnt(0)
    s_add_u32 m0, s30, 38912
    s_mov_b32 s31, 1069312
    buffer_load_dwordx4 v9, s[12:15], s31 offen lds
    s_add_u32 m0, s30, 39936
    s_mov_b32 s31, 1087744
    buffer_load_dwordx4 v9, s[12:15], s31 offen lds
    s_add_u32 m0, s30, 0
    s_mov_b32 s31, 1105920
    buffer_load_dwordx4 v8, s[12:15], s31 offen lds
    s_add_u32 m0, s30, 1024
    s_mov_b32 s31, 1124352
    buffer_load_dwordx4 v8, s[12:15], s31 offen lds
    s_add_u32 m0, s30, 2048
    s_mov_b32 s31, 1106176
    buffer_load_dwordx4 v9, s[12:15], s31 offen lds
    s_add_u32 m0, s30, 3072
    s_mov_b32 s31, 1124608
    buffer_load_dwordx4 v9, s[12:15], s31 offen lds
    s_waitcnt vmcnt(34)
    ds_read_b64_tr_b16 a[252:253], v10 offset:4096
    ds_read_b64_tr_b16 a[254:255], v10 offset:4352
    ds_read_b64_tr_b16 v[80:81], v10 offset:4104
    ds_read_b64_tr_b16 v[82:83], v10 offset:4360
    ds_read_b64_tr_b16 v[84:85], v11 offset:6144
    ds_read_b64_tr_b16 v[86:87], v11 offset:6400
    ds_read_b64_tr_b16 v[88:89], v10 offset:8192
    ds_read_b64_tr_b16 v[90:91], v10 offset:8448
    ds_read_b64_tr_b16 v[92:93], v10 offset:8200
    ds_read_b64_tr_b16 v[94:95], v10 offset:8456
    s_waitcnt lgkmcnt(0)
    s_add_u32 m0, s30, 4096
    s_mov_b32 s31, 1142784
    buffer_load_dwordx4 v8, s[12:15], s31 offen lds
    s_add_u32 m0, s30, 5120
    s_mov_b32 s31, 1161216
    buffer_load_dwordx4 v8, s[12:15], s31 offen lds
    s_add_u32 m0, s30, 6144
    s_mov_b32 s31, 1143040
    buffer_load_dwordx4 v9, s[12:15], s31 offen lds
    s_add_u32 m0, s30, 7168
    s_mov_b32 s31, 1161472
    buffer_load_dwordx4 v9, s[12:15], s31 offen lds
    s_add_u32 m0, s30, 8192
    s_mov_b32 s31, 1179648
    buffer_load_dwordx4 v8, s[12:15], s31 offen lds
    s_add_u32 m0, s30, 9216
    s_mov_b32 s31, 1198080
    buffer_load_dwordx4 v8, s[12:15], s31 offen lds
    s_waitcnt vmcnt(34)
    ds_read_b64_tr_b16 v[96:97], v11 offset:10240
    ds_read_b64_tr_b16 v[98:99], v11 offset:10496
    ds_read_b64_tr_b16 v[100:101], v10 offset:12288
    ds_read_b64_tr_b16 v[102:103], v10 offset:12544
    ds_read_b64_tr_b16 v[104:105], v10 offset:12296
    ds_read_b64_tr_b16 v[106:107], v10 offset:12552
    ds_read_b64_tr_b16 v[108:109], v11 offset:14336
    ds_read_b64_tr_b16 v[110:111], v11 offset:14592
    s_waitcnt lgkmcnt(0)
    s_add_u32 m0, s30, 10240
    s_mov_b32 s31, 1179904
    buffer_load_dwordx4 v9, s[12:15], s31 offen lds
    s_add_u32 m0, s30, 11264
    s_mov_b32 s31, 1198336
    buffer_load_dwordx4 v9, s[12:15], s31 offen lds
    s_add_u32 m0, s30, 12288
    s_mov_b32 s31, 1216512
    buffer_load_dwordx4 v8, s[12:15], s31 offen lds
    s_add_u32 m0, s30, 13312
    s_mov_b32 s31, 1234944
    buffer_load_dwordx4 v8, s[12:15], s31 offen lds
    s_add_u32 m0, s30, 14336
    s_mov_b32 s31, 1216768
    buffer_load_dwordx4 v9, s[12:15], s31 offen lds
    s_add_u32 m0, s30, 15360
    s_mov_b32 s31, 1235200
    buffer_load_dwordx4 v9, s[12:15], s31 offen lds
    s_waitcnt vmcnt(34)
    ds_read_b64_tr_b16 v[112:113], v10 offset:16384
    ds_read_b64_tr_b16 v[114:115], v10 offset:16640
    ds_read_b64_tr_b16 v[116:117], v10 offset:16392
    ds_read_b64_tr_b16 v[118:119], v10 offset:16648
    ds_read_b64_tr_b16 v[120:121], v11 offset:18432
    ds_read_b64_tr_b16 v[122:123], v11 offset:18688
    ds_read_b64_tr_b16 v[124:125], v10 offset:20480
    ds_read_b64_tr_b16 v[126:127], v10 offset:20736
    ds_read_b64_tr_b16 v[128:129], v10 offset:20488
    ds_read_b64_tr_b16 v[130:131], v10 offset:20744
    s_waitcnt lgkmcnt(0)
    s_add_u32 m0, s30, 16384
    s_mov_b32 s31, 1253376
    buffer_load_dwordx4 v8, s[12:15], s31 offen lds
    s_add_u32 m0, s30, 17408
    s_mov_b32 s31, 1271808
    buffer_load_dwordx4 v8, s[12:15], s31 offen lds
    s_add_u32 m0, s30, 18432
    s_mov_b32 s31, 1253632
    buffer_load_dwordx4 v9, s[12:15], s31 offen lds
    s_add_u32 m0, s30, 19456
    s_mov_b32 s31, 1272064
    buffer_load_dwordx4 v9, s[12:15], s31 offen lds
    s_add_u32 m0, s30, 20480
    s_mov_b32 s31, 1290240
    buffer_load_dwordx4 v8, s[12:15], s31 offen lds
    s_add_u32 m0, s30, 21504
    s_mov_b32 s31, 1308672
    buffer_load_dwordx4 v8, s[12:15], s31 offen lds
    s_waitcnt vmcnt(34)
    ds_read_b64_tr_b16 v[132:133], v11 offset:22528
    ds_read_b64_tr_b16 v[134:135], v11 offset:22784
    ds_read_b64_tr_b16 v[136:137], v10 offset:24576
    ds_read_b64_tr_b16 v[138:139], v10 offset:24832
    ds_read_b64_tr_b16 v[140:141], v10 offset:24584
    ds_read_b64_tr_b16 v[142:143], v10 offset:24840
    ds_read_b64_tr_b16 v[144:145], v11 offset:26624
    ds_read_b64_tr_b16 v[146:147], v11 offset:26880
    s_waitcnt lgkmcnt(0)
    s_add_u32 m0, s30, 22528
    s_mov_b32 s31, 1290496
    buffer_load_dwordx4 v9, s[12:15], s31 offen lds
    s_add_u32 m0, s30, 23552
    s_mov_b32 s31, 1308928
    buffer_load_dwordx4 v9, s[12:15], s31 offen lds
    s_waitcnt vmcnt(30)
    ds_read_b64_tr_b16 v[148:149], v10 offset:28672
    ds_read_b64_tr_b16 v[150:151], v10 offset:28928
    ds_read_b64_tr_b16 v[152:153], v10 offset:28680
    ds_read_b64_tr_b16 v[154:155], v10 offset:28936
    ds_read_b64_tr_b16 v[156:157], v11 offset:30720
    ds_read_b64_tr_b16 v[158:159], v11 offset:30976
    ds_read_b64_tr_b16 v[160:161], v10 offset:32768
    ds_read_b64_tr_b16 v[162:163], v10 offset:33024
    ds_read_b64_tr_b16 v[164:165], v10 offset:32776
    ds_read_b64_tr_b16 v[166:167], v10 offset:33032
    s_waitcnt vmcnt(24) lgkmcnt(0)
    ds_read_b64_tr_b16 v[168:169], v11 offset:34816
    ds_read_b64_tr_b16 v[170:171], v11 offset:35072
    ds_read_b64_tr_b16 v[172:173], v10 offset:36864
    ds_read_b64_tr_b16 v[174:175], v10 offset:37120
    ds_read_b64_tr_b16 v[176:177], v10 offset:36872
    ds_read_b64_tr_b16 v[178:179], v10 offset:37128
    ds_read_b64_tr_b16 v[180:181], v11 offset:38912
    ds_read_b64_tr_b16 v[182:183], v11 offset:39168
    s_waitcnt vmcnt(18) lgkmcnt(0)
    ds_read_b64_tr_b16 v[184:185], v10 offset:0
    ds_read_b64_tr_b16 v[186:187], v10 offset:256
    ds_read_b64_tr_b16 v[188:189], v10 offset:8
    ds_read_b64_tr_b16 v[190:191], v10 offset:264
    ds_read_b64_tr_b16 v[192:193], v11 offset:2048
    ds_read_b64_tr_b16 v[194:195], v11 offset:2304
    ds_read_b64_tr_b16 v[196:197], v10 offset:4096
    ds_read_b64_tr_b16 v[198:199], v10 offset:4352
    ds_read_b64_tr_b16 v[200:201], v10 offset:4104
    ds_read_b64_tr_b16 v[202:203], v10 offset:4360
    s_waitcnt vmcnt(12) lgkmcnt(0)
    ds_read_b64_tr_b16 v[204:205], v11 offset:6144
    ds_read_b64_tr_b16 v[206:207], v11 offset:6400
    ds_read_b64_tr_b16 v[208:209], v10 offset:8192
    ds_read_b64_tr_b16 v[210:211], v10 offset:8448
    ds_read_b64_tr_b16 v[212:213], v10 offset:8200
    ds_read_b64_tr_b16 v[214:215], v10 offset:8456
    ds_read_b64_tr_b16 v[216:217], v11 offset:10240
    ds_read_b64_tr_b16 v[218:219], v11 offset:10496
    s_waitcnt vmcnt(6) lgkmcnt(0)
    ds_read_b64_tr_b16 v[220:221], v10 offset:12288
    ds_read_b64_tr_b16 v[222:223], v10 offset:12544
    ds_read_b64_tr_b16 v[224:225], v10 offset:12296
    ds_read_b64_tr_b16 v[226:227], v10 offset:12552
    ds_read_b64_tr_b16 v[228:229], v11 offset:14336
    ds_read_b64_tr_b16 v[230:231], v11 offset:14592
    ds_read_b64_tr_b16 v[232:233], v10 offset:16384
    ds_read_b64_tr_b16 v[234:235], v10 offset:16640
    ds_read_b64_tr_b16 v[236:237], v10 offset:16392
    ds_read_b64_tr_b16 v[238:239], v10 offset:16648
    s_waitcnt vmcnt(0) lgkmcnt(0)
    ds_read_b64_tr_b16 v[240:241], v11 offset:18432
    ds_read_b64_tr_b16 v[242:243], v11 offset:18688
    ds_read_b64_tr_b16 v[244:245], v10 offset:20480
    ds_read_b64_tr_b16 v[246:247], v10 offset:20736
    ds_read_b64_tr_b16 v[248:249], v10 offset:20488
    ds_read_b64_tr_b16 v[250:251], v10 offset:20744
    ds_read_b64_tr_b16 v[252:253], v11 offset:22528
    ds_read_b64_tr_b16 v[254:255], v11 offset:22784
    s_waitcnt lgkmcnt(0)
    v_mov_b32 v6, 244
    s_mov_b32 s27, 0
SP_8:
    buffer_load_dword v7, v6, s[8:11], 0 offen sc1
    s_waitcnt vmcnt(0)
    v_cmp_gt_u32 vcc, 18, v7
    s_cbranch_vccz SD_9
    s_add_u32 s27, s27, 1
    s_cmp_lt_u32 s27, 400000
    s_cbranch_scc1 SP_8
    s_movk_i32 s27, 1
    s_branch FAIL
SD_9:
    s_mov_b32 s40, 0
    s_mul_i32 s33, s37, 4
    s_add_u32 s33, s33, s36
    s_mul_i32 s41, s33, 18432
    s_mul_i32 s34, s38, 6144
    s_add_u32 s41, s41, s34
    s_lshl_b32 s34, s24, 10
    s_add_u32 s41, s41, s34
    s_add_u32 s41, s41, 0x9000000
    s_lshl_b32 s34, s24, 9
    s_sub_u32 s34, 4096, s34
    v_lshlrev_b32 v6, 3, v1
    v_add_u32 v6, s34, v6
    s_lshl_b32 s33, s33, 2
    s_add_u32 s33, s33, s24
    s_mul_i32 s42, s33, 9216
    s_add_u32 s42, s42, 0x6000000
    s_lshl_b32 s33, s36, 2
    s_add_u32 s33, s33, s24
    s_lshl_b32 s34, s37, 2
    s_add_u32 s34, s34, s38
    s_lshl_b32 s34, s34, 4
    s_add_u32 s45, s34, s33
    s_add_u32 s45, s45, 4032
    s_lshl_b32 s45, s45, 7
    s_mul_i32 s33, s33, 6
    s_and_b32 s33, s33, -4
    s_mul_i32 s34, s37, 160
    s_add_u32 s33, s33, s34
    s_add_u32 s33, s33, 3712
    v_min_u32 v4, 7, v1
    v_add_u32 v4, s33, v4
    v_lshlrev_b32 v4, 7, v4
    v_lshlrev_b32 v0, 4, v1
    v_mov_b32 v60, 0xff81ff81
    v_mov_b32 v61, 0xff81ff81
    v_mov_b32 v62, 0xff81ff81
    v_mov_b32 v63, 0xff81ff81
    s_add_u32 s34, s41, 9289728
    buffer_store_dwordx4 v[60:63], v0, s[4:7], s34 offen sc1
    buffer_store_dwordx2 v[60:61], v6, s[4:7], s34 offen sc1
    v_lshlrev_b32 v0, 4, v1
    v_mov_b32 v3, v0
    v_mov_b32 v5, 0
    s_mul_i32 s43, s24, 9216
    s_mov_b32 s46, 0
    v_and_b32 v76, 3, v1
    v_cmp_eq_u32 s[54:55], s24, v76
    v_lshlrev_b32 v76, 2, v76
    v_add_u32 v76, 0x20000, v76
    s_barrier
    ds_write_b32 v76, v5
F2_S:
    s_add_u32 s48, s40, 1
    s_mov_b32 s27, 0
SP_10:
    buffer_load_dword v5, v4, s[4:7], 0 offen sc1
    s_waitcnt vmcnt(0)
    v_cmp_gt_u32 vcc, s48, v5
    s_cbranch_vccz SD_11
    s_add_u32 s27, s27, 1
    s_cmp_lt_u32 s27, 400000
    s_cbranch_scc1 SP_10
    s_movk_i32 s27, 20
    s_branch FAIL
SD_11:
F2_D:
    s_add_u32 m0, s43, 0
    s_nop 0
    buffer_load_dwordx4 v0, s[4:7], s42 offen offset:0 sc1 lds
    buffer_load_dwordx4 v0, s[4:7], s42 offen offset:1024 sc1 lds
    buffer_load_dwordx4 v0, s[4:7], s42 offen offset:2048 sc1 lds
    buffer_load_dwordx4 v0, s[4:7], s42 offen offset:3072 sc1 lds
    s_add_u32 m0, s43, 4096
    s_add_u32 s47, s42, 4096
    buffer_load_dwordx4 v0, s[4:7], s47 offen offset:0 sc1 lds
    buffer_load_dwordx4 v0, s[4:7], s47 offen offset:1024 sc1 lds
    buffer_load_dwordx4 v0, s[4:7], s47 offen offset:2048 sc1 lds
    buffer_load_dwordx4 v0, s[4:7], s47 offen offset:3072 sc1 lds
    s_add_u32 m0, s43, 8192
    s_add_u32 s47, s42, 8192
    buffer_load_dwordx4 v0, s[4:7], s47 offen offset:0 sc1 lds
    s_add_u32 s42, s42, 294912
    s_xor_b32 s43, s43, 65536
    s_waitcnt vmcnt(0)
F2_L:
    s_barrier
    ds_read_b128 v[20:23], v3 offset:0
    ds_read_b128 v[24:27], v3 offset:1024
    ds_read_b128 v[28:31], v3 offset:2048
    ds_read_b128 v[32:35], v3 offset:3072
    ds_read_b128 v[36:39], v3 offset:4096
    ds_read_b128 v[40:43], v3 offset:5120
    s_add_u32 s44, s40, 1
    s_cmp_lt_u32 s44, 64
    s_cselect_b32 s44, s44, -1
    v_cmp_ge_u32 vcc, s44, v5
    s_cbranch_vccz F2_V0
    buffer_load_dword v5, v4, s[4:7], 0 offen sc1
    s_waitcnt lgkmcnt(5)
    v_mfma_f32_16x16x32_bf16 v[8:11], a[0:3], v[20:23], 0
    ds_read_b128 v[44:47], v3 offset:6144
    v_mfma_f32_16x16x32_bf16 v[12:15], a[4:7], v[20:23], 0
    v_mfma_f32_16x16x32_bf16 v[16:19], a[8:11], v[20:23], 0
    s_waitcnt lgkmcnt(5)
    v_mfma_f32_16x16x32_bf16 v[8:11], a[12:15], v[24:27], v[8:11]
    ds_read_b128 v[48:51], v3 offset:7168
    v_mfma_f32_16x16x32_bf16 v[12:15], a[16:19], v[24:27], v[12:15]
    v_mfma_f32_16x16x32_bf16 v[16:19], a[20:23], v[24:27], v[16:19]
    s_waitcnt lgkmcnt(5)
    v_mfma_f32_16x16x32_bf16 v[8:11], a[24:27], v[28:31], v[8:11]
    ds_read_b128 v[20:23], v3 offset:8192
    v_mfma_f32_16x16x32_bf16 v[12:15], a[28:31], v[28:31], v[12:15]
    v_mfma_f32_16x16x32_bf16 v[16:19], a[32:35], v[28:31], v[16:19]
    s_waitcnt lgkmcnt(5)
    v_mfma_f32_16x16x32_bf16 v[8:11], a[36:39], v[32:35], v[8:11]
    ds_read_b128 v[24:27], v3 offset:9216
    v_mfma_f32_16x16x32_bf16 v[12:15], a[40:43], v[32:35], v[12:15]
    v_mfma_f32_16x16x32_bf16 v[16:19], a[44:47], v[32:35], v[16:19]
    s_waitcnt lgkmcnt(5)
    v_mfma_f32_16x16x32_bf16 v[8:11], a[48:51], v[36:39], v[8:11]
    ds_read_b128 v[28:31], v3 offset:10240
    v_mfma_f32_16x16x32_bf16 v[12:15], a[52:55], v[36:39], v[12:15]
    v_mfma_f32_16x16x32_bf16 v[16:19], a[56:59], v[36:39], v[16:19]
    s_waitcnt lgkmcnt(5)
    v_mfma_f32_16x16x32_bf16 v[8:11], a[60:63], v[40:43], v[8:11]
    ds_read_b128 v[32:35], v3 offset:11264
    v_mfma_f32_16x16x32_bf16 v[12:15], a[64:67], v[40:43], v[12:15]
    v_mfma_f32_16x16x32_bf16 v[16:19], a[68:71], v[40:43], v[16:19]
    s_waitcnt lgkmcnt(5)
    v_mfma_f32_16x16x32_bf16 v[8:11], a[72:75], v[44:47], v[8:11]
    ds_read_b128 v[36:39], v3 offset:12288
    v_mfma_f32_16x16x32_bf16 v[12:15], a[76:79], v[44:47], v[12:15]
    v_mfma_f32_16x16x32_bf16 v[16:19], a[80:83], v[44:47], v[16:19]
    s_waitcnt lgkmcnt(5)
    v_mfma_f32_16x16x32_bf16 v[8:11], a[84:87], v[48:51], v[8:11]
    ds_read_b128 v[40:43], v3 offset:13312
    v_mfma_f32_16x16x32_bf16 v[12:15], a[88:91], v[48:51], v[12:15]
    v_mfma_f32_16x16x32_bf16 v[16:19], a[92:95], v[48:51], v[16:19]
    s_waitcnt lgkmcnt(5)
    v_mfma_f32_16x16x32_bf16 v[8:11], a[96:99], v[20:23], v[8:11]
    ds_read_b128 v[44:47], v3 offset:14336
    v_mfma_f32_16x16x32_bf16 v[12:15], a[100:103], v[20:23], v[12:15]
    v_cmp_ge_u32 vcc, s44, v5
    v_mfma_f32_16x16x32_bf16 v[16:19], a[104:107], v[20:23], v[16:19]
    s_cbranch_vccz F2_V9
    buffer_load_dword v5, v4, s[4:7], 0 offen sc1
    s_waitcnt lgkmcnt(5)
    v_mfma_f32_16x16x32_bf16 v[8:11], a[108:111], v[24:27], v[8:11]
    ds_read_b128 v[48:51], v3 offset:15360
    v_mfma_f32_16x16x32_bf16 v[12:15], a[112:115], v[24:27], v[12:15]
    v_mfma_f32_16x16x32_bf16 v[16:19], a[116:119], v[24:27], v[16:19]
    s_waitcnt lgkmcnt(5)
    v_mfma_f32_16x16x32_bf16 v[8:11], a[120:123], v[28:31], v[8:11]
    ds_read_b128 v[20:23], v3 offset:16384
    v_mfma_f32_16x16x32_bf16 v[12:15], a[124:127], v[28:31], v[12:15]
    s_cmp_eq_u32 s46, 0
    s_cbranch_scc1 NP_12
    s_waitcnt vmcnt(2)
    v_mov_b32 v7, s40
    s_mov_b64 exec, 1
    buffer_store_dword v7, off, s[4:7], s45 sc1
    s_mov_b64 exec, -1
    s_mov_b32 s46, 0
NP_12:
    v_mfma_f32_16x16x32_bf16 v[16:19], a[128:131], v[28:31], v[16:19]
    s_waitcnt lgkmcnt(5)
    v_mfma_f32_16x16x32_bf16 v[8:11], a[132:135], v[32:35], v[8:11]
    ds_read_b128 v[24:27], v3 offset:17408
    v_mfma_f32_16x16x32_bf16 v[12:15], a[136:139], v[32:35], v[12:15]
    v_mfma_f32_16x16x32_bf16 v[16:19], a[140:143], v[32:35], v[16:19]
    s_waitcnt lgkmcnt(5)
    v_mfma_f32_16x16x32_bf16 v[8:11], a[144:147], v[36:39], v[8:11]
    ds_read_b128 v[28:31], v3 offset:18432
    v_mfma_f32_16x16x32_bf16 v[12:15], a[148:151], v[36:39], v[12:15]
    v_mfma_f32_16x16x32_bf16 v[16:19], a[152:155], v[36:39], v[16:19]
    s_waitcnt lgkmcnt(5)
    v_mfma_f32_16x16x32_bf16 v[8:11], a[156:159], v[40:43], v[8:11]
    ds_read_b128 v[32:35], v3 offset:19456
    v_mfma_f32_16x16x32_bf16 v[12:15], a[160:163], v[40:43], v[12:15]
    v_mfma_f32_16x16x32_bf16 v[16:19], a[164:167], v[40:43], v[16:19]
    s_waitcnt lgkmcnt(5)
    v_mfma_f32_16x16x32_bf16 v[8:11], a[168:171], v[44:47], v[8:11]
    ds_read_b128 v[36:39], v3 offset:20480
    v_mfma_f32_16x16x32_bf16 v[12:15], a[172:175], v[44:47], v[12:15]
    v_mfma_f32_16x16x32_bf16 v[16:19], a[176:179], v[44:47], v[16:19]
    s_waitcnt lgkmcnt(5)
    v_mfma_f32_16x16x32_bf16 v[8:11], a[180:183], v[48:51], v[8:11]
    ds_read_b128 v[40:43], v3 offset:21504
    v_mfma_f32_16x16x32_bf16 v[12:15], a[184:187], v[48:51], v[12:15]
    v_mfma_f32_16x16x32_bf16 v[16:19], a[188:191], v[48:51], v[16:19]
    s_waitcnt lgkmcnt(5)
    v_mfma_f32_16x16x32_bf16 v[8:11], a[192:195], v[20:23], v[8:11]
    ds_read_b128 v[44:47], v3 offset:22528
    v_mfma_f32_16x16x32_bf16 v[12:15], a[196:199], v[20:23], v[12:15]
    v_mfma_f32_16x16x32_bf16 v[16:19], a[200:203], v[20:23], v[16:19]
    s_waitcnt lgkmcnt(5)
    v_mfma_f32_16x16x32_bf16 v[8:11], a[204:207], v[24:27], v[8:11]
    ds_read_b128 v[48:51], v3 offset:23552
    v_mfma_f32_16x16x32_bf16 v[12:15], a[208:211], v[24:27], v[12:15]
    v_cmp_ge_u32 vcc, s44, v5
    v_mfma_f32_16x16x32_bf16 v[16:19], a[212:215], v[24:27], v[16:19]
    s_cbranch_vccz F2_V18
    buffer_load_dword v5, v4, s[4:7], 0 offen sc1
    s_waitcnt lgkmcnt(5)
    v_mfma_f32_16x16x32_bf16 v[8:11], a[216:219], v[28:31], v[8:11]
    ds_read_b128 v[20:23], v3 offset:24576
    v_mfma_f32_16x16x32_bf16 v[12:15], a[220:223], v[28:31], v[12:15]
    v_mfma_f32_16x16x32_bf16 v[16:19], a[224:227], v[28:31], v[16:19]
    s_waitcnt lgkmcnt(5)
    v_mfma_f32_16x16x32_bf16 v[8:11], a[228:231], v[32:35], v[8:11]
    ds_read_b128 v[24:27], v3 offset:25600
    v_mfma_f32_16x16x32_bf16 v[12:15], a[232:235], v[32:35], v[12:15]
    v_mfma_f32_16x16x32_bf16 v[16:19], a[236:239], v[32:35], v[16:19]
    s_waitcnt lgkmcnt(5)
    v_mfma_f32_16x16x32_bf16 v[8:11], a[240:243], v[36:39], v[8:11]
    ds_read_b128 v[28:31], v3 offset:26624
    v_mfma_f32_16x16x32_bf16 v[12:15], a[244:247], v[36:39], v[12:15]
    v_mfma_f32_16x16x32_bf16 v[16:19], a[248:251], v[36:39], v[16:19]
    s_waitcnt lgkmcnt(5)
    v_mfma_f32_16x16x32_bf16 v[8:11], a[252:255], v[40:43], v[8:11]
    ds_read_b128 v[32:35], v3 offset:27648
    v_mfma_f32_16x16x32_bf16 v[12:15], v[80:83], v[40:43], v[12:15]
    v_mfma_f32_16x16x32_bf16 v[16:19], v[84:87], v[40:43], v[16:19]
    s_waitcnt lgkmcnt(5)
    v_mfma_f32_16x16x32_bf16 v[8:11], v[88:91], v[44:47], v[8:11]
    ds_read_b128 v[36:39], v3 offset:28672
    v_mfma_f32_16x16x32_bf16 v[12:15], v[92:95], v[44:47], v[12:15]
    v_mfma_f32_16x16x32_bf16 v[16:19], v[96:99], v[44:47], v[16:19]
    s_waitcnt lgkmcnt(5)
    v_mfma_f32_16x16x32_bf16 v[8:11], v[100:103], v[48:51], v[8:11]
    ds_read_b128 v[40:43], v3 offset:29696
    v_mfma_f32_16x16x32_bf16 v[12:15], v[104:107], v[48:51], v[12:15]
    v_mfma_f32_16x16x32_bf16 v[16:19], v[108:111], v[48:51], v[16:19]
    s_waitcnt lgkmcnt(5)
    v_mfma_f32_16x16x32_bf16 v[8:11], v[112:115], v[20:23], v[8:11]
    ds_read_b128 v[44:47], v3 offset:30720
    v_mfma_f32_16x16x32_bf16 v[12:15], v[116:119], v[20:23], v[12:15]
    v_mfma_f32_16x16x32_bf16 v[16:19], v[120:123], v[20:23], v[16:19]
    s_waitcnt lgkmcnt(5)
    v_mfma_f32_16x16x32_bf16 v[8:11], v[124:127], v[24:27], v[8:11]
    ds_read_b128 v[48:51], v3 offset:31744
    v_mfma_f32_16x16x32_bf16 v[12:15], v[128:131], v[24:27], v[12:15]
    v_mfma_f32_16x16x32_bf16 v[16:19], v[132:135], v[24:27], v[16:19]
    s_waitcnt lgkmcnt(5)
    v_mfma_f32_16x16x32_bf16 v[8:11], v[136:139], v[28:31], v[8:11]
    ds_read_b128 v[20:23], v3 offset:32768
    v_mfma_f32_16x16x32_bf16 v[12:15], v[140:143], v[28:31], v[12:15]
    v_cmp_ge_u32 vcc, s44, v5
    v_mfma_f32_16x16x32_bf16 v[16:19], v[144:147], v[28:31], v[16:19]
    s_cbranch_vccz F2_V27
    buffer_load_dword v5, v4, s[4:7], 0 offen sc1
    s_waitcnt lgkmcnt(5)
    v_mfma_f32_16x16x32_bf16 v[8:11], v[148:151], v[32:35], v[8:11]
    ds_read_b128 v[24:27], v3 offset:33792
    v_mfma_f32_16x16x32_bf16 v[12:15], v[152:155], v[32:35], v[12:15]
    v_mfma_f32_16x16x32_bf16 v[16:19], v[156:159], v[32:35], v[16:19]
    s_waitcnt lgkmcnt(5)
    v_mfma_f32_16x16x32_bf16 v[8:11], v[160:163], v[36:39], v[8:11]
    ds_read_b128 v[28:31], v3 offset:34816
    v_mfma_f32_16x16x32_bf16 v[12:15], v[164:167], v[36:39], v[12:15]
    v_mfma_f32_16x16x32_bf16 v[16:19], v[168:171], v[36:39], v[16:19]
    s_waitcnt lgkmcnt(5)
    v_mfma_f32_16x16x32_bf16 v[8:11], v[172:175], v[40:43], v[8:11]
    ds_read_b128 v[32:35], v3 offset:35840
    v_mfma_f32_16x16x32_bf16 v[12:15], v[176:179], v[40:43], v[12:15]
    v_mfma_f32_16x16x32_bf16 v[16:19], v[180:183], v[40:43], v[16:19]
    s_waitcnt lgkmcnt(5)
    v_mfma_f32_16x16x32_bf16 v[8:11], v[184:187], v[44:47], v[8:11]
    v_mfma_f32_16x16x32_bf16 v[12:15], v[188:191], v[44:47], v[12:15]
    v_mfma_f32_16x16x32_bf16 v[16:19], v[192:195], v[44:47], v[16:19]
    s_waitcnt lgkmcnt(4)
    v_mfma_f32_16x16x32_bf16 v[8:11], v[196:199], v[48:51], v[8:11]
    buffer_load_dword v5, v4, s[4:7], 0 offen sc1
    v_mfma_f32_16x16x32_bf16 v[12:15], v[200:203], v[48:51], v[12:15]
    v_mfma_f32_16x16x32_bf16 v[16:19], v[204:207], v[48:51], v[16:19]
    s_waitcnt lgkmcnt(3)
    v_mfma_f32_16x16x32_bf16 v[8:11], v[208:211], v[20:23], v[8:11]
    v_mfma_f32_16x16x32_bf16 v[12:15], v[212:215], v[20:23], v[12:15]
    v_mfma_f32_16x16x32_bf16 v[16:19], v[216:219], v[20:23], v[16:19]
    s_waitcnt lgkmcnt(2)
    v_mfma_f32_16x16x32_bf16 v[8:11], v[220:223], v[24:27], v[8:11]
    v_mfma_f32_16x16x32_bf16 v[12:15], v[224:227], v[24:27], v[12:15]
    v_mfma_f32_16x16x32_bf16 v[16:19], v[228:231], v[24:27], v[16:19]
    s_waitcnt lgkmcnt(1)
    v_mfma_f32_16x16x32_bf16 v[8:11], v[232:235], v[28:31], v[8:11]
    v_mfma_f32_16x16x32_bf16 v[12:15], v[236:239], v[28:31], v[12:15]
    v_mfma_f32_16x16x32_bf16 v[16:19], v[240:243], v[28:31], v[16:19]
    s_waitcnt lgkmcnt(0)
    v_mfma_f32_16x16x32_bf16 v[8:11], v[244:247], v[32:35], v[8:11]
    v_mfma_f32_16x16x32_bf16 v[12:15], v[248:251], v[32:35], v[12:15]
    v_mfma_f32_16x16x32_bf16 v[16:19], v[252:255], v[32:35], v[16:19]
    v_xor_b32 v3, 65536, v3
    v_cvt_pk_bf16_f32 v60, v8, v9
    v_cvt_pk_bf16_f32 v61, v10, v11
    s_nop 0
    v_cvt_pk_bf16_f32 v62, v12, v13
    v_cvt_pk_bf16_f32 v63, v14, v15
    buffer_store_dwordx4 v[60:63], v0, s[4:7], s41 offen sc1
    s_nop 0
    v_cvt_pk_bf16_f32 v64, v16, v17
    v_cvt_pk_bf16_f32 v65, v18, v19
    buffer_store_dwordx2 v[64:65], v6, s[4:7], s41 offen sc1
    s_add_u32 s41, s41, 147456
    s_add_u32 s40, s40, 1
    v_cmp_ge_u32 vcc, s44, v5
    s_cbranch_vccz F2_E1
    buffer_load_dword v5, v4, s[4:7], 0 offen sc1
    s_waitcnt vmcnt(1)
    v_mov_b32 v7, s40
    s_mov_b64 exec, 1
    buffer_store_dword v7, off, s[4:7], s45 sc1
    s_mov_b64 exec, -1
    s_waitcnt vmcnt(1)
    v_cmp_ge_u32 vcc, s44, v5
    s_cbranch_vccz F2_D
    s_cmp_ge_u32 s40, 64
    s_cbranch_scc1 F2_E
    s_branch F2_S
F2_E1:
    s_add_u32 m0, s43, 0
    s_nop 0
    buffer_load_dwordx4 v0, s[4:7], s42 offen offset:0 sc1 lds
    buffer_load_dwordx4 v0, s[4:7], s42 offen offset:1024 sc1 lds
    buffer_load_dwordx4 v0, s[4:7], s42 offen offset:2048 sc1 lds
    buffer_load_dwordx4 v0, s[4:7], s42 offen offset:3072 sc1 lds
    s_add_u32 m0, s43, 4096
    s_add_u32 s47, s42, 4096
    buffer_load_dwordx4 v0, s[4:7], s47 offen offset:0 sc1 lds
    buffer_load_dwordx4 v0, s[4:7], s47 offen offset:1024 sc1 lds
    buffer_load_dwordx4 v0, s[4:7], s47 offen offset:2048 sc1 lds
    buffer_load_dwordx4 v0, s[4:7], s47 offen offset:3072 sc1 lds
    s_add_u32 m0, s43, 8192
    s_add_u32 s47, s42, 8192
    buffer_load_dwordx4 v0, s[4:7], s47 offen offset:0 sc1 lds
    s_add_u32 s42, s42, 294912
    s_xor_b32 s43, s43, 65536
    s_waitcnt vmcnt(9)
    v_mov_b32 v7, s40
    s_mov_b64 exec, 1
    buffer_store_dword v7, off, s[4:7], s45 sc1
    s_mov_b64 exec, -1
    s_waitcnt vmcnt(1)
    s_branch F2_L
F2_P:
    s_waitcnt vmcnt(0)
    v_mov_b32 v7, s40
    s_mov_b64 exec, 1
    buffer_store_dword v7, off, s[4:7], s45 sc1
    s_mov_b64 exec, -1
    s_branch F2_L
F2_V0:
    s_waitcnt lgkmcnt(5)
    v_mfma_f32_16x16x32_bf16 v[8:11], a[0:3], v[20:23], 0
    v_mov_b32 v77, s44
    s_mov_b64 exec, s[54:55]
    ds_write_b32 v76, v77
    s_mov_b64 exec, -1
    v_mfma_f32_16x16x32_bf16 v[12:15], a[4:7], v[20:23], 0
    ds_read_b128 v[44:47], v3 offset:6144
    v_mfma_f32_16x16x32_bf16 v[16:19], a[8:11], v[20:23], 0
    s_add_u32 m0, s43, 0
    s_nop 0
    buffer_load_dwordx4 v0, s[4:7], s42 offen offset:0 sc1 lds
    s_waitcnt lgkmcnt(6)
    v_mfma_f32_16x16x32_bf16 v[8:11], a[12:15], v[24:27], v[8:11]
    ds_read_b128 v[48:51], v3 offset:7168
    v_mfma_f32_16x16x32_bf16 v[12:15], a[16:19], v[24:27], v[12:15]
    v_mfma_f32_16x16x32_bf16 v[16:19], a[20:23], v[24:27], v[16:19]
    s_waitcnt lgkmcnt(6)
    v_mfma_f32_16x16x32_bf16 v[8:11], a[24:27], v[28:31], v[8:11]
    ds_read_b128 v[20:23], v3 offset:8192
    v_mfma_f32_16x16x32_bf16 v[12:15], a[28:31], v[28:31], v[12:15]
    v_mfma_f32_16x16x32_bf16 v[16:19], a[32:35], v[28:31], v[16:19]
    s_waitcnt lgkmcnt(6)
    v_mfma_f32_16x16x32_bf16 v[8:11], a[36:39], v[32:35], v[8:11]
    ds_read_b128 v[24:27], v3 offset:9216
    v_mfma_f32_16x16x32_bf16 v[12:15], a[40:43], v[32:35], v[12:15]
    buffer_load_dwordx4 v0, s[4:7], s42 offen offset:1024 sc1 lds
    v_mfma_f32_16x16x32_bf16 v[16:19], a[44:47], v[32:35], v[16:19]
    s_waitcnt lgkmcnt(6)
    v_mfma_f32_16x16x32_bf16 v[8:11], a[48:51], v[36:39], v[8:11]
    ds_read_b128 v[28:31], v3 offset:10240
    v_mfma_f32_16x16x32_bf16 v[12:15], a[52:55], v[36:39], v[12:15]
    v_mfma_f32_16x16x32_bf16 v[16:19], a[56:59], v[36:39], v[16:19]
    s_waitcnt lgkmcnt(6)
    v_mfma_f32_16x16x32_bf16 v[8:11], a[60:63], v[40:43], v[8:11]
    ds_read_b128 v[32:35], v3 offset:11264
    v_mfma_f32_16x16x32_bf16 v[12:15], a[64:67], v[40:43], v[12:15]
    v_mfma_f32_16x16x32_bf16 v[16:19], a[68:71], v[40:43], v[16:19]
    s_waitcnt lgkmcnt(5)
    v_mfma_f32_16x16x32_bf16 v[8:11], a[72:75], v[44:47], v[8:11]
    ds_read_b128 v[36:39], v3 offset:12288
    v_mfma_f32_16x16x32_bf16 v[12:15], a[76:79], v[44:47], v[12:15]
    buffer_load_dwordx4 v0, s[4:7], s42 offen offset:2048 sc1 lds
    v_mfma_f32_16x16x32_bf16 v[16:19], a[80:83], v[44:47], v[16:19]
    s_waitcnt lgkmcnt(5)
    v_mfma_f32_16x16x32_bf16 v[8:11], a[84:87], v[48:51], v[8:11]
    ds_read_b128 v[40:43], v3 offset:13312
    v_mfma_f32_16x16x32_bf16 v[12:15], a[88:91], v[48:51], v[12:15]
    v_mfma_f32_16x16x32_bf16 v[16:19], a[92:95], v[48:51], v[16:19]
    s_waitcnt lgkmcnt(5)
    v_mfma_f32_16x16x32_bf16 v[8:11], a[96:99], v[20:23], v[8:11]
    ds_read_b128 v[44:47], v3 offset:14336
    v_mfma_f32_16x16x32_bf16 v[12:15], a[100:103], v[20:23], v[12:15]
    v_mfma_f32_16x16x32_bf16 v[16:19], a[104:107], v[20:23], v[16:19]
    s_waitcnt lgkmcnt(5)
    v_mfma_f32_16x16x32_bf16 v[8:11], a[108:111], v[24:27], v[8:11]
    ds_read_b128 v[48:51], v3 offset:15360
    v_mfma_f32_16x16x32_bf16 v[12:15], a[112:115], v[24:27], v[12:15]
    buffer_load_dwordx4 v0, s[4:7], s42 offen offset:3072 sc1 lds
    v_mfma_f32_16x16x32_bf16 v[16:19], a[116:119], v[24:27], v[16:19]
    s_waitcnt lgkmcnt(5)
    v_mfma_f32_16x16x32_bf16 v[8:11], a[120:123], v[28:31], v[8:11]
    ds_read_b128 v[20:23], v3 offset:16384
    v_mfma_f32_16x16x32_bf16 v[12:15], a[124:127], v[28:31], v[12:15]
    s_cmp_eq_u32 s46, 0
    s_cbranch_scc1 NP_13
    s_waitcnt vmcnt(4)
    v_mov_b32 v7, s40
    s_mov_b64 exec, 1
    buffer_store_dword v7, off, s[4:7], s45 sc1
    s_mov_b64 exec, -1
    s_mov_b32 s46, 0
NP_13:
    v_mfma_f32_16x16x32_bf16 v[16:19], a[128:131], v[28:31], v[16:19]
    s_waitcnt lgkmcnt(5)
    v_mfma_f32_16x16x32_bf16 v[8:11], a[132:135], v[32:35], v[8:11]
    ds_read_b128 v[24:27], v3 offset:17408
    v_mfma_f32_16x16x32_bf16 v[12:15], a[136:139], v[32:35], v[12:15]
    v_mfma_f32_16x16x32_bf16 v[16:19], a[140:143], v[32:35], v[16:19]
    s_waitcnt lgkmcnt(5)
    v_mfma_f32_16x16x32_bf16 v[8:11], a[144:147], v[36:39], v[8:11]
    ds_read_b128 v[28:31], v3 offset:18432
    v_mfma_f32_16x16x32_bf16 v[12:15], a[148:151], v[36:39], v[12:15]
    s_add_u32 m0, s43, 4096
    s_add_u32 s47, s42, 4096
    buffer_load_dwordx4 v0, s[4:7], s47 offen offset:0 sc1 lds
    v_mfma_f32_16x16x32_bf16 v[16:19], a[152:155], v[36:39], v[16:19]
    s_waitcnt lgkmcnt(5)
    v_mfma_f32_16x16x32_bf16 v[8:11], a[156:159], v[40:43], v[8:11]
    ds_read_b128 v[32:35], v3 offset:19456
    v_mfma_f32_16x16x32_bf16 v[12:15], a[160:163], v[40:43], v[12:15]
    v_mfma_f32_16x16x32_bf16 v[16:19], a[164:167], v[40:43], v[16:19]
    s_waitcnt lgkmcnt(5)
    v_mfma_f32_16x16x32_bf16 v[8:11], a[168:171], v[44:47], v[8:11]
    ds_read_b128 v[36:39], v3 offset:20480
    v_mfma_f32_16x16x32_bf16 v[12:15], a[172:175], v[44:47], v[12:15]
    v_mfma_f32_16x16x32_bf16 v[16:19], a[176:179], v[44:47], v[16:19]
    s_waitcnt lgkmcnt(5)
    v_mfma_f32_16x16x32_bf16 v[8:11], a[180:183], v[48:51], v[8:11]
    ds_read_b128 v[40:43], v3 offset:21504
    v_mfma_f32_16x16x32_bf16 v[12:15], a[184:187], v[48:51], v[12:15]
    buffer_load_dwordx4 v0, s[4:7], s47 offen offset:1024 sc1 lds
    v_mfma_f32_16x16x32_bf16 v[16:19], a[188:191], v[48:51], v[16:19]
    s_waitcnt lgkmcnt(5)
    v_mfma_f32_16x16x32_bf16 v[8:11], a[192:195], v[20:23], v[8:11]
    ds_read_b128 v[44:47], v3 offset:22528
    v_mfma_f32_16x16x32_bf16 v[12:15], a[196:199], v[20:23], v[12:15]
    v_mfma_f32_16x16x32_bf16 v[16:19], a[200:203], v[20:23], v[16:19]
    s_waitcnt lgkmcnt(5)
    v_mfma_f32_16x16x32_bf16 v[8:11], a[204:207], v[24:27], v[8:11]
    ds_read_b128 v[48:51], v3 offset:23552
    v_mfma_f32_16x16x32_bf16 v[12:15], a[208:211], v[24:27], v[12:15]
    v_mfma_f32_16x16x32_bf16 v[16:19], a[212:215], v[24:27], v[16:19]
    s_waitcnt lgkmcnt(5)
    v_mfma_f32_16x16x32_bf16 v[8:11], a[216:219], v[28:31], v[8:11]
    ds_read_b128 v[20:23], v3 offset:24576
    v_mfma_f32_16x16x32_bf16 v[12:15], a[220:223], v[28:31], v[12:15]
    buffer_load_dwordx4 v0, s[4:7], s47 offen offset:2048 sc1 lds
    v_mfma_f32_16x16x32_bf16 v[16:19], a[224:227], v[28:31], v[16:19]
    s_waitcnt lgkmcnt(5)
    v_mfma_f32_16x16x32_bf16 v[8:11], a[228:231], v[32:35], v[8:11]
    ds_read_b128 v[24:27], v3 offset:25600
    v_mfma_f32_16x16x32_bf16 v[12:15], a[232:235], v[32:35], v[12:15]
    v_mfma_f32_16x16x32_bf16 v[16:19], a[236:239], v[32:35], v[16:19]
    s_waitcnt lgkmcnt(5)
    v_mfma_f32_16x16x32_bf16 v[8:11], a[240:243], v[36:39], v[8:11]
    ds_read_b128 v[28:31], v3 offset:26624
    v_mfma_f32_16x16x32_bf16 v[12:15], a[244:247], v[36:39], v[12:15]
    v_mfma_f32_16x16x32_bf16 v[16:19], a[248:251], v[36:39], v[16:19]
    s_waitcnt lgkmcnt(5)
    v_mfma_f32_16x16x32_bf16 v[8:11], a[252:255], v[40:43], v[8:11]
    ds_read_b128 v[32:35], v3 offset:27648
    v_mfma_f32_16x16x32_bf16 v[12:15], v[80:83], v[40:43], v[12:15]
    buffer_load_dwordx4 v0, s[4:7], s47 offen offset:3072 sc1 lds
    v_mfma_f32_16x16x32_bf16 v[16:19], v[84:87], v[40:43], v[16:19]
    s_waitcnt lgkmcnt(5)
    v_mfma_f32_16x16x32_bf16 v[8:11], v[88:91], v[44:47], v[8:11]
    ds_read_b128 v[36:39], v3 offset:28672
    v_mfma_f32_16x16x32_bf16 v[12:15], v[92:95], v[44:47], v[12:15]
    v_mfma_f32_16x16x32_bf16 v[16:19], v[96:99], v[44:47], v[16:19]
    s_waitcnt lgkmcnt(5)
    v_mfma_f32_16x16x32_bf16 v[8:11], v[100:103], v[48:51], v[8:11]
    ds_read_b128 v[40:43], v3 offset:29696
    v_mfma_f32_16x16x32_bf16 v[12:15], v[104:107], v[48:51], v[12:15]
    v_mfma_f32_16x16x32_bf16 v[16:19], v[108:111], v[48:51], v[16:19]
    s_waitcnt lgkmcnt(5)
    v_mfma_f32_16x16x32_bf16 v[8:11], v[112:115], v[20:23], v[8:11]
    ds_read_b128 v[44:47], v3 offset:30720
    v_mfma_f32_16x16x32_bf16 v[12:15], v[116:119], v[20:23], v[12:15]
    s_add_u32 m0, s43, 8192
    s_add_u32 s47, s42, 8192
    buffer_load_dwordx4 v0, s[4:7], s47 offen offset:0 sc1 lds
    s_add_u32 s42, s42, 294912
    s_xor_b32 s43, s43, 65536
    v_mfma_f32_16x16x32_bf16 v[16:19], v[120:123], v[20:23], v[16:19]
    s_waitcnt lgkmcnt(5)
    v_mfma_f32_16x16x32_bf16 v[8:11], v[124:127], v[24:27], v[8:11]
    ds_read_b128 v[48:51], v3 offset:31744
    v_mfma_f32_16x16x32_bf16 v[12:15], v[128:131], v[24:27], v[12:15]
    buffer_load_dword v5, v4, s[4:7], 0 offen sc1
    v_mfma_f32_16x16x32_bf16 v[16:19], v[132:135], v[24:27], v[16:19]
    s_waitcnt lgkmcnt(5)
    v_mfma_f32_16x16x32_bf16 v[8:11], v[136:139], v[28:31], v[8:11]
    ds_read_b128 v[20:23], v3 offset:32768
    v_mfma_f32_16x16x32_bf16 v[12:15], v[140:143], v[28:31], v[12:15]
    v_mfma_f32_16x16x32_bf16 v[16:19], v[144:147], v[28:31], v[16:19]
    s_waitcnt lgkmcnt(5)
    v_mfma_f32_16x16x32_bf16 v[8:11], v[148:151], v[32:35], v[8:11]
    ds_read_b128 v[24:27], v3 offset:33792
    v_mfma_f32_16x16x32_bf16 v[12:15], v[152:155], v[32:35], v[12:15]
    v_mfma_f32_16x16x32_bf16 v[16:19], v[156:159], v[32:35], v[16:19]
    s_waitcnt lgkmcnt(5)
    v_mfma_f32_16x16x32_bf16 v[8:11], v[160:163], v[36:39], v[8:11]
    ds_read_b128 v[28:31], v3 offset:34816
    v_mfma_f32_16x16x32_bf16 v[12:15], v[164:167], v[36:39], v[12:15]
    v_mfma_f32_16x16x32_bf16 v[16:19], v[168:171], v[36:39], v[16:19]
    s_waitcnt lgkmcnt(5)
    v_mfma_f32_16x16x32_bf16 v[8:11], v[172:175], v[40:43], v[8:11]
    ds_read_b128 v[32:35], v3 offset:35840
    v_mfma_f32_16x16x32_bf16 v[12:15], v[176:179], v[40:43], v[12:15]
    v_mfma_f32_16x16x32_bf16 v[16:19], v[180:183], v[40:43], v[16:19]
    s_waitcnt lgkmcnt(5)
    v_mfma_f32_16x16x32_bf16 v[8:11], v[184:187], v[44:47], v[8:11]
    v_mfma_f32_16x16x32_bf16 v[12:15], v[188:191], v[44:47], v[12:15]
    v_mfma_f32_16x16x32_bf16 v[16:19], v[192:195], v[44:47], v[16:19]
    s_waitcnt lgkmcnt(4)
    v_mfma_f32_16x16x32_bf16 v[8:11], v[196:199], v[48:51], v[8:11]
    v_mfma_f32_16x16x32_bf16 v[12:15], v[200:203], v[48:51], v[12:15]
    v_mfma_f32_16x16x32_bf16 v[16:19], v[204:207], v[48:51], v[16:19]
    s_waitcnt lgkmcnt(3)
    v_mfma_f32_16x16x32_bf16 v[8:11], v[208:211], v[20:23], v[8:11]
    v_mfma_f32_16x16x32_bf16 v[12:15], v[212:215], v[20:23], v[12:15]
    v_mfma_f32_16x16x32_bf16 v[16:19], v[216:219], v[20:23], v[16:19]
    s_waitcnt lgkmcnt(2)
    v_mfma_f32_16x16x32_bf16 v[8:11], v[220:223], v[24:27], v[8:11]
    v_mfma_f32_16x16x32_bf16 v[12:15], v[224:227], v[24:27], v[12:15]
    v_mfma_f32_16x16x32_bf16 v[16:19], v[228:231], v[24:27], v[16:19]
    s_waitcnt lgkmcnt(1)
    v_mfma_f32_16x16x32_bf16 v[8:11], v[232:235], v[28:31], v[8:11]
    v_mfma_f32_16x16x32_bf16 v[12:15], v[236:239], v[28:31], v[12:15]
    v_mfma_f32_16x16x32_bf16 v[16:19], v[240:243], v[28:31], v[16:19]
    s_waitcnt lgkmcnt(0)
    v_mfma_f32_16x16x32_bf16 v[8:11], v[244:247], v[32:35], v[8:11]
    ds_read_b32 v77, v76
    v_mfma_f32_16x16x32_bf16 v[12:15], v[248:251], v[32:35], v[12:15]
    v_mfma_f32_16x16x32_bf16 v[16:19], v[252:255], v[32:35], v[16:19]
    v_xor_b32 v3, 65536, v3
    v_cvt_pk_bf16_f32 v60, v8, v9
    v_cvt_pk_bf16_f32 v61, v10, v11
    s_nop 0
    v_cvt_pk_bf16_f32 v62, v12, v13
    v_cvt_pk_bf16_f32 v63, v14, v15
    buffer_store_dwordx4 v[60:63], v0, s[4:7], s41 offen sc1
    s_nop 0
    v_cvt_pk_bf16_f32 v64, v16, v17
    v_cvt_pk_bf16_f32 v65, v18, v19
    buffer_store_dwordx2 v[64:65], v6, s[4:7], s41 offen sc1
    s_add_u32 s41, s41, 147456
    s_add_u32 s40, s40, 1
    s_waitcnt lgkmcnt(0)
    v_cmp_ne_u32 vcc, s40, v77
    s_cbranch_vccnz F2_P
    s_waitcnt vmcnt(3)
    s_mov_b32 s46, 1
    s_branch F2_L
F2_V9:
    s_waitcnt lgkmcnt(5)
    v_mfma_f32_16x16x32_bf16 v[8:11], a[108:111], v[24:27], v[8:11]
    v_mov_b32 v77, s44
    s_mov_b64 exec, s[54:55]
    ds_write_b32 v76, v77
    s_mov_b64 exec, -1
    v_mfma_f32_16x16x32_bf16 v[12:15], a[112:115], v[24:27], v[12:15]
    ds_read_b128 v[48:51], v3 offset:15360
    v_mfma_f32_16x16x32_bf16 v[16:19], a[116:119], v[24:27], v[16:19]
    s_add_u32 m0, s43, 0
    s_nop 0
    buffer_load_dwordx4 v0, s[4:7], s42 offen offset:0 sc1 lds
    s_waitcnt lgkmcnt(6)
    v_mfma_f32_16x16x32_bf16 v[8:11], a[120:123], v[28:31], v[8:11]
    ds_read_b128 v[20:23], v3 offset:16384
    v_mfma_f32_16x16x32_bf16 v[12:15], a[124:127], v[28:31], v[12:15]
    s_cmp_eq_u32 s46, 0
    s_cbranch_scc1 NP_14
    s_waitcnt vmcnt(2)
    v_mov_b32 v7, s40
    s_mov_b64 exec, 1
    buffer_store_dword v7, off, s[4:7], s45 sc1
    s_mov_b64 exec, -1
    s_mov_b32 s46, 0
NP_14:
    v_mfma_f32_16x16x32_bf16 v[16:19], a[128:131], v[28:31], v[16:19]
    s_waitcnt lgkmcnt(6)
    v_mfma_f32_16x16x32_bf16 v[8:11], a[132:135], v[32:35], v[8:11]
    ds_read_b128 v[24:27], v3 offset:17408
    v_mfma_f32_16x16x32_bf16 v[12:15], a[136:139], v[32:35], v[12:15]
    buffer_load_dwordx4 v0, s[4:7], s42 offen offset:1024 sc1 lds
    v_mfma_f32_16x16x32_bf16 v[16:19], a[140:143], v[32:35], v[16:19]
    s_waitcnt lgkmcnt(6)
    v_mfma_f32_16x16x32_bf16 v[8:11], a[144:147], v[36:39], v[8:11]
    ds_read_b128 v[28:31], v3 offset:18432
    v_mfma_f32_16x16x32_bf16 v[12:15], a[148:151], v[36:39], v[12:15]
    v_mfma_f32_16x16x32_bf16 v[16:19], a[152:155], v[36:39], v[16:19]
    s_waitcnt lgkmcnt(6)
    v_mfma_f32_16x16x32_bf16 v[8:11], a[156:159], v[40:43], v[8:11]
    ds_read_b128 v[32:35], v3 offset:19456
    v_mfma_f32_16x16x32_bf16 v[12:15], a[160:163], v[40:43], v[12:15]
    buffer_load_dwordx4 v0, s[4:7], s42 offen offset:2048 sc1 lds
    v_mfma_f32_16x16x32_bf16 v[16:19], a[164:167], v[40:43], v[16:19]
    s_waitcnt lgkmcnt(6)
    v_mfma_f32_16x16x32_bf16 v[8:11], a[168:171], v[44:47], v[8:11]
    ds_read_b128 v[36:39], v3 offset:20480
    v_mfma_f32_16x16x32_bf16 v[12:15], a[172:175], v[44:47], v[12:15]
    v_mfma_f32_16x16x32_bf16 v[16:19], a[176:179], v[44:47], v[16:19]
    s_waitcnt lgkmcnt(5)
    v_mfma_f32_16x16x32_bf16 v[8:11], a[180:183], v[48:51], v[8:11]
    ds_read_b128 v[40:43], v3 offset:21504
    v_mfma_f32_16x16x32_bf16 v[12:15], a[184:187], v[48:51], v[12:15]
    buffer_load_dwordx4 v0, s[4:7], s42 offen offset:3072 sc1 lds
    v_mfma_f32_16x16x32_bf16 v[16:19], a[188:191], v[48:51], v[16:19]
    s_waitcnt lgkmcnt(5)
    v_mfma_f32_16x16x32_bf16 v[8:11], a[192:195], v[20:23], v[8:11]
    ds_read_b128 v[44:47], v3 offset:22528
    v_mfma_f32_16x16x32_bf16 v[12:15], a[196:199], v[20:23], v[12:15]
    v_mfma_f32_16x16x32_bf16 v[16:19], a[200:203], v[20:23], v[16:19]
    s_waitcnt lgkmcnt(5)
    v_mfma_f32_16x16x32_bf16 v[8:11], a[204:207], v[24:27], v[8:11]
    ds_read_b128 v[48:51], v3 offset:23552
    v_mfma_f32_16x16x32_bf16 v[12:15], a[208:211], v[24:27], v[12:15]
    s_add_u32 m0, s43, 4096
    s_add_u32 s47, s42, 4096
    buffer_load_dwordx4 v0, s[4:7], s47 offen offset:0 sc1 lds
    v_mfma_f32_16x16x32_bf16 v[16:19], a[212:215], v[24:27], v[16:19]
    s_waitcnt lgkmcnt(5)
    v_mfma_f32_16x16x32_bf16 v[8:11], a[216:219], v[28:31], v[8:11]
    ds_read_b128 v[20:23], v3 offset:24576
    v_mfma_f32_16x16x32_bf16 v[12:15], a[220:223], v[28:31], v[12:15]
    v_mfma_f32_16x16x32_bf16 v[16:19], a[224:227], v[28:31], v[16:19]
    s_waitcnt lgkmcnt(5)
    v_mfma_f32_16x16x32_bf16 v[8:11], a[228:231], v[32:35], v[8:11]
    ds_read_b128 v[24:27], v3 offset:25600
    v_mfma_f32_16x16x32_bf16 v[12:15], a[232:235], v[32:35], v[12:15]
    buffer_load_dwordx4 v0, s[4:7], s47 offen offset:1024 sc1 lds
    v_mfma_f32_16x16x32_bf16 v[16:19], a[236:239], v[32:35], v[16:19]
    s_waitcnt lgkmcnt(5)
    v_mfma_f32_16x16x32_bf16 v[8:11], a[240:243], v[36:39], v[8:11]
    ds_read_b128 v[28:31], v3 offset:26624
    v_mfma_f32_16x16x32_bf16 v[12:15], a[244:247], v[36:39], v[12:15]
    v_mfma_f32_16x16x32_bf16 v[16:19], a[248:251], v[36:39], v[16:19]
    s_waitcnt lgkmcnt(5)
    v_mfma_f32_16x16x32_bf16 v[8:11], a[252:255], v[40:43], v[8:11]
    ds_read_b128 v[32:35], v3 offset:27648
    v_mfma_f32_16x16x32_bf16 v[12:15], v[80:83], v[40:43], v[12:15]
    buffer_load_dwordx4 v0, s[4:7], s47 offen offset:2048 sc1 lds
    v_mfma_f32_16x16x32_bf16 v[16:19], v[84:87], v[40:43], v[16:19]
    s_waitcnt lgkmcnt(5)
    v_mfma_f32_16x16x32_bf16 v[8:11], v[88:91], v[44:47], v[8:11]
    ds_read_b128 v[36:39], v3 offset:28672
    v_mfma_f32_16x16x32_bf16 v[12:15], v[92:95], v[44:47], v[12:15]
    v_mfma_f32_16x16x32_bf16 v[16:19], v[96:99], v[44:47], v[16:19]
    s_waitcnt lgkmcnt(5)
    v_mfma_f32_16x16x32_bf16 v[8:11], v[100:103], v[48:51], v[8:11]
    ds_read_b128 v[40:43], v3 offset:29696
    v_mfma_f32_16x16x32_bf16 v[12:15], v[104:107], v[48:51], v[12:15]
    buffer_load_dwordx4 v0, s[4:7], s47 offen offset:3072 sc1 lds
    v_mfma_f32_16x16x32_bf16 v[16:19], v[108:111], v[48:51], v[16:19]
    s_waitcnt lgkmcnt(5)
    v_mfma_f32_16x16x32_bf16 v[8:11], v[112:115], v[20:23], v[8:11]
    ds_read_b128 v[44:47], v3 offset:30720
    v_mfma_f32_16x16x32_bf16 v[12:15], v[116:119], v[20:23], v[12:15]
    v_mfma_f32_16x16x32_bf16 v[16:19], v[120:123], v[20:23], v[16:19]
    s_waitcnt lgkmcnt(5)
    v_mfma_f32_16x16x32_bf16 v[8:11], v[124:127], v[24:27], v[8:11]
    ds_read_b128 v[48:51], v3 offset:31744
    v_mfma_f32_16x16x32_bf16 v[12:15], v[128:131], v[24:27], v[12:15]
    s_add_u32 m0, s43, 8192
    s_add_u32 s47, s42, 8192
    buffer_load_dwordx4 v0, s[4:7], s47 offen offset:0 sc1 lds
    s_add_u32 s42, s42, 294912
    s_xor_b32 s43, s43, 65536
    v_mfma_f32_16x16x32_bf16 v[16:19], v[132:135], v[24:27], v[16:19]
    s_waitcnt lgkmcnt(5)
    v_mfma_f32_16x16x32_bf16 v[8:11], v[136:139], v[28:31], v[8:11]
    ds_read_b128 v[20:23], v3 offset:32768
    v_mfma_f32_16x16x32_bf16 v[12:15], v[140:143], v[28:31], v[12:15]
    buffer_load_dword v5, v4, s[4:7], 0 offen sc1
    v_mfma_f32_16x16x32_bf16 v[16:19], v[144:147], v[28:31], v[16:19]
    s_waitcnt lgkmcnt(5)
    v_mfma_f32_16x16x32_bf16 v[8:11], v[148:151], v[32:35], v[8:11]
    ds_read_b128 v[24:27], v3 offset:33792
    v_mfma_f32_16x16x32_bf16 v[12:15], v[152:155], v[32:35], v[12:15]
    v_mfma_f32_16x16x32_bf16 v[16:19], v[156:159], v[32:35], v[16:19]
    s_waitcnt lgkmcnt(5)
    v_mfma_f32_16x16x32_bf16 v[8:11], v[160:163], v[36:39], v[8:11]
    ds_read_b128 v[28:31], v3 offset:34816
    v_mfma_f32_16x16x32_bf16 v[12:15], v[164:167], v[36:39], v[12:15]
    v_mfma_f32_16x16x32_bf16 v[16:19], v[168:171], v[36:39], v[16:19]
    s_waitcnt lgkmcnt(5)
    v_mfma_f32_16x16x32_bf16 v[8:11], v[172:175], v[40:43], v[8:11]
    ds_read_b128 v[32:35], v3 offset:35840
    v_mfma_f32_16x16x32_bf16 v[12:15], v[176:179], v[40:43], v[12:15]
    v_mfma_f32_16x16x32_bf16 v[16:19], v[180:183], v[40:43], v[16:19]
    s_waitcnt lgkmcnt(5)
    v_mfma_f32_16x16x32_bf16 v[8:11], v[184:187], v[44:47], v[8:11]
    v_mfma_f32_16x16x32_bf16 v[12:15], v[188:191], v[44:47], v[12:15]
    v_mfma_f32_16x16x32_bf16 v[16:19], v[192:195], v[44:47], v[16:19]
    s_waitcnt lgkmcnt(4)
    v_mfma_f32_16x16x32_bf16 v[8:11], v[196:199], v[48:51], v[8:11]
    v_mfma_f32_16x16x32_bf16 v[12:15], v[200:203], v[48:51], v[12:15]
    v_mfma_f32_16x16x32_bf16 v[16:19], v[204:207], v[48:51], v[16:19]
    s_waitcnt lgkmcnt(3)
    v_mfma_f32_16x16x32_bf16 v[8:11], v[208:211], v[20:23], v[8:11]
    v_mfma_f32_16x16x32_bf16 v[12:15], v[212:215], v[20:23], v[12:15]
    v_mfma_f32_16x16x32_bf16 v[16:19], v[216:219], v[20:23], v[16:19]
    s_waitcnt lgkmcnt(2)
    v_mfma_f32_16x16x32_bf16 v[8:11], v[220:223], v[24:27], v[8:11]
    v_mfma_f32_16x16x32_bf16 v[12:15], v[224:227], v[24:27], v[12:15]
    v_mfma_f32_16x16x32_bf16 v[16:19], v[228:231], v[24:27], v[16:19]
    s_waitcnt lgkmcnt(1)
    v_mfma_f32_16x16x32_bf16 v[8:11], v[232:235], v[28:31], v[8:11]
    v_mfma_f32_16x16x32_bf16 v[12:15], v[236:239], v[28:31], v[12:15]
    v_mfma_f32_16x16x32_bf16 v[16:19], v[240:243], v[28:31], v[16:19]
    s_waitcnt lgkmcnt(0)
    v_mfma_f32_16x16x32_bf16 v[8:11], v[244:247], v[32:35], v[8:11]
    ds_read_b32 v77, v76
    v_mfma_f32_16x16x32_bf16 v[12:15], v[248:251], v[32:35], v[12:15]
    v_mfma_f32_16x16x32_bf16 v[16:19], v[252:255], v[32:35], v[16:19]
    v_xor_b32 v3, 65536, v3
    v_cvt_pk_bf16_f32 v60, v8, v9
    v_cvt_pk_bf16_f32 v61, v10, v11
    s_nop 0
    v_cvt_pk_bf16_f32 v62, v12, v13
    v_cvt_pk_bf16_f32 v63, v14, v15
    buffer_store_dwordx4 v[60:63], v0, s[4:7], s41 offen sc1
    s_nop 0
    v_cvt_pk_bf16_f32 v64, v16, v17
    v_cvt_pk_bf16_f32 v65, v18, v19
    buffer_store_dwordx2 v[64:65], v6, s[4:7], s41 offen sc1
    s_add_u32 s41, s41, 147456
    s_add_u32 s40, s40, 1
    s_waitcnt lgkmcnt(0)
    v_cmp_ne_u32 vcc, s40, v77
    s_cbranch_vccnz F2_P
    s_waitcnt vmcnt(3)
    s_mov_b32 s46, 1
    s_branch F2_L
F2_V18:
    s_waitcnt lgkmcnt(5)
    v_mfma_f32_16x16x32_bf16 v[8:11], a[216:219], v[28:31], v[8:11]
    v_mov_b32 v77, s44
    s_mov_b64 exec, s[54:55]
    ds_write_b32 v76, v77
    s_mov_b64 exec, -1
    v_mfma_f32_16x16x32_bf16 v[12:15], a[220:223], v[28:31], v[12:15]
    ds_read_b128 v[20:23], v3 offset:24576
    v_mfma_f32_16x16x32_bf16 v[16:19], a[224:227], v[28:31], v[16:19]
    s_add_u32 m0, s43, 0
    s_nop 0
    buffer_load_dwordx4 v0, s[4:7], s42 offen offset:0 sc1 lds
    s_waitcnt lgkmcnt(6)
    v_mfma_f32_16x16x32_bf16 v[8:11], a[228:231], v[32:35], v[8:11]
    ds_read_b128 v[24:27], v3 offset:25600
    v_mfma_f32_16x16x32_bf16 v[12:15], a[232:235], v[32:35], v[12:15]
    buffer_load_dwordx4 v0, s[4:7], s42 offen offset:1024 sc1 lds
    v_mfma_f32_16x16x32_bf16 v[16:19], a[236:239], v[32:35], v[16:19]
    s_waitcnt lgkmcnt(6)
    v_mfma_f32_16x16x32_bf16 v[8:11], a[240:243], v[36:39], v[8:11]
    ds_read_b128 v[28:31], v3 offset:26624
    v_mfma_f32_16x16x32_bf16 v[12:15], a[244:247], v[36:39], v[12:15]
    buffer_load_dwordx4 v0, s[4:7], s42 offen offset:2048 sc1 lds
    v_mfma_f32_16x16x32_bf16 v[16:19], a[248:251], v[36:39], v[16:19]
    s_waitcnt lgkmcnt(6)
    v_mfma_f32_16x16x32_bf16 v[8:11], a[252:255], v[40:43], v[8:11]
    ds_read_b128 v[32:35], v3 offset:27648
    v_mfma_f32_16x16x32_bf16 v[12:15], v[80:83], v[40:43], v[12:15]
    buffer_load_dwordx4 v0, s[4:7], s42 offen offset:3072 sc1 lds
    v_mfma_f32_16x16x32_bf16 v[16:19], v[84:87], v[40:43], v[16:19]
    s_waitcnt lgkmcnt(6)
    v_mfma_f32_16x16x32_bf16 v[8:11], v[88:91], v[44:47], v[8:11]
    ds_read_b128 v[36:39], v3 offset:28672
    v_mfma_f32_16x16x32_bf16 v[12:15], v[92:95], v[44:47], v[12:15]
    s_add_u32 m0, s43, 4096
    s_add_u32 s47, s42, 4096
    buffer_load_dwordx4 v0, s[4:7], s47 offen offset:0 sc1 lds
    v_mfma_f32_16x16x32_bf16 v[16:19], v[96:99], v[44:47], v[16:19]
    s_waitcnt lgkmcnt(6)
    v_mfma_f32_16x16x32_bf16 v[8:11], v[100:103], v[48:51], v[8:11]
    ds_read_b128 v[40:43], v3 offset:29696
    v_mfma_f32_16x16x32_bf16 v[12:15], v[104:107], v[48:51], v[12:15]
    buffer_load_dwordx4 v0, s[4:7], s47 offen offset:1024 sc1 lds
    v_mfma_f32_16x16x32_bf16 v[16:19], v[108:111], v[48:51], v[16:19]
    s_waitcnt lgkmcnt(5)
    v_mfma_f32_16x16x32_bf16 v[8:11], v[112:115], v[20:23], v[8:11]
    ds_read_b128 v[44:47], v3 offset:30720
    v_mfma_f32_16x16x32_bf16 v[12:15], v[116:119], v[20:23], v[12:15]
    buffer_load_dwordx4 v0, s[4:7], s47 offen offset:2048 sc1 lds
    v_mfma_f32_16x16x32_bf16 v[16:19], v[120:123], v[20:23], v[16:19]
    s_waitcnt lgkmcnt(5)
    v_mfma_f32_16x16x32_bf16 v[8:11], v[124:127], v[24:27], v[8:11]
    ds_read_b128 v[48:51], v3 offset:31744
    v_mfma_f32_16x16x32_bf16 v[12:15], v[128:131], v[24:27], v[12:15]
    buffer_load_dwordx4 v0, s[4:7], s47 offen offset:3072 sc1 lds
    v_mfma_f32_16x16x32_bf16 v[16:19], v[132:135], v[24:27], v[16:19]
    s_waitcnt lgkmcnt(5)
    v_mfma_f32_16x16x32_bf16 v[8:11], v[136:139], v[28:31], v[8:11]
    ds_read_b128 v[20:23], v3 offset:32768
    v_mfma_f32_16x16x32_bf16 v[12:15], v[140:143], v[28:31], v[12:15]
    s_add_u32 m0, s43, 8192
    s_add_u32 s47, s42, 8192
    buffer_load_dwordx4 v0, s[4:7], s47 offen offset:0 sc1 lds
    s_add_u32 s42, s42, 294912
    s_xor_b32 s43, s43, 65536
    v_mfma_f32_16x16x32_bf16 v[16:19], v[144:147], v[28:31], v[16:19]
    s_waitcnt lgkmcnt(5)
    v_mfma_f32_16x16x32_bf16 v[8:11], v[148:151], v[32:35], v[8:11]
    ds_read_b128 v[24:27], v3 offset:33792
    v_mfma_f32_16x16x32_bf16 v[12:15], v[152:155], v[32:35], v[12:15]
    buffer_load_dword v5, v4, s[4:7], 0 offen sc1
    v_mfma_f32_16x16x32_bf16 v[16:19], v[156:159], v[32:35], v[16:19]
    s_waitcnt lgkmcnt(5)
    v_mfma_f32_16x16x32_bf16 v[8:11], v[160:163], v[36:39], v[8:11]
    ds_read_b128 v[28:31], v3 offset:34816
    v_mfma_f32_16x16x32_bf16 v[12:15], v[164:167], v[36:39], v[12:15]
    v_mfma_f32_16x16x32_bf16 v[16:19], v[168:171], v[36:39], v[16:19]
    s_waitcnt lgkmcnt(5)
    v_mfma_f32_16x16x32_bf16 v[8:11], v[172:175], v[40:43], v[8:11]
    ds_read_b128 v[32:35], v3 offset:35840
    v_mfma_f32_16x16x32_bf16 v[12:15], v[176:179], v[40:43], v[12:15]
    v_mfma_f32_16x16x32_bf16 v[16:19], v[180:183], v[40:43], v[16:19]
    s_waitcnt lgkmcnt(5)
    v_mfma_f32_16x16x32_bf16 v[8:11], v[184:187], v[44:47], v[8:11]
    v_mfma_f32_16x16x32_bf16 v[12:15], v[188:191], v[44:47], v[12:15]
    v_mfma_f32_16x16x32_bf16 v[16:19], v[192:195], v[44:47], v[16:19]
    s_waitcnt lgkmcnt(4)
    v_mfma_f32_16x16x32_bf16 v[8:11], v[196:199], v[48:51], v[8:11]
    v_mfma_f32_16x16x32_bf16 v[12:15], v[200:203], v[48:51], v[12:15]
    v_mfma_f32_16x16x32_bf16 v[16:19], v[204:207], v[48:51], v[16:19]
    s_waitcnt lgkmcnt(3)
    v_mfma_f32_16x16x32_bf16 v[8:11], v[208:211], v[20:23], v[8:11]
    v_mfma_f32_16x16x32_bf16 v[12:15], v[212:215], v[20:23], v[12:15]
    v_mfma_f32_16x16x32_bf16 v[16:19], v[216:219], v[20:23], v[16:19]
    s_waitcnt lgkmcnt(2)
    v_mfma_f32_16x16x32_bf16 v[8:11], v[220:223], v[24:27], v[8:11]
    v_mfma_f32_16x16x32_bf16 v[12:15], v[224:227], v[24:27], v[12:15]
    v_mfma_f32_16x16x32_bf16 v[16:19], v[228:231], v[24:27], v[16:19]
    s_waitcnt lgkmcnt(1)
    v_mfma_f32_16x16x32_bf16 v[8:11], v[232:235], v[28:31], v[8:11]
    v_mfma_f32_16x16x32_bf16 v[12:15], v[236:239], v[28:31], v[12:15]
    v_mfma_f32_16x16x32_bf16 v[16:19], v[240:243], v[28:31], v[16:19]
    s_waitcnt lgkmcnt(0)
    v_mfma_f32_16x16x32_bf16 v[8:11], v[244:247], v[32:35], v[8:11]
    ds_read_b32 v77, v76
    v_mfma_f32_16x16x32_bf16 v[12:15], v[248:251], v[32:35], v[12:15]
    v_mfma_f32_16x16x32_bf16 v[16:19], v[252:255], v[32:35], v[16:19]
    v_xor_b32 v3, 65536, v3
    v_cvt_pk_bf16_f32 v60, v8, v9
    v_cvt_pk_bf16_f32 v61, v10, v11
    s_nop 0
    v_cvt_pk_bf16_f32 v62, v12, v13
    v_cvt_pk_bf16_f32 v63, v14, v15
    buffer_store_dwordx4 v[60:63], v0, s[4:7], s41 offen sc1
    s_nop 0
    v_cvt_pk_bf16_f32 v64, v16, v17
    v_cvt_pk_bf16_f32 v65, v18, v19
    buffer_store_dwordx2 v[64:65], v6, s[4:7], s41 offen sc1
    s_add_u32 s41, s41, 147456
    s_add_u32 s40, s40, 1
    s_waitcnt lgkmcnt(0)
    v_cmp_ne_u32 vcc, s40, v77
    s_cbranch_vccnz F2_P
    s_waitcnt vmcnt(3)
    s_mov_b32 s46, 1
    s_branch F2_L
F2_V27:
    s_waitcnt lgkmcnt(5)
    v_mfma_f32_16x16x32_bf16 v[8:11], v[148:151], v[32:35], v[8:11]
    v_mov_b32 v77, s44
    s_mov_b64 exec, s[54:55]
    ds_write_b32 v76, v77
    s_mov_b64 exec, -1
    v_mfma_f32_16x16x32_bf16 v[12:15], v[152:155], v[32:35], v[12:15]
    ds_read_b128 v[24:27], v3 offset:33792
    v_mfma_f32_16x16x32_bf16 v[16:19], v[156:159], v[32:35], v[16:19]
    s_add_u32 m0, s43, 0
    s_nop 0
    buffer_load_dwordx4 v0, s[4:7], s42 offen offset:0 sc1 lds
    s_waitcnt lgkmcnt(6)
    v_mfma_f32_16x16x32_bf16 v[8:11], v[160:163], v[36:39], v[8:11]
    ds_read_b128 v[28:31], v3 offset:34816
    v_mfma_f32_16x16x32_bf16 v[12:15], v[164:167], v[36:39], v[12:15]
    buffer_load_dwordx4 v0, s[4:7], s42 offen offset:1024 sc1 lds
    v_mfma_f32_16x16x32_bf16 v[16:19], v[168:171], v[36:39], v[16:19]
    s_waitcnt lgkmcnt(6)
    v_mfma_f32_16x16x32_bf16 v[8:11], v[172:175], v[40:43], v[8:11]
    ds_read_b128 v[32:35], v3 offset:35840
    v_mfma_f32_16x16x32_bf16 v[12:15], v[176:179], v[40:43], v[12:15]
    buffer_load_dwordx4 v0, s[4:7], s42 offen offset:2048 sc1 lds
    v_mfma_f32_16x16x32_bf16 v[16:19], v[180:183], v[40:43], v[16:19]
    s_waitcnt lgkmcnt(6)
    v_mfma_f32_16x16x32_bf16 v[8:11], v[184:187], v[44:47], v[8:11]
    buffer_load_dwordx4 v0, s[4:7], s42 offen offset:3072 sc1 lds
    v_mfma_f32_16x16x32_bf16 v[12:15], v[188:191], v[44:47], v[12:15]
    v_mfma_f32_16x16x32_bf16 v[16:19], v[192:195], v[44:47], v[16:19]
    s_waitcnt lgkmcnt(5)
    v_mfma_f32_16x16x32_bf16 v[8:11], v[196:199], v[48:51], v[8:11]
    s_add_u32 m0, s43, 4096
    s_add_u32 s47, s42, 4096
    buffer_load_dwordx4 v0, s[4:7], s47 offen offset:0 sc1 lds
    v_mfma_f32_16x16x32_bf16 v[12:15], v[200:203], v[48:51], v[12:15]
    v_mfma_f32_16x16x32_bf16 v[16:19], v[204:207], v[48:51], v[16:19]
    s_waitcnt lgkmcnt(4)
    v_mfma_f32_16x16x32_bf16 v[8:11], v[208:211], v[20:23], v[8:11]
    buffer_load_dwordx4 v0, s[4:7], s47 offen offset:1024 sc1 lds
    v_mfma_f32_16x16x32_bf16 v[12:15], v[212:215], v[20:23], v[12:15]
    v_mfma_f32_16x16x32_bf16 v[16:19], v[216:219], v[20:23], v[16:19]
    s_waitcnt lgkmcnt(2)
    v_mfma_f32_16x16x32_bf16 v[8:11], v[220:223], v[24:27], v[8:11]
    buffer_load_dwordx4 v0, s[4:7], s47 offen offset:2048 sc1 lds
    v_mfma_f32_16x16x32_bf16 v[12:15], v[224:227], v[24:27], v[12:15]
    v_mfma_f32_16x16x32_bf16 v[16:19], v[228:231], v[24:27], v[16:19]
    s_waitcnt lgkmcnt(1)
    v_mfma_f32_16x16x32_bf16 v[8:11], v[232:235], v[28:31], v[8:11]
    buffer_load_dwordx4 v0, s[4:7], s47 offen offset:3072 sc1 lds
    v_mfma_f32_16x16x32_bf16 v[12:15], v[236:239], v[28:31], v[12:15]
    v_mfma_f32_16x16x32_bf16 v[16:19], v[240:243], v[28:31], v[16:19]
    s_waitcnt lgkmcnt(0)
    v_mfma_f32_16x16x32_bf16 v[8:11], v[244:247], v[32:35], v[8:11]
    ds_read_b32 v77, v76
    v_mfma_f32_16x16x32_bf16 v[12:15], v[248:251], v[32:35], v[12:15]
    s_add_u32 m0, s43, 8192
    s_add_u32 s47, s42, 8192
    buffer_load_dwordx4 v0, s[4:7], s47 offen offset:0 sc1 lds
    s_add_u32 s42, s42, 294912
    s_xor_b32 s43, s43, 65536
    v_mfma_f32_16x16x32_bf16 v[16:19], v[252:255], v[32:35], v[16:19]
    v_xor_b32 v3, 65536, v3
    v_cvt_pk_bf16_f32 v60, v8, v9
    v_cvt_pk_bf16_f32 v61, v10, v11
    v_cvt_pk_bf16_f32 v62, v12, v13
    v_cvt_pk_bf16_f32 v63, v14, v15
    buffer_store_dwordx4 v[60:63], v0, s[4:7], s41 offen sc1
    s_nop 1
    v_cvt_pk_bf16_f32 v64, v16, v17
    v_cvt_pk_bf16_f32 v65, v18, v19
    buffer_store_dwordx2 v[64:65], v6, s[4:7], s41 offen sc1
    s_add_u32 s41, s41, 147456
    s_add_u32 s40, s40, 1
    s_waitcnt lgkmcnt(0)
    v_cmp_ne_u32 vcc, s40, v77
    s_cbranch_vccnz F2_P
    s_waitcnt vmcnt(2)
    s_mov_b32 s46, 1
    s_branch F2_L
F2_E:
    s_endpgm
R_WO:
    s_mov_b32 s12, s74
    s_mov_b32 s13, s75
    s_mov_b32 s14, 0x480000
    s_mov_b32 s15, 0x20000
    v_lshrrev_b32 v7, 2, v1
    v_mul_u32_u24 v8, 1152, v7
    v_and_b32 v6, 3, v1
    v_lshl_add_u32 v8, v6, 4, v8
    v_lshrrev_b32 v5, 4, v1
    v_and_b32 v7, 3, v7
    v_lshl_add_u32 v7, v5, 2, v7
    v_lshlrev_b32 v10, 6, v7
    v_lshl_add_u32 v10, v6, 4, v10
    s_mul_i32 s30, s24, 40960
    v_add_u32 v10, s30, v10
    s_mul_i32 s33, s36, 1179648
    s_mul_i32 s34, s38, 384
    s_add_u32 s33, s33, s34
    s_lshr_b32 s34, s24, 1
    s_lshl_b32 s34, s34, 6
    s_add_u32 s34, s34, s33
    v_add_u32 v9, s34, v8
    s_lshl_b32 s34, s24, 6
    s_add_u32 s34, s34, s33
    v_add_u32 v8, s34, v8
    s_and_b32 s34, s24, 1
    s_lshl_b32 s34, s34, 3
    v_add_u32 v11, s34, v10
    s_mul_i32 s30, s24, 40960
    s_add_u32 m0, s30, 0
    s_mov_b32 s31, 0
    buffer_load_dwordx4 v8, s[12:15], s31 offen lds
    s_add_u32 m0, s30, 1024
    s_mov_b32 s31, 18432
    buffer_load_dwordx4 v8, s[12:15], s31 offen lds
    s_add_u32 m0, s30, 2048
    s_mov_b32 s31, 256
    buffer_load_dwordx4 v9, s[12:15], s31 offen lds
    s_add_u32 m0, s30, 3072
    s_mov_b32 s31, 18688
    buffer_load_dwordx4 v9, s[12:15], s31 offen lds
    s_add_u32 m0, s30, 4096
    s_mov_b32 s31, 36864
    buffer_load_dwordx4 v8, s[12:15], s31 offen lds
    s_add_u32 m0, s30, 5120
    s_mov_b32 s31, 55296
    buffer_load_dwordx4 v8, s[12:15], s31 offen lds
    s_add_u32 m0, s30, 6144
    s_mov_b32 s31, 37120
    buffer_load_dwordx4 v9, s[12:15], s31 offen lds
    s_add_u32 m0, s30, 7168
    s_mov_b32 s31, 55552
    buffer_load_dwordx4 v9, s[12:15], s31 offen lds
    s_add_u32 m0, s30, 8192
    s_mov_b32 s31, 73728
    buffer_load_dwordx4 v8, s[12:15], s31 offen lds
    s_add_u32 m0, s30, 9216
    s_mov_b32 s31, 92160
    buffer_load_dwordx4 v8, s[12:15], s31 offen lds
    s_add_u32 m0, s30, 10240
    s_mov_b32 s31, 73984
    buffer_load_dwordx4 v9, s[12:15], s31 offen lds
    s_add_u32 m0, s30, 11264
    s_mov_b32 s31, 92416
    buffer_load_dwordx4 v9, s[12:15], s31 offen lds
    s_add_u32 m0, s30, 12288
    s_mov_b32 s31, 110592
    buffer_load_dwordx4 v8, s[12:15], s31 offen lds
    s_add_u32 m0, s30, 13312
    s_mov_b32 s31, 129024
    buffer_load_dwordx4 v8, s[12:15], s31 offen lds
    s_add_u32 m0, s30, 14336
    s_mov_b32 s31, 110848
    buffer_load_dwordx4 v9, s[12:15], s31 offen lds
    s_add_u32 m0, s30, 15360
    s_mov_b32 s31, 129280
    buffer_load_dwordx4 v9, s[12:15], s31 offen lds
    s_add_u32 m0, s30, 16384
    s_mov_b32 s31, 147456
    buffer_load_dwordx4 v8, s[12:15], s31 offen lds
    s_add_u32 m0, s30, 17408
    s_mov_b32 s31, 165888
    buffer_load_dwordx4 v8, s[12:15], s31 offen lds
    s_add_u32 m0, s30, 18432
    s_mov_b32 s31, 147712
    buffer_load_dwordx4 v9, s[12:15], s31 offen lds
    s_add_u32 m0, s30, 19456
    s_mov_b32 s31, 166144
    buffer_load_dwordx4 v9, s[12:15], s31 offen lds
    s_add_u32 m0, s30, 20480
    s_mov_b32 s31, 184320
    buffer_load_dwordx4 v8, s[12:15], s31 offen lds
    s_add_u32 m0, s30, 21504
    s_mov_b32 s31, 202752
    buffer_load_dwordx4 v8, s[12:15], s31 offen lds
    s_add_u32 m0, s30, 22528
    s_mov_b32 s31, 184576
    buffer_load_dwordx4 v9, s[12:15], s31 offen lds
    s_add_u32 m0, s30, 23552
    s_mov_b32 s31, 203008
    buffer_load_dwordx4 v9, s[12:15], s31 offen lds
    s_add_u32 m0, s30, 24576
    s_mov_b32 s31, 221184
    buffer_load_dwordx4 v8, s[12:15], s31 offen lds
    s_add_u32 m0, s30, 25600
    s_mov_b32 s31, 239616
    buffer_load_dwordx4 v8, s[12:15], s31 offen lds
    s_add_u32 m0, s30, 26624
    s_mov_b32 s31, 221440
    buffer_load_dwordx4 v9, s[12:15], s31 offen lds
    s_add_u32 m0, s30, 27648
    s_mov_b32 s31, 239872
    buffer_load_dwordx4 v9, s[12:15], s31 offen lds
    s_add_u32 m0, s30, 28672
    s_mov_b32 s31, 258048
    buffer_load_dwordx4 v8, s[12:15], s31 offen lds
    s_add_u32 m0, s30, 29696
    s_mov_b32 s31, 276480
    buffer_load_dwordx4 v8, s[12:15], s31 offen lds
    s_add_u32 m0, s30, 30720
    s_mov_b32 s31, 258304
    buffer_load_dwordx4 v9, s[12:15], s31 offen lds
    s_add_u32 m0, s30, 31744
    s_mov_b32 s31, 276736
    buffer_load_dwordx4 v9, s[12:15], s31 offen lds
    s_add_u32 m0, s30, 32768
    s_mov_b32 s31, 294912
    buffer_load_dwordx4 v8, s[12:15], s31 offen lds
    s_add_u32 m0, s30, 33792
    s_mov_b32 s31, 313344
    buffer_load_dwordx4 v8, s[12:15], s31 offen lds
    s_add_u32 m0, s30, 34816
    s_mov_b32 s31, 295168
    buffer_load_dwordx4 v9, s[12:15], s31 offen lds
    s_add_u32 m0, s30, 35840
    s_mov_b32 s31, 313600
    buffer_load_dwordx4 v9, s[12:15], s31 offen lds
    s_add_u32 m0, s30, 36864
    s_mov_b32 s31, 331776
    buffer_load_dwordx4 v8, s[12:15], s31 offen lds
    s_add_u32 m0, s30, 37888
    s_mov_b32 s31, 350208
    buffer_load_dwordx4 v8, s[12:15], s31 offen lds
    s_add_u32 m0, s30, 38912
    s_mov_b32 s31, 332032
    buffer_load_dwordx4 v9, s[12:15], s31 offen lds
    s_add_u32 m0, s30, 39936
    s_mov_b32 s31, 350464
    buffer_load_dwordx4 v9, s[12:15], s31 offen lds
    s_waitcnt vmcnt(34)
    ds_read_b64_tr_b16 a[0:1], v10 offset:0
    ds_read_b64_tr_b16 a[2:3], v10 offset:1024
    ds_read_b64_tr_b16 a[4:5], v10 offset:8
    ds_read_b64_tr_b16 a[6:7], v10 offset:1032
    ds_read_b64_tr_b16 a[8:9], v11 offset:2048
    ds_read_b64_tr_b16 a[10:11], v11 offset:3072
    ds_read_b64_tr_b16 a[12:13], v10 offset:4096
    ds_read_b64_tr_b16 a[14:15], v10 offset:5120
    ds_read_b64_tr_b16 a[16:17], v10 offset:4104
    ds_read_b64_tr_b16 a[18:19], v10 offset:5128
    s_waitcnt lgkmcnt(0)
    s_add_u32 m0, s30, 0
    s_mov_b32 s31, 368640
    buffer_load_dwordx4 v8, s[12:15], s31 offen lds
    s_add_u32 m0, s30, 1024
    s_mov_b32 s31, 387072
    buffer_load_dwordx4 v8, s[12:15], s31 offen lds
    s_add_u32 m0, s30, 2048
    s_mov_b32 s31, 368896
    buffer_load_dwordx4 v9, s[12:15], s31 offen lds
    s_add_u32 m0, s30, 3072
    s_mov_b32 s31, 387328
    buffer_load_dwordx4 v9, s[12:15], s31 offen lds
    s_add_u32 m0, s30, 4096
    s_mov_b32 s31, 405504
    buffer_load_dwordx4 v8, s[12:15], s31 offen lds
    s_add_u32 m0, s30, 5120
    s_mov_b32 s31, 423936
    buffer_load_dwordx4 v8, s[12:15], s31 offen lds
    s_waitcnt vmcnt(34)
    ds_read_b64_tr_b16 a[20:21], v11 offset:6144
    ds_read_b64_tr_b16 a[22:23], v11 offset:7168
    ds_read_b64_tr_b16 a[24:25], v10 offset:8192
    ds_read_b64_tr_b16 a[26:27], v10 offset:9216
    ds_read_b64_tr_b16 a[28:29], v10 offset:8200
    ds_read_b64_tr_b16 a[30:31], v10 offset:9224
    ds_read_b64_tr_b16 a[32:33], v11 offset:10240
    ds_read_b64_tr_b16 a[34:35], v11 offset:11264
    s_waitcnt lgkmcnt(0)
    s_add_u32 m0, s30, 6144
    s_mov_b32 s31, 405760
    buffer_load_dwordx4 v9, s[12:15], s31 offen lds
    s_add_u32 m0, s30, 7168
    s_mov_b32 s31, 424192
    buffer_load_dwordx4 v9, s[12:15], s31 offen lds
    s_add_u32 m0, s30, 8192
    s_mov_b32 s31, 442368
    buffer_load_dwordx4 v8, s[12:15], s31 offen lds
    s_add_u32 m0, s30, 9216
    s_mov_b32 s31, 460800
    buffer_load_dwordx4 v8, s[12:15], s31 offen lds
    s_add_u32 m0, s30, 10240
    s_mov_b32 s31, 442624
    buffer_load_dwordx4 v9, s[12:15], s31 offen lds
    s_add_u32 m0, s30, 11264
    s_mov_b32 s31, 461056
    buffer_load_dwordx4 v9, s[12:15], s31 offen lds
    s_waitcnt vmcnt(34)
    ds_read_b64_tr_b16 a[36:37], v10 offset:12288
    ds_read_b64_tr_b16 a[38:39], v10 offset:13312
    ds_read_b64_tr_b16 a[40:41], v10 offset:12296
    ds_read_b64_tr_b16 a[42:43], v10 offset:13320
    ds_read_b64_tr_b16 a[44:45], v11 offset:14336
    ds_read_b64_tr_b16 a[46:47], v11 offset:15360
    ds_read_b64_tr_b16 a[48:49], v10 offset:16384
    ds_read_b64_tr_b16 a[50:51], v10 offset:17408
    ds_read_b64_tr_b16 a[52:53], v10 offset:16392
    ds_read_b64_tr_b16 a[54:55], v10 offset:17416
    s_waitcnt lgkmcnt(0)
    s_add_u32 m0, s30, 12288
    s_mov_b32 s31, 479232
    buffer_load_dwordx4 v8, s[12:15], s31 offen lds
    s_add_u32 m0, s30, 13312
    s_mov_b32 s31, 497664
    buffer_load_dwordx4 v8, s[12:15], s31 offen lds
    s_add_u32 m0, s30, 14336
    s_mov_b32 s31, 479488
    buffer_load_dwordx4 v9, s[12:15], s31 offen lds
    s_add_u32 m0, s30, 15360
    s_mov_b32 s31, 497920
    buffer_load_dwordx4 v9, s[12:15], s31 offen lds
    s_add_u32 m0, s30, 16384
    s_mov_b32 s31, 516096
    buffer_load_dwordx4 v8, s[12:15], s31 offen lds
    s_add_u32 m0, s30, 17408
    s_mov_b32 s31, 534528
    buffer_load_dwordx4 v8, s[12:15], s31 offen lds
    s_waitcnt vmcnt(34)
    ds_read_b64_tr_b16 a[56:57], v11 offset:18432
    ds_read_b64_tr_b16 a[58:59], v11 offset:19456
    ds_read_b64_tr_b16 a[60:61], v10 offset:20480
    ds_read_b64_tr_b16 a[62:63], v10 offset:21504
    ds_read_b64_tr_b16 a[64:65], v10 offset:20488
    ds_read_b64_tr_b16 a[66:67], v10 offset:21512
    ds_read_b64_tr_b16 a[68:69], v11 offset:22528
    ds_read_b64_tr_b16 a[70:71], v11 offset:23552
    s_waitcnt lgkmcnt(0)
    s_add_u32 m0, s30, 18432
    s_mov_b32 s31, 516352
    buffer_load_dwordx4 v9, s[12:15], s31 offen lds
    s_add_u32 m0, s30, 19456
    s_mov_b32 s31, 534784
    buffer_load_dwordx4 v9, s[12:15], s31 offen lds
    s_add_u32 m0, s30, 20480
    s_mov_b32 s31, 552960
    buffer_load_dwordx4 v8, s[12:15], s31 offen lds
    s_add_u32 m0, s30, 21504
    s_mov_b32 s31, 571392
    buffer_load_dwordx4 v8, s[12:15], s31 offen lds
    s_add_u32 m0, s30, 22528
    s_mov_b32 s31, 553216
    buffer_load_dwordx4 v9, s[12:15], s31 offen lds
    s_add_u32 m0, s30, 23552
    s_mov_b32 s31, 571648
    buffer_load_dwordx4 v9, s[12:15], s31 offen lds
    s_waitcnt vmcnt(34)
    ds_read_b64_tr_b16 a[72:73], v10 offset:24576
    ds_read_b64_tr_b16 a[74:75], v10 offset:25600
    ds_read_b64_tr_b16 a[76:77], v10 offset:24584
    ds_read_b64_tr_b16 a[78:79], v10 offset:25608
    ds_read_b64_tr_b16 a[80:81], v11 offset:26624
    ds_read_b64_tr_b16 a[82:83], v11 offset:27648
    ds_read_b64_tr_b16 a[84:85], v10 offset:28672
    ds_read_b64_tr_b16 a[86:87], v10 offset:29696
    ds_read_b64_tr_b16 a[88:89], v10 offset:28680
    ds_read_b64_tr_b16 a[90:91], v10 offset:29704
    s_waitcnt lgkmcnt(0)
    s_add_u32 m0, s30, 24576
    s_mov_b32 s31, 589824
    buffer_load_dwordx4 v8, s[12:15], s31 offen lds
    s_add_u32 m0, s30, 25600
    s_mov_b32 s31, 608256
    buffer_load_dwordx4 v8, s[12:15], s31 offen lds
    s_add_u32 m0, s30, 26624
    s_mov_b32 s31, 590080
    buffer_load_dwordx4 v9, s[12:15], s31 offen lds
    s_add_u32 m0, s30, 27648
    s_mov_b32 s31, 608512
    buffer_load_dwordx4 v9, s[12:15], s31 offen lds
    s_add_u32 m0, s30, 28672
    s_mov_b32 s31, 626688
    buffer_load_dwordx4 v8, s[12:15], s31 offen lds
    s_add_u32 m0, s30, 29696
    s_mov_b32 s31, 645120
    buffer_load_dwordx4 v8, s[12:15], s31 offen lds
    s_waitcnt vmcnt(34)
    ds_read_b64_tr_b16 a[92:93], v11 offset:30720
    ds_read_b64_tr_b16 a[94:95], v11 offset:31744
    ds_read_b64_tr_b16 a[96:97], v10 offset:32768
    ds_read_b64_tr_b16 a[98:99], v10 offset:33792
    ds_read_b64_tr_b16 a[100:101], v10 offset:32776
    ds_read_b64_tr_b16 a[102:103], v10 offset:33800
    ds_read_b64_tr_b16 a[104:105], v11 offset:34816
    ds_read_b64_tr_b16 a[106:107], v11 offset:35840
    s_waitcnt lgkmcnt(0)
    s_add_u32 m0, s30, 30720
    s_mov_b32 s31, 626944
    buffer_load_dwordx4 v9, s[12:15], s31 offen lds
    s_add_u32 m0, s30, 31744
    s_mov_b32 s31, 645376
    buffer_load_dwordx4 v9, s[12:15], s31 offen lds
    s_add_u32 m0, s30, 32768
    s_mov_b32 s31, 663552
    buffer_load_dwordx4 v8, s[12:15], s31 offen lds
    s_add_u32 m0, s30, 33792
    s_mov_b32 s31, 681984
    buffer_load_dwordx4 v8, s[12:15], s31 offen lds
    s_add_u32 m0, s30, 34816
    s_mov_b32 s31, 663808
    buffer_load_dwordx4 v9, s[12:15], s31 offen lds
    s_add_u32 m0, s30, 35840
    s_mov_b32 s31, 682240
    buffer_load_dwordx4 v9, s[12:15], s31 offen lds
    s_waitcnt vmcnt(34)
    ds_read_b64_tr_b16 a[108:109], v10 offset:36864
    ds_read_b64_tr_b16 a[110:111], v10 offset:37888
    ds_read_b64_tr_b16 a[112:113], v10 offset:36872
    ds_read_b64_tr_b16 a[114:115], v10 offset:37896
    ds_read_b64_tr_b16 a[116:117], v11 offset:38912
    ds_read_b64_tr_b16 a[118:119], v11 offset:39936
    ds_read_b64_tr_b16 a[120:121], v10 offset:0
    ds_read_b64_tr_b16 a[122:123], v10 offset:1024
    ds_read_b64_tr_b16 a[124:125], v10 offset:8
    ds_read_b64_tr_b16 a[126:127], v10 offset:1032
    s_waitcnt lgkmcnt(0)
    s_add_u32 m0, s30, 36864
    s_mov_b32 s31, 700416
    buffer_load_dwordx4 v8, s[12:15], s31 offen lds
    s_add_u32 m0, s30, 37888
    s_mov_b32 s31, 718848
    buffer_load_dwordx4 v8, s[12:15], s31 offen lds
    s_add_u32 m0, s30, 38912
    s_mov_b32 s31, 700672
    buffer_load_dwordx4 v9, s[12:15], s31 offen lds
    s_add_u32 m0, s30, 39936
    s_mov_b32 s31, 719104
    buffer_load_dwordx4 v9, s[12:15], s31 offen lds
    s_add_u32 m0, s30, 0
    s_mov_b32 s31, 737280
    buffer_load_dwordx4 v8, s[12:15], s31 offen lds
    s_add_u32 m0, s30, 1024
    s_mov_b32 s31, 755712
    buffer_load_dwordx4 v8, s[12:15], s31 offen lds
    s_waitcnt vmcnt(34)
    ds_read_b64_tr_b16 a[128:129], v11 offset:2048
    ds_read_b64_tr_b16 a[130:131], v11 offset:3072
    ds_read_b64_tr_b16 a[132:133], v10 offset:4096
    ds_read_b64_tr_b16 a[134:135], v10 offset:5120
    ds_read_b64_tr_b16 a[136:137], v10 offset:4104
    ds_read_b64_tr_b16 a[138:139], v10 offset:5128
    ds_read_b64_tr_b16 a[140:141], v11 offset:6144
    ds_read_b64_tr_b16 a[142:143], v11 offset:7168
    s_waitcnt lgkmcnt(0)
    s_add_u32 m0, s30, 2048
    s_mov_b32 s31, 737536
    buffer_load_dwordx4 v9, s[12:15], s31 offen lds
    s_add_u32 m0, s30, 3072
    s_mov_b32 s31, 755968
    buffer_load_dwordx4 v9, s[12:15], s31 offen lds
    s_add_u32 m0, s30, 4096
    s_mov_b32 s31, 774144
    buffer_load_dwordx4 v8, s[12:15], s31 offen lds
    s_add_u32 m0, s30, 5120
    s_mov_b32 s31, 792576
    buffer_load_dwordx4 v8, s[12:15], s31 offen lds
    s_add_u32 m0, s30, 6144
    s_mov_b32 s31, 774400
    buffer_load_dwordx4 v9, s[12:15], s31 offen lds
    s_add_u32 m0, s30, 7168
    s_mov_b32 s31, 792832
    buffer_load_dwordx4 v9, s[12:15], s31 offen lds
    s_waitcnt vmcnt(34)
    ds_read_b64_tr_b16 a[144:145], v10 offset:8192
    ds_read_b64_tr_b16 a[146:147], v10 offset:9216
    ds_read_b64_tr_b16 a[148:149], v10 offset:8200
    ds_read_b64_tr_b16 a[150:151], v10 offset:9224
    ds_read_b64_tr_b16 a[152:153], v11 offset:10240
    ds_read_b64_tr_b16 a[154:155], v11 offset:11264
    ds_read_b64_tr_b16 a[156:157], v10 offset:12288
    ds_read_b64_tr_b16 a[158:159], v10 offset:13312
    ds_read_b64_tr_b16 a[160:161], v10 offset:12296
    ds_read_b64_tr_b16 a[162:163], v10 offset:13320
    s_waitcnt lgkmcnt(0)
    s_add_u32 m0, s30, 8192
    s_mov_b32 s31, 811008
    buffer_load_dwordx4 v8, s[12:15], s31 offen lds
    s_add_u32 m0, s30, 9216
    s_mov_b32 s31, 829440
    buffer_load_dwordx4 v8, s[12:15], s31 offen lds
    s_add_u32 m0, s30, 10240
    s_mov_b32 s31, 811264
    buffer_load_dwordx4 v9, s[12:15], s31 offen lds
    s_add_u32 m0, s30, 11264
    s_mov_b32 s31, 829696
    buffer_load_dwordx4 v9, s[12:15], s31 offen lds
    s_add_u32 m0, s30, 12288
    s_mov_b32 s31, 847872
    buffer_load_dwordx4 v8, s[12:15], s31 offen lds
    s_add_u32 m0, s30, 13312
    s_mov_b32 s31, 866304
    buffer_load_dwordx4 v8, s[12:15], s31 offen lds
    s_waitcnt vmcnt(34)
    ds_read_b64_tr_b16 a[164:165], v11 offset:14336
    ds_read_b64_tr_b16 a[166:167], v11 offset:15360
    ds_read_b64_tr_b16 a[168:169], v10 offset:16384
    ds_read_b64_tr_b16 a[170:171], v10 offset:17408
    ds_read_b64_tr_b16 a[172:173], v10 offset:16392
    ds_read_b64_tr_b16 a[174:175], v10 offset:17416
    ds_read_b64_tr_b16 a[176:177], v11 offset:18432
    ds_read_b64_tr_b16 a[178:179], v11 offset:19456
    s_waitcnt lgkmcnt(0)
    s_add_u32 m0, s30, 14336
    s_mov_b32 s31, 848128
    buffer_load_dwordx4 v9, s[12:15], s31 offen lds
    s_add_u32 m0, s30, 15360
    s_mov_b32 s31, 866560
    buffer_load_dwordx4 v9, s[12:15], s31 offen lds
    s_add_u32 m0, s30, 16384
    s_mov_b32 s31, 884736
    buffer_load_dwordx4 v8, s[12:15], s31 offen lds
    s_add_u32 m0, s30, 17408
    s_mov_b32 s31, 903168
    buffer_load_dwordx4 v8, s[12:15], s31 offen lds
    s_add_u32 m0, s30, 18432
    s_mov_b32 s31, 884992
    buffer_load_dwordx4 v9, s[12:15], s31 offen lds
    s_add_u32 m0, s30, 19456
    s_mov_b32 s31, 903424
    buffer_load_dwordx4 v9, s[12:15], s31 offen lds
    s_waitcnt vmcnt(34)
    ds_read_b64_tr_b16 a[180:181], v10 offset:20480
    ds_read_b64_tr_b16 a[182:183], v10 offset:21504
    ds_read_b64_tr_b16 a[184:185], v10 offset:20488
    ds_read_b64_tr_b16 a[186:187], v10 offset:21512
    ds_read_b64_tr_b16 a[188:189], v11 offset:22528
    ds_read_b64_tr_b16 a[190:191], v11 offset:23552
    ds_read_b64_tr_b16 a[192:193], v10 offset:24576
    ds_read_b64_tr_b16 a[194:195], v10 offset:25600
    ds_read_b64_tr_b16 a[196:197], v10 offset:24584
    ds_read_b64_tr_b16 a[198:199], v10 offset:25608
    s_waitcnt lgkmcnt(0)
    s_add_u32 m0, s30, 20480
    s_mov_b32 s31, 921600
    buffer_load_dwordx4 v8, s[12:15], s31 offen lds
    s_add_u32 m0, s30, 21504
    s_mov_b32 s31, 940032
    buffer_load_dwordx4 v8, s[12:15], s31 offen lds
    s_add_u32 m0, s30, 22528
    s_mov_b32 s31, 921856
    buffer_load_dwordx4 v9, s[12:15], s31 offen lds
    s_add_u32 m0, s30, 23552
    s_mov_b32 s31, 940288
    buffer_load_dwordx4 v9, s[12:15], s31 offen lds
    s_add_u32 m0, s30, 24576
    s_mov_b32 s31, 958464
    buffer_load_dwordx4 v8, s[12:15], s31 offen lds
    s_add_u32 m0, s30, 25600
    s_mov_b32 s31, 976896
    buffer_load_dwordx4 v8, s[12:15], s31 offen lds
    s_waitcnt vmcnt(34)
    ds_read_b64_tr_b16 a[200:201], v11 offset:26624
    ds_read_b64_tr_b16 a[202:203], v11 offset:27648
    ds_read_b64_tr_b16 a[204:205], v10 offset:28672
    ds_read_b64_tr_b16 a[206:207], v10 offset:29696
    ds_read_b64_tr_b16 a[208:209], v10 offset:28680
    ds_read_b64_tr_b16 a[210:211], v10 offset:29704
    ds_read_b64_tr_b16 a[212:213], v11 offset:30720
    ds_read_b64_tr_b16 a[214:215], v11 offset:31744
    s_waitcnt lgkmcnt(0)
    s_add_u32 m0, s30, 26624
    s_mov_b32 s31, 958720
    buffer_load_dwordx4 v9, s[12:15], s31 offen lds
    s_add_u32 m0, s30, 27648
    s_mov_b32 s31, 977152
    buffer_load_dwordx4 v9, s[12:15], s31 offen lds
    s_add_u32 m0, s30, 28672
    s_mov_b32 s31, 995328
    buffer_load_dwordx4 v8, s[12:15], s31 offen lds
    s_add_u32 m0, s30, 29696
    s_mov_b32 s31, 1013760
    buffer_load_dwordx4 v8, s[12:15], s31 offen lds
    s_add_u32 m0, s30, 30720
    s_mov_b32 s31, 995584
    buffer_load_dwordx4 v9, s[12:15], s31 offen lds
    s_add_u32 m0, s30, 31744
    s_mov_b32 s31, 1014016
    buffer_load_dwordx4 v9, s[12:15], s31 offen lds
    s_waitcnt vmcnt(34)
    ds_read_b64_tr_b16 a[216:217], v10 offset:32768
    ds_read_b64_tr_b16 a[218:219], v10 offset:33792
    ds_read_b64_tr_b16 a[220:221], v10 offset:32776
    ds_read_b64_tr_b16 a[222:223], v10 offset:33800
    ds_read_b64_tr_b16 a[224:225], v11 offset:34816
    ds_read_b64_tr_b16 a[226:227], v11 offset:35840
    ds_read_b64_tr_b16 a[228:229], v10 offset:36864
    ds_read_b64_tr_b16 a[230:231], v10 offset:37888
    ds_read_b64_tr_b16 a[232:233], v10 offset:36872
    ds_read_b64_tr_b16 a[234:235], v10 offset:37896
    s_waitcnt lgkmcnt(0)
    s_add_u32 m0, s30, 32768
    s_mov_b32 s31, 1032192
    buffer_load_dwordx4 v8, s[12:15], s31 offen lds
    s_add_u32 m0, s30, 33792
    s_mov_b32 s31, 1050624
    buffer_load_dwordx4 v8, s[12:15], s31 offen lds
    s_add_u32 m0, s30, 34816
    s_mov_b32 s31, 1032448
    buffer_load_dwordx4 v9, s[12:15], s31 offen lds
    s_add_u32 m0, s30, 35840
    s_mov_b32 s31, 1050880
    buffer_load_dwordx4 v9, s[12:15], s31 offen lds
    s_add_u32 m0, s30, 36864
    s_mov_b32 s31, 1069056
    buffer_load_dwordx4 v8, s[12:15], s31 offen lds
    s_add_u32 m0, s30, 37888
    s_mov_b32 s31, 1087488
    buffer_load_dwordx4 v8, s[12:15], s31 offen lds
    s_waitcnt vmcnt(34)
    ds_read_b64_tr_b16 a[236:237], v11 offset:38912
    ds_read_b64_tr_b16 a[238:239], v11 offset:39936
    ds_read_b64_tr_b16 a[240:241], v10 offset:0
    ds_read_b64_tr_b16 a[242:243], v10 offset:1024
    ds_read_b64_tr_b16 a[244:245], v10 offset:8
    ds_read_b64_tr_b16 a[246:247], v10 offset:1032
    ds_read_b64_tr_b16 a[248:249], v11 offset:2048
    ds_read_b64_tr_b16 a[250:251], v11 offset:3072
    s_waitcnt lgkmcnt(0)
    s_add_u32 m0, s30, 38912
    s_mov_b32 s31, 1069312
    buffer_load_dwordx4 v9, s[12:15], s31 offen lds
    s_add_u32 m0, s30, 39936
    s_mov_b32 s31, 1087744
    buffer_load_dwordx4 v9, s[12:15], s31 offen lds
    s_add_u32 m0, s30, 0
    s_mov_b32 s31, 1105920
    buffer_load_dwordx4 v8, s[12:15], s31 offen lds
    s_add_u32 m0, s30, 1024
    s_mov_b32 s31, 1124352
    buffer_load_dwordx4 v8, s[12:15], s31 offen lds
    s_add_u32 m0, s30, 2048
    s_mov_b32 s31, 1106176
    buffer_load_dwordx4 v9, s[12:15], s31 offen lds
    s_add_u32 m0, s30, 3072
    s_mov_b32 s31, 1124608
    buffer_load_dwordx4 v9, s[12:15], s31 offen lds
    s_waitcnt vmcnt(34)
    ds_read_b64_tr_b16 a[252:253], v10 offset:4096
    ds_read_b64_tr_b16 a[254:255], v10 offset:5120
    ds_read_b64_tr_b16 v[128:129], v10 offset:4104
    ds_read_b64_tr_b16 v[130:131], v10 offset:5128
    ds_read_b64_tr_b16 v[132:133], v11 offset:6144
    ds_read_b64_tr_b16 v[134:135], v11 offset:7168
    ds_read_b64_tr_b16 v[136:137], v10 offset:8192
    ds_read_b64_tr_b16 v[138:139], v10 offset:9216
    ds_read_b64_tr_b16 v[140:141], v10 offset:8200
    ds_read_b64_tr_b16 v[142:143], v10 offset:9224
    s_waitcnt lgkmcnt(0)
    s_add_u32 m0, s30, 4096
    s_mov_b32 s31, 1142784
    buffer_load_dwordx4 v8, s[12:15], s31 offen lds
    s_add_u32 m0, s30, 5120
    s_mov_b32 s31, 1161216
    buffer_load_dwordx4 v8, s[12:15], s31 offen lds
    s_add_u32 m0, s30, 6144
    s_mov_b32 s31, 1143040
    buffer_load_dwordx4 v9, s[12:15], s31 offen lds
    s_add_u32 m0, s30, 7168
    s_mov_b32 s31, 1161472
    buffer_load_dwordx4 v9, s[12:15], s31 offen lds
    s_waitcnt vmcnt(32)
    ds_read_b64_tr_b16 v[144:145], v11 offset:10240
    ds_read_b64_tr_b16 v[146:147], v11 offset:11264
    ds_read_b64_tr_b16 v[148:149], v10 offset:12288
    ds_read_b64_tr_b16 v[150:151], v10 offset:13312
    ds_read_b64_tr_b16 v[152:153], v10 offset:12296
    ds_read_b64_tr_b16 v[154:155], v10 offset:13320
    ds_read_b64_tr_b16 v[156:157], v11 offset:14336
    ds_read_b64_tr_b16 v[158:159], v11 offset:15360
    s_waitcnt vmcnt(26) lgkmcnt(0)
    ds_read_b64_tr_b16 v[160:161], v10 offset:16384
    ds_read_b64_tr_b16 v[162:163], v10 offset:17408
    ds_read_b64_tr_b16 v[164:165], v10 offset:16392
    ds_read_b64_tr_b16 v[166:167], v10 offset:17416
    ds_read_b64_tr_b16 v[168:169], v11 offset:18432
    ds_read_b64_tr_b16 v[170:171], v11 offset:19456
    ds_read_b64_tr_b16 v[172:173], v10 offset:20480
    ds_read_b64_tr_b16 v[174:175], v10 offset:21504
    ds_read_b64_tr_b16 v[176:177], v10 offset:20488
    ds_read_b64_tr_b16 v[178:179], v10 offset:21512
    s_waitcnt vmcnt(20) lgkmcnt(0)
    ds_read_b64_tr_b16 v[180:181], v11 offset:22528
    ds_read_b64_tr_b16 v[182:183], v11 offset:23552
    ds_read_b64_tr_b16 v[184:185], v10 offset:24576
    ds_read_b64_tr_b16 v[186:187], v10 offset:25600
    ds_read_b64_tr_b16 v[188:189], v10 offset:24584
    ds_read_b64_tr_b16 v[190:191], v10 offset:25608
    ds_read_b64_tr_b16 v[192:193], v11 offset:26624
    ds_read_b64_tr_b16 v[194:195], v11 offset:27648
    s_waitcnt vmcnt(14) lgkmcnt(0)
    ds_read_b64_tr_b16 v[196:197], v10 offset:28672
    ds_read_b64_tr_b16 v[198:199], v10 offset:29696
    ds_read_b64_tr_b16 v[200:201], v10 offset:28680
    ds_read_b64_tr_b16 v[202:203], v10 offset:29704
    ds_read_b64_tr_b16 v[204:205], v11 offset:30720
    ds_read_b64_tr_b16 v[206:207], v11 offset:31744
    ds_read_b64_tr_b16 v[208:209], v10 offset:32768
    ds_read_b64_tr_b16 v[210:211], v10 offset:33792
    ds_read_b64_tr_b16 v[212:213], v10 offset:32776
    ds_read_b64_tr_b16 v[214:215], v10 offset:33800
    s_waitcnt vmcnt(8) lgkmcnt(0)
    ds_read_b64_tr_b16 v[216:217], v11 offset:34816
    ds_read_b64_tr_b16 v[218:219], v11 offset:35840
    ds_read_b64_tr_b16 v[220:221], v10 offset:36864
    ds_read_b64_tr_b16 v[222:223], v10 offset:37888
    ds_read_b64_tr_b16 v[224:225], v10 offset:36872
    ds_read_b64_tr_b16 v[226:227], v10 offset:37896
    ds_read_b64_tr_b16 v[228:229], v11 offset:38912
    ds_read_b64_tr_b16 v[230:231], v11 offset:39936
    s_waitcnt vmcnt(2) lgkmcnt(0)
    ds_read_b64_tr_b16 v[232:233], v10 offset:0
    ds_read_b64_tr_b16 v[234:235], v10 offset:1024
    ds_read_b64_tr_b16 v[236:237], v10 offset:8
    ds_read_b64_tr_b16 v[238:239], v10 offset:1032
    ds_read_b64_tr_b16 v[240:241], v11 offset:2048
    ds_read_b64_tr_b16 v[242:243], v11 offset:3072
    ds_read_b64_tr_b16 v[244:245], v10 offset:4096
    ds_read_b64_tr_b16 v[246:247], v10 offset:5120
    ds_read_b64_tr_b16 v[248:249], v10 offset:4104
    ds_read_b64_tr_b16 v[250:251], v10 offset:5128
    s_waitcnt vmcnt(0) lgkmcnt(0)
    ds_read_b64_tr_b16 v[252:253], v11 offset:6144
    ds_read_b64_tr_b16 v[254:255], v11 offset:7168
    s_waitcnt lgkmcnt(0)
    v_mov_b32 v6, 244
    s_mov_b32 s27, 0
SP_15:
    buffer_load_dword v7, v6, s[8:11], 0 offen sc1
    s_waitcnt vmcnt(0)
    v_cmp_gt_u32 vcc, 18, v7
    s_cbranch_vccz SD_16
    s_add_u32 s27, s27, 1
    s_cmp_lt_u32 s27, 400000
    s_cbranch_scc1 SP_15
    s_movk_i32 s27, 1
    s_branch FAIL
SD_16:
    s_mov_b32 s40, 0
    s_mul_i32 s33, s37, 4
    s_add_u32 s33, s33, s36
    s_mul_i32 s41, s33, 18432
    s_mul_i32 s34, s38, 6144
    s_add_u32 s41, s41, s34
    s_lshl_b32 s34, s24, 10
    s_add_u32 s41, s41, s34
    s_add_u32 s41, s41, 0x8000000
    s_lshl_b32 s34, s24, 9
    s_sub_u32 s34, 4096, s34
    v_lshlrev_b32 v6, 3, v1
    v_add_u32 v6, s34, v6
    s_lshl_b32 s33, s33, 2
    s_add_u32 s33, s33, s24
    s_mul_i32 s42, s33, 8192
    s_add_u32 s42, s42, 0x5000000
    s_lshl_b32 s33, s36, 2
    s_add_u32 s33, s33, s24
    s_lshl_b32 s34, s37, 2
    s_add_u32 s34, s34, s38
    s_lshl_b32 s34, s34, 4
    s_add_u32 s45, s34, s33
    s_add_u32 s45, s45, 3520
    s_lshl_b32 s45, s45, 7
    s_lshl_b32 s33, s33, 3
    s_add_u32 s33, s33, 3392
    v_min_u32 v4, 7, v1
    v_add_u32 v4, s33, v4
    v_lshlrev_b32 v4, 7, v4
    v_lshlrev_b32 v0, 4, v1
    v_mov_b32 v60, 0xff81ff81
    v_mov_b32 v61, 0xff81ff81
    v_mov_b32 v62, 0xff81ff81
    v_mov_b32 v63, 0xff81ff81
    s_add_u32 s34, s41, 8257536
    buffer_store_dwordx4 v[60:63], v0, s[4:7], s34 offen sc1
    buffer_store_dwordx2 v[60:61], v6, s[4:7], s34 offen sc1
    s_add_u32 s34, s41, 8404992
    buffer_store_dwordx4 v[60:63], v0, s[4:7], s34 offen sc1
    buffer_store_dwordx2 v[60:61], v6, s[4:7], s34 offen sc1
    s_add_u32 s34, s41, 8552448
    buffer_store_dwordx4 v[60:63], v0, s[4:7], s34 offen sc1
    buffer_store_dwordx2 v[60:61], v6, s[4:7], s34 offen sc1
    s_add_u32 s34, s41, 8699904
    buffer_store_dwordx4 v[60:63], v0, s[4:7], s34 offen sc1
    buffer_store_dwordx2 v[60:61], v6, s[4:7], s34 offen sc1
    s_add_u32 s34, s41, 8847360
    buffer_store_dwordx4 v[60:63], v0, s[4:7], s34 offen sc1
    buffer_store_dwordx2 v[60:61], v6, s[4:7], s34 offen sc1
    s_add_u32 s34, s41, 8994816
    buffer_store_dwordx4 v[60:63], v0, s[4:7], s34 offen sc1
    buffer_store_dwordx2 v[60:61], v6, s[4:7], s34 offen sc1
    s_add_u32 s34, s41, 9142272
    buffer_store_dwordx4 v[60:63], v0, s[4:7], s34 offen sc1
    buffer_store_dwordx2 v[60:61], v6, s[4:7], s34 offen sc1
    s_add_u32 s34, s41, 9289728
    buffer_store_dwordx4 v[60:63], v0, s[4:7], s34 offen sc1
    buffer_store_dwordx2 v[60:61], v6, s[4:7], s34 offen sc1
    v_lshlrev_b32 v0, 4, v1
    v_mov_b32 v3, v0
    v_mov_b32 v5, 0
    s_mul_i32 s43, s24, 8192
    s_mov_b32 s46, 0
    v_and_b32 v76, 3, v1
    v_cmp_eq_u32 s[54:55], s24, v76
    v_lshlrev_b32 v76, 2, v76
    v_add_u32 v76, 0x20000, v76
    s_barrier
    ds_write_b32 v76, v5
WO_S:
    s_add_u32 s48, s40, 1
    s_mov_b32 s27, 0
SP_17:
    buffer_load_dword v5, v4, s[4:7], 0 offen sc1
    s_waitcnt vmcnt(0)
    v_cmp_gt_u32 vcc, s48, v5
    s_cbranch_vccz SD_18
    s_add_u32 s27, s27, 1
    s_cmp_lt_u32 s27, 400000
    s_cbranch_scc1 SP_17
    s_movk_i32 s27, 20
    s_branch FAIL
SD_18:
WO_D:
    s_add_u32 m0, s43, 0
    s_nop 0
    buffer_load_dwordx4 v0, s[4:7], s42 offen offset:0 sc1 lds
    buffer_load_dwordx4 v0, s[4:7], s42 offen offset:1024 sc1 lds
    buffer_load_dwordx4 v0, s[4:7], s42 offen offset:2048 sc1 lds
    buffer_load_dwordx4 v0, s[4:7], s42 offen offset:3072 sc1 lds
    s_add_u32 m0, s43, 4096
    s_add_u32 s47, s42, 4096
    buffer_load_dwordx4 v0, s[4:7], s47 offen offset:0 sc1 lds
    buffer_load_dwordx4 v0, s[4:7], s47 offen offset:1024 sc1 lds
    buffer_load_dwordx4 v0, s[4:7], s47 offen offset:2048 sc1 lds
    buffer_load_dwordx4 v0, s[4:7], s47 offen offset:3072 sc1 lds
    s_add_u32 s42, s42, 262144
    s_xor_b32 s43, s43, 32768
    s_waitcnt vmcnt(0)
WO_L:
    s_barrier
    ds_read_b128 v[20:23], v3 offset:0
    ds_read_b128 v[24:27], v3 offset:1024
    ds_read_b128 v[28:31], v3 offset:2048
    ds_read_b128 v[32:35], v3 offset:3072
    ds_read_b128 v[36:39], v3 offset:4096
    ds_read_b128 v[40:43], v3 offset:5120
    s_add_u32 s44, s40, 1
    s_cmp_lt_u32 s44, 64
    s_cselect_b32 s44, s44, -1
    v_cmp_ge_u32 vcc, s44, v5
    s_cbranch_vccz WO_V0
    buffer_load_dword v5, v4, s[4:7], 0 offen sc1
    s_waitcnt lgkmcnt(5)
    v_mfma_f32_16x16x32_bf16 v[8:11], a[0:3], v[20:23], 0
    ds_read_b128 v[44:47], v3 offset:6144
    v_mfma_f32_16x16x32_bf16 v[12:15], a[4:7], v[20:23], 0
    v_mfma_f32_16x16x32_bf16 v[16:19], a[8:11], v[20:23], 0
    s_waitcnt lgkmcnt(5)
    v_mfma_f32_16x16x32_bf16 v[8:11], a[12:15], v[24:27], v[8:11]
    ds_read_b128 v[48:51], v3 offset:7168
    v_mfma_f32_16x16x32_bf16 v[12:15], a[16:19], v[24:27], v[12:15]
    v_mfma_f32_16x16x32_bf16 v[16:19], a[20:23], v[24:27], v[16:19]
    s_waitcnt lgkmcnt(5)
    v_mfma_f32_16x16x32_bf16 v[8:11], a[24:27], v[28:31], v[8:11]
    ds_read_b128 v[20:23], v3 offset:8192
    v_mfma_f32_16x16x32_bf16 v[12:15], a[28:31], v[28:31], v[12:15]
    v_mfma_f32_16x16x32_bf16 v[16:19], a[32:35], v[28:31], v[16:19]
    s_waitcnt lgkmcnt(5)
    v_mfma_f32_16x16x32_bf16 v[8:11], a[36:39], v[32:35], v[8:11]
    ds_read_b128 v[24:27], v3 offset:9216
    v_mfma_f32_16x16x32_bf16 v[12:15], a[40:43], v[32:35], v[12:15]
    v_mfma_f32_16x16x32_bf16 v[16:19], a[44:47], v[32:35], v[16:19]
    s_waitcnt lgkmcnt(5)
    v_mfma_f32_16x16x32_bf16 v[8:11], a[48:51], v[36:39], v[8:11]
    ds_read_b128 v[28:31], v3 offset:10240
    v_mfma_f32_16x16x32_bf16 v[12:15], a[52:55], v[36:39], v[12:15]
    v_mfma_f32_16x16x32_bf16 v[16:19], a[56:59], v[36:39], v[16:19]
    s_waitcnt lgkmcnt(5)
    v_mfma_f32_16x16x32_bf16 v[8:11], a[60:63], v[40:43], v[8:11]
    ds_read_b128 v[32:35], v3 offset:11264
    v_mfma_f32_16x16x32_bf16 v[12:15], a[64:67], v[40:43], v[12:15]
    v_mfma_f32_16x16x32_bf16 v[16:19], a[68:71], v[40:43], v[16:19]
    s_waitcnt lgkmcnt(5)
    v_mfma_f32_16x16x32_bf16 v[8:11], a[72:75], v[44:47], v[8:11]
    ds_read_b128 v[36:39], v3 offset:12288
    v_mfma_f32_16x16x32_bf16 v[12:15], a[76:79], v[44:47], v[12:15]
    v_mfma_f32_16x16x32_bf16 v[16:19], a[80:83], v[44:47], v[16:19]
    s_waitcnt lgkmcnt(5)
    v_mfma_f32_16x16x32_bf16 v[8:11], a[84:87], v[48:51], v[8:11]
    ds_read_b128 v[40:43], v3 offset:13312
    v_mfma_f32_16x16x32_bf16 v[12:15], a[88:91], v[48:51], v[12:15]
    v_cmp_ge_u32 vcc, s44, v5
    v_mfma_f32_16x16x32_bf16 v[16:19], a[92:95], v[48:51], v[16:19]
    s_cbranch_vccz WO_V8
    buffer_load_dword v5, v4, s[4:7], 0 offen sc1
    s_waitcnt lgkmcnt(5)
    v_mfma_f32_16x16x32_bf16 v[8:11], a[96:99], v[20:23], v[8:11]
    ds_read_b128 v[44:47], v3 offset:14336
    v_mfma_f32_16x16x32_bf16 v[12:15], a[100:103], v[20:23], v[12:15]
    v_mfma_f32_16x16x32_bf16 v[16:19], a[104:107], v[20:23], v[16:19]
    s_waitcnt lgkmcnt(5)
    v_mfma_f32_16x16x32_bf16 v[8:11], a[108:111], v[24:27], v[8:11]
    ds_read_b128 v[48:51], v3 offset:15360
    v_mfma_f32_16x16x32_bf16 v[12:15], a[112:115], v[24:27], v[12:15]
    v_mfma_f32_16x16x32_bf16 v[16:19], a[116:119], v[24:27], v[16:19]
    s_waitcnt lgkmcnt(5)
    v_mfma_f32_16x16x32_bf16 v[8:11], a[120:123], v[28:31], v[8:11]
    ds_read_b128 v[20:23], v3 offset:16384
    v_mfma_f32_16x16x32_bf16 v[12:15], a[124:127], v[28:31], v[12:15]
    s_cmp_eq_u32 s46, 0
    s_cbranch_scc1 NP_19
    s_waitcnt vmcnt(2)
    v_mov_b32 v7, s40
    s_mov_b64 exec, 1
    buffer_store_dword v7, off, s[4:7], s45 sc1
    s_mov_b64 exec, -1
    s_mov_b32 s46, 0
NP_19:
    v_mfma_f32_16x16x32_bf16 v[16:19], a[128:131], v[28:31], v[16:19]
    s_waitcnt lgkmcnt(5)
    v_mfma_f32_16x16x32_bf16 v[8:11], a[132:135], v[32:35], v[8:11]
    ds_read_b128 v[24:27], v3 offset:17408
    v_mfma_f32_16x16x32_bf16 v[12:15], a[136:139], v[32:35], v[12:15]
    v_mfma_f32_16x16x32_bf16 v[16:19], a[140:143], v[32:35], v[16:19]
    s_waitcnt lgkmcnt(5)
    v_mfma_f32_16x16x32_bf16 v[8:11], a[144:147], v[36:39], v[8:11]
    ds_read_b128 v[28:31], v3 offset:18432
    v_mfma_f32_16x16x32_bf16 v[12:15], a[148:151], v[36:39], v[12:15]
    v_mfma_f32_16x16x32_bf16 v[16:19], a[152:155], v[36:39], v[16:19]
    s_waitcnt lgkmcnt(5)
    v_mfma_f32_16x16x32_bf16 v[8:11], a[156:159], v[40:43], v[8:11]
    ds_read_b128 v[32:35], v3 offset:19456
    v_mfma_f32_16x16x32_bf16 v[12:15], a[160:163], v[40:43], v[12:15]
    v_mfma_f32_16x16x32_bf16 v[16:19], a[164:167], v[40:43], v[16:19]
    s_waitcnt lgkmcnt(5)
    v_mfma_f32_16x16x32_bf16 v[8:11], a[168:171], v[44:47], v[8:11]
    ds_read_b128 v[36:39], v3 offset:20480
    v_mfma_f32_16x16x32_bf16 v[12:15], a[172:175], v[44:47], v[12:15]
    v_mfma_f32_16x16x32_bf16 v[16:19], a[176:179], v[44:47], v[16:19]
    s_waitcnt lgkmcnt(5)
    v_mfma_f32_16x16x32_bf16 v[8:11], a[180:183], v[48:51], v[8:11]
    ds_read_b128 v[40:43], v3 offset:21504
    v_mfma_f32_16x16x32_bf16 v[12:15], a[184:187], v[48:51], v[12:15]
    v_cmp_ge_u32 vcc, s44, v5
    v_mfma_f32_16x16x32_bf16 v[16:19], a[188:191], v[48:51], v[16:19]
    s_cbranch_vccz WO_V16
    buffer_load_dword v5, v4, s[4:7], 0 offen sc1
    s_waitcnt lgkmcnt(5)
    v_mfma_f32_16x16x32_bf16 v[8:11], a[192:195], v[20:23], v[8:11]
    ds_read_b128 v[44:47], v3 offset:22528
    v_mfma_f32_16x16x32_bf16 v[12:15], a[196:199], v[20:23], v[12:15]
    v_mfma_f32_16x16x32_bf16 v[16:19], a[200:203], v[20:23], v[16:19]
    s_waitcnt lgkmcnt(5)
    v_mfma_f32_16x16x32_bf16 v[8:11], a[204:207], v[24:27], v[8:11]
    ds_read_b128 v[48:51], v3 offset:23552
    v_mfma_f32_16x16x32_bf16 v[12:15], a[208:211], v[24:27], v[12:15]
    v_mfma_f32_16x16x32_bf16 v[16:19], a[212:215], v[24:27], v[16:19]
    s_waitcnt lgkmcnt(5)
    v_mfma_f32_16x16x32_bf16 v[8:11], a[216:219], v[28:31], v[8:11]
    ds_read_b128 v[20:23], v3 offset:24576
    v_mfma_f32_16x16x32_bf16 v[12:15], a[220:223], v[28:31], v[12:15]
    v_mfma_f32_16x16x32_bf16 v[16:19], a[224:227], v[28:31], v[16:19]
    s_waitcnt lgkmcnt(5)
    v_mfma_f32_16x16x32_bf16 v[8:11], a[228:231], v[32:35], v[8:11]
    ds_read_b128 v[24:27], v3 offset:25600
    v_mfma_f32_16x16x32_bf16 v[12:15], a[232:235], v[32:35], v[12:15]
    v_mfma_f32_16x16x32_bf16 v[16:19], a[236:239], v[32:35], v[16:19]
    s_waitcnt lgkmcnt(5)
    v_mfma_f32_16x16x32_bf16 v[8:11], a[240:243], v[36:39], v[8:11]
    ds_read_b128 v[28:31], v3 offset:26624
    v_mfma_f32_16x16x32_bf16 v[12:15], a[244:247], v[36:39], v[12:15]
    v_mfma_f32_16x16x32_bf16 v[16:19], a[248:251], v[36:39], v[16:19]
    s_waitcnt lgkmcnt(5)
    v_mfma_f32_16x16x32_bf16 v[8:11], a[252:255], v[40:43], v[8:11]
    ds_read_b128 v[32:35], v3 offset:27648
    v_mfma_f32_16x16x32_bf16 v[12:15], v[128:131], v[40:43], v[12:15]
    v_mfma_f32_16x16x32_bf16 v[16:19], v[132:135], v[40:43], v[16:19]
    s_waitcnt lgkmcnt(5)
    v_mfma_f32_16x16x32_bf16 v[8:11], v[136:139], v[44:47], v[8:11]
    ds_read_b128 v[36:39], v3 offset:28672
    v_mfma_f32_16x16x32_bf16 v[12:15], v[140:143], v[44:47], v[12:15]
    v_mfma_f32_16x16x32_bf16 v[16:19], v[144:147], v[44:47], v[16:19]
    s_waitcnt lgkmcnt(5)
    v_mfma_f32_16x16x32_bf16 v[8:11], v[148:151], v[48:51], v[8:11]
    ds_read_b128 v[40:43], v3 offset:29696
    v_mfma_f32_16x16x32_bf16 v[12:15], v[152:155], v[48:51], v[12:15]
    v_cmp_ge_u32 vcc, s44, v5
    v_mfma_f32_16x16x32_bf16 v[16:19], v[156:159], v[48:51], v[16:19]
    s_cbranch_vccz WO_V24
    buffer_load_dword v5, v4, s[4:7], 0 offen sc1
    s_waitcnt lgkmcnt(5)
    v_mfma_f32_16x16x32_bf16 v[8:11], v[160:163], v[20:23], v[8:11]
    ds_read_b128 v[44:47], v3 offset:30720
    v_mfma_f32_16x16x32_bf16 v[12:15], v[164:167], v[20:23], v[12:15]
    v_mfma_f32_16x16x32_bf16 v[16:19], v[168:171], v[20:23], v[16:19]
    s_waitcnt lgkmcnt(5)
    v_mfma_f32_16x16x32_bf16 v[8:11], v[172:175], v[24:27], v[8:11]
    ds_read_b128 v[48:51], v3 offset:31744
    v_mfma_f32_16x16x32_bf16 v[12:15], v[176:179], v[24:27], v[12:15]
    v_mfma_f32_16x16x32_bf16 v[16:19], v[180:183], v[24:27], v[16:19]
    s_waitcnt lgkmcnt(5)
    v_mfma_f32_16x16x32_bf16 v[8:11], v[184:187], v[28:31], v[8:11]
    v_mfma_f32_16x16x32_bf16 v[12:15], v[188:191], v[28:31], v[12:15]
    v_mfma_f32_16x16x32_bf16 v[16:19], v[192:195], v[28:31], v[16:19]
    s_waitcnt lgkmcnt(4)
    v_mfma_f32_16x16x32_bf16 v[8:11], v[196:199], v[32:35], v[8:11]
    buffer_load_dword v5, v4, s[4:7], 0 offen sc1
    v_mfma_f32_16x16x32_bf16 v[12:15], v[200:203], v[32:35], v[12:15]
    v_mfma_f32_16x16x32_bf16 v[16:19], v[204:207], v[32:35], v[16:19]
    s_waitcnt lgkmcnt(3)
    v_mfma_f32_16x16x32_bf16 v[8:11], v[208:211], v[36:39], v[8:11]
    v_mfma_f32_16x16x32_bf16 v[12:15], v[212:215], v[36:39], v[12:15]
    v_mfma_f32_16x16x32_bf16 v[16:19], v[216:219], v[36:39], v[16:19]
    s_waitcnt lgkmcnt(2)
    v_mfma_f32_16x16x32_bf16 v[8:11], v[220:223], v[40:43], v[8:11]
    v_mfma_f32_16x16x32_bf16 v[12:15], v[224:227], v[40:43], v[12:15]
    v_mfma_f32_16x16x32_bf16 v[16:19], v[228:231], v[40:43], v[16:19]
    s_waitcnt lgkmcnt(1)
    v_mfma_f32_16x16x32_bf16 v[8:11], v[232:235], v[44:47], v[8:11]
    v_mfma_f32_16x16x32_bf16 v[12:15], v[236:239], v[44:47], v[12:15]
    v_mfma_f32_16x16x32_bf16 v[16:19], v[240:243], v[44:47], v[16:19]
    s_waitcnt lgkmcnt(0)
    v_mfma_f32_16x16x32_bf16 v[8:11], v[244:247], v[48:51], v[8:11]
    v_mfma_f32_16x16x32_bf16 v[12:15], v[248:251], v[48:51], v[12:15]
    v_mfma_f32_16x16x32_bf16 v[16:19], v[252:255], v[48:51], v[16:19]
    v_xor_b32 v3, 32768, v3
    v_cvt_pk_bf16_f32 v60, v8, v9
    v_cvt_pk_bf16_f32 v61, v10, v11
    s_nop 0
    v_cvt_pk_bf16_f32 v62, v12, v13
    v_cvt_pk_bf16_f32 v63, v14, v15
    buffer_store_dwordx4 v[60:63], v0, s[4:7], s41 offen sc1
    s_nop 0
    v_cvt_pk_bf16_f32 v64, v16, v17
    v_cvt_pk_bf16_f32 v65, v18, v19
    buffer_store_dwordx2 v[64:65], v6, s[4:7], s41 offen sc1
    s_add_u32 s41, s41, 147456
    s_add_u32 s40, s40, 1
    v_cmp_ge_u32 vcc, s44, v5
    s_cbranch_vccz WO_E1
    buffer_load_dword v5, v4, s[4:7], 0 offen sc1
    s_waitcnt vmcnt(1)
    v_mov_b32 v7, s40
    s_mov_b64 exec, 1
    buffer_store_dword v7, off, s[4:7], s45 sc1
    s_mov_b64 exec, -1
    s_waitcnt vmcnt(1)
    v_cmp_ge_u32 vcc, s44, v5
    s_cbranch_vccz WO_D
    s_cmp_ge_u32 s40, 64
    s_cbranch_scc1 WO_E
    s_branch WO_S
WO_E1:
    s_add_u32 m0, s43, 0
    s_nop 0
    buffer_load_dwordx4 v0, s[4:7], s42 offen offset:0 sc1 lds
    buffer_load_dwordx4 v0, s[4:7], s42 offen offset:1024 sc1 lds
    buffer_load_dwordx4 v0, s[4:7], s42 offen offset:2048 sc1 lds
    buffer_load_dwordx4 v0, s[4:7], s42 offen offset:3072 sc1 lds
    s_add_u32 m0, s43, 4096
    s_add_u32 s47, s42, 4096
    buffer_load_dwordx4 v0, s[4:7], s47 offen offset:0 sc1 lds
    buffer_load_dwordx4 v0, s[4:7], s47 offen offset:1024 sc1 lds
    buffer_load_dwordx4 v0, s[4:7], s47 offen offset:2048 sc1 lds
    buffer_load_dwordx4 v0, s[4:7], s47 offen offset:3072 sc1 lds
    s_add_u32 s42, s42, 262144
    s_xor_b32 s43, s43, 32768
    s_waitcnt vmcnt(8)
    v_mov_b32 v7, s40
    s_mov_b64 exec, 1
    buffer_store_dword v7, off, s[4:7], s45 sc1
    s_mov_b64 exec, -1
    s_waitcnt vmcnt(1)
    s_branch WO_L
WO_P:
    s_waitcnt vmcnt(0)
    v_mov_b32 v7, s40
    s_mov_b64 exec, 1
    buffer_store_dword v7, off, s[4:7], s45 sc1
    s_mov_b64 exec, -1
    s_branch WO_L
WO_V0:
    s_waitcnt lgkmcnt(5)
    v_mfma_f32_16x16x32_bf16 v[8:11], a[0:3], v[20:23], 0
    v_mov_b32 v77, s44
    s_mov_b64 exec, s[54:55]
    ds_write_b32 v76, v77
    s_mov_b64 exec, -1
    v_mfma_f32_16x16x32_bf16 v[12:15], a[4:7], v[20:23], 0
    ds_read_b128 v[44:47], v3 offset:6144
    v_mfma_f32_16x16x32_bf16 v[16:19], a[8:11], v[20:23], 0
    s_add_u32 m0, s43, 0
    s_nop 0
    buffer_load_dwordx4 v0, s[4:7], s42 offen offset:0 sc1 lds
    s_waitcnt lgkmcnt(6)
    v_mfma_f32_16x16x32_bf16 v[8:11], a[12:15], v[24:27], v[8:11]
    ds_read_b128 v[48:51], v3 offset:7168
    v_mfma_f32_16x16x32_bf16 v[12:15], a[16:19], v[24:27], v[12:15]
    v_mfma_f32_16x16x32_bf16 v[16:19], a[20:23], v[24:27], v[16:19]
    s_waitcnt lgkmcnt(6)
    v_mfma_f32_16x16x32_bf16 v[8:11], a[24:27], v[28:31], v[8:11]
    ds_read_b128 v[20:23], v3 offset:8192
    v_mfma_f32_16x16x32_bf16 v[12:15], a[28:31], v[28:31], v[12:15]
    v_mfma_f32_16x16x32_bf16 v[16:19], a[32:35], v[28:31], v[16:19]
    s_waitcnt lgkmcnt(6)
    v_mfma_f32_16x16x32_bf16 v[8:11], a[36:39], v[32:35], v[8:11]
    ds_read_b128 v[24:27], v3 offset:9216
    v_mfma_f32_16x16x32_bf16 v[12:15], a[40:43], v[32:35], v[12:15]
    buffer_load_dwordx4 v0, s[4:7], s42 offen offset:1024 sc1 lds
    v_mfma_f32_16x16x32_bf16 v[16:19], a[44:47], v[32:35], v[16:19]
    s_waitcnt lgkmcnt(6)
    v_mfma_f32_16x16x32_bf16 v[8:11], a[48:51], v[36:39], v[8:11]
    ds_read_b128 v[28:31], v3 offset:10240
    v_mfma_f32_16x16x32_bf16 v[12:15], a[52:55], v[36:39], v[12:15]
    v_mfma_f32_16x16x32_bf16 v[16:19], a[56:59], v[36:39], v[16:19]
    s_waitcnt lgkmcnt(6)
    v_mfma_f32_16x16x32_bf16 v[8:11], a[60:63], v[40:43], v[8:11]
    ds_read_b128 v[32:35], v3 offset:11264
    v_mfma_f32_16x16x32_bf16 v[12:15], a[64:67], v[40:43], v[12:15]
    v_mfma_f32_16x16x32_bf16 v[16:19], a[68:71], v[40:43], v[16:19]
    s_waitcnt lgkmcnt(5)
    v_mfma_f32_16x16x32_bf16 v[8:11], a[72:75], v[44:47], v[8:11]
    ds_read_b128 v[36:39], v3 offset:12288
    v_mfma_f32_16x16x32_bf16 v[12:15], a[76:79], v[44:47], v[12:15]
    buffer_load_dwordx4 v0, s[4:7], s42 offen offset:2048 sc1 lds
    v_mfma_f32_16x16x32_bf16 v[16:19], a[80:83], v[44:47], v[16:19]
    s_waitcnt lgkmcnt(5)
    v_mfma_f32_16x16x32_bf16 v[8:11], a[84:87], v[48:51], v[8:11]
    ds_read_b128 v[40:43], v3 offset:13312
    v_mfma_f32_16x16x32_bf16 v[12:15], a[88:91], v[48:51], v[12:15]
    v_mfma_f32_16x16x32_bf16 v[16:19], a[92:95], v[48:51], v[16:19]
    s_waitcnt lgkmcnt(5)
    v_mfma_f32_16x16x32_bf16 v[8:11], a[96:99], v[20:23], v[8:11]
    ds_read_b128 v[44:47], v3 offset:14336
    v_mfma_f32_16x16x32_bf16 v[12:15], a[100:103], v[20:23], v[12:15]
    v_mfma_f32_16x16x32_bf16 v[16:19], a[104:107], v[20:23], v[16:19]
    s_waitcnt lgkmcnt(5)
    v_mfma_f32_16x16x32_bf16 v[8:11], a[108:111], v[24:27], v[8:11]
    ds_read_b128 v[48:51], v3 offset:15360
    v_mfma_f32_16x16x32_bf16 v[12:15], a[112:115], v[24:27], v[12:15]
    buffer_load_dwordx4 v0, s[4:7], s42 offen offset:3072 sc1 lds
    v_mfma_f32_16x16x32_bf16 v[16:19], a[116:119], v[24:27], v[16:19]
    s_waitcnt lgkmcnt(5)
    v_mfma_f32_16x16x32_bf16 v[8:11], a[120:123], v[28:31], v[8:11]
    ds_read_b128 v[20:23], v3 offset:16384
    v_mfma_f32_16x16x32_bf16 v[12:15], a[124:127], v[28:31], v[12:15]
    s_cmp_eq_u32 s46, 0
    s_cbranch_scc1 NP_20
    s_waitcnt vmcnt(4)
    v_mov_b32 v7, s40
    s_mov_b64 exec, 1
    buffer_store_dword v7, off, s[4:7], s45 sc1
    s_mov_b64 exec, -1
    s_mov_b32 s46, 0
NP_20:
    v_mfma_f32_16x16x32_bf16 v[16:19], a[128:131], v[28:31], v[16:19]
    s_waitcnt lgkmcnt(5)
    v_mfma_f32_16x16x32_bf16 v[8:11], a[132:135], v[32:35], v[8:11]
    ds_read_b128 v[24:27], v3 offset:17408
    v_mfma_f32_16x16x32_bf16 v[12:15], a[136:139], v[32:35], v[12:15]
    v_mfma_f32_16x16x32_bf16 v[16:19], a[140:143], v[32:35], v[16:19]
    s_waitcnt lgkmcnt(5)
    v_mfma_f32_16x16x32_bf16 v[8:11], a[144:147], v[36:39], v[8:11]
    ds_read_b128 v[28:31], v3 offset:18432
    v_mfma_f32_16x16x32_bf16 v[12:15], a[148:151], v[36:39], v[12:15]
    s_add_u32 m0, s43, 4096
    s_add_u32 s47, s42, 4096
    buffer_load_dwordx4 v0, s[4:7], s47 offen offset:0 sc1 lds
    v_mfma_f32_16x16x32_bf16 v[16:19], a[152:155], v[36:39], v[16:19]
    s_waitcnt lgkmcnt(5)
    v_mfma_f32_16x16x32_bf16 v[8:11], a[156:159], v[40:43], v[8:11]
    ds_read_b128 v[32:35], v3 offset:19456
    v_mfma_f32_16x16x32_bf16 v[12:15], a[160:163], v[40:43], v[12:15]
    v_mfma_f32_16x16x32_bf16 v[16:19], a[164:167], v[40:43], v[16:19]
    s_waitcnt lgkmcnt(5)
    v_mfma_f32_16x16x32_bf16 v[8:11], a[168:171], v[44:47], v[8:11]
    ds_read_b128 v[36:39], v3 offset:20480
    v_mfma_f32_16x16x32_bf16 v[12:15], a[172:175], v[44:47], v[12:15]
    v_mfma_f32_16x16x32_bf16 v[16:19], a[176:179], v[44:47], v[16:19]
    s_waitcnt lgkmcnt(5)
    v_mfma_f32_16x16x32_bf16 v[8:11], a[180:183], v[48:51], v[8:11]
    ds_read_b128 v[40:43], v3 offset:21504
    v_mfma_f32_16x16x32_bf16 v[12:15], a[184:187], v[48:51], v[12:15]
    buffer_load_dwordx4 v0, s[4:7], s47 offen offset:1024 sc1 lds
    v_mfma_f32_16x16x32_bf16 v[16:19], a[188:191], v[48:51], v[16:19]
    s_waitcnt lgkmcnt(5)
    v_mfma_f32_16x16x32_bf16 v[8:11], a[192:195], v[20:23], v[8:11]
    ds_read_b128 v[44:47], v3 offset:22528
    v_mfma_f32_16x16x32_bf16 v[12:15], a[196:199], v[20:23], v[12:15]
    v_mfma_f32_16x16x32_bf16 v[16:19], a[200:203], v[20:23], v[16:19]
    s_waitcnt lgkmcnt(5)
    v_mfma_f32_16x16x32_bf16 v[8:11], a[204:207], v[24:27], v[8:11]
    ds_read_b128 v[48:51], v3 offset:23552
    v_mfma_f32_16x16x32_bf16 v[12:15], a[208:211], v[24:27], v[12:15]
    v_mfma_f32_16x16x32_bf16 v[16:19], a[212:215], v[24:27], v[16:19]
    s_waitcnt lgkmcnt(5)
    v_mfma_f32_16x16x32_bf16 v[8:11], a[216:219], v[28:31], v[8:11]
    ds_read_b128 v[20:23], v3 offset:24576
    v_mfma_f32_16x16x32_bf16 v[12:15], a[220:223], v[28:31], v[12:15]
    buffer_load_dwordx4 v0, s[4:7], s47 offen offset:2048 sc1 lds
    v_mfma_f32_16x16x32_bf16 v[16:19], a[224:227], v[28:31], v[16:19]
    s_waitcnt lgkmcnt(5)
    v_mfma_f32_16x16x32_bf16 v[8:11], a[228:231], v[32:35], v[8:11]
    ds_read_b128 v[24:27], v3 offset:25600
    v_mfma_f32_16x16x32_bf16 v[12:15], a[232:235], v[32:35], v[12:15]
    v_mfma_f32_16x16x32_bf16 v[16:19], a[236:239], v[32:35], v[16:19]
    s_waitcnt lgkmcnt(5)
    v_mfma_f32_16x16x32_bf16 v[8:11], a[240:243], v[36:39], v[8:11]
    ds_read_b128 v[28:31], v3 offset:26624
    v_mfma_f32_16x16x32_bf16 v[12:15], a[244:247], v[36:39], v[12:15]
    v_mfma_f32_16x16x32_bf16 v[16:19], a[248:251], v[36:39], v[16:19]
    s_waitcnt lgkmcnt(5)
    v_mfma_f32_16x16x32_bf16 v[8:11], a[252:255], v[40:43], v[8:11]
    ds_read_b128 v[32:35], v3 offset:27648
    v_mfma_f32_16x16x32_bf16 v[12:15], v[128:131], v[40:43], v[12:15]
    buffer_load_dwordx4 v0, s[4:7], s47 offen offset:3072 sc1 lds
    s_add_u32 s42, s42, 262144
    s_xor_b32 s43, s43, 32768
    v_mfma_f32_16x16x32_bf16 v[16:19], v[132:135], v[40:43], v[16:19]
    s_waitcnt lgkmcnt(5)
    v_mfma_f32_16x16x32_bf16 v[8:11], v[136:139], v[44:47], v[8:11]
    ds_read_b128 v[36:39], v3 offset:28672
    v_mfma_f32_16x16x32_bf16 v[12:15], v[140:143], v[44:47], v[12:15]
    buffer_load_dword v5, v4, s[4:7], 0 offen sc1
    v_mfma_f32_16x16x32_bf16 v[16:19], v[144:147], v[44:47], v[16:19]
    s_waitcnt lgkmcnt(5)
    v_mfma_f32_16x16x32_bf16 v[8:11], v[148:151], v[48:51], v[8:11]
    ds_read_b128 v[40:43], v3 offset:29696
    v_mfma_f32_16x16x32_bf16 v[12:15], v[152:155], v[48:51], v[12:15]
    v_mfma_f32_16x16x32_bf16 v[16:19], v[156:159], v[48:51], v[16:19]
    s_waitcnt lgkmcnt(5)
    v_mfma_f32_16x16x32_bf16 v[8:11], v[160:163], v[20:23], v[8:11]
    ds_read_b128 v[44:47], v3 offset:30720
    v_mfma_f32_16x16x32_bf16 v[12:15], v[164:167], v[20:23], v[12:15]
    v_mfma_f32_16x16x32_bf16 v[16:19], v[168:171], v[20:23], v[16:19]
    s_waitcnt lgkmcnt(5)
    v_mfma_f32_16x16x32_bf16 v[8:11], v[172:175], v[24:27], v[8:11]
    ds_read_b128 v[48:51], v3 offset:31744
    v_mfma_f32_16x16x32_bf16 v[12:15], v[176:179], v[24:27], v[12:15]
    v_mfma_f32_16x16x32_bf16 v[16:19], v[180:183], v[24:27], v[16:19]
    s_waitcnt lgkmcnt(5)
    v_mfma_f32_16x16x32_bf16 v[8:11], v[184:187], v[28:31], v[8:11]
    v_mfma_f32_16x16x32_bf16 v[12:15], v[188:191], v[28:31], v[12:15]
    v_mfma_f32_16x16x32_bf16 v[16:19], v[192:195], v[28:31], v[16:19]
    s_waitcnt lgkmcnt(4)
    v_mfma_f32_16x16x32_bf16 v[8:11], v[196:199], v[32:35], v[8:11]
    v_mfma_f32_16x16x32_bf16 v[12:15], v[200:203], v[32:35], v[12:15]
    v_mfma_f32_16x16x32_bf16 v[16:19], v[204:207], v[32:35], v[16:19]
    s_waitcnt lgkmcnt(3)
    v_mfma_f32_16x16x32_bf16 v[8:11], v[208:211], v[36:39], v[8:11]
    v_mfma_f32_16x16x32_bf16 v[12:15], v[212:215], v[36:39], v[12:15]
    v_mfma_f32_16x16x32_bf16 v[16:19], v[216:219], v[36:39], v[16:19]
    s_waitcnt lgkmcnt(2)
    v_mfma_f32_16x16x32_bf16 v[8:11], v[220:223], v[40:43], v[8:11]
    v_mfma_f32_16x16x32_bf16 v[12:15], v[224:227], v[40:43], v[12:15]
    v_mfma_f32_16x16x32_bf16 v[16:19], v[228:231], v[40:43], v[16:19]
    s_waitcnt lgkmcnt(1)
    v_mfma_f32_16x16x32_bf16 v[8:11], v[232:235], v[44:47], v[8:11]
    v_mfma_f32_16x16x32_bf16 v[12:15], v[236:239], v[44:47], v[12:15]
    v_mfma_f32_16x16x32_bf16 v[16:19], v[240:243], v[44:47], v[16:19]
    s_waitcnt lgkmcnt(0)
    v_mfma_f32_16x16x32_bf16 v[8:11], v[244:247], v[48:51], v[8:11]
    ds_read_b32 v77, v76
    v_mfma_f32_16x16x32_bf16 v[12:15], v[248:251], v[48:51], v[12:15]
    v_mfma_f32_16x16x32_bf16 v[16:19], v[252:255], v[48:51], v[16:19]
    v_xor_b32 v3, 32768, v3
    v_cvt_pk_bf16_f32 v60, v8, v9
    v_cvt_pk_bf16_f32 v61, v10, v11
    s_nop 0
    v_cvt_pk_bf16_f32 v62, v12, v13
    v_cvt_pk_bf16_f32 v63, v14, v15
    buffer_store_dwordx4 v[60:63], v0, s[4:7], s41 offen sc1
    s_nop 0
    v_cvt_pk_bf16_f32 v64, v16, v17
    v_cvt_pk_bf16_f32 v65, v18, v19
    buffer_store_dwordx2 v[64:65], v6, s[4:7], s41 offen sc1
    s_add_u32 s41, s41, 147456
    s_add_u32 s40, s40, 1
    s_waitcnt lgkmcnt(0)
    v_cmp_ne_u32 vcc, s40, v77
    s_cbranch_vccnz WO_P
    s_waitcnt vmcnt(3)
    s_mov_b32 s46, 1
    s_branch WO_L
WO_V8:
    s_waitcnt lgkmcnt(5)
    v_mfma_f32_16x16x32_bf16 v[8:11], a[96:99], v[20:23], v[8:11]
    v_mov_b32 v77, s44
    s_mov_b64 exec, s[54:55]
    ds_write_b32 v76, v77
    s_mov_b64 exec, -1
    v_mfma_f32_16x16x32_bf16 v[12:15], a[100:103], v[20:23], v[12:15]
    ds_read_b128 v[44:47], v3 offset:14336
    v_mfma_f32_16x16x32_bf16 v[16:19], a[104:107], v[20:23], v[16:19]
    s_add_u32 m0, s43, 0
    s_nop 0
    buffer_load_dwordx4 v0, s[4:7], s42 offen offset:0 sc1 lds
    s_waitcnt lgkmcnt(6)
    v_mfma_f32_16x16x32_bf16 v[8:11], a[108:111], v[24:27], v[8:11]
    ds_read_b128 v[48:51], v3 offset:15360
    v_mfma_f32_16x16x32_bf16 v[12:15], a[112:115], v[24:27], v[12:15]
    v_mfma_f32_16x16x32_bf16 v[16:19], a[116:119], v[24:27], v[16:19]
    s_waitcnt lgkmcnt(6)
    v_mfma_f32_16x16x32_bf16 v[8:11], a[120:123], v[28:31], v[8:11]
    ds_read_b128 v[20:23], v3 offset:16384
    v_mfma_f32_16x16x32_bf16 v[12:15], a[124:127], v[28:31], v[12:15]
    buffer_load_dwordx4 v0, s[4:7], s42 offen offset:1024 sc1 lds
    v_mfma_f32_16x16x32_bf16 v[16:19], a[128:131], v[28:31], v[16:19]
    s_cmp_eq_u32 s46, 0
    s_cbranch_scc1 NP_21
    s_waitcnt vmcnt(3)
    v_mov_b32 v7, s40
    s_mov_b64 exec, 1
    buffer_store_dword v7, off, s[4:7], s45 sc1
    s_mov_b64 exec, -1
    s_mov_b32 s46, 0
NP_21:
    s_waitcnt lgkmcnt(6)
    v_mfma_f32_16x16x32_bf16 v[8:11], a[132:135], v[32:35], v[8:11]
    ds_read_b128 v[24:27], v3 offset:17408
    v_mfma_f32_16x16x32_bf16 v[12:15], a[136:139], v[32:35], v[12:15]
    v_mfma_f32_16x16x32_bf16 v[16:19], a[140:143], v[32:35], v[16:19]
    s_waitcnt lgkmcnt(6)
    v_mfma_f32_16x16x32_bf16 v[8:11], a[144:147], v[36:39], v[8:11]
    ds_read_b128 v[28:31], v3 offset:18432
    v_mfma_f32_16x16x32_bf16 v[12:15], a[148:151], v[36:39], v[12:15]
    buffer_load_dwordx4 v0, s[4:7], s42 offen offset:2048 sc1 lds
    v_mfma_f32_16x16x32_bf16 v[16:19], a[152:155], v[36:39], v[16:19]
    s_waitcnt lgkmcnt(6)
    v_mfma_f32_16x16x32_bf16 v[8:11], a[156:159], v[40:43], v[8:11]
    ds_read_b128 v[32:35], v3 offset:19456
    v_mfma_f32_16x16x32_bf16 v[12:15], a[160:163], v[40:43], v[12:15]
    v_mfma_f32_16x16x32_bf16 v[16:19], a[164:167], v[40:43], v[16:19]
    s_waitcnt lgkmcnt(5)
    v_mfma_f32_16x16x32_bf16 v[8:11], a[168:171], v[44:47], v[8:11]
    ds_read_b128 v[36:39], v3 offset:20480
    v_mfma_f32_16x16x32_bf16 v[12:15], a[172:175], v[44:47], v[12:15]
    buffer_load_dwordx4 v0, s[4:7], s42 offen offset:3072 sc1 lds
    v_mfma_f32_16x16x32_bf16 v[16:19], a[176:179], v[44:47], v[16:19]
    s_waitcnt lgkmcnt(5)
    v_mfma_f32_16x16x32_bf16 v[8:11], a[180:183], v[48:51], v[8:11]
    ds_read_b128 v[40:43], v3 offset:21504
    v_mfma_f32_16x16x32_bf16 v[12:15], a[184:187], v[48:51], v[12:15]
    v_mfma_f32_16x16x32_bf16 v[16:19], a[188:191], v[48:51], v[16:19]
    s_waitcnt lgkmcnt(5)
    v_mfma_f32_16x16x32_bf16 v[8:11], a[192:195], v[20:23], v[8:11]
    ds_read_b128 v[44:47], v3 offset:22528
    v_mfma_f32_16x16x32_bf16 v[12:15], a[196:199], v[20:23], v[12:15]
    s_add_u32 m0, s43, 4096
    s_add_u32 s47, s42, 4096
    buffer_load_dwordx4 v0, s[4:7], s47 offen offset:0 sc1 lds
    v_mfma_f32_16x16x32_bf16 v[16:19], a[200:203], v[20:23], v[16:19]
    s_waitcnt lgkmcnt(5)
    v_mfma_f32_16x16x32_bf16 v[8:11], a[204:207], v[24:27], v[8:11]
    ds_read_b128 v[48:51], v3 offset:23552
    v_mfma_f32_16x16x32_bf16 v[12:15], a[208:211], v[24:27], v[12:15]
    v_mfma_f32_16x16x32_bf16 v[16:19], a[212:215], v[24:27], v[16:19]
    s_waitcnt lgkmcnt(5)
    v_mfma_f32_16x16x32_bf16 v[8:11], a[216:219], v[28:31], v[8:11]
    ds_read_b128 v[20:23], v3 offset:24576
    v_mfma_f32_16x16x32_bf16 v[12:15], a[220:223], v[28:31], v[12:15]
    buffer_load_dwordx4 v0, s[4:7], s47 offen offset:1024 sc1 lds
    v_mfma_f32_16x16x32_bf16 v[16:19], a[224:227], v[28:31], v[16:19]
    s_waitcnt lgkmcnt(5)
    v_mfma_f32_16x16x32_bf16 v[8:11], a[228:231], v[32:35], v[8:11]
    ds_read_b128 v[24:27], v3 offset:25600
    v_mfma_f32_16x16x32_bf16 v[12:15], a[232:235], v[32:35], v[12:15]
    v_mfma_f32_16x16x32_bf16 v[16:19], a[236:239], v[32:35], v[16:19]
    s_waitcnt lgkmcnt(5)
    v_mfma_f32_16x16x32_bf16 v[8:11], a[240:243], v[36:39], v[8:11]
    ds_read_b128 v[28:31], v3 offset:26624
    v_mfma_f32_16x16x32_bf16 v[12:15], a[244:247], v[36:39], v[12:15]
    buffer_load_dwordx4 v0, s[4:7], s47 offen offset:2048 sc1 lds
    v_mfma_f32_16x16x32_bf16 v[16:19], a[248:251], v[36:39], v[16:19]
    s_waitcnt lgkmcnt(5)
    v_mfma_f32_16x16x32_bf16 v[8:11], a[252:255], v[40:43], v[8:11]
    ds_read_b128 v[32:35], v3 offset:27648
    v_mfma_f32_16x16x32_bf16 v[12:15], v[128:131], v[40:43], v[12:15]
    v_mfma_f32_16x16x32_bf16 v[16:19], v[132:135], v[40:43], v[16:19]
    s_waitcnt lgkmcnt(5)
    v_mfma_f32_16x16x32_bf16 v[8:11], v[136:139], v[44:47], v[8:11]
    ds_read_b128 v[36:39], v3 offset:28672
    v_mfma_f32_16x16x32_bf16 v[12:15], v[140:143], v[44:47], v[12:15]
    buffer_load_dwordx4 v0, s[4:7], s47 offen offset:3072 sc1 lds
    s_add_u32 s42, s42, 262144
    s_xor_b32 s43, s43, 32768
    v_mfma_f32_16x16x32_bf16 v[16:19], v[144:147], v[44:47], v[16:19]
    s_waitcnt lgkmcnt(5)
    v_mfma_f32_16x16x32_bf16 v[8:11], v[148:151], v[48:51], v[8:11]
    ds_read_b128 v[40:43], v3 offset:29696
    v_mfma_f32_16x16x32_bf16 v[12:15], v[152:155], v[48:51], v[12:15]
    buffer_load_dword v5, v4, s[4:7], 0 offen sc1
    v_mfma_f32_16x16x32_bf16 v[16:19], v[156:159], v[48:51], v[16:19]
    s_waitcnt lgkmcnt(5)
    v_mfma_f32_16x16x32_bf16 v[8:11], v[160:163], v[20:23], v[8:11]
    ds_read_b128 v[44:47], v3 offset:30720
    v_mfma_f32_16x16x32_bf16 v[12:15], v[164:167], v[20:23], v[12:15]
    v_mfma_f32_16x16x32_bf16 v[16:19], v[168:171], v[20:23], v[16:19]
    s_waitcnt lgkmcnt(5)
    v_mfma_f32_16x16x32_bf16 v[8:11], v[172:175], v[24:27], v[8:11]
    ds_read_b128 v[48:51], v3 offset:31744
    v_mfma_f32_16x16x32_bf16 v[12:15], v[176:179], v[24:27], v[12:15]
    v_mfma_f32_16x16x32_bf16 v[16:19], v[180:183], v[24:27], v[16:19]
    s_waitcnt lgkmcnt(5)
    v_mfma_f32_16x16x32_bf16 v[8:11], v[184:187], v[28:31], v[8:11]
    v_mfma_f32_16x16x32_bf16 v[12:15], v[188:191], v[28:31], v[12:15]
    v_mfma_f32_16x16x32_bf16 v[16:19], v[192:195], v[28:31], v[16:19]
    s_waitcnt lgkmcnt(4)
    v_mfma_f32_16x16x32_bf16 v[8:11], v[196:199], v[32:35], v[8:11]
    v_mfma_f32_16x16x32_bf16 v[12:15], v[200:203], v[32:35], v[12:15]
    v_mfma_f32_16x16x32_bf16 v[16:19], v[204:207], v[32:35], v[16:19]
    s_waitcnt lgkmcnt(3)
    v_mfma_f32_16x16x32_bf16 v[8:11], v[208:211], v[36:39], v[8:11]
    v_mfma_f32_16x16x32_bf16 v[12:15], v[212:215], v[36:39], v[12:15]
    v_mfma_f32_16x16x32_bf16 v[16:19], v[216:219], v[36:39], v[16:19]
    s_waitcnt lgkmcnt(2)
    v_mfma_f32_16x16x32_bf16 v[8:11], v[220:223], v[40:43], v[8:11]
    v_mfma_f32_16x16x32_bf16 v[12:15], v[224:227], v[40:43], v[12:15]
    v_mfma_f32_16x16x32_bf16 v[16:19], v[228:231], v[40:43], v[16:19]
    s_waitcnt lgkmcnt(1)
    v_mfma_f32_16x16x32_bf16 v[8:11], v[232:235], v[44:47], v[8:11]
    v_mfma_f32_16x16x32_bf16 v[12:15], v[236:239], v[44:47], v[12:15]
    v_mfma_f32_16x16x32_bf16 v[16:19], v[240:243], v[44:47], v[16:19]
    s_waitcnt lgkmcnt(0)
    v_mfma_f32_16x16x32_bf16 v[8:11], v[244:247], v[48:51], v[8:11]
    ds_read_b32 v77, v76
    v_mfma_f32_16x16x32_bf16 v[12:15], v[248:251], v[48:51], v[12:15]
    v_mfma_f32_16x16x32_bf16 v[16:19], v[252:255], v[48:51], v[16:19]
    v_xor_b32 v3, 32768, v3
    v_cvt_pk_bf16_f32 v60, v8, v9
    v_cvt_pk_bf16_f32 v61, v10, v11
    s_nop 0
    v_cvt_pk_bf16_f32 v62, v12, v13
    v_cvt_pk_bf16_f32 v63, v14, v15
    buffer_store_dwordx4 v[60:63], v0, s[4:7], s41 offen sc1
    s_nop 0
    v_cvt_pk_bf16_f32 v64, v16, v17
    v_cvt_pk_bf16_f32 v65, v18, v19
    buffer_store_dwordx2 v[64:65], v6, s[4:7], s41 offen sc1
    s_add_u32 s41, s41, 147456
    s_add_u32 s40, s40, 1
    s_waitcnt lgkmcnt(0)
    v_cmp_ne_u32 vcc, s40, v77
    s_cbranch_vccnz WO_P
    s_waitcnt vmcnt(3)
    s_mov_b32 s46, 1
    s_branch WO_L
WO_V16:
    s_waitcnt lgkmcnt(5)
    v_mfma_f32_16x16x32_bf16 v[8:11], a[192:195], v[20:23], v[8:11]
    v_mov_b32 v77, s44
    s_mov_b64 exec, s[54:55]
    ds_write_b32 v76, v77
    s_mov_b64 exec, -1
    v_mfma_f32_16x16x32_bf16 v[12:15], a[196:199], v[20:23], v[12:15]
    ds_read_b128 v[44:47], v3 offset:22528
    v_mfma_f32_16x16x32_bf16 v[16:19], a[200:203], v[20:23], v[16:19]
    s_add_u32 m0, s43, 0
    s_nop 0
    buffer_load_dwordx4 v0, s[4:7], s42 offen offset:0 sc1 lds
    s_waitcnt lgkmcnt(6)
    v_mfma_f32_16x16x32_bf16 v[8:11], a[204:207], v[24:27], v[8:11]
    ds_read_b128 v[48:51], v3 offset:23552
    v_mfma_f32_16x16x32_bf16 v[12:15], a[208:211], v[24:27], v[12:15]
    buffer_load_dwordx4 v0, s[4:7], s42 offen offset:1024 sc1 lds
    v_mfma_f32_16x16x32_bf16 v[16:19], a[212:215], v[24:27], v[16:19]
    s_waitcnt lgkmcnt(6)
    v_mfma_f32_16x16x32_bf16 v[8:11], a[216:219], v[28:31], v[8:11]
    ds_read_b128 v[20:23], v3 offset:24576
    v_mfma_f32_16x16x32_bf16 v[12:15], a[220:223], v[28:31], v[12:15]
    buffer_load_dwordx4 v0, s[4:7], s42 offen offset:2048 sc1 lds
    v_mfma_f32_16x16x32_bf16 v[16:19], a[224:227], v[28:31], v[16:19]
    s_waitcnt lgkmcnt(6)
    v_mfma_f32_16x16x32_bf16 v[8:11], a[228:231], v[32:35], v[8:11]
    ds_read_b128 v[24:27], v3 offset:25600
    v_mfma_f32_16x16x32_bf16 v[12:15], a[232:235], v[32:35], v[12:15]
    buffer_load_dwordx4 v0, s[4:7], s42 offen offset:3072 sc1 lds
    v_mfma_f32_16x16x32_bf16 v[16:19], a[236:239], v[32:35], v[16:19]
    s_waitcnt lgkmcnt(6)
    v_mfma_f32_16x16x32_bf16 v[8:11], a[240:243], v[36:39], v[8:11]
    ds_read_b128 v[28:31], v3 offset:26624
    v_mfma_f32_16x16x32_bf16 v[12:15], a[244:247], v[36:39], v[12:15]
    s_add_u32 m0, s43, 4096
    s_add_u32 s47, s42, 4096
    buffer_load_dwordx4 v0, s[4:7], s47 offen offset:0 sc1 lds
    v_mfma_f32_16x16x32_bf16 v[16:19], a[248:251], v[36:39], v[16:19]
    s_waitcnt lgkmcnt(6)
    v_mfma_f32_16x16x32_bf16 v[8:11], a[252:255], v[40:43], v[8:11]
    ds_read_b128 v[32:35], v3 offset:27648
    v_mfma_f32_16x16x32_bf16 v[12:15], v[128:131], v[40:43], v[12:15]
    buffer_load_dwordx4 v0, s[4:7], s47 offen offset:1024 sc1 lds
    v_mfma_f32_16x16x32_bf16 v[16:19], v[132:135], v[40:43], v[16:19]
    s_waitcnt lgkmcnt(5)
    v_mfma_f32_16x16x32_bf16 v[8:11], v[136:139], v[44:47], v[8:11]
    ds_read_b128 v[36:39], v3 offset:28672
    v_mfma_f32_16x16x32_bf16 v[12:15], v[140:143], v[44:47], v[12:15]
    buffer_load_dwordx4 v0, s[4:7], s47 offen offset:2048 sc1 lds
    v_mfma_f32_16x16x32_bf16 v[16:19], v[144:147], v[44:47], v[16:19]
    s_waitcnt lgkmcnt(5)
    v_mfma_f32_16x16x32_bf16 v[8:11], v[148:151], v[48:51], v[8:11]
    ds_read_b128 v[40:43], v3 offset:29696
    v_mfma_f32_16x16x32_bf16 v[12:15], v[152:155], v[48:51], v[12:15]
    buffer_load_dwordx4 v0, s[4:7], s47 offen offset:3072 sc1 lds
    s_add_u32 s42, s42, 262144
    s_xor_b32 s43, s43, 32768
    v_mfma_f32_16x16x32_bf16 v[16:19], v[156:159], v[48:51], v[16:19]
    s_waitcnt lgkmcnt(5)
    v_mfma_f32_16x16x32_bf16 v[8:11], v[160:163], v[20:23], v[8:11]
    ds_read_b128 v[44:47], v3 offset:30720
    v_mfma_f32_16x16x32_bf16 v[12:15], v[164:167], v[20:23], v[12:15]
    buffer_load_dword v5, v4, s[4:7], 0 offen sc1
    v_mfma_f32_16x16x32_bf16 v[16:19], v[168:171], v[20:23], v[16:19]
    s_waitcnt lgkmcnt(5)
    v_mfma_f32_16x16x32_bf16 v[8:11], v[172:175], v[24:27], v[8:11]
    ds_read_b128 v[48:51], v3 offset:31744
    v_mfma_f32_16x16x32_bf16 v[12:15], v[176:179], v[24:27], v[12:15]
    v_mfma_f32_16x16x32_bf16 v[16:19], v[180:183], v[24:27], v[16:19]
    s_waitcnt lgkmcnt(5)
    v_mfma_f32_16x16x32_bf16 v[8:11], v[184:187], v[28:31], v[8:11]
    v_mfma_f32_16x16x32_bf16 v[12:15], v[188:191], v[28:31], v[12:15]
    v_mfma_f32_16x16x32_bf16 v[16:19], v[192:195], v[28:31], v[16:19]
    s_waitcnt lgkmcnt(4)
    v_mfma_f32_16x16x32_bf16 v[8:11], v[196:199], v[32:35], v[8:11]
    v_mfma_f32_16x16x32_bf16 v[12:15], v[200:203], v[32:35], v[12:15]
    v_mfma_f32_16x16x32_bf16 v[16:19], v[204:207], v[32:35], v[16:19]
    s_waitcnt lgkmcnt(3)
    v_mfma_f32_16x16x32_bf16 v[8:11], v[208:211], v[36:39], v[8:11]
    v_mfma_f32_16x16x32_bf16 v[12:15], v[212:215], v[36:39], v[12:15]
    v_mfma_f32_16x16x32_bf16 v[16:19], v[216:219], v[36:39], v[16:19]
    s_waitcnt lgkmcnt(2)
    v_mfma_f32_16x16x32_bf16 v[8:11], v[220:223], v[40:43], v[8:11]
    v_mfma_f32_16x16x32_bf16 v[12:15], v[224:227], v[40:43], v[12:15]
    v_mfma_f32_16x16x32_bf16 v[16:19], v[228:231], v[40:43], v[16:19]
    s_waitcnt lgkmcnt(1)
    v_mfma_f32_16x16x32_bf16 v[8:11], v[232:235], v[44:47], v[8:11]
    v_mfma_f32_16x16x32_bf16 v[12:15], v[236:239], v[44:47], v[12:15]
    v_mfma_f32_16x16x32_bf16 v[16:19], v[240:243], v[44:47], v[16:19]
    s_waitcnt lgkmcnt(0)
    v_mfma_f32_16x16x32_bf16 v[8:11], v[244:247], v[48:51], v[8:11]
    ds_read_b32 v77, v76
    v_mfma_f32_16x16x32_bf16 v[12:15], v[248:251], v[48:51], v[12:15]
    v_mfma_f32_16x16x32_bf16 v[16:19], v[252:255], v[48:51], v[16:19]
    v_xor_b32 v3, 32768, v3
    v_cvt_pk_bf16_f32 v60, v8, v9
    v_cvt_pk_bf16_f32 v61, v10, v11
    s_nop 0
    v_cvt_pk_bf16_f32 v62, v12, v13
    v_cvt_pk_bf16_f32 v63, v14, v15
    buffer_store_dwordx4 v[60:63], v0, s[4:7], s41 offen sc1
    s_nop 0
    v_cvt_pk_bf16_f32 v64, v16, v17
    v_cvt_pk_bf16_f32 v65, v18, v19
    buffer_store_dwordx2 v[64:65], v6, s[4:7], s41 offen sc1
    s_add_u32 s41, s41, 147456
    s_add_u32 s40, s40, 1
    s_waitcnt lgkmcnt(0)
    v_cmp_ne_u32 vcc, s40, v77
    s_cbranch_vccnz WO_P
    s_waitcnt vmcnt(3)
    s_mov_b32 s46, 1
    s_branch WO_L
WO_V24:
    s_waitcnt lgkmcnt(5)
    v_mfma_f32_16x16x32_bf16 v[8:11], v[160:163], v[20:23], v[8:11]
    v_mov_b32 v77, s44
    s_mov_b64 exec, s[54:55]
    ds_write_b32 v76, v77
    s_mov_b64 exec, -1
    v_mfma_f32_16x16x32_bf16 v[12:15], v[164:167], v[20:23], v[12:15]
    ds_read_b128 v[44:47], v3 offset:30720
    v_mfma_f32_16x16x32_bf16 v[16:19], v[168:171], v[20:23], v[16:19]
    s_add_u32 m0, s43, 0
    s_nop 0
    buffer_load_dwordx4 v0, s[4:7], s42 offen offset:0 sc1 lds
    s_waitcnt lgkmcnt(6)
    v_mfma_f32_16x16x32_bf16 v[8:11], v[172:175], v[24:27], v[8:11]
    ds_read_b128 v[48:51], v3 offset:31744
    v_mfma_f32_16x16x32_bf16 v[12:15], v[176:179], v[24:27], v[12:15]
    buffer_load_dwordx4 v0, s[4:7], s42 offen offset:1024 sc1 lds
    v_mfma_f32_16x16x32_bf16 v[16:19], v[180:183], v[24:27], v[16:19]
    s_waitcnt lgkmcnt(6)
    v_mfma_f32_16x16x32_bf16 v[8:11], v[184:187], v[28:31], v[8:11]
    buffer_load_dwordx4 v0, s[4:7], s42 offen offset:2048 sc1 lds
    v_mfma_f32_16x16x32_bf16 v[12:15], v[188:191], v[28:31], v[12:15]
    v_mfma_f32_16x16x32_bf16 v[16:19], v[192:195], v[28:31], v[16:19]
    s_waitcnt lgkmcnt(5)
    v_mfma_f32_16x16x32_bf16 v[8:11], v[196:199], v[32:35], v[8:11]
    buffer_load_dwordx4 v0, s[4:7], s42 offen offset:3072 sc1 lds
    v_mfma_f32_16x16x32_bf16 v[12:15], v[200:203], v[32:35], v[12:15]
    v_mfma_f32_16x16x32_bf16 v[16:19], v[204:207], v[32:35], v[16:19]
    s_waitcnt lgkmcnt(4)
    v_mfma_f32_16x16x32_bf16 v[8:11], v[208:211], v[36:39], v[8:11]
    s_add_u32 m0, s43, 4096
    s_add_u32 s47, s42, 4096
    buffer_load_dwordx4 v0, s[4:7], s47 offen offset:0 sc1 lds
    v_mfma_f32_16x16x32_bf16 v[12:15], v[212:215], v[36:39], v[12:15]
    v_mfma_f32_16x16x32_bf16 v[16:19], v[216:219], v[36:39], v[16:19]
    s_waitcnt lgkmcnt(3)
    v_mfma_f32_16x16x32_bf16 v[8:11], v[220:223], v[40:43], v[8:11]
    buffer_load_dwordx4 v0, s[4:7], s47 offen offset:1024 sc1 lds
    v_mfma_f32_16x16x32_bf16 v[12:15], v[224:227], v[40:43], v[12:15]
    v_mfma_f32_16x16x32_bf16 v[16:19], v[228:231], v[40:43], v[16:19]
    s_waitcnt lgkmcnt(1)
    v_mfma_f32_16x16x32_bf16 v[8:11], v[232:235], v[44:47], v[8:11]
    buffer_load_dwordx4 v0, s[4:7], s47 offen offset:2048 sc1 lds
    v_mfma_f32_16x16x32_bf16 v[12:15], v[236:239], v[44:47], v[12:15]
    v_mfma_f32_16x16x32_bf16 v[16:19], v[240:243], v[44:47], v[16:19]
    s_waitcnt lgkmcnt(0)
    v_mfma_f32_16x16x32_bf16 v[8:11], v[244:247], v[48:51], v[8:11]
    ds_read_b32 v77, v76
    v_mfma_f32_16x16x32_bf16 v[12:15], v[248:251], v[48:51], v[12:15]
    buffer_load_dwordx4 v0, s[4:7], s47 offen offset:3072 sc1 lds
    s_add_u32 s42, s42, 262144
    s_xor_b32 s43, s43, 32768
    v_mfma_f32_16x16x32_bf16 v[16:19], v[252:255], v[48:51], v[16:19]
    v_xor_b32 v3, 32768, v3
    v_cvt_pk_bf16_f32 v60, v8, v9
    v_cvt_pk_bf16_f32 v61, v10, v11
    s_nop 0
    v_cvt_pk_bf16_f32 v62, v12, v13
    v_cvt_pk_bf16_f32 v63, v14, v15
    buffer_store_dwordx4 v[60:63], v0, s[4:7], s41 offen sc1
    s_nop 0
    v_cvt_pk_bf16_f32 v64, v16, v17
    v_cvt_pk_bf16_f32 v65, v18, v19
    buffer_store_dwordx2 v[64:65], v6, s[4:7], s41 offen sc1
    s_add_u32 s41, s41, 147456
    s_add_u32 s40, s40, 1
    s_waitcnt lgkmcnt(0)
    v_cmp_ne_u32 vcc, s40, v77
    s_cbranch_vccnz WO_P
    s_waitcnt vmcnt(2)
    s_mov_b32 s46, 1
    s_branch WO_L
WO_E:
    s_endpgm
R_QKV:
    s_mov_b32 s12, s68
    s_mov_b32 s13, s69
    s_mov_b32 s14, 0x480000
    s_mov_b32 s15, 0x20000
    s_mov_b32 s16, s70
    s_mov_b32 s17, s71
    s_mov_b32 s18, 0x480000
    s_mov_b32 s19, 0x20000
    s_mov_b32 s20, s72
    s_mov_b32 s21, s73
    s_mov_b32 s22, 0x480000
    s_mov_b32 s23, 0x20000
    v_lshrrev_b32 v7, 3, v1
    v_and_b32 v6, 3, v7
    v_lshlrev_b32 v6, 1, v6
    v_and_b32 v5, 7, v1
    v_xor_b32 v6, v6, v5
    v_lshlrev_b32 v8, 13, v7
    v_lshl_add_u32 v8, v6, 4, v8
    s_and_b32 s32, s24, 1
    s_and_b32 s33, s24, 2
    s_lshl_b32 s34, s36, 2
    s_add_u32 s34, s34, s33
    s_lshl_b32 s34, s34, 6
    s_lshl_b32 s31, s32, 17
    s_add_u32 s34, s34, s31
    v_add_u32 v8, s34, v8
    s_mul_i32 s30, s24, 36864
    s_add_u32 m0, s30, 0
    s_mov_b32 s31, 0
    buffer_load_dwordx4 v8, s[12:15], s31 offen lds
    s_add_u32 m0, s30, 1024
    s_mov_b32 s31, 65536
    buffer_load_dwordx4 v8, s[12:15], s31 offen lds
    s_add_u32 m0, s30, 2048
    s_mov_b32 s31, 0
    buffer_load_dwordx4 v8, s[16:19], s31 offen lds
    s_add_u32 m0, s30, 3072
    s_mov_b32 s31, 65536
    buffer_load_dwordx4 v8, s[16:19], s31 offen lds
    s_add_u32 m0, s30, 4096
    s_mov_b32 s31, 0
    buffer_load_dwordx4 v8, s[20:23], s31 offen lds
    s_add_u32 m0, s30, 5120
    s_mov_b32 s31, 65536
    buffer_load_dwordx4 v8, s[20:23], s31 offen lds
    s_add_u32 m0, s30, 6144
    s_mov_b32 s31, 262144
    buffer_load_dwordx4 v8, s[12:15], s31 offen lds
    s_add_u32 m0, s30, 7168
    s_mov_b32 s31, 327680
    buffer_load_dwordx4 v8, s[12:15], s31 offen lds
    s_add_u32 m0, s30, 8192
    s_mov_b32 s31, 262144
    buffer_load_dwordx4 v8, s[16:19], s31 offen lds
    s_add_u32 m0, s30, 9216
    s_mov_b32 s31, 327680
    buffer_load_dwordx4 v8, s[16:19], s31 offen lds
    s_add_u32 m0, s30, 10240
    s_mov_b32 s31, 262144
    buffer_load_dwordx4 v8, s[20:23], s31 offen lds
    s_add_u32 m0, s30, 11264
    s_mov_b32 s31, 327680
    buffer_load_dwordx4 v8, s[20:23], s31 offen lds
    s_add_u32 m0, s30, 12288
    s_mov_b32 s31, 524288
    buffer_load_dwordx4 v8, s[12:15], s31 offen lds
    s_add_u32 m0, s30, 13312
    s_mov_b32 s31, 589824
    buffer_load_dwordx4 v8, s[12:15], s31 offen lds
    s_add_u32 m0, s30, 14336
    s_mov_b32 s31, 524288
    buffer_load_dwordx4 v8, s[16:19], s31 offen lds
    s_add_u32 m0, s30, 15360
    s_mov_b32 s31, 589824
    buffer_load_dwordx4 v8, s[16:19], s31 offen lds
    s_add_u32 m0, s30, 16384
    s_mov_b32 s31, 524288
    buffer_load_dwordx4 v8, s[20:23], s31 offen lds
    s_add_u32 m0, s30, 17408
    s_mov_b32 s31, 589824
    buffer_load_dwordx4 v8, s[20:23], s31 offen lds
    s_add_u32 m0, s30, 18432
    s_mov_b32 s31, 786432
    buffer_load_dwordx4 v8, s[12:15], s31 offen lds
    s_add_u32 m0, s30, 19456
    s_mov_b32 s31, 851968
    buffer_load_dwordx4 v8, s[12:15], s31 offen lds
    s_add_u32 m0, s30, 20480
    s_mov_b32 s31, 786432
    buffer_load_dwordx4 v8, s[16:19], s31 offen lds
    s_add_u32 m0, s30, 21504
    s_mov_b32 s31, 851968
    buffer_load_dwordx4 v8, s[16:19], s31 offen lds
    s_add_u32 m0, s30, 22528
    s_mov_b32 s31, 786432
    buffer_load_dwordx4 v8, s[20:23], s31 offen lds
    s_add_u32 m0, s30, 23552
    s_mov_b32 s31, 851968
    buffer_load_dwordx4 v8, s[20:23], s31 offen lds
    s_add_u32 m0, s30, 24576
    s_mov_b32 s31, 1048576
    buffer_load_dwordx4 v8, s[12:15], s31 offen lds
    s_add_u32 m0, s30, 25600
    s_mov_b32 s31, 1114112
    buffer_load_dwordx4 v8, s[12:15], s31 offen lds
    s_add_u32 m0, s30, 26624
    s_mov_b32 s31, 1048576
    buffer_load_dwordx4 v8, s[16:19], s31 offen lds
    s_add_u32 m0, s30, 27648
    s_mov_b32 s31, 1114112
    buffer_load_dwordx4 v8, s[16:19], s31 offen lds
    s_add_u32 m0, s30, 28672
    s_mov_b32 s31, 1048576
    buffer_load_dwordx4 v8, s[20:23], s31 offen lds
    s_add_u32 m0, s30, 29696
    s_mov_b32 s31, 1114112
    buffer_load_dwordx4 v8, s[20:23], s31 offen lds
    s_add_u32 m0, s30, 30720
    s_mov_b32 s31, 1310720
    buffer_load_dwordx4 v8, s[12:15], s31 offen lds
    s_add_u32 m0, s30, 31744
    s_mov_b32 s31, 1376256
    buffer_load_dwordx4 v8, s[12:15], s31 offen lds
    s_add_u32 m0, s30, 32768
    s_mov_b32 s31, 1310720
    buffer_load_dwordx4 v8, s[16:19], s31 offen lds
    s_add_u32 m0, s30, 33792
    s_mov_b32 s31, 1376256
    buffer_load_dwordx4 v8, s[16:19], s31 offen lds
    s_add_u32 m0, s30, 34816
    s_mov_b32 s31, 1310720
    buffer_load_dwordx4 v8, s[20:23], s31 offen lds
    s_add_u32 m0, s30, 35840
    s_mov_b32 s31, 1376256
    buffer_load_dwordx4 v8, s[20:23], s31 offen lds
    v_lshrrev_b32 v5, 5, v1
    v_add_u32 v5, s33, v5
    v_mul_u32_u24 v10, 36864, v5
    v_bfe_u32 v5, v1, 4, 1
    v_bfe_u32 v6, v1, 2, 2
    v_lshl_add_u32 v5, v5, 3, v6
    v_lshl_add_u32 v10, v5, 7, v10
    s_lshl_b32 s32, s32, 1
    v_xor_b32 v6, s32, v6
    v_lshl_add_u32 v10, v6, 5, v10
    v_and_b32 v6, 3, v1
    v_lshl_add_u32 v10, v6, 3, v10
    v_xor_b32 v11, 32, v10
    s_waitcnt vmcnt(30)
    s_barrier
    ds_read_b64_tr_b16 a[0:1], v10 offset:0
    ds_read_b64_tr_b16 a[2:3], v10 offset:512
    ds_read_b64_tr_b16 a[4:5], v11 offset:0
    ds_read_b64_tr_b16 a[6:7], v11 offset:512
    ds_read_b64_tr_b16 a[8:9], v10 offset:2048
    ds_read_b64_tr_b16 a[10:11], v10 offset:2560
    ds_read_b64_tr_b16 a[12:13], v11 offset:2048
    ds_read_b64_tr_b16 a[14:15], v11 offset:2560
    ds_read_b64_tr_b16 a[16:17], v10 offset:4096
    ds_read_b64_tr_b16 a[18:19], v10 offset:4608
    ds_read_b64_tr_b16 a[20:21], v11 offset:4096
    ds_read_b64_tr_b16 a[22:23], v11 offset:4608
    s_waitcnt vmcnt(24) lgkmcnt(0)
    s_barrier
    s_add_u32 m0, s30, 0
    s_mov_b32 s31, 1572864
    buffer_load_dwordx4 v8, s[12:15], s31 offen lds
    s_add_u32 m0, s30, 1024
    s_mov_b32 s31, 1638400
    buffer_load_dwordx4 v8, s[12:15], s31 offen lds
    s_add_u32 m0, s30, 2048
    s_mov_b32 s31, 1572864
    buffer_load_dwordx4 v8, s[16:19], s31 offen lds
    s_add_u32 m0, s30, 3072
    s_mov_b32 s31, 1638400
    buffer_load_dwordx4 v8, s[16:19], s31 offen lds
    s_add_u32 m0, s30, 4096
    s_mov_b32 s31, 1572864
    buffer_load_dwordx4 v8, s[20:23], s31 offen lds
    s_add_u32 m0, s30, 5120
    s_mov_b32 s31, 1638400
    buffer_load_dwordx4 v8, s[20:23], s31 offen lds
    ds_read_b64_tr_b16 a[24:25], v10 offset:6144
    ds_read_b64_tr_b16 a[26:27], v10 offset:6656
    ds_read_b64_tr_b16 a[28:29], v11 offset:6144
    ds_read_b64_tr_b16 a[30:31], v11 offset:6656
    ds_read_b64_tr_b16 a[32:33], v10 offset:8192
    ds_read_b64_tr_b16 a[34:35], v10 offset:8704
    ds_read_b64_tr_b16 a[36:37], v11 offset:8192
    ds_read_b64_tr_b16 a[38:39], v11 offset:8704
    ds_read_b64_tr_b16 a[40:41], v10 offset:10240
    ds_read_b64_tr_b16 a[42:43], v10 offset:10752
    ds_read_b64_tr_b16 a[44:45], v11 offset:10240
    ds_read_b64_tr_b16 a[46:47], v11 offset:10752
    s_waitcnt vmcnt(24) lgkmcnt(0)
    s_barrier
    s_add_u32 m0, s30, 6144
    s_mov_b32 s31, 1835008
    buffer_load_dwordx4 v8, s[12:15], s31 offen lds
    s_add_u32 m0, s30, 7168
    s_mov_b32 s31, 1900544
    buffer_load_dwordx4 v8, s[12:15], s31 offen lds
    s_add_u32 m0, s30, 8192
    s_mov_b32 s31, 1835008
    buffer_load_dwordx4 v8, s[16:19], s31 offen lds
    s_add_u32 m0, s30, 9216
    s_mov_b32 s31, 1900544
    buffer_load_dwordx4 v8, s[16:19], s31 offen lds
    s_add_u32 m0, s30, 10240
    s_mov_b32 s31, 1835008
    buffer_load_dwordx4 v8, s[20:23], s31 offen lds
    s_add_u32 m0, s30, 11264
    s_mov_b32 s31, 1900544
    buffer_load_dwordx4 v8, s[20:23], s31 offen lds
    ds_read_b64_tr_b16 a[48:49], v10 offset:12288
    ds_read_b64_tr_b16 a[50:51], v10 offset:12800
    ds_read_b64_tr_b16 a[52:53], v11 offset:12288
    ds_read_b64_tr_b16 a[54:55], v11 offset:12800
    ds_read_b64_tr_b16 a[56:57], v10 offset:14336
    ds_read_b64_tr_b16 a[58:59], v10 offset:14848
    ds_read_b64_tr_b16 a[60:61], v11 offset:14336
    ds_read_b64_tr_b16 a[62:63], v11 offset:14848
    ds_read_b64_tr_b16 a[64:65], v10 offset:16384
    ds_read_b64_tr_b16 a[66:67], v10 offset:16896
    ds_read_b64_tr_b16 a[68:69], v11 offset:16384
    ds_read_b64_tr_b16 a[70:71], v11 offset:16896
    s_waitcnt vmcnt(24) lgkmcnt(0)
    s_barrier
    s_add_u32 m0, s30, 12288
    s_mov_b32 s31, 2097152
    buffer_load_dwordx4 v8, s[12:15], s31 offen lds
    s_add_u32 m0, s30, 13312
    s_mov_b32 s31, 2162688
    buffer_load_dwordx4 v8, s[12:15], s31 offen lds
    s_add_u32 m0, s30, 14336
    s_mov_b32 s31, 2097152
    buffer_load_dwordx4 v8, s[16:19], s31 offen lds
    s_add_u32 m0, s30, 15360
    s_mov_b32 s31, 2162688
    buffer_load_dwordx4 v8, s[16:19], s31 offen lds
    s_add_u32 m0, s30, 16384
    s_mov_b32 s31, 2097152
    buffer_load_dwordx4 v8, s[20:23], s31 offen lds
    s_add_u32 m0, s30, 17408
    s_mov_b32 s31, 2162688
    buffer_load_dwordx4 v8, s[20:23], s31 offen lds
    ds_read_b64_tr_b16 a[72:73], v10 offset:18432
    ds_read_b64_tr_b16 a[74:75], v10 offset:18944
    ds_read_b64_tr_b16 a[76:77], v11 offset:18432
    ds_read_b64_tr_b16 a[78:79], v11 offset:18944
    ds_read_b64_tr_b16 a[80:81], v10 offset:20480
    ds_read_b64_tr_b16 a[82:83], v10 offset:20992
    ds_read_b64_tr_b16 a[84:85], v11 offset:20480
    ds_read_b64_tr_b16 a[86:87], v11 offset:20992
    ds_read_b64_tr_b16 a[88:89], v10 offset:22528
    ds_read_b64_tr_b16 a[90:91], v10 offset:23040
    ds_read_b64_tr_b16 a[92:93], v11 offset:22528
    ds_read_b64_tr_b16 a[94:95], v11 offset:23040
    s_waitcnt vmcnt(24) lgkmcnt(0)
    s_barrier
    s_add_u32 m0, s30, 18432
    s_mov_b32 s31, 2359296
    buffer_load_dwordx4 v8, s[12:15], s31 offen lds
    s_add_u32 m0, s30, 19456
    s_mov_b32 s31, 2424832
    buffer_load_dwordx4 v8, s[12:15], s31 offen lds
    s_add_u32 m0, s30, 20480
    s_mov_b32 s31, 2359296
    buffer_load_dwordx4 v8, s[16:19], s31 offen lds
    s_add_u32 m0, s30, 21504
    s_mov_b32 s31, 2424832
    buffer_load_dwordx4 v8, s[16:19], s31 offen lds
    s_add_u32 m0, s30, 22528
    s_mov_b32 s31, 2359296
    buffer_load_dwordx4 v8, s[20:23], s31 offen lds
    s_add_u32 m0, s30, 23552
    s_mov_b32 s31, 2424832
    buffer_load_dwordx4 v8, s[20:23], s31 offen lds
    ds_read_b64_tr_b16 a[96:97], v10 offset:24576
    ds_read_b64_tr_b16 a[98:99], v10 offset:25088
    ds_read_b64_tr_b16 a[100:101], v11 offset:24576
    ds_read_b64_tr_b16 a[102:103], v11 offset:25088
    ds_read_b64_tr_b16 a[104:105], v10 offset:26624
    ds_read_b64_tr_b16 a[106:107], v10 offset:27136
    ds_read_b64_tr_b16 a[108:109], v11 offset:26624
    ds_read_b64_tr_b16 a[110:111], v11 offset:27136
    ds_read_b64_tr_b16 a[112:113], v10 offset:28672
    ds_read_b64_tr_b16 a[114:115], v10 offset:29184
    ds_read_b64_tr_b16 a[116:117], v11 offset:28672
    ds_read_b64_tr_b16 a[118:119], v11 offset:29184
    s_waitcnt vmcnt(24) lgkmcnt(0)
    s_barrier
    s_add_u32 m0, s30, 24576
    s_mov_b32 s31, 2621440
    buffer_load_dwordx4 v8, s[12:15], s31 offen lds
    s_add_u32 m0, s30, 25600
    s_mov_b32 s31, 2686976
    buffer_load_dwordx4 v8, s[12:15], s31 offen lds
    s_add_u32 m0, s30, 26624
    s_mov_b32 s31, 2621440
    buffer_load_dwordx4 v8, s[16:19], s31 offen lds
    s_add_u32 m0, s30, 27648
    s_mov_b32 s31, 2686976
    buffer_load_dwordx4 v8, s[16:19], s31 offen lds
    s_add_u32 m0, s30, 28672
    s_mov_b32 s31, 2621440
    buffer_load_dwordx4 v8, s[20:23], s31 offen lds
    s_add_u32 m0, s30, 29696
    s_mov_b32 s31, 2686976
    buffer_load_dwordx4 v8, s[20:23], s31 offen lds
    ds_read_b64_tr_b16 a[120:121], v10 offset:30720
    ds_read_b64_tr_b16 a[122:123], v10 offset:31232
    ds_read_b64_tr_b16 a[124:125], v11 offset:30720
    ds_read_b64_tr_b16 a[126:127], v11 offset:31232
    ds_read_b64_tr_b16 a[128:129], v10 offset:32768
    ds_read_b64_tr_b16 a[130:131], v10 offset:33280
    ds_read_b64_tr_b16 a[132:133], v11 offset:32768
    ds_read_b64_tr_b16 a[134:135], v11 offset:33280
    ds_read_b64_tr_b16 a[136:137], v10 offset:34816
    ds_read_b64_tr_b16 a[138:139], v10 offset:35328
    ds_read_b64_tr_b16 a[140:141], v11 offset:34816
    ds_read_b64_tr_b16 a[142:143], v11 offset:35328
    s_waitcnt vmcnt(24) lgkmcnt(0)
    s_barrier
    s_add_u32 m0, s30, 30720
    s_mov_b32 s31, 2883584
    buffer_load_dwordx4 v8, s[12:15], s31 offen lds
    s_add_u32 m0, s30, 31744
    s_mov_b32 s31, 2949120
    buffer_load_dwordx4 v8, s[12:15], s31 offen lds
    s_add_u32 m0, s30, 32768
    s_mov_b32 s31, 2883584
    buffer_load_dwordx4 v8, s[16:19], s31 offen lds
    s_add_u32 m0, s30, 33792
    s_mov_b32 s31, 2949120
    buffer_load_dwordx4 v8, s[16:19], s31 offen lds
    s_add_u32 m0, s30, 34816
    s_mov_b32 s31, 2883584
    buffer_load_dwordx4 v8, s[20:23], s31 offen lds
    s_add_u32 m0, s30, 35840
    s_mov_b32 s31, 2949120
    buffer_load_dwordx4 v8, s[20:23], s31 offen lds
    v_mov_b32 v12, 244
    buffer_load_dword v12, v12, s[8:11], 0 offen sc1
    ds_read_b64_tr_b16 a[144:145], v10 offset:0
    ds_read_b64_tr_b16 a[146:147], v10 offset:512
    ds_read_b64_tr_b16 a[148:149], v11 offset:0
    ds_read_b64_tr_b16 a[150:151], v11 offset:512
    ds_read_b64_tr_b16 a[152:153], v10 offset:2048
    ds_read_b64_tr_b16 a[154:155], v10 offset:2560
    ds_read_b64_tr_b16 a[156:157], v11 offset:2048
    ds_read_b64_tr_b16 a[158:159], v11 offset:2560
    ds_read_b64_tr_b16 a[160:161], v10 offset:4096
    ds_read_b64_tr_b16 a[162:163], v10 offset:4608
    ds_read_b64_tr_b16 a[164:165], v11 offset:4096
    ds_read_b64_tr_b16 a[166:167], v11 offset:4608
    s_waitcnt vmcnt(25) lgkmcnt(0)
    s_barrier
    s_add_u32 m0, s30, 0
    s_mov_b32 s31, 3145728
    buffer_load_dwordx4 v8, s[12:15], s31 offen lds
    s_add_u32 m0, s30, 1024
    s_mov_b32 s31, 3211264
    buffer_load_dwordx4 v8, s[12:15], s31 offen lds
    s_add_u32 m0, s30, 2048
    s_mov_b32 s31, 3145728
    buffer_load_dwordx4 v8, s[16:19], s31 offen lds
    s_add_u32 m0, s30, 3072
    s_mov_b32 s31, 3211264
    buffer_load_dwordx4 v8, s[16:19], s31 offen lds
    s_add_u32 m0, s30, 4096
    s_mov_b32 s31, 3145728
    buffer_load_dwordx4 v8, s[20:23], s31 offen lds
    s_add_u32 m0, s30, 5120
    s_mov_b32 s31, 3211264
    buffer_load_dwordx4 v8, s[20:23], s31 offen lds
    ds_read_b64_tr_b16 a[168:169], v10 offset:6144
    ds_read_b64_tr_b16 a[170:171], v10 offset:6656
    ds_read_b64_tr_b16 a[172:173], v11 offset:6144
    ds_read_b64_tr_b16 a[174:175], v11 offset:6656
    ds_read_b64_tr_b16 a[176:177], v10 offset:8192
    ds_read_b64_tr_b16 a[178:179], v10 offset:8704
    ds_read_b64_tr_b16 a[180:181], v11 offset:8192
    ds_read_b64_tr_b16 a[182:183], v11 offset:8704
    ds_read_b64_tr_b16 a[184:185], v10 offset:10240
    ds_read_b64_tr_b16 a[186:187], v10 offset:10752
    ds_read_b64_tr_b16 a[188:189], v11 offset:10240
    ds_read_b64_tr_b16 a[190:191], v11 offset:10752
    s_waitcnt vmcnt(25) lgkmcnt(0)
    s_barrier
    s_add_u32 m0, s30, 6144
    s_mov_b32 s31, 3407872
    buffer_load_dwordx4 v8, s[12:15], s31 offen lds
    s_add_u32 m0, s30, 7168
    s_mov_b32 s31, 3473408
    buffer_load_dwordx4 v8, s[12:15], s31 offen lds
    s_add_u32 m0, s30, 8192
    s_mov_b32 s31, 3407872
    buffer_load_dwordx4 v8, s[16:19], s31 offen lds
    s_add_u32 m0, s30, 9216
    s_mov_b32 s31, 3473408
    buffer_load_dwordx4 v8, s[16:19], s31 offen lds
    s_add_u32 m0, s30, 10240
    s_mov_b32 s31, 3407872
    buffer_load_dwordx4 v8, s[20:23], s31 offen lds
    s_add_u32 m0, s30, 11264
    s_mov_b32 s31, 3473408
    buffer_load_dwordx4 v8, s[20:23], s31 offen lds
    ds_read_b64_tr_b16 a[192:193], v10 offset:12288
    ds_read_b64_tr_b16 a[194:195], v10 offset:12800
    ds_read_b64_tr_b16 a[196:197], v11 offset:12288
    ds_read_b64_tr_b16 a[198:199], v11 offset:12800
    ds_read_b64_tr_b16 a[200:201], v10 offset:14336
    ds_read_b64_tr_b16 a[202:203], v10 offset:14848
    ds_read_b64_tr_b16 a[204:205], v11 offset:14336
    ds_read_b64_tr_b16 a[206:207], v11 offset:14848
    ds_read_b64_tr_b16 a[208:209], v10 offset:16384
    ds_read_b64_tr_b16 a[210:211], v10 offset:16896
    ds_read_b64_tr_b16 a[212:213], v11 offset:16384
    ds_read_b64_tr_b16 a[214:215], v11 offset:16896
    s_waitcnt vmcnt(25) lgkmcnt(0)
    s_barrier
    s_add_u32 m0, s30, 12288
    s_mov_b32 s31, 3670016
    buffer_load_dwordx4 v8, s[12:15], s31 offen lds
    s_add_u32 m0, s30, 13312
    s_mov_b32 s31, 3735552
    buffer_load_dwordx4 v8, s[12:15], s31 offen lds
    s_add_u32 m0, s30, 14336
    s_mov_b32 s31, 3670016
    buffer_load_dwordx4 v8, s[16:19], s31 offen lds
    s_add_u32 m0, s30, 15360
    s_mov_b32 s31, 3735552
    buffer_load_dwordx4 v8, s[16:19], s31 offen lds
    s_add_u32 m0, s30, 16384
    s_mov_b32 s31, 3670016
    buffer_load_dwordx4 v8, s[20:23], s31 offen lds
    s_add_u32 m0, s30, 17408
    s_mov_b32 s31, 3735552
    buffer_load_dwordx4 v8, s[20:23], s31 offen lds
    ds_read_b64_tr_b16 a[216:217], v10 offset:18432
    ds_read_b64_tr_b16 a[218:219], v10 offset:18944
    ds_read_b64_tr_b16 a[220:221], v11 offset:18432
    ds_read_b64_tr_b16 a[222:223], v11 offset:18944
    ds_read_b64_tr_b16 a[224:225], v10 offset:20480
    ds_read_b64_tr_b16 a[226:227], v10 offset:20992
    ds_read_b64_tr_b16 a[228:229], v11 offset:20480
    ds_read_b64_tr_b16 a[230:231], v11 offset:20992
    ds_read_b64_tr_b16 a[232:233], v10 offset:22528
    ds_read_b64_tr_b16 a[234:235], v10 offset:23040
    ds_read_b64_tr_b16 a[236:237], v11 offset:22528
    ds_read_b64_tr_b16 a[238:239], v11 offset:23040
    s_waitcnt vmcnt(25) lgkmcnt(0)
    s_barrier
    s_add_u32 m0, s30, 18432
    s_mov_b32 s31, 3932160
    buffer_load_dwordx4 v8, s[12:15], s31 offen lds
    s_add_u32 m0, s30, 19456
    s_mov_b32 s31, 3997696
    buffer_load_dwordx4 v8, s[12:15], s31 offen lds
    s_add_u32 m0, s30, 20480
    s_mov_b32 s31, 3932160
    buffer_load_dwordx4 v8, s[16:19], s31 offen lds
    s_add_u32 m0, s30, 21504
    s_mov_b32 s31, 3997696
    buffer_load_dwordx4 v8, s[16:19], s31 offen lds
    s_add_u32 m0, s30, 22528
    s_mov_b32 s31, 3932160
    buffer_load_dwordx4 v8, s[20:23], s31 offen lds
    s_add_u32 m0, s30, 23552
    s_mov_b32 s31, 3997696
    buffer_load_dwordx4 v8, s[20:23], s31 offen lds
    ds_read_b64_tr_b16 a[240:241], v10 offset:24576
    ds_read_b64_tr_b16 a[242:243], v10 offset:25088
    ds_read_b64_tr_b16 a[244:245], v11 offset:24576
    ds_read_b64_tr_b16 a[246:247], v11 offset:25088
    ds_read_b64_tr_b16 a[248:249], v10 offset:26624
    ds_read_b64_tr_b16 a[250:251], v10 offset:27136
    ds_read_b64_tr_b16 a[252:253], v11 offset:26624
    ds_read_b64_tr_b16 a[254:255], v11 offset:27136
    ds_read_b64_tr_b16 v[80:81], v10 offset:28672
    ds_read_b64_tr_b16 v[82:83], v10 offset:29184
    ds_read_b64_tr_b16 v[84:85], v11 offset:28672
    ds_read_b64_tr_b16 v[86:87], v11 offset:29184
    s_waitcnt vmcnt(25) lgkmcnt(0)
    s_barrier
    s_add_u32 m0, s30, 24576
    s_mov_b32 s31, 4194304
    buffer_load_dwordx4 v8, s[12:15], s31 offen lds
    s_add_u32 m0, s30, 25600
    s_mov_b32 s31, 4259840
    buffer_load_dwordx4 v8, s[12:15], s31 offen lds
    s_add_u32 m0, s30, 26624
    s_mov_b32 s31, 4194304
    buffer_load_dwordx4 v8, s[16:19], s31 offen lds
    s_add_u32 m0, s30, 27648
    s_mov_b32 s31, 4259840
    buffer_load_dwordx4 v8, s[16:19], s31 offen lds
    s_add_u32 m0, s30, 28672
    s_mov_b32 s31, 4194304
    buffer_load_dwordx4 v8, s[20:23], s31 offen lds
    s_add_u32 m0, s30, 29696
    s_mov_b32 s31, 4259840
    buffer_load_dwordx4 v8, s[20:23], s31 offen lds
    ds_read_b64_tr_b16 v[88:89], v10 offset:30720
    ds_read_b64_tr_b16 v[90:91], v10 offset:31232
    ds_read_b64_tr_b16 v[92:93], v11 offset:30720
    ds_read_b64_tr_b16 v[94:95], v11 offset:31232
    ds_read_b64_tr_b16 v[96:97], v10 offset:32768
    ds_read_b64_tr_b16 v[98:99], v10 offset:33280
    ds_read_b64_tr_b16 v[100:101], v11 offset:32768
    ds_read_b64_tr_b16 v[102:103], v11 offset:33280
    ds_read_b64_tr_b16 v[104:105], v10 offset:34816
    ds_read_b64_tr_b16 v[106:107], v10 offset:35328
    ds_read_b64_tr_b16 v[108:109], v11 offset:34816
    ds_read_b64_tr_b16 v[110:111], v11 offset:35328
    s_waitcnt vmcnt(24) lgkmcnt(0)
    s_barrier
    s_add_u32 m0, s30, 30720
    s_mov_b32 s31, 4456448
    buffer_load_dwordx4 v8, s[12:15], s31 offen lds
    s_add_u32 m0, s30, 31744
    s_mov_b32 s31, 4521984
    buffer_load_dwordx4 v8, s[12:15], s31 offen lds
    s_add_u32 m0, s30, 32768
    s_mov_b32 s31, 4456448
    buffer_load_dwordx4 v8, s[16:19], s31 offen lds
    s_add_u32 m0, s30, 33792
    s_mov_b32 s31, 4521984
    buffer_load_dwordx4 v8, s[16:19], s31 offen lds
    s_add_u32 m0, s30, 34816
    s_mov_b32 s31, 4456448
    buffer_load_dwordx4 v8, s[20:23], s31 offen lds
    s_add_u32 m0, s30, 35840
    s_mov_b32 s31, 4521984
    buffer_load_dwordx4 v8, s[20:23], s31 offen lds
    ds_read_b64_tr_b16 v[112:113], v10 offset:0
    ds_read_b64_tr_b16 v[114:115], v10 offset:512
    ds_read_b64_tr_b16 v[116:117], v11 offset:0
    ds_read_b64_tr_b16 v[118:119], v11 offset:512
    ds_read_b64_tr_b16 v[120:121], v10 offset:2048
    ds_read_b64_tr_b16 v[122:123], v10 offset:2560
    ds_read_b64_tr_b16 v[124:125], v11 offset:2048
    ds_read_b64_tr_b16 v[126:127], v11 offset:2560
    ds_read_b64_tr_b16 v[128:129], v10 offset:4096
    ds_read_b64_tr_b16 v[130:131], v10 offset:4608
    ds_read_b64_tr_b16 v[132:133], v11 offset:4096
    ds_read_b64_tr_b16 v[134:135], v11 offset:4608
    s_waitcnt vmcnt(24) lgkmcnt(0)
    s_barrier
    ds_read_b64_tr_b16 v[136:137], v10 offset:6144
    ds_read_b64_tr_b16 v[138:139], v10 offset:6656
    ds_read_b64_tr_b16 v[140:141], v11 offset:6144
    ds_read_b64_tr_b16 v[142:143], v11 offset:6656
    ds_read_b64_tr_b16 v[144:145], v10 offset:8192
    ds_read_b64_tr_b16 v[146:147], v10 offset:8704
    ds_read_b64_tr_b16 v[148:149], v11 offset:8192
    ds_read_b64_tr_b16 v[150:151], v11 offset:8704
    ds_read_b64_tr_b16 v[152:153], v10 offset:10240
    ds_read_b64_tr_b16 v[154:155], v10 offset:10752
    ds_read_b64_tr_b16 v[156:157], v11 offset:10240
    ds_read_b64_tr_b16 v[158:159], v11 offset:10752
    s_waitcnt vmcnt(18) lgkmcnt(0)
    s_barrier
    v_lshlrev_b32 v4, 7, v1
    s_mov_b32 s48, 393216
    buffer_load_dword v13, v4, s[4:7], s48 offen sc1
    s_mov_b32 s48, 401408
    buffer_load_dword v14, v4, s[4:7], s48 offen sc1
    ds_read_b64_tr_b16 v[160:161], v10 offset:12288
    ds_read_b64_tr_b16 v[162:163], v10 offset:12800
    ds_read_b64_tr_b16 v[164:165], v11 offset:12288
    ds_read_b64_tr_b16 v[166:167], v11 offset:12800
    ds_read_b64_tr_b16 v[168:169], v10 offset:14336
    ds_read_b64_tr_b16 v[170:171], v10 offset:14848
    ds_read_b64_tr_b16 v[172:173], v11 offset:14336
    ds_read_b64_tr_b16 v[174:175], v11 offset:14848
    ds_read_b64_tr_b16 v[176:177], v10 offset:16384
    ds_read_b64_tr_b16 v[178:179], v10 offset:16896
    ds_read_b64_tr_b16 v[180:181], v11 offset:16384
    ds_read_b64_tr_b16 v[182:183], v11 offset:16896
    s_waitcnt vmcnt(14) lgkmcnt(0)
    s_barrier
    ds_read_b64_tr_b16 v[184:185], v10 offset:18432
    ds_read_b64_tr_b16 v[186:187], v10 offset:18944
    ds_read_b64_tr_b16 v[188:189], v11 offset:18432
    ds_read_b64_tr_b16 v[190:191], v11 offset:18944
    ds_read_b64_tr_b16 v[192:193], v10 offset:20480
    ds_read_b64_tr_b16 v[194:195], v10 offset:20992
    ds_read_b64_tr_b16 v[196:197], v11 offset:20480
    ds_read_b64_tr_b16 v[198:199], v11 offset:20992
    ds_read_b64_tr_b16 v[200:201], v10 offset:22528
    ds_read_b64_tr_b16 v[202:203], v10 offset:23040
    ds_read_b64_tr_b16 v[204:205], v11 offset:22528
    ds_read_b64_tr_b16 v[206:207], v11 offset:23040
    s_waitcnt vmcnt(8) lgkmcnt(0)
    s_barrier
    ds_read_b64_tr_b16 v[208:209], v10 offset:24576
    ds_read_b64_tr_b16 v[210:211], v10 offset:25088
    ds_read_b64_tr_b16 v[212:213], v11 offset:24576
    ds_read_b64_tr_b16 v[214:215], v11 offset:25088
    ds_read_b64_tr_b16 v[216:217], v10 offset:26624
    ds_read_b64_tr_b16 v[218:219], v10 offset:27136
    ds_read_b64_tr_b16 v[220:221], v11 offset:26624
    ds_read_b64_tr_b16 v[222:223], v11 offset:27136
    ds_read_b64_tr_b16 v[224:225], v10 offset:28672
    ds_read_b64_tr_b16 v[226:227], v10 offset:29184
    ds_read_b64_tr_b16 v[228:229], v11 offset:28672
    ds_read_b64_tr_b16 v[230:231], v11 offset:29184
    s_waitcnt vmcnt(2) lgkmcnt(0)
    s_barrier
    ds_read_b64_tr_b16 v[232:233], v10 offset:30720
    ds_read_b64_tr_b16 v[234:235], v10 offset:31232
    ds_read_b64_tr_b16 v[236:237], v11 offset:30720
    ds_read_b64_tr_b16 v[238:239], v11 offset:31232
    ds_read_b64_tr_b16 v[240:241], v10 offset:32768
    ds_read_b64_tr_b16 v[242:243], v10 offset:33280
    ds_read_b64_tr_b16 v[244:245], v11 offset:32768
    ds_read_b64_tr_b16 v[246:247], v11 offset:33280
    ds_read_b64_tr_b16 v[248:249], v10 offset:34816
    ds_read_b64_tr_b16 v[250:251], v10 offset:35328
    ds_read_b64_tr_b16 v[252:253], v11 offset:34816
    ds_read_b64_tr_b16 v[254:255], v11 offset:35328
    s_waitcnt vmcnt(0) lgkmcnt(0)
    v_cmp_gt_u32 s[48:49], 18, v12
    v_min_u32 v13, v13, v14
    v_cmp_gt_u32 vcc, 1, v13
    s_or_b64 vcc, vcc, s[48:49]
    s_cbranch_vccz QKV_GO
    v_mov_b32 v6, 244
    s_mov_b32 s27, 0
SP_22:
    buffer_load_dword v7, v6, s[8:11], 0 offen sc1
    s_waitcnt vmcnt(0)
    v_cmp_gt_u32 vcc, 18, v7
    s_cbranch_vccz SD_23
    s_add_u32 s27, s27, 1
    s_cmp_lt_u32 s27, 400000
    s_cbranch_scc1 SP_22
    s_movk_i32 s27, 1
    s_branch FAIL
SD_23:
    v_lshlrev_b32 v4, 7, v1
    s_mov_b32 s48, 393216
    s_mov_b32 s27, 0
SP_24:
    buffer_load_dword v5, v4, s[4:7], s48 offen sc1
    s_waitcnt vmcnt(0)
    v_cmp_gt_u32 vcc, 1, v5
    s_cbranch_vccz SD_25
    s_add_u32 s27, s27, 1
    s_cmp_lt_u32 s27, 400000
    s_cbranch_scc1 SP_24
    s_movk_i32 s27, 23
    s_branch FAIL
SD_25:
    s_mov_b32 s48, 401408
    s_mov_b32 s27, 0
SP_26:
    buffer_load_dword v5, v4, s[4:7], s48 offen sc1
    s_waitcnt vmcnt(0)
    v_cmp_gt_u32 vcc, 1, v5
    s_cbranch_vccz SD_27
    s_add_u32 s27, s27, 1
    s_cmp_lt_u32 s27, 400000
    s_cbranch_scc1 SP_26
    s_movk_i32 s27, 23
    s_branch FAIL
SD_27:
QKV_GO:
    s_mov_b32 s40, s37
    s_mul_i32 s41, s37, 32768
    s_lshl_b32 s33, s36, 21
    s_add_u32 s41, s41, s33
    s_lshl_b32 s50, s24, 11
    s_add_u32 s41, s41, s50
    s_add_u32 s41, s41, 0x1000000
    s_add_u32 s50, s50, 8192
    s_mul_i32 s42, s37, 36864
    s_mul_i32 s33, s24, 9216
    s_add_u32 s42, s42, s33
    s_add_u32 s42, s42, 0x400000
    s_lshl_b32 s35, s36, 1
    s_add_u32 s35, s35, s37
    s_lshl_b32 s35, s35, 2
    s_add_u32 s35, s35, s24
    s_lshr_b32 s45, s35, 2
    s_add_u32 s45, s45, 3328
    s_lshl_b32 s45, s45, 5
    s_add_u32 s45, s45, s24
    s_lshl_b32 s45, s45, 2
    s_mov_b32 s52, 0x3e0293ee
    s_mov_b32 s53, s52
    v_lshlrev_b32 v0, 4, v1
    v_mov_b32 v3, v0
    v_mov_b32 v5, 0
    s_mul_i32 s43, s24, 9216
    s_mov_b32 s46, 0
    s_barrier
QKV_S:
QKV_D:
    s_add_u32 m0, s43, 0
    s_nop 0
    buffer_load_dwordx4 v0, s[4:7], s42 offen offset:0 sc1 lds
    buffer_load_dwordx4 v0, s[4:7], s42 offen offset:1024 sc1 lds
    buffer_load_dwordx4 v0, s[4:7], s42 offen offset:2048 sc1 lds
    buffer_load_dwordx4 v0, s[4:7], s42 offen offset:3072 sc1 lds
    s_add_u32 m0, s43, 4096
    s_add_u32 s47, s42, 4096
    buffer_load_dwordx4 v0, s[4:7], s47 offen offset:0 sc1 lds
    buffer_load_dwordx4 v0, s[4:7], s47 offen offset:1024 sc1 lds
    buffer_load_dwordx4 v0, s[4:7], s47 offen offset:2048 sc1 lds
    buffer_load_dwordx4 v0, s[4:7], s47 offen offset:3072 sc1 lds
    s_add_u32 m0, s43, 8192
    s_add_u32 s47, s42, 8192
    buffer_load_dwordx4 v0, s[4:7], s47 offen offset:0 sc1 lds
    s_add_u32 s42, s42, 73728
    s_xor_b32 s43, s43, 65536
    s_waitcnt vmcnt(0)
QKV_L:
    s_barrier
    ds_read_b128 v[56:59], v3 offset:0
    ds_read_b128 v[60:63], v3 offset:1024
    ds_read_b128 v[64:67], v3 offset:2048
    ds_read_b128 v[68:71], v3 offset:3072
    s_add_u32 s44, s40, 2
    s_cmp_lt_u32 s44, 64
    s_cbranch_scc1 QKV_V0
    s_waitcnt lgkmcnt(3)
    v_mfma_f32_16x16x32_bf16 v[8:11], a[0:3], v[56:59], 0
    ds_read_b128 v[72:75], v3 offset:4096
    v_mfma_f32_16x16x32_bf16 v[12:15], a[4:7], v[56:59], 0
    v_mfma_f32_16x16x32_bf16 v[16:19], a[8:11], v[56:59], 0
    v_mfma_f32_16x16x32_bf16 v[20:23], a[12:15], v[56:59], 0
    v_mfma_f32_16x16x32_bf16 v[24:27], v[56:59], a[16:19], 0
    v_mfma_f32_16x16x32_bf16 v[28:31], v[56:59], a[20:23], 0
    s_waitcnt lgkmcnt(3)
    v_mfma_f32_16x16x32_bf16 v[8:11], a[24:27], v[60:63], v[8:11]
    ds_read_b128 v[76:79], v3 offset:5120
    v_mfma_f32_16x16x32_bf16 v[12:15], a[28:31], v[60:63], v[12:15]
    v_mfma_f32_16x16x32_bf16 v[16:19], a[32:35], v[60:63], v[16:19]
    v_mfma_f32_16x16x32_bf16 v[20:23], a[36:39], v[60:63], v[20:23]
    v_mfma_f32_16x16x32_bf16 v[24:27], v[60:63], a[40:43], v[24:27]
    v_mfma_f32_16x16x32_bf16 v[28:31], v[60:63], a[44:47], v[28:31]
    s_waitcnt lgkmcnt(3)
    v_mfma_f32_16x16x32_bf16 v[8:11], a[48:51], v[64:67], v[8:11]
    ds_read_b128 v[56:59], v3 offset:6144
    v_mfma_f32_16x16x32_bf16 v[12:15], a[52:55], v[64:67], v[12:15]
    v_mfma_f32_16x16x32_bf16 v[16:19], a[56:59], v[64:67], v[16:19]
    v_mfma_f32_16x16x32_bf16 v[20:23], a[60:63], v[64:67], v[20:23]
    v_mfma_f32_16x16x32_bf16 v[24:27], v[64:67], a[64:67], v[24:27]
    v_mfma_f32_16x16x32_bf16 v[28:31], v[64:67], a[68:71], v[28:31]
    s_waitcnt lgkmcnt(3)
    v_mfma_f32_16x16x32_bf16 v[8:11], a[72:75], v[68:71], v[8:11]
    ds_read_b128 v[60:63], v3 offset:7168
    v_mfma_f32_16x16x32_bf16 v[12:15], a[76:79], v[68:71], v[12:15]
    v_mfma_f32_16x16x32_bf16 v[16:19], a[80:83], v[68:71], v[16:19]
    v_mfma_f32_16x16x32_bf16 v[20:23], a[84:87], v[68:71], v[20:23]
    v_mfma_f32_16x16x32_bf16 v[24:27], v[68:71], a[88:91], v[24:27]
    v_mfma_f32_16x16x32_bf16 v[28:31], v[68:71], a[92:95], v[28:31]
    s_waitcnt lgkmcnt(3)
    v_mfma_f32_16x16x32_bf16 v[8:11], a[96:99], v[72:75], v[8:11]
    ds_read_b128 v[64:67], v3 offset:8192
    v_mfma_f32_16x16x32_bf16 v[12:15], a[100:103], v[72:75], v[12:15]
    v_mfma_f32_16x16x32_bf16 v[16:19], a[104:107], v[72:75], v[16:19]
    v_mfma_f32_16x16x32_bf16 v[20:23], a[108:111], v[72:75], v[20:23]
    v_mfma_f32_16x16x32_bf16 v[24:27], v[72:75], a[112:115], v[24:27]
    v_mfma_f32_16x16x32_bf16 v[28:31], v[72:75], a[116:119], v[28:31]
    s_waitcnt lgkmcnt(3)
    v_mfma_f32_16x16x32_bf16 v[8:11], a[120:123], v[76:79], v[8:11]
    ds_read_b128 v[68:71], v3 offset:9216
    v_mfma_f32_16x16x32_bf16 v[12:15], a[124:127], v[76:79], v[12:15]
    v_mfma_f32_16x16x32_bf16 v[16:19], a[128:131], v[76:79], v[16:19]
    v_mfma_f32_16x16x32_bf16 v[20:23], a[132:135], v[76:79], v[20:23]
    v_mfma_f32_16x16x32_bf16 v[24:27], v[76:79], a[136:139], v[24:27]
    v_mfma_f32_16x16x32_bf16 v[28:31], v[76:79], a[140:143], v[28:31]
    s_waitcnt lgkmcnt(3)
    v_mfma_f32_16x16x32_bf16 v[8:11], a[144:147], v[56:59], v[8:11]
    ds_read_b128 v[72:75], v3 offset:10240
    v_mfma_f32_16x16x32_bf16 v[12:15], a[148:151], v[56:59], v[12:15]
    v_mfma_f32_16x16x32_bf16 v[16:19], a[152:155], v[56:59], v[16:19]
    v_mfma_f32_16x16x32_bf16 v[20:23], a[156:159], v[56:59], v[20:23]
    v_mfma_f32_16x16x32_bf16 v[24:27], v[56:59], a[160:163], v[24:27]
    v_mfma_f32_16x16x32_bf16 v[28:31], v[56:59], a[164:167], v[28:31]
    s_waitcnt lgkmcnt(3)
    v_mfma_f32_16x16x32_bf16 v[8:11], a[168:171], v[60:63], v[8:11]
    ds_read_b128 v[76:79], v3 offset:11264
    v_mfma_f32_16x16x32_bf16 v[12:15], a[172:175], v[60:63], v[12:15]
    s_cmp_eq_u32 s46, 0
    s_cbranch_scc1 NP_28
    s_waitcnt vmcnt(0)
    v_mov_b32 v7, s40
    s_mov_b64 exec, 1
    buffer_store_dword v7, off, s[4:7], s45 sc1
    s_mov_b64 exec, -1
    s_mov_b32 s46, 0
NP_28:
    v_mfma_f32_16x16x32_bf16 v[16:19], a[176:179], v[60:63], v[16:19]
    v_mfma_f32_16x16x32_bf16 v[20:23], a[180:183], v[60:63], v[20:23]
    v_mfma_f32_16x16x32_bf16 v[24:27], v[60:63], a[184:187], v[24:27]
    v_mfma_f32_16x16x32_bf16 v[28:31], v[60:63], a[188:191], v[28:31]
    s_waitcnt lgkmcnt(3)
    v_mfma_f32_16x16x32_bf16 v[8:11], a[192:195], v[64:67], v[8:11]
    ds_read_b128 v[56:59], v3 offset:12288
    v_mfma_f32_16x16x32_bf16 v[12:15], a[196:199], v[64:67], v[12:15]
    v_mfma_f32_16x16x32_bf16 v[16:19], a[200:203], v[64:67], v[16:19]
    v_mfma_f32_16x16x32_bf16 v[20:23], a[204:207], v[64:67], v[20:23]
    v_mfma_f32_16x16x32_bf16 v[24:27], v[64:67], a[208:211], v[24:27]
    v_mfma_f32_16x16x32_bf16 v[28:31], v[64:67], a[212:215], v[28:31]
    s_waitcnt lgkmcnt(3)
    v_mfma_f32_16x16x32_bf16 v[8:11], a[216:219], v[68:71], v[8:11]
    ds_read_b128 v[60:63], v3 offset:13312
    v_mfma_f32_16x16x32_bf16 v[12:15], a[220:223], v[68:71], v[12:15]
    v_mfma_f32_16x16x32_bf16 v[16:19], a[224:227], v[68:71], v[16:19]
    v_mfma_f32_16x16x32_bf16 v[20:23], a[228:231], v[68:71], v[20:23]
    v_mfma_f32_16x16x32_bf16 v[24:27], v[68:71], a[232:235], v[24:27]
    v_mfma_f32_16x16x32_bf16 v[28:31], v[68:71], a[236:239], v[28:31]
    s_waitcnt lgkmcnt(3)
    v_mfma_f32_16x16x32_bf16 v[8:11], a[240:243], v[72:75], v[8:11]
    ds_read_b128 v[64:67], v3 offset:14336
    v_mfma_f32_16x16x32_bf16 v[12:15], a[244:247], v[72:75], v[12:15]
    v_mfma_f32_16x16x32_bf16 v[16:19], a[248:251], v[72:75], v[16:19]
    v_mfma_f32_16x16x32_bf16 v[20:23], a[252:255], v[72:75], v[20:23]
    v_mfma_f32_16x16x32_bf16 v[24:27], v[72:75], v[80:83], v[24:27]
    v_mfma_f32_16x16x32_bf16 v[28:31], v[72:75], v[84:87], v[28:31]
    s_waitcnt lgkmcnt(3)
    v_mfma_f32_16x16x32_bf16 v[8:11], v[88:91], v[76:79], v[8:11]
    ds_read_b128 v[68:71], v3 offset:15360
    v_mfma_f32_16x16x32_bf16 v[12:15], v[92:95], v[76:79], v[12:15]
    v_mfma_f32_16x16x32_bf16 v[16:19], v[96:99], v[76:79], v[16:19]
    v_mfma_f32_16x16x32_bf16 v[20:23], v[100:103], v[76:79], v[20:23]
    v_mfma_f32_16x16x32_bf16 v[24:27], v[76:79], v[104:107], v[24:27]
    v_mfma_f32_16x16x32_bf16 v[28:31], v[76:79], v[108:111], v[28:31]
    s_waitcnt lgkmcnt(3)
    v_mfma_f32_16x16x32_bf16 v[8:11], v[112:115], v[56:59], v[8:11]
    ds_read_b128 v[72:75], v3 offset:16384
    v_mfma_f32_16x16x32_bf16 v[12:15], v[116:119], v[56:59], v[12:15]
    v_mfma_f32_16x16x32_bf16 v[16:19], v[120:123], v[56:59], v[16:19]
    v_mfma_f32_16x16x32_bf16 v[20:23], v[124:127], v[56:59], v[20:23]
    v_mfma_f32_16x16x32_bf16 v[24:27], v[56:59], v[128:131], v[24:27]
    v_mfma_f32_16x16x32_bf16 v[28:31], v[56:59], v[132:135], v[28:31]
    s_waitcnt lgkmcnt(3)
    v_mfma_f32_16x16x32_bf16 v[8:11], v[136:139], v[60:63], v[8:11]
    ds_read_b128 v[76:79], v3 offset:17408
    v_mfma_f32_16x16x32_bf16 v[12:15], v[140:143], v[60:63], v[12:15]
    v_mfma_f32_16x16x32_bf16 v[16:19], v[144:147], v[60:63], v[16:19]
    v_mfma_f32_16x16x32_bf16 v[20:23], v[148:151], v[60:63], v[20:23]
    v_mfma_f32_16x16x32_bf16 v[24:27], v[60:63], v[152:155], v[24:27]
    v_mfma_f32_16x16x32_bf16 v[28:31], v[60:63], v[156:159], v[28:31]
    s_waitcnt lgkmcnt(3)
    v_mfma_f32_16x16x32_bf16 v[8:11], v[160:163], v[64:67], v[8:11]
    ds_read_b128 v[56:59], v3 offset:18432
    v_mfma_f32_16x16x32_bf16 v[12:15], v[164:167], v[64:67], v[12:15]
    v_mfma_f32_16x16x32_bf16 v[16:19], v[168:171], v[64:67], v[16:19]
    v_mfma_f32_16x16x32_bf16 v[20:23], v[172:175], v[64:67], v[20:23]
    v_mfma_f32_16x16x32_bf16 v[24:27], v[64:67], v[176:179], v[24:27]
    v_mfma_f32_16x16x32_bf16 v[28:31], v[64:67], v[180:183], v[28:31]
    s_waitcnt lgkmcnt(3)
    v_mfma_f32_16x16x32_bf16 v[8:11], v[184:187], v[68:71], v[8:11]
    ds_read_b128 v[60:63], v3 offset:19456
    v_mfma_f32_16x16x32_bf16 v[12:15], v[188:191], v[68:71], v[12:15]
    v_mfma_f32_16x16x32_bf16 v[16:19], v[192:195], v[68:71], v[16:19]
    v_mfma_f32_16x16x32_bf16 v[20:23], v[196:199], v[68:71], v[20:23]
    v_mfma_f32_16x16x32_bf16 v[24:27], v[68:71], v[200:203], v[24:27]
    v_mfma_f32_16x16x32_bf16 v[28:31], v[68:71], v[204:207], v[28:31]
    s_waitcnt lgkmcnt(3)
    v_mfma_f32_16x16x32_bf16 v[8:11], v[208:211], v[72:75], v[8:11]
    ds_read_b128 v[64:67], v3 offset:20480
    v_mfma_f32_16x16x32_bf16 v[12:15], v[212:215], v[72:75], v[12:15]
    v_mfma_f32_16x16x32_bf16 v[16:19], v[216:219], v[72:75], v[16:19]
    v_mfma_f32_16x16x32_bf16 v[20:23], v[220:223], v[72:75], v[20:23]
    v_mfma_f32_16x16x32_bf16 v[24:27], v[72:75], v[224:227], v[24:27]
    v_mfma_f32_16x16x32_bf16 v[28:31], v[72:75], v[228:231], v[28:31]
    s_waitcnt lgkmcnt(3)
    v_mfma_f32_16x16x32_bf16 v[8:11], v[232:235], v[76:79], v[8:11]
    ds_read_b128 v[68:71], v3 offset:21504
    v_mfma_f32_16x16x32_bf16 v[12:15], v[236:239], v[76:79], v[12:15]
    v_mfma_f32_16x16x32_bf16 v[16:19], v[240:243], v[76:79], v[16:19]
    v_mfma_f32_16x16x32_bf16 v[20:23], v[244:247], v[76:79], v[20:23]
    v_mfma_f32_16x16x32_bf16 v[24:27], v[76:79], v[248:251], v[24:27]
    v_mfma_f32_16x16x32_bf16 v[28:31], v[76:79], v[252:255], v[28:31]
    s_waitcnt lgkmcnt(3)
    v_mfma_f32_16x16x32_bf16 v[32:35], a[0:3], v[56:59], 0
    ds_read_b128 v[72:75], v3 offset:22528
    v_mfma_f32_16x16x32_bf16 v[36:39], a[4:7], v[56:59], 0
    v_mfma_f32_16x16x32_bf16 v[40:43], a[8:11], v[56:59], 0
    v_mfma_f32_16x16x32_bf16 v[44:47], a[12:15], v[56:59], 0
    v_mfma_f32_16x16x32_bf16 v[48:51], v[56:59], a[16:19], 0
    v_mfma_f32_16x16x32_bf16 v[52:55], v[56:59], a[20:23], 0
    s_waitcnt lgkmcnt(3)
    v_mfma_f32_16x16x32_bf16 v[32:35], a[24:27], v[60:63], v[32:35]
    ds_read_b128 v[76:79], v3 offset:23552
    v_mfma_f32_16x16x32_bf16 v[36:39], a[28:31], v[60:63], v[36:39]
    v_cvt_pk_bf16_f32 v8, v8, v9
    v_cvt_pk_bf16_f32 v9, v10, v11
    v_mfma_f32_16x16x32_bf16 v[40:43], a[32:35], v[60:63], v[40:43]
    v_cvt_pk_bf16_f32 v10, v12, v13
    v_cvt_pk_bf16_f32 v11, v14, v15
    v_mfma_f32_16x16x32_bf16 v[44:47], a[36:39], v[60:63], v[44:47]
    buffer_store_dwordx4 v[8:11], v0, s[4:7], s41 offen offset:0 sc1
    v_mfma_f32_16x16x32_bf16 v[48:51], v[60:63], a[40:43], v[48:51]
    s_add_u32 s49, s41, s50
    v_mfma_f32_16x16x32_bf16 v[52:55], v[60:63], a[44:47], v[52:55]
    s_waitcnt lgkmcnt(3)
    v_mfma_f32_16x16x32_bf16 v[32:35], a[48:51], v[64:67], v[32:35]
    ds_read_b128 v[56:59], v3 offset:24576
    v_mfma_f32_16x16x32_bf16 v[36:39], a[52:55], v[64:67], v[36:39]
    v_pk_mul_f32 v[16:17], v[16:17], s[52:53]
    v_pk_mul_f32 v[18:19], v[18:19], s[52:53]
    v_mfma_f32_16x16x32_bf16 v[40:43], a[56:59], v[64:67], v[40:43]
    v_pk_mul_f32 v[20:21], v[20:21], s[52:53]
    v_pk_mul_f32 v[22:23], v[22:23], s[52:53]
    v_mfma_f32_16x16x32_bf16 v[44:47], a[60:63], v[64:67], v[44:47]
    v_mfma_f32_16x16x32_bf16 v[48:51], v[64:67], a[64:67], v[48:51]
    v_mfma_f32_16x16x32_bf16 v[52:55], v[64:67], a[68:71], v[52:55]
    s_waitcnt lgkmcnt(3)
    v_mfma_f32_16x16x32_bf16 v[32:35], a[72:75], v[68:71], v[32:35]
    ds_read_b128 v[60:63], v3 offset:25600
    v_mfma_f32_16x16x32_bf16 v[36:39], a[76:79], v[68:71], v[36:39]
    v_cvt_pk_bf16_f32 v16, v16, v17
    v_cvt_pk_bf16_f32 v17, v18, v19
    v_mfma_f32_16x16x32_bf16 v[40:43], a[80:83], v[68:71], v[40:43]
    v_cvt_pk_bf16_f32 v18, v20, v21
    v_cvt_pk_bf16_f32 v19, v22, v23
    v_mfma_f32_16x16x32_bf16 v[44:47], a[84:87], v[68:71], v[44:47]
    buffer_store_dwordx4 v[16:19], v0, s[4:7], s49 offen offset:0 sc1
    v_mfma_f32_16x16x32_bf16 v[48:51], v[68:71], a[88:91], v[48:51]
    v_mfma_f32_16x16x32_bf16 v[52:55], v[68:71], a[92:95], v[52:55]
    s_waitcnt lgkmcnt(3)
    v_mfma_f32_16x16x32_bf16 v[32:35], a[96:99], v[72:75], v[32:35]
    ds_read_b128 v[64:67], v3 offset:26624
    v_mfma_f32_16x16x32_bf16 v[36:39], a[100:103], v[72:75], v[36:39]
    v_cvt_pk_bf16_f32 v24, v24, v25
    v_cvt_pk_bf16_f32 v25, v26, v27
    v_mfma_f32_16x16x32_bf16 v[40:43], a[104:107], v[72:75], v[40:43]
    v_cvt_pk_bf16_f32 v28, v28, v29
    v_cvt_pk_bf16_f32 v29, v30, v31
    v_mfma_f32_16x16x32_bf16 v[44:47], a[108:111], v[72:75], v[44:47]
    v_mfma_f32_16x16x32_bf16 v[48:51], v[72:75], a[112:115], v[48:51]
    v_mfma_f32_16x16x32_bf16 v[52:55], v[72:75], a[116:119], v[52:55]
    s_waitcnt lgkmcnt(3)
    v_mfma_f32_16x16x32_bf16 v[32:35], a[120:123], v[76:79], v[32:35]
    ds_read_b128 v[68:71], v3 offset:27648
    v_mfma_f32_16x16x32_bf16 v[36:39], a[124:127], v[76:79], v[36:39]
    v_mfma_f32_16x16x32_bf16 v[40:43], a[128:131], v[76:79], v[40:43]
    v_mfma_f32_16x16x32_bf16 v[44:47], a[132:135], v[76:79], v[44:47]
    v_mfma_f32_16x16x32_bf16 v[48:51], v[76:79], a[136:139], v[48:51]
    v_mfma_f32_16x16x32_bf16 v[52:55], v[76:79], a[140:143], v[52:55]
    s_waitcnt lgkmcnt(3)
    v_mfma_f32_16x16x32_bf16 v[32:35], a[144:147], v[56:59], v[32:35]
    ds_read_b128 v[72:75], v3 offset:28672
    v_mfma_f32_16x16x32_bf16 v[36:39], a[148:151], v[56:59], v[36:39]
    v_mfma_f32_16x16x32_bf16 v[40:43], a[152:155], v[56:59], v[40:43]
    v_mfma_f32_16x16x32_bf16 v[44:47], a[156:159], v[56:59], v[44:47]
    v_mfma_f32_16x16x32_bf16 v[48:51], v[56:59], a[160:163], v[48:51]
    v_mfma_f32_16x16x32_bf16 v[52:55], v[56:59], a[164:167], v[52:55]
    s_waitcnt lgkmcnt(3)
    v_mfma_f32_16x16x32_bf16 v[32:35], a[168:171], v[60:63], v[32:35]
    ds_read_b128 v[76:79], v3 offset:29696
    v_mfma_f32_16x16x32_bf16 v[36:39], a[172:175], v[60:63], v[36:39]
    v_mfma_f32_16x16x32_bf16 v[40:43], a[176:179], v[60:63], v[40:43]
    v_mfma_f32_16x16x32_bf16 v[44:47], a[180:183], v[60:63], v[44:47]
    v_mfma_f32_16x16x32_bf16 v[48:51], v[60:63], a[184:187], v[48:51]
    v_mfma_f32_16x16x32_bf16 v[52:55], v[60:63], a[188:191], v[52:55]
    s_waitcnt lgkmcnt(3)
    v_mfma_f32_16x16x32_bf16 v[32:35], a[192:195], v[64:67], v[32:35]
    ds_read_b128 v[56:59], v3 offset:30720
    v_mfma_f32_16x16x32_bf16 v[36:39], a[196:199], v[64:67], v[36:39]
    v_mfma_f32_16x16x32_bf16 v[40:43], a[200:203], v[64:67], v[40:43]
    v_mfma_f32_16x16x32_bf16 v[44:47], a[204:207], v[64:67], v[44:47]
    v_mfma_f32_16x16x32_bf16 v[48:51], v[64:67], a[208:211], v[48:51]
    v_mfma_f32_16x16x32_bf16 v[52:55], v[64:67], a[212:215], v[52:55]
    s_waitcnt lgkmcnt(3)
    v_mfma_f32_16x16x32_bf16 v[32:35], a[216:219], v[68:71], v[32:35]
    ds_read_b128 v[60:63], v3 offset:31744
    v_mfma_f32_16x16x32_bf16 v[36:39], a[220:223], v[68:71], v[36:39]
    v_mfma_f32_16x16x32_bf16 v[40:43], a[224:227], v[68:71], v[40:43]
    v_mfma_f32_16x16x32_bf16 v[44:47], a[228:231], v[68:71], v[44:47]
    v_mfma_f32_16x16x32_bf16 v[48:51], v[68:71], a[232:235], v[48:51]
    v_mfma_f32_16x16x32_bf16 v[52:55], v[68:71], a[236:239], v[52:55]
    s_waitcnt lgkmcnt(3)
    v_mfma_f32_16x16x32_bf16 v[32:35], a[240:243], v[72:75], v[32:35]
    ds_read_b128 v[64:67], v3 offset:32768
    v_mfma_f32_16x16x32_bf16 v[36:39], a[244:247], v[72:75], v[36:39]
    v_mfma_f32_16x16x32_bf16 v[40:43], a[248:251], v[72:75], v[40:43]
    v_mfma_f32_16x16x32_bf16 v[44:47], a[252:255], v[72:75], v[44:47]
    v_mfma_f32_16x16x32_bf16 v[48:51], v[72:75], v[80:83], v[48:51]
    v_mfma_f32_16x16x32_bf16 v[52:55], v[72:75], v[84:87], v[52:55]
    s_waitcnt lgkmcnt(3)
    v_mfma_f32_16x16x32_bf16 v[32:35], v[88:91], v[76:79], v[32:35]
    ds_read_b128 v[68:71], v3 offset:33792
    v_mfma_f32_16x16x32_bf16 v[36:39], v[92:95], v[76:79], v[36:39]
    v_mfma_f32_16x16x32_bf16 v[40:43], v[96:99], v[76:79], v[40:43]
    v_mfma_f32_16x16x32_bf16 v[44:47], v[100:103], v[76:79], v[44:47]
    v_mfma_f32_16x16x32_bf16 v[48:51], v[76:79], v[104:107], v[48:51]
    v_mfma_f32_16x16x32_bf16 v[52:55], v[76:79], v[108:111], v[52:55]
    s_waitcnt lgkmcnt(3)
    v_mfma_f32_16x16x32_bf16 v[32:35], v[112:115], v[56:59], v[32:35]
    ds_read_b128 v[72:75], v3 offset:34816
    v_mfma_f32_16x16x32_bf16 v[36:39], v[116:119], v[56:59], v[36:39]
    v_mfma_f32_16x16x32_bf16 v[40:43], v[120:123], v[56:59], v[40:43]
    v_mfma_f32_16x16x32_bf16 v[44:47], v[124:127], v[56:59], v[44:47]
    v_mfma_f32_16x16x32_bf16 v[48:51], v[56:59], v[128:131], v[48:51]
    v_mfma_f32_16x16x32_bf16 v[52:55], v[56:59], v[132:135], v[52:55]
    s_waitcnt lgkmcnt(3)
    v_mfma_f32_16x16x32_bf16 v[32:35], v[136:139], v[60:63], v[32:35]
    ds_read_b128 v[76:79], v3 offset:35840
    v_mfma_f32_16x16x32_bf16 v[36:39], v[140:143], v[60:63], v[36:39]
    v_mfma_f32_16x16x32_bf16 v[40:43], v[144:147], v[60:63], v[40:43]
    v_mfma_f32_16x16x32_bf16 v[44:47], v[148:151], v[60:63], v[44:47]
    v_mfma_f32_16x16x32_bf16 v[48:51], v[60:63], v[152:155], v[48:51]
    v_mfma_f32_16x16x32_bf16 v[52:55], v[60:63], v[156:159], v[52:55]
    s_waitcnt lgkmcnt(3)
    v_mfma_f32_16x16x32_bf16 v[32:35], v[160:163], v[64:67], v[32:35]
    v_mfma_f32_16x16x32_bf16 v[36:39], v[164:167], v[64:67], v[36:39]
    v_mfma_f32_16x16x32_bf16 v[40:43], v[168:171], v[64:67], v[40:43]
    v_mfma_f32_16x16x32_bf16 v[44:47], v[172:175], v[64:67], v[44:47]
    v_mfma_f32_16x16x32_bf16 v[48:51], v[64:67], v[176:179], v[48:51]
    v_mfma_f32_16x16x32_bf16 v[52:55], v[64:67], v[180:183], v[52:55]
    s_waitcnt lgkmcnt(2)
    v_mfma_f32_16x16x32_bf16 v[32:35], v[184:187], v[68:71], v[32:35]
    v_mfma_f32_16x16x32_bf16 v[36:39], v[188:191], v[68:71], v[36:39]
    v_mfma_f32_16x16x32_bf16 v[40:43], v[192:195], v[68:71], v[40:43]
    v_mfma_f32_16x16x32_bf16 v[44:47], v[196:199], v[68:71], v[44:47]
    v_mfma_f32_16x16x32_bf16 v[48:51], v[68:71], v[200:203], v[48:51]
    v_mfma_f32_16x16x32_bf16 v[52:55], v[68:71], v[204:207], v[52:55]
    s_waitcnt lgkmcnt(1)
    v_mfma_f32_16x16x32_bf16 v[32:35], v[208:211], v[72:75], v[32:35]
    v_mfma_f32_16x16x32_bf16 v[36:39], v[212:215], v[72:75], v[36:39]
    v_mfma_f32_16x16x32_bf16 v[40:43], v[216:219], v[72:75], v[40:43]
    v_mfma_f32_16x16x32_bf16 v[44:47], v[220:223], v[72:75], v[44:47]
    v_mfma_f32_16x16x32_bf16 v[48:51], v[72:75], v[224:227], v[48:51]
    v_mfma_f32_16x16x32_bf16 v[52:55], v[72:75], v[228:231], v[52:55]
    s_waitcnt lgkmcnt(0)
    v_mfma_f32_16x16x32_bf16 v[32:35], v[232:235], v[76:79], v[32:35]
    v_mfma_f32_16x16x32_bf16 v[36:39], v[236:239], v[76:79], v[36:39]
    v_mfma_f32_16x16x32_bf16 v[40:43], v[240:243], v[76:79], v[40:43]
    v_mfma_f32_16x16x32_bf16 v[44:47], v[244:247], v[76:79], v[44:47]
    v_mfma_f32_16x16x32_bf16 v[48:51], v[76:79], v[248:251], v[48:51]
    v_mfma_f32_16x16x32_bf16 v[52:55], v[76:79], v[252:255], v[52:55]
    v_xor_b32 v3, 65536, v3
    v_cvt_pk_bf16_f32 v32, v32, v33
    v_cvt_pk_bf16_f32 v33, v34, v35
    v_cvt_pk_bf16_f32 v34, v36, v37
    v_cvt_pk_bf16_f32 v35, v38, v39
    buffer_store_dwordx4 v[32:35], v0, s[4:7], s41 offen offset:1024 sc1
    v_pk_mul_f32 v[40:41], v[40:41], s[52:53]
    v_pk_mul_f32 v[42:43], v[42:43], s[52:53]
    v_pk_mul_f32 v[44:45], v[44:45], s[52:53]
    v_pk_mul_f32 v[46:47], v[46:47], s[52:53]
    v_cvt_pk_bf16_f32 v40, v40, v41
    v_cvt_pk_bf16_f32 v41, v42, v43
    v_cvt_pk_bf16_f32 v42, v44, v45
    v_cvt_pk_bf16_f32 v43, v46, v47
    buffer_store_dwordx4 v[40:43], v0, s[4:7], s49 offen offset:1024 sc1
    v_cvt_pk_bf16_f32 v26, v48, v49
    v_cvt_pk_bf16_f32 v27, v50, v51
    buffer_store_dwordx4 v[24:27], v0, s[4:7], s49 offen offset:2048 sc1
    v_cvt_pk_bf16_f32 v30, v52, v53
    v_cvt_pk_bf16_f32 v31, v54, v55
    buffer_store_dwordx4 v[28:31], v0, s[4:7], s49 offen offset:3072 sc1
    s_add_u32 s41, s41, 65536
    s_add_u32 s40, s40, 2
    s_waitcnt vmcnt(0)
    v_mov_b32 v7, s40
    s_mov_b64 exec, 1
    buffer_store_dword v7, off, s[4:7], s45 sc1
    s_mov_b64 exec, -1
    s_cmp_ge_u32 s40, 64
    s_cbranch_scc1 QKV_E
    s_branch QKV_S
QKV_V0:
    s_waitcnt lgkmcnt(3)
    v_mfma_f32_16x16x32_bf16 v[8:11], a[0:3], v[56:59], 0
    ds_read_b128 v[72:75], v3 offset:4096
    v_mfma_f32_16x16x32_bf16 v[12:15], a[4:7], v[56:59], 0
    s_add_u32 m0, s43, 0
    s_nop 0
    buffer_load_dwordx4 v0, s[4:7], s42 offen offset:0 sc1 lds
    v_mfma_f32_16x16x32_bf16 v[16:19], a[8:11], v[56:59], 0
    v_mfma_f32_16x16x32_bf16 v[20:23], a[12:15], v[56:59], 0
    v_mfma_f32_16x16x32_bf16 v[24:27], v[56:59], a[16:19], 0
    v_mfma_f32_16x16x32_bf16 v[28:31], v[56:59], a[20:23], 0
    s_waitcnt lgkmcnt(3)
    v_mfma_f32_16x16x32_bf16 v[8:11], a[24:27], v[60:63], v[8:11]
    ds_read_b128 v[76:79], v3 offset:5120
    v_mfma_f32_16x16x32_bf16 v[12:15], a[28:31], v[60:63], v[12:15]
    v_mfma_f32_16x16x32_bf16 v[16:19], a[32:35], v[60:63], v[16:19]
    v_mfma_f32_16x16x32_bf16 v[20:23], a[36:39], v[60:63], v[20:23]
    v_mfma_f32_16x16x32_bf16 v[24:27], v[60:63], a[40:43], v[24:27]
    v_mfma_f32_16x16x32_bf16 v[28:31], v[60:63], a[44:47], v[28:31]
    s_waitcnt lgkmcnt(3)
    v_mfma_f32_16x16x32_bf16 v[8:11], a[48:51], v[64:67], v[8:11]
    ds_read_b128 v[56:59], v3 offset:6144
    v_mfma_f32_16x16x32_bf16 v[12:15], a[52:55], v[64:67], v[12:15]
    v_mfma_f32_16x16x32_bf16 v[16:19], a[56:59], v[64:67], v[16:19]
    v_mfma_f32_16x16x32_bf16 v[20:23], a[60:63], v[64:67], v[20:23]
    v_mfma_f32_16x16x32_bf16 v[24:27], v[64:67], a[64:67], v[24:27]
    v_mfma_f32_16x16x32_bf16 v[28:31], v[64:67], a[68:71], v[28:31]
    s_waitcnt lgkmcnt(3)
    v_mfma_f32_16x16x32_bf16 v[8:11], a[72:75], v[68:71], v[8:11]
    ds_read_b128 v[60:63], v3 offset:7168
    v_mfma_f32_16x16x32_bf16 v[12:15], a[76:79], v[68:71], v[12:15]
    buffer_load_dwordx4 v0, s[4:7], s42 offen offset:1024 sc1 lds
    v_mfma_f32_16x16x32_bf16 v[16:19], a[80:83], v[68:71], v[16:19]
    v_mfma_f32_16x16x32_bf16 v[20:23], a[84:87], v[68:71], v[20:23]
    v_mfma_f32_16x16x32_bf16 v[24:27], v[68:71], a[88:91], v[24:27]
    v_mfma_f32_16x16x32_bf16 v[28:31], v[68:71], a[92:95], v[28:31]
    s_waitcnt lgkmcnt(3)
    v_mfma_f32_16x16x32_bf16 v[8:11], a[96:99], v[72:75], v[8:11]
    ds_read_b128 v[64:67], v3 offset:8192
    v_mfma_f32_16x16x32_bf16 v[12:15], a[100:103], v[72:75], v[12:15]
    v_mfma_f32_16x16x32_bf16 v[16:19], a[104:107], v[72:75], v[16:19]
    v_mfma_f32_16x16x32_bf16 v[20:23], a[108:111], v[72:75], v[20:23]
    v_mfma_f32_16x16x32_bf16 v[24:27], v[72:75], a[112:115], v[24:27]
    v_mfma_f32_16x16x32_bf16 v[28:31], v[72:75], a[116:119], v[28:31]
    s_waitcnt lgkmcnt(3)
    v_mfma_f32_16x16x32_bf16 v[8:11], a[120:123], v[76:79], v[8:11]
    ds_read_b128 v[68:71], v3 offset:9216
    v_mfma_f32_16x16x32_bf16 v[12:15], a[124:127], v[76:79], v[12:15]
    v_mfma_f32_16x16x32_bf16 v[16:19], a[128:131], v[76:79], v[16:19]
    v_mfma_f32_16x16x32_bf16 v[20:23], a[132:135], v[76:79], v[20:23]
    v_mfma_f32_16x16x32_bf16 v[24:27], v[76:79], a[136:139], v[24:27]
    v_mfma_f32_16x16x32_bf16 v[28:31], v[76:79], a[140:143], v[28:31]
    s_waitcnt lgkmcnt(3)
    v_mfma_f32_16x16x32_bf16 v[8:11], a[144:147], v[56:59], v[8:11]
    ds_read_b128 v[72:75], v3 offset:10240
    v_mfma_f32_16x16x32_bf16 v[12:15], a[148:151], v[56:59], v[12:15]
    buffer_load_dwordx4 v0, s[4:7], s42 offen offset:2048 sc1 lds
    v_mfma_f32_16x16x32_bf16 v[16:19], a[152:155], v[56:59], v[16:19]
    v_mfma_f32_16x16x32_bf16 v[20:23], a[156:159], v[56:59], v[20:23]
    v_mfma_f32_16x16x32_bf16 v[24:27], v[56:59], a[160:163], v[24:27]
    v_mfma_f32_16x16x32_bf16 v[28:31], v[56:59], a[164:167], v[28:31]
    s_waitcnt lgkmcnt(3)
    v_mfma_f32_16x16x32_bf16 v[8:11], a[168:171], v[60:63], v[8:11]
    ds_read_b128 v[76:79], v3 offset:11264
    v_mfma_f32_16x16x32_bf16 v[12:15], a[172:175], v[60:63], v[12:15]
    s_cmp_eq_u32 s46, 0
    s_cbranch_scc1 NP_29
    s_waitcnt vmcnt(3)
    v_mov_b32 v7, s40
    s_mov_b64 exec, 1
    buffer_store_dword v7, off, s[4:7], s45 sc1
    s_mov_b64 exec, -1
    s_mov_b32 s46, 0
NP_29:
    v_mfma_f32_16x16x32_bf16 v[16:19], a[176:179], v[60:63], v[16:19]
    v_mfma_f32_16x16x32_bf16 v[20:23], a[180:183], v[60:63], v[20:23]
    v_mfma_f32_16x16x32_bf16 v[24:27], v[60:63], a[184:187], v[24:27]
    v_mfma_f32_16x16x32_bf16 v[28:31], v[60:63], a[188:191], v[28:31]
    s_waitcnt lgkmcnt(3)
    v_mfma_f32_16x16x32_bf16 v[8:11], a[192:195], v[64:67], v[8:11]
    ds_read_b128 v[56:59], v3 offset:12288
    v_mfma_f32_16x16x32_bf16 v[12:15], a[196:199], v[64:67], v[12:15]
    v_mfma_f32_16x16x32_bf16 v[16:19], a[200:203], v[64:67], v[16:19]
    v_mfma_f32_16x16x32_bf16 v[20:23], a[204:207], v[64:67], v[20:23]
    v_mfma_f32_16x16x32_bf16 v[24:27], v[64:67], a[208:211], v[24:27]
    v_mfma_f32_16x16x32_bf16 v[28:31], v[64:67], a[212:215], v[28:31]
    s_waitcnt lgkmcnt(3)
    v_mfma_f32_16x16x32_bf16 v[8:11], a[216:219], v[68:71], v[8:11]
    ds_read_b128 v[60:63], v3 offset:13312
    v_mfma_f32_16x16x32_bf16 v[12:15], a[220:223], v[68:71], v[12:15]
    buffer_load_dwordx4 v0, s[4:7], s42 offen offset:3072 sc1 lds
    v_mfma_f32_16x16x32_bf16 v[16:19], a[224:227], v[68:71], v[16:19]
    v_mfma_f32_16x16x32_bf16 v[20:23], a[228:231], v[68:71], v[20:23]
    v_mfma_f32_16x16x32_bf16 v[24:27], v[68:71], a[232:235], v[24:27]
    v_mfma_f32_16x16x32_bf16 v[28:31], v[68:71], a[236:239], v[28:31]
    s_waitcnt lgkmcnt(3)
    v_mfma_f32_16x16x32_bf16 v[8:11], a[240:243], v[72:75], v[8:11]
    ds_read_b128 v[64:67], v3 offset:14336
    v_mfma_f32_16x16x32_bf16 v[12:15], a[244:247], v[72:75], v[12:15]
    v_mfma_f32_16x16x32_bf16 v[16:19], a[248:251], v[72:75], v[16:19]
    v_mfma_f32_16x16x32_bf16 v[20:23], a[252:255], v[72:75], v[20:23]
    v_mfma_f32_16x16x32_bf16 v[24:27], v[72:75], v[80:83], v[24:27]
    v_mfma_f32_16x16x32_bf16 v[28:31], v[72:75], v[84:87], v[28:31]
    s_waitcnt lgkmcnt(3)
    v_mfma_f32_16x16x32_bf16 v[8:11], v[88:91], v[76:79], v[8:11]
    ds_read_b128 v[68:71], v3 offset:15360
    v_mfma_f32_16x16x32_bf16 v[12:15], v[92:95], v[76:79], v[12:15]
    v_mfma_f32_16x16x32_bf16 v[16:19], v[96:99], v[76:79], v[16:19]
    v_mfma_f32_16x16x32_bf16 v[20:23], v[100:103], v[76:79], v[20:23]
    v_mfma_f32_16x16x32_bf16 v[24:27], v[76:79], v[104:107], v[24:27]
    v_mfma_f32_16x16x32_bf16 v[28:31], v[76:79], v[108:111], v[28:31]
    s_waitcnt lgkmcnt(3)
    v_mfma_f32_16x16x32_bf16 v[8:11], v[112:115], v[56:59], v[8:11]
    ds_read_b128 v[72:75], v3 offset:16384
    v_mfma_f32_16x16x32_bf16 v[12:15], v[116:119], v[56:59], v[12:15]
    s_add_u32 m0, s43, 4096
    s_add_u32 s47, s42, 4096
    buffer_load_dwordx4 v0, s[4:7], s47 offen offset:0 sc1 lds
    v_mfma_f32_16x16x32_bf16 v[16:19], v[120:123], v[56:59], v[16:19]
    v_mfma_f32_16x16x32_bf16 v[20:23], v[124:127], v[56:59], v[20:23]
    v_mfma_f32_16x16x32_bf16 v[24:27], v[56:59], v[128:131], v[24:27]
    v_mfma_f32_16x16x32_bf16 v[28:31], v[56:59], v[132:135], v[28:31]
    s_waitcnt lgkmcnt(3)
    v_mfma_f32_16x16x32_bf16 v[8:11], v[136:139], v[60:63], v[8:11]
    ds_read_b128 v[76:79], v3 offset:17408
    v_mfma_f32_16x16x32_bf16 v[12:15], v[140:143], v[60:63], v[12:15]
    v_mfma_f32_16x16x32_bf16 v[16:19], v[144:147], v[60:63], v[16:19]
    v_mfma_f32_16x16x32_bf16 v[20:23], v[148:151], v[60:63], v[20:23]
    v_mfma_f32_16x16x32_bf16 v[24:27], v[60:63], v[152:155], v[24:27]
    v_mfma_f32_16x16x32_bf16 v[28:31], v[60:63], v[156:159], v[28:31]
    s_waitcnt lgkmcnt(3)
    v_mfma_f32_16x16x32_bf16 v[8:11], v[160:163], v[64:67], v[8:11]
    ds_read_b128 v[56:59], v3 offset:18432
    v_mfma_f32_16x16x32_bf16 v[12:15], v[164:167], v[64:67], v[12:15]
    v_mfma_f32_16x16x32_bf16 v[16:19], v[168:171], v[64:67], v[16:19]
    v_mfma_f32_16x16x32_bf16 v[20:23], v[172:175], v[64:67], v[20:23]
    v_mfma_f32_16x16x32_bf16 v[24:27], v[64:67], v[176:179], v[24:27]
    v_mfma_f32_16x16x32_bf16 v[28:31], v[64:67], v[180:183], v[28:31]
    s_waitcnt lgkmcnt(3)
    v_mfma_f32_16x16x32_bf16 v[8:11], v[184:187], v[68:71], v[8:11]
    ds_read_b128 v[60:63], v3 offset:19456
    v_mfma_f32_16x16x32_bf16 v[12:15], v[188:191], v[68:71], v[12:15]
    buffer_load_dwordx4 v0, s[4:7], s47 offen offset:1024 sc1 lds
    v_mfma_f32_16x16x32_bf16 v[16:19], v[192:195], v[68:71], v[16:19]
    v_mfma_f32_16x16x32_bf16 v[20:23], v[196:199], v[68:71], v[20:23]
    v_mfma_f32_16x16x32_bf16 v[24:27], v[68:71], v[200:203], v[24:27]
    v_mfma_f32_16x16x32_bf16 v[28:31], v[68:71], v[204:207], v[28:31]
    s_waitcnt lgkmcnt(3)
    v_mfma_f32_16x16x32_bf16 v[8:11], v[208:211], v[72:75], v[8:11]
    ds_read_b128 v[64:67], v3 offset:20480
    v_mfma_f32_16x16x32_bf16 v[12:15], v[212:215], v[72:75], v[12:15]
    v_mfma_f32_16x16x32_bf16 v[16:19], v[216:219], v[72:75], v[16:19]
    v_mfma_f32_16x16x32_bf16 v[20:23], v[220:223], v[72:75], v[20:23]
    v_mfma_f32_16x16x32_bf16 v[24:27], v[72:75], v[224:227], v[24:27]
    v_mfma_f32_16x16x32_bf16 v[28:31], v[72:75], v[228:231], v[28:31]
    s_waitcnt lgkmcnt(3)
    v_mfma_f32_16x16x32_bf16 v[8:11], v[232:235], v[76:79], v[8:11]
    ds_read_b128 v[68:71], v3 offset:21504
    v_mfma_f32_16x16x32_bf16 v[12:15], v[236:239], v[76:79], v[12:15]
    v_mfma_f32_16x16x32_bf16 v[16:19], v[240:243], v[76:79], v[16:19]
    v_mfma_f32_16x16x32_bf16 v[20:23], v[244:247], v[76:79], v[20:23]
    v_mfma_f32_16x16x32_bf16 v[24:27], v[76:79], v[248:251], v[24:27]
    v_mfma_f32_16x16x32_bf16 v[28:31], v[76:79], v[252:255], v[28:31]
    s_waitcnt lgkmcnt(3)
    v_mfma_f32_16x16x32_bf16 v[32:35], a[0:3], v[56:59], 0
    ds_read_b128 v[72:75], v3 offset:22528
    v_mfma_f32_16x16x32_bf16 v[36:39], a[4:7], v[56:59], 0
    buffer_load_dwordx4 v0, s[4:7], s47 offen offset:2048 sc1 lds
    v_mfma_f32_16x16x32_bf16 v[40:43], a[8:11], v[56:59], 0
    v_mfma_f32_16x16x32_bf16 v[44:47], a[12:15], v[56:59], 0
    v_mfma_f32_16x16x32_bf16 v[48:51], v[56:59], a[16:19], 0
    v_mfma_f32_16x16x32_bf16 v[52:55], v[56:59], a[20:23], 0
    s_waitcnt lgkmcnt(3)
    v_mfma_f32_16x16x32_bf16 v[32:35], a[24:27], v[60:63], v[32:35]
    ds_read_b128 v[76:79], v3 offset:23552
    v_mfma_f32_16x16x32_bf16 v[36:39], a[28:31], v[60:63], v[36:39]
    v_cvt_pk_bf16_f32 v8, v8, v9
    v_cvt_pk_bf16_f32 v9, v10, v11
    v_mfma_f32_16x16x32_bf16 v[40:43], a[32:35], v[60:63], v[40:43]
    v_cvt_pk_bf16_f32 v10, v12, v13
    v_cvt_pk_bf16_f32 v11, v14, v15
    v_mfma_f32_16x16x32_bf16 v[44:47], a[36:39], v[60:63], v[44:47]
    buffer_store_dwordx4 v[8:11], v0, s[4:7], s41 offen offset:0 sc1
    v_mfma_f32_16x16x32_bf16 v[48:51], v[60:63], a[40:43], v[48:51]
    s_add_u32 s49, s41, s50
    v_mfma_f32_16x16x32_bf16 v[52:55], v[60:63], a[44:47], v[52:55]
    s_waitcnt lgkmcnt(3)
    v_mfma_f32_16x16x32_bf16 v[32:35], a[48:51], v[64:67], v[32:35]
    ds_read_b128 v[56:59], v3 offset:24576
    v_mfma_f32_16x16x32_bf16 v[36:39], a[52:55], v[64:67], v[36:39]
    v_pk_mul_f32 v[16:17], v[16:17], s[52:53]
    v_pk_mul_f32 v[18:19], v[18:19], s[52:53]
    v_mfma_f32_16x16x32_bf16 v[40:43], a[56:59], v[64:67], v[40:43]
    v_pk_mul_f32 v[20:21], v[20:21], s[52:53]
    v_pk_mul_f32 v[22:23], v[22:23], s[52:53]
    v_mfma_f32_16x16x32_bf16 v[44:47], a[60:63], v[64:67], v[44:47]
    v_mfma_f32_16x16x32_bf16 v[48:51], v[64:67], a[64:67], v[48:51]
    v_mfma_f32_16x16x32_bf16 v[52:55], v[64:67], a[68:71], v[52:55]
    s_waitcnt lgkmcnt(3)
    v_mfma_f32_16x16x32_bf16 v[32:35], a[72:75], v[68:71], v[32:35]
    ds_read_b128 v[60:63], v3 offset:25600
    v_mfma_f32_16x16x32_bf16 v[36:39], a[76:79], v[68:71], v[36:39]
    buffer_load_dwordx4 v0, s[4:7], s47 offen offset:3072 sc1 lds
    v_mfma_f32_16x16x32_bf16 v[40:43], a[80:83], v[68:71], v[40:43]
    v_cvt_pk_bf16_f32 v16, v16, v17
    v_cvt_pk_bf16_f32 v17, v18, v19
    v_mfma_f32_16x16x32_bf16 v[44:47], a[84:87], v[68:71], v[44:47]
    v_cvt_pk_bf16_f32 v18, v20, v21
    v_cvt_pk_bf16_f32 v19, v22, v23
    v_mfma_f32_16x16x32_bf16 v[48:51], v[68:71], a[88:91], v[48:51]
    buffer_store_dwordx4 v[16:19], v0, s[4:7], s49 offen offset:0 sc1
    v_mfma_f32_16x16x32_bf16 v[52:55], v[68:71], a[92:95], v[52:55]
    s_waitcnt lgkmcnt(3)
    v_mfma_f32_16x16x32_bf16 v[32:35], a[96:99], v[72:75], v[32:35]
    ds_read_b128 v[64:67], v3 offset:26624
    v_mfma_f32_16x16x32_bf16 v[36:39], a[100:103], v[72:75], v[36:39]
    v_cvt_pk_bf16_f32 v24, v24, v25
    v_cvt_pk_bf16_f32 v25, v26, v27
    v_mfma_f32_16x16x32_bf16 v[40:43], a[104:107], v[72:75], v[40:43]
    v_cvt_pk_bf16_f32 v28, v28, v29
    v_cvt_pk_bf16_f32 v29, v30, v31
    v_mfma_f32_16x16x32_bf16 v[44:47], a[108:111], v[72:75], v[44:47]
    v_mfma_f32_16x16x32_bf16 v[48:51], v[72:75], a[112:115], v[48:51]
    v_mfma_f32_16x16x32_bf16 v[52:55], v[72:75], a[116:119], v[52:55]
    s_waitcnt lgkmcnt(3)
    v_mfma_f32_16x16x32_bf16 v[32:35], a[120:123], v[76:79], v[32:35]
    ds_read_b128 v[68:71], v3 offset:27648
    v_mfma_f32_16x16x32_bf16 v[36:39], a[124:127], v[76:79], v[36:39]
    v_mfma_f32_16x16x32_bf16 v[40:43], a[128:131], v[76:79], v[40:43]
    v_mfma_f32_16x16x32_bf16 v[44:47], a[132:135], v[76:79], v[44:47]
    v_mfma_f32_16x16x32_bf16 v[48:51], v[76:79], a[136:139], v[48:51]
    v_mfma_f32_16x16x32_bf16 v[52:55], v[76:79], a[140:143], v[52:55]
    s_waitcnt lgkmcnt(3)
    v_mfma_f32_16x16x32_bf16 v[32:35], a[144:147], v[56:59], v[32:35]
    ds_read_b128 v[72:75], v3 offset:28672
    v_mfma_f32_16x16x32_bf16 v[36:39], a[148:151], v[56:59], v[36:39]
    s_add_u32 m0, s43, 8192
    s_add_u32 s47, s42, 8192
    buffer_load_dwordx4 v0, s[4:7], s47 offen offset:0 sc1 lds
    s_add_u32 s42, s42, 73728
    s_xor_b32 s43, s43, 65536
    v_mfma_f32_16x16x32_bf16 v[40:43], a[152:155], v[56:59], v[40:43]
    v_mfma_f32_16x16x32_bf16 v[44:47], a[156:159], v[56:59], v[44:47]
    v_mfma_f32_16x16x32_bf16 v[48:51], v[56:59], a[160:163], v[48:51]
    v_mfma_f32_16x16x32_bf16 v[52:55], v[56:59], a[164:167], v[52:55]
    s_waitcnt lgkmcnt(3)
    v_mfma_f32_16x16x32_bf16 v[32:35], a[168:171], v[60:63], v[32:35]
    ds_read_b128 v[76:79], v3 offset:29696
    v_mfma_f32_16x16x32_bf16 v[36:39], a[172:175], v[60:63], v[36:39]
    v_mfma_f32_16x16x32_bf16 v[40:43], a[176:179], v[60:63], v[40:43]
    v_mfma_f32_16x16x32_bf16 v[44:47], a[180:183], v[60:63], v[44:47]
    v_mfma_f32_16x16x32_bf16 v[48:51], v[60:63], a[184:187], v[48:51]
    v_mfma_f32_16x16x32_bf16 v[52:55], v[60:63], a[188:191], v[52:55]
    s_waitcnt lgkmcnt(3)
    v_mfma_f32_16x16x32_bf16 v[32:35], a[192:195], v[64:67], v[32:35]
    ds_read_b128 v[56:59], v3 offset:30720
    v_mfma_f32_16x16x32_bf16 v[36:39], a[196:199], v[64:67], v[36:39]
    v_mfma_f32_16x16x32_bf16 v[40:43], a[200:203], v[64:67], v[40:43]
    v_mfma_f32_16x16x32_bf16 v[44:47], a[204:207], v[64:67], v[44:47]
    v_mfma_f32_16x16x32_bf16 v[48:51], v[64:67], a[208:211], v[48:51]
    v_mfma_f32_16x16x32_bf16 v[52:55], v[64:67], a[212:215], v[52:55]
    s_waitcnt lgkmcnt(3)
    v_mfma_f32_16x16x32_bf16 v[32:35], a[216:219], v[68:71], v[32:35]
    ds_read_b128 v[60:63], v3 offset:31744
    v_mfma_f32_16x16x32_bf16 v[36:39], a[220:223], v[68:71], v[36:39]
    v_mfma_f32_16x16x32_bf16 v[40:43], a[224:227], v[68:71], v[40:43]
    v_mfma_f32_16x16x32_bf16 v[44:47], a[228:231], v[68:71], v[44:47]
    v_mfma_f32_16x16x32_bf16 v[48:51], v[68:71], a[232:235], v[48:51]
    v_mfma_f32_16x16x32_bf16 v[52:55], v[68:71], a[236:239], v[52:55]
    s_waitcnt lgkmcnt(3)
    v_mfma_f32_16x16x32_bf16 v[32:35], a[240:243], v[72:75], v[32:35]
    ds_read_b128 v[64:67], v3 offset:32768
    v_mfma_f32_16x16x32_bf16 v[36:39], a[244:247], v[72:75], v[36:39]
    v_mfma_f32_16x16x32_bf16 v[40:43], a[248:251], v[72:75], v[40:43]
    v_mfma_f32_16x16x32_bf16 v[44:47], a[252:255], v[72:75], v[44:47]
    v_mfma_f32_16x16x32_bf16 v[48:51], v[72:75], v[80:83], v[48:51]
    v_mfma_f32_16x16x32_bf16 v[52:55], v[72:75], v[84:87], v[52:55]
    s_waitcnt lgkmcnt(3)
    v_mfma_f32_16x16x32_bf16 v[32:35], v[88:91], v[76:79], v[32:35]
    ds_read_b128 v[68:71], v3 offset:33792
    v_mfma_f32_16x16x32_bf16 v[36:39], v[92:95], v[76:79], v[36:39]
    v_mfma_f32_16x16x32_bf16 v[40:43], v[96:99], v[76:79], v[40:43]
    v_mfma_f32_16x16x32_bf16 v[44:47], v[100:103], v[76:79], v[44:47]
    v_mfma_f32_16x16x32_bf16 v[48:51], v[76:79], v[104:107], v[48:51]
    v_mfma_f32_16x16x32_bf16 v[52:55], v[76:79], v[108:111], v[52:55]
    s_waitcnt lgkmcnt(3)
    v_mfma_f32_16x16x32_bf16 v[32:35], v[112:115], v[56:59], v[32:35]
    ds_read_b128 v[72:75], v3 offset:34816
    v_mfma_f32_16x16x32_bf16 v[36:39], v[116:119], v[56:59], v[36:39]
    v_mfma_f32_16x16x32_bf16 v[40:43], v[120:123], v[56:59], v[40:43]
    v_mfma_f32_16x16x32_bf16 v[44:47], v[124:127], v[56:59], v[44:47]
    v_mfma_f32_16x16x32_bf16 v[48:51], v[56:59], v[128:131], v[48:51]
    v_mfma_f32_16x16x32_bf16 v[52:55], v[56:59], v[132:135], v[52:55]
    s_waitcnt lgkmcnt(3)
    v_mfma_f32_16x16x32_bf16 v[32:35], v[136:139], v[60:63], v[32:35]
    ds_read_b128 v[76:79], v3 offset:35840
    v_mfma_f32_16x16x32_bf16 v[36:39], v[140:143], v[60:63], v[36:39]
    v_mfma_f32_16x16x32_bf16 v[40:43], v[144:147], v[60:63], v[40:43]
    v_mfma_f32_16x16x32_bf16 v[44:47], v[148:151], v[60:63], v[44:47]
    v_mfma_f32_16x16x32_bf16 v[48:51], v[60:63], v[152:155], v[48:51]
    v_mfma_f32_16x16x32_bf16 v[52:55], v[60:63], v[156:159], v[52:55]
    s_waitcnt lgkmcnt(3)
    v_mfma_f32_16x16x32_bf16 v[32:35], v[160:163], v[64:67], v[32:35]
    v_mfma_f32_16x16x32_bf16 v[36:39], v[164:167], v[64:67], v[36:39]
    v_mfma_f32_16x16x32_bf16 v[40:43], v[168:171], v[64:67], v[40:43]
    v_mfma_f32_16x16x32_bf16 v[44:47], v[172:175], v[64:67], v[44:47]
    v_mfma_f32_16x16x32_bf16 v[48:51], v[64:67], v[176:179], v[48:51]
    v_mfma_f32_16x16x32_bf16 v[52:55], v[64:67], v[180:183], v[52:55]
    s_waitcnt lgkmcnt(2)
    v_mfma_f32_16x16x32_bf16 v[32:35], v[184:187], v[68:71], v[32:35]
    v_mfma_f32_16x16x32_bf16 v[36:39], v[188:191], v[68:71], v[36:39]
    v_mfma_f32_16x16x32_bf16 v[40:43], v[192:195], v[68:71], v[40:43]
    v_mfma_f32_16x16x32_bf16 v[44:47], v[196:199], v[68:71], v[44:47]
    v_mfma_f32_16x16x32_bf16 v[48:51], v[68:71], v[200:203], v[48:51]
    v_mfma_f32_16x16x32_bf16 v[52:55], v[68:71], v[204:207], v[52:55]
    s_waitcnt lgkmcnt(1)
    v_mfma_f32_16x16x32_bf16 v[32:35], v[208:211], v[72:75], v[32:35]
    v_mfma_f32_16x16x32_bf16 v[36:39], v[212:215], v[72:75], v[36:39]
    v_mfma_f32_16x16x32_bf16 v[40:43], v[216:219], v[72:75], v[40:43]
    v_mfma_f32_16x16x32_bf16 v[44:47], v[220:223], v[72:75], v[44:47]
    v_mfma_f32_16x16x32_bf16 v[48:51], v[72:75], v[224:227], v[48:51]
    v_mfma_f32_16x16x32_bf16 v[52:55], v[72:75], v[228:231], v[52:55]
    s_waitcnt lgkmcnt(0)
    v_mfma_f32_16x16x32_bf16 v[32:35], v[232:235], v[76:79], v[32:35]
    v_mfma_f32_16x16x32_bf16 v[36:39], v[236:239], v[76:79], v[36:39]
    v_mfma_f32_16x16x32_bf16 v[40:43], v[240:243], v[76:79], v[40:43]
    v_mfma_f32_16x16x32_bf16 v[44:47], v[244:247], v[76:79], v[44:47]
    v_mfma_f32_16x16x32_bf16 v[48:51], v[76:79], v[248:251], v[48:51]
    v_mfma_f32_16x16x32_bf16 v[52:55], v[76:79], v[252:255], v[52:55]
    v_xor_b32 v3, 65536, v3
    v_cvt_pk_bf16_f32 v32, v32, v33
    v_cvt_pk_bf16_f32 v33, v34, v35
    v_cvt_pk_bf16_f32 v34, v36, v37
    v_cvt_pk_bf16_f32 v35, v38, v39
    buffer_store_dwordx4 v[32:35], v0, s[4:7], s41 offen offset:1024 sc1
    v_pk_mul_f32 v[40:41], v[40:41], s[52:53]
    v_pk_mul_f32 v[42:43], v[42:43], s[52:53]
    v_pk_mul_f32 v[44:45], v[44:45], s[52:53]
    v_pk_mul_f32 v[46:47], v[46:47], s[52:53]
    v_cvt_pk_bf16_f32 v40, v40, v41
    v_cvt_pk_bf16_f32 v41, v42, v43
    v_cvt_pk_bf16_f32 v42, v44, v45
    v_cvt_pk_bf16_f32 v43, v46, v47
    buffer_store_dwordx4 v[40:43], v0, s[4:7], s49 offen offset:1024 sc1
    v_cvt_pk_bf16_f32 v26, v48, v49
    v_cvt_pk_bf16_f32 v27, v50, v51
    buffer_store_dwordx4 v[24:27], v0, s[4:7], s49 offen offset:2048 sc1
    v_cvt_pk_bf16_f32 v30, v52, v53
    v_cvt_pk_bf16_f32 v31, v54, v55
    buffer_store_dwordx4 v[28:31], v0, s[4:7], s49 offen offset:3072 sc1
    s_add_u32 s41, s41, 65536
    s_add_u32 s40, s40, 2
    s_waitcnt vmcnt(4)
    s_mov_b32 s46, 1
    s_branch QKV_L
QKV_E:
    s_mov_b32 s20, s86
    s_mov_b32 s21, s87
    s_mov_b32 s22, 0x240000
    s_mov_b32 s23, 0x20000
    v_and_b32 v7, 15, v1
    v_lshrrev_b32 v6, 4, v1
    v_lshlrev_b32 v6, 2, v6
    v_sub_u32 v7, v7, v6
    v_mov_b32 v5, 0x3f80
    v_mov_b32 v6, 0x3f800000
    v_mov_b32 v10, 0
    v_cmp_eq_u32 vcc, 0, v7
    s_nop 1
    v_cndmask_b32 v10, v10, v5, vcc
    v_cmp_eq_u32 vcc, 1, v7
    s_nop 1
    v_cndmask_b32 v10, v10, v6, vcc
    v_mov_b32 v11, 0
    v_cmp_eq_u32 vcc, 2, v7
    s_nop 1
    v_cndmask_b32 v11, v11, v5, vcc
    v_cmp_eq_u32 vcc, 3, v7
    s_nop 1
    v_cndmask_b32 v11, v11, v6, vcc
    v_and_b32 v7, 7, v1
    v_bfe_u32 v6, v1, 3, 1
    v_lshrrev_b32 v5, 4, v1
    v_mul_u32_u24 v3, 1152, v7
    v_lshl_add_u32 v3, v6, 6, v3
    v_lshl_add_u32 v3, v5, 4, v3
    v_lshl_add_u32 v7, v5, 4, v7
    v_lshlrev_b32 v6, 10, v6
    v_lshl_add_u32 v0, v7, 4, v6
    v_lshl_add_u32 v4, v7, 3, v6
    v_add_u32 v36, 4096, v4
    v_min_u32 v4, 15, v1
    v_lshlrev_b32 v4, 7, v4
FIN_L:
    s_mul_i32 s40, s35, 43691
    s_lshr_b32 s40, s40, 19
    s_mul_i32 s36, s40, 12
    s_sub_u32 s36, s35, s36
    s_and_b32 s37, s36, 3
    s_lshr_b32 s36, s36, 2
    s_lshr_b32 s38, s37, 1
    s_and_b32 s39, s37, 1
    s_mul_i32 s33, s36, 6144
    s_lshl_b32 s34, s39, 7
    s_add_u32 s34, s34, s33
    v_add_u32 v8, s34, v0
    s_lshl_b32 s34, s39, 6
    s_add_u32 s34, s34, s33
    v_add_u32 v9, s34, v36
    s_lshl_b32 s34, s38, 2
    s_add_u32 s34, s34, s36
    s_lshl_b32 s34, s34, 11
    s_add_u32 s34, s34, 516096
    s_lshl_b32 s41, s40, 1
    s_add_u32 s41, s41, s38
    s_mul_i32 s43, s41, 18432
    s_add_u32 s43, s43, 0x800000
    s_add_u32 s46, s43, 4096
    s_mul_i32 s44, s41, 73728
    s_add_u32 s44, s44, 0x9000000
    s_add_u32 s48, s40, 1
    s_sub_u32 s33, s40, 1
    s_cmp_lt_u32 s40, 63
    s_cselect_b32 s48, s48, s33
    s_mov_b32 s27, 0
SP_30:
    buffer_load_dword v5, v4, s[4:7], s34 offen sc1
    s_waitcnt vmcnt(0)
    v_cmp_gt_u32 vcc, s48, v5
    s_cbranch_vccz SD_31
    s_cmp_gt_u32 s48, 62
    s_cbranch_scc1 SP_30_n
    s_sleep 8
SP_30_n:
    s_add_u32 s27, s27, 1
    s_cmp_lt_u32 s27, 400000
    s_cbranch_scc1 SP_30
    s_movk_i32 s27, 22
    s_branch FAIL
SD_31:
    s_mov_b32 s48, 0
    s_cmp_lt_u32 s40, 63
    s_cbranch_scc1 FIN_H
    s_and_b32 s48, s40, 1
    s_lshl_b32 s48, s48, 1
    s_add_u32 s48, s48, s39
    s_mul_i32 s48, s48, 3
    s_add_u32 s48, s48, s36
    s_lshl_b32 s33, s38, 5
    s_add_u32 s48, s48, s33
    s_add_u32 s48, s48, 3648
    s_lshl_b32 s48, s48, 7
    v_mov_b32 v6, 0
    s_add_u32 s33, s40, 1
    s_mov_b32 s27, 0
SP_32:
    buffer_load_dword v5, v6, s[4:7], s48 offen sc1
    s_waitcnt vmcnt(0)
    v_cmp_gt_u32 vcc, s33, v5
    s_cbranch_vccz SD_33
    s_add_u32 s27, s27, 1
    s_cmp_lt_u32 s27, 400000
    s_cbranch_scc1 SP_32
    s_movk_i32 s27, 24
    s_branch FAIL
SD_33:
FIN_H:
    buffer_load_dwordx4 v[40:43], v8, s[4:7], s43 offen offset:0 sc1
    buffer_load_dwordx4 v[44:47], v8, s[4:7], s43 offen offset:2048 sc1
    buffer_load_dwordx4 v[48:51], v8, s[4:7], s46 offen offset:0 sc1
FIN_R:
    buffer_load_dwordx4 v[52:55], v8, s[4:7], s44 offen offset:0 sc1
    buffer_load_dwordx4 v[56:59], v8, s[4:7], s44 offen offset:2048 sc1
    buffer_load_dwordx2 v[60:61], v9, s[4:7], s44 offen offset:0 sc1
    buffer_load_dwordx2 v[62:63], v9, s[4:7], s44 offen offset:512 sc1
    s_add_u32 s44, s44, 18432
    buffer_load_dwordx4 v[64:67], v8, s[4:7], s44 offen offset:0 sc1
    buffer_load_dwordx4 v[68:71], v8, s[4:7], s44 offen offset:2048 sc1
    buffer_load_dwordx2 v[72:73], v9, s[4:7], s44 offen offset:0 sc1
    buffer_load_dwordx2 v[74:75], v9, s[4:7], s44 offen offset:512 sc1
    s_add_u32 s44, s44, 18432
    buffer_load_dwordx4 v[76:79], v8, s[4:7], s44 offen offset:0 sc1
    buffer_load_dwordx4 v[80:83], v8, s[4:7], s44 offen offset:2048 sc1
    buffer_load_dwordx2 v[84:85], v9, s[4:7], s44 offen offset:0 sc1
    buffer_load_dwordx2 v[86:87], v9, s[4:7], s44 offen offset:512 sc1
    s_add_u32 s44, s44, 18432
    buffer_load_dwordx4 v[88:91], v8, s[4:7], s44 offen offset:0 sc1
    buffer_load_dwordx4 v[92:95], v8, s[4:7], s44 offen offset:2048 sc1
    buffer_load_dwordx2 v[96:97], v9, s[4:7], s44 offen offset:0 sc1
    buffer_load_dwordx2 v[98:99], v9, s[4:7], s44 offen offset:512 sc1
    buffer_load_dword v5, v4, s[4:7], s34 offen sc1
    s_lshl_b32 s41, s40, 2
    s_add_u32 s41, s41, s37
    s_mul_i32 s41, s41, 9216
    s_mul_i32 s33, s36, 384
    s_add_u32 s41, s41, s33
    s_waitcnt vmcnt(19)
    v_mfma_f32_16x16x16_bf16 v[12:15], v[10:11], v[40:41], 0
    v_mfma_f32_16x16x16_bf16 v[16:19], v[10:11], v[42:43], 0
    s_waitcnt vmcnt(18)
    v_mfma_f32_16x16x16_bf16 v[20:23], v[10:11], v[44:45], 0
    v_mfma_f32_16x16x16_bf16 v[24:27], v[10:11], v[46:47], 0
    s_waitcnt vmcnt(17)
    v_mfma_f32_16x16x16_bf16 v[28:31], v[10:11], v[48:49], 0
    v_mfma_f32_16x16x16_bf16 v[32:35], v[10:11], v[50:51], 0
    s_waitcnt vmcnt(16)
    v_mfma_f32_16x16x16_bf16 v[12:15], v[10:11], v[52:53], v[12:15]
    v_mfma_f32_16x16x16_bf16 v[16:19], v[10:11], v[54:55], v[16:19]
    s_waitcnt vmcnt(15)
    v_mfma_f32_16x16x16_bf16 v[20:23], v[10:11], v[56:57], v[20:23]
    v_mfma_f32_16x16x16_bf16 v[24:27], v[10:11], v[58:59], v[24:27]
    s_waitcnt vmcnt(13)
    v_mfma_f32_16x16x16_bf16 v[28:31], v[10:11], v[60:61], v[28:31]
    v_mfma_f32_16x16x16_bf16 v[32:35], v[10:11], v[62:63], v[32:35]
    s_waitcnt vmcnt(12)
    v_mfma_f32_16x16x16_bf16 v[12:15], v[10:11], v[64:65], v[12:15]
    v_mfma_f32_16x16x16_bf16 v[16:19], v[10:11], v[66:67], v[16:19]
    s_waitcnt vmcnt(11)
    v_mfma_f32_16x16x16_bf16 v[20:23], v[10:11], v[68:69], v[20:23]
    v_mfma_f32_16x16x16_bf16 v[24:27], v[10:11], v[70:71], v[24:27]
    s_waitcnt vmcnt(9)
    v_mfma_f32_16x16x16_bf16 v[28:31], v[10:11], v[72:73], v[28:31]
    v_mfma_f32_16x16x16_bf16 v[32:35], v[10:11], v[74:75], v[32:35]
    s_waitcnt vmcnt(8)
    v_mfma_f32_16x16x16_bf16 v[12:15], v[10:11], v[76:77], v[12:15]
    v_mfma_f32_16x16x16_bf16 v[16:19], v[10:11], v[78:79], v[16:19]
    s_waitcnt vmcnt(7)
    v_mfma_f32_16x16x16_bf16 v[20:23], v[10:11], v[80:81], v[20:23]
    v_mfma_f32_16x16x16_bf16 v[24:27], v[10:11], v[82:83], v[24:27]
    s_waitcnt vmcnt(5)
    v_mfma_f32_16x16x16_bf16 v[28:31], v[10:11], v[84:85], v[28:31]
    v_mfma_f32_16x16x16_bf16 v[32:35], v[10:11], v[86:87], v[32:35]
    s_waitcnt vmcnt(4)
    v_mfma_f32_16x16x16_bf16 v[12:15], v[10:11], v[88:89], v[12:15]
    v_mfma_f32_16x16x16_bf16 v[16:19], v[10:11], v[90:91], v[16:19]
    s_waitcnt vmcnt(3)
    v_mfma_f32_16x16x16_bf16 v[20:23], v[10:11], v[92:93], v[20:23]
    v_mfma_f32_16x16x16_bf16 v[24:27], v[10:11], v[94:95], v[24:27]
    s_waitcnt vmcnt(1)
    v_mfma_f32_16x16x16_bf16 v[28:31], v[10:11], v[96:97], v[28:31]
    v_mfma_f32_16x16x16_bf16 v[32:35], v[10:11], v[98:99], v[32:35]
    v_pk_add_f32 v[52:53], v[12:13], v[20:21]
    v_pk_add_f32 v[54:55], v[14:15], v[22:23]
    v_pk_add_f32 v[56:57], v[16:17], v[24:25]
    v_pk_add_f32 v[58:59], v[18:19], v[26:27]
    v_pk_add_f32 v[52:53], v[52:53], v[28:29]
    v_pk_add_f32 v[54:55], v[54:55], v[30:31]
    s_nop 1
    v_pk_add_f32 v[56:57], v[56:57], v[32:33]
    v_pk_add_f32 v[58:59], v[58:59], v[34:35]
    v_pk_add_f32 v[52:53], v[52:53], v[56:57]
    v_pk_add_f32 v[54:55], v[54:55], v[58:59]
    v_pk_add_f32 v[52:53], v[52:53], v[54:55]
    v_add_f32 v52, v52, v53
    v_cmp_u_f32 vcc, v52, v52
    s_cbranch_vccz FIN_K
    s_cmp_eq_u32 s48, 0
    s_cbranch_scc1 FIN_K
    s_waitcnt vmcnt(0)
    v_cmp_ge_u32 vcc, s40, v5
    s_or_b32 s48, vcc_lo, vcc_hi
    s_sub_u32 s44, s44, 55296
    s_add_u32 s27, s27, 1
    s_cmp_lt_u32 s27, 400000
    s_cbranch_scc1 FIN_R
    s_movk_i32 s27, 25
    s_branch FAIL
FIN_K:
    v_cvt_pk_bf16_f32 v40, v12, v13
    v_cvt_pk_bf16_f32 v41, v14, v15
    v_cvt_pk_bf16_f32 v42, v16, v17
    v_cvt_pk_bf16_f32 v43, v18, v19
    buffer_store_dwordx4 v[40:43], v3, s[20:23], s41 offen offset:0
    v_cvt_pk_bf16_f32 v44, v20, v21
    v_cvt_pk_bf16_f32 v45, v22, v23
    v_cvt_pk_bf16_f32 v46, v24, v25
    v_cvt_pk_bf16_f32 v47, v26, v27
    buffer_store_dwordx4 v[44:47], v3, s[20:23], s41 offen offset:128
    v_cvt_pk_bf16_f32 v48, v28, v29
    v_cvt_pk_bf16_f32 v49, v30, v31
    v_cvt_pk_bf16_f32 v50, v32, v33
    v_cvt_pk_bf16_f32 v51, v34, v35
    buffer_store_dwordx4 v[48:51], v3, s[20:23], s41 offen offset:256
    s_add_u32 s35, s35, 256
    s_cmp_lt_u32 s35, 768
    s_cbranch_scc1 FIN_L
    s_endpgm
R_LN:
    s_mov_b32 s35, s26
    s_mov_b32 s20, s64
    s_mov_b32 s21, s65
    s_mov_b32 s22, 0x240000
    s_mov_b32 s23, 0x20000
    v_and_b32 v7, 7, v1
    v_bfe_u32 v6, v1, 3, 1
    v_lshrrev_b32 v5, 4, v1
    v_mul_u32_u24 v3, 1152, v7
    v_lshl_add_u32 v3, v6, 6, v3
    v_lshl_add_u32 v3, v5, 4, v3
    v_lshl_add_u32 v7, v5, 4, v7
    v_lshlrev_b32 v6, 10, v6
    v_lshl_add_u32 v4, v7, 4, v6
    s_lshl_b32 s36, s35, 2
    s_add_u32 s36, s36, s24
    s_mul_i32 s32, s36, 9216
    buffer_load_dwordx4 v[16:19], v3, s[20:23], s32 offen offset:0
    buffer_load_dwordx4 v[20:23], v3, s[20:23], s32 offen offset:128
    buffer_load_dwordx4 v[24:27], v3, s[20:23], s32 offen offset:256
    buffer_load_dwordx4 v[28:31], v3, s[20:23], s32 offen offset:384
    buffer_load_dwordx4 v[32:35], v3, s[20:23], s32 offen offset:512
    buffer_load_dwordx4 v[36:39], v3, s[20:23], s32 offen offset:640
    buffer_load_dwordx4 v[40:43], v3, s[20:23], s32 offen offset:768
    buffer_load_dwordx4 v[44:47], v3, s[20:23], s32 offen offset:896
    buffer_load_dwordx4 v[48:51], v3, s[20:23], s32 offen offset:1024
    s_add_u32 s32, s32, 1179648
    buffer_load_dwordx4 v[124:127], v3, s[20:23], s32 offen offset:0
    buffer_load_dwordx4 v[128:131], v3, s[20:23], s32 offen offset:128
    buffer_load_dwordx4 v[132:135], v3, s[20:23], s32 offen offset:256
    buffer_load_dwordx4 v[136:139], v3, s[20:23], s32 offen offset:384
    buffer_load_dwordx4 v[140:143], v3, s[20:23], s32 offen offset:512
    buffer_load_dwordx4 v[144:147], v3, s[20:23], s32 offen offset:640
    buffer_load_dwordx4 v[148:151], v3, s[20:23], s32 offen offset:768
    buffer_load_dwordx4 v[152:155], v3, s[20:23], s32 offen offset:896
    buffer_load_dwordx4 v[156:159], v3, s[20:23], s32 offen offset:1024
    s_add_u32 s32, s32, 1179648
    s_lshr_b32 s33, s36, 1
    s_mul_i32 s33, s33, 18432
    s_and_b32 s34, s24, 1
    s_lshl_b32 s34, s34, 7
    s_add_u32 s33, s33, s34
    s_add_u32 s33, s33, 0x400000
    v_mov_b32 v6, 244
    s_waitcnt vmcnt(17)
    v_lshlrev_b32 v52, 16, v16
    v_and_b32 v53, 0xffff0000, v16
    v_lshlrev_b32 v54, 16, v17
    v_and_b32 v55, 0xffff0000, v17
    v_lshlrev_b32 v56, 16, v18
    v_and_b32 v57, 0xffff0000, v18
    v_lshlrev_b32 v58, 16, v19
    v_and_b32 v59, 0xffff0000, v19
    v_pk_add_f32 v[8:9], v[52:53], v[56:57]
    v_pk_add_f32 v[10:11], v[54:55], v[58:59]
    s_waitcnt vmcnt(16)
    v_lshlrev_b32 v60, 16, v20
    v_and_b32 v61, 0xffff0000, v20
    v_lshlrev_b32 v62, 16, v21
    v_and_b32 v63, 0xffff0000, v21
    v_lshlrev_b32 v64, 16, v22
    v_and_b32 v65, 0xffff0000, v22
    v_lshlrev_b32 v66, 16, v23
    v_and_b32 v67, 0xffff0000, v23
    v_pk_add_f32 v[8:9], v[8:9], v[60:61]
    v_pk_add_f32 v[10:11], v[10:11], v[62:63]
    v_pk_add_f32 v[8:9], v[8:9], v[64:65]
    v_pk_add_f32 v[10:11], v[10:11], v[66:67]
    s_waitcnt vmcnt(15)
    v_lshlrev_b32 v68, 16, v24
    v_and_b32 v69, 0xffff0000, v24
    v_lshlrev_b32 v70, 16, v25
    v_and_b32 v71, 0xffff0000, v25
    v_lshlrev_b32 v72, 16, v26
    v_and_b32 v73, 0xffff0000, v26
    v_lshlrev_b32 v74, 16, v27
    v_and_b32 v75, 0xffff0000, v27
    v_pk_add_f32 v[8:9], v[8:9], v[68:69]
    v_pk_add_f32 v[10:11], v[10:11], v[70:71]
    v_pk_add_f32 v[8:9], v[8:9], v[72:73]
    v_pk_add_f32 v[10:11], v[10:11], v[74:75]
    s_waitcnt vmcnt(14)
    v_lshlrev_b32 v76, 16, v28
    v_and_b32 v77, 0xffff0000, v28
    v_lshlrev_b32 v78, 16, v29
    v_and_b32 v79, 0xffff0000, v29
    v_lshlrev_b32 v80, 16, v30
    v_and_b32 v81, 0xffff0000, v30
    v_lshlrev_b32 v82, 16, v31
    v_and_b32 v83, 0xffff0000, v31
    v_pk_add_f32 v[8:9], v[8:9], v[76:77]
    v_pk_add_f32 v[10:11], v[10:11], v[78:79]
    v_pk_add_f32 v[8:9], v[8:9], v[80:81]
    v_pk_add_f32 v[10:11], v[10:11], v[82:83]
    s_waitcnt vmcnt(13)
    v_lshlrev_b32 v84, 16, v32
    v_and_b32 v85, 0xffff0000, v32
    v_lshlrev_b32 v86, 16, v33
    v_and_b32 v87, 0xffff0000, v33
    v_lshlrev_b32 v88, 16, v34
    v_and_b32 v89, 0xffff0000, v34
    v_lshlrev_b32 v90, 16, v35
    v_and_b32 v91, 0xffff0000, v35
    v_pk_add_f32 v[8:9], v[8:9], v[84:85]
    v_pk_add_f32 v[10:11], v[10:11], v[86:87]
    v_pk_add_f32 v[8:9], v[8:9], v[88:89]
    v_pk_add_f32 v[10:11], v[10:11], v[90:91]
    s_waitcnt vmcnt(12)
    v_lshlrev_b32 v92, 16, v36
    v_and_b32 v93, 0xffff0000, v36
    v_lshlrev_b32 v94, 16, v37
    v_and_b32 v95, 0xffff0000, v37
    v_lshlrev_b32 v96, 16, v38
    v_and_b32 v97, 0xffff0000, v38
    v_lshlrev_b32 v98, 16, v39
    v_and_b32 v99, 0xffff0000, v39
    v_pk_add_f32 v[8:9], v[8:9], v[92:93]
    v_pk_add_f32 v[10:11], v[10:11], v[94:95]
    v_pk_add_f32 v[8:9], v[8:9], v[96:97]
    v_pk_add_f32 v[10:11], v[10:11], v[98:99]
    s_waitcnt vmcnt(11)
    v_lshlrev_b32 v100, 16, v40
    v_and_b32 v101, 0xffff0000, v40
    v_lshlrev_b32 v102, 16, v41
    v_and_b32 v103, 0xffff0000, v41
    v_lshlrev_b32 v104, 16, v42
    v_and_b32 v105, 0xffff0000, v42
    v_lshlrev_b32 v106, 16, v43
    v_and_b32 v107, 0xffff0000, v43
    v_pk_add_f32 v[8:9], v[8:9], v[100:101]
    v_pk_add_f32 v[10:11], v[10:11], v[102:103]
    v_pk_add_f32 v[8:9], v[8:9], v[104:105]
    v_pk_add_f32 v[10:11], v[10:11], v[106:107]
    s_waitcnt vmcnt(10)
    v_lshlrev_b32 v108, 16, v44
    v_and_b32 v109, 0xffff0000, v44
    v_lshlrev_b32 v110, 16, v45
    v_and_b32 v111, 0xffff0000, v45
    v_lshlrev_b32 v112, 16, v46
    v_and_b32 v113, 0xffff0000, v46
    v_lshlrev_b32 v114, 16, v47
    v_and_b32 v115, 0xffff0000, v47
    v_pk_add_f32 v[8:9], v[8:9], v[108:109]
    v_pk_add_f32 v[10:11], v[10:11], v[110:111]
    v_pk_add_f32 v[8:9], v[8:9], v[112:113]
    v_pk_add_f32 v[10:11], v[10:11], v[114:115]
    s_waitcnt vmcnt(9)
    v_lshlrev_b32 v116, 16, v48
    v_and_b32 v117, 0xffff0000, v48
    v_lshlrev_b32 v118, 16, v49
    v_and_b32 v119, 0xffff0000, v49
    v_lshlrev_b32 v120, 16, v50
    v_and_b32 v121, 0xffff0000, v50
    v_lshlrev_b32 v122, 16, v51
    v_and_b32 v123, 0xffff0000, v51
    v_pk_add_f32 v[8:9], v[8:9], v[116:117]
    v_pk_add_f32 v[10:11], v[10:11], v[118:119]
    v_pk_add_f32 v[8:9], v[8:9], v[120:121]
    v_pk_add_f32 v[10:11], v[10:11], v[122:123]
    v_pk_add_f32 v[8:9], v[8:9], v[10:11]
    v_add_f32 v8, v8, v9
    s_nop 1
    v_add_f32_dpp v8, v8, v8 row_ror:8 row_mask:0xf bank_mask:0xf
    v_mov_b32 v9, v8
    s_nop 1
    v_permlane16_swap_b32 v8, v9
    v_add_f32 v8, v8, v9
    v_mov_b32 v9, v8
    s_nop 1
    v_permlane32_swap_b32 v8, v9
    v_add_f32 v8, v8, v9
    v_mul_f32 v12, 0xbae38e39, v8
    v_mov_b32 v13, v12
    v_pk_add_f32 v[52:53], v[52:53], v[12:13]
    v_pk_add_f32 v[54:55], v[54:55], v[12:13]
    v_pk_add_f32 v[56:57], v[56:57], v[12:13]
    v_pk_add_f32 v[58:59], v[58:59], v[12:13]
    v_pk_add_f32 v[60:61], v[60:61], v[12:13]
    v_pk_add_f32 v[62:63], v[62:63], v[12:13]
    v_pk_add_f32 v[64:65], v[64:65], v[12:13]
    v_pk_add_f32 v[66:67], v[66:67], v[12:13]
    v_pk_add_f32 v[68:69], v[68:69], v[12:13]
    v_pk_add_f32 v[70:71], v[70:71], v[12:13]
    v_pk_add_f32 v[72:73], v[72:73], v[12:13]
    v_pk_add_f32 v[74:75], v[74:75], v[12:13]
    v_pk_add_f32 v[76:77], v[76:77], v[12:13]
    v_pk_add_f32 v[78:79], v[78:79], v[12:13]
    v_pk_add_f32 v[80:81], v[80:81], v[12:13]
    v_pk_add_f32 v[82:83], v[82:83], v[12:13]
    v_pk_add_f32 v[84:85], v[84:85], v[12:13]
    v_pk_add_f32 v[86:87], v[86:87], v[12:13]
    v_pk_add_f32 v[88:89], v[88:89], v[12:13]
    v_pk_add_f32 v[90:91], v[90:91], v[12:13]
    v_pk_add_f32 v[92:93], v[92:93], v[12:13]
    v_pk_add_f32 v[94:95], v[94:95], v[12:13]
    v_pk_add_f32 v[96:97], v[96:97], v[12:13]
    v_pk_add_f32 v[98:99], v[98:99], v[12:13]
    v_pk_add_f32 v[100:101], v[100:101], v[12:13]
    v_pk_add_f32 v[102:103], v[102:103], v[12:13]
    v_pk_add_f32 v[104:105], v[104:105], v[12:13]
    v_pk_add_f32 v[106:107], v[106:107], v[12:13]
    v_pk_add_f32 v[108:109], v[108:109], v[12:13]
    v_pk_add_f32 v[110:111], v[110:111], v[12:13]
    v_pk_add_f32 v[112:113], v[112:113], v[12:13]
    v_pk_add_f32 v[114:115], v[114:115], v[12:13]
    v_pk_add_f32 v[116:117], v[116:117], v[12:13]
    v_pk_add_f32 v[118:119], v[118:119], v[12:13]
    v_pk_add_f32 v[120:121], v[120:121], v[12:13]
    v_pk_add_f32 v[122:123], v[122:123], v[12:13]
    v_pk_mul_f32 v[8:9], v[52:53], v[52:53]
    v_pk_mul_f32 v[10:11], v[54:55], v[54:55]
    v_pk_fma_f32 v[8:9], v[56:57], v[56:57], v[8:9]
    v_pk_fma_f32 v[10:11], v[58:59], v[58:59], v[10:11]
    v_pk_fma_f32 v[8:9], v[60:61], v[60:61], v[8:9]
    v_pk_fma_f32 v[10:11], v[62:63], v[62:63], v[10:11]
    v_pk_fma_f32 v[8:9], v[64:65], v[64:65], v[8:9]
    v_pk_fma_f32 v[10:11], v[66:67], v[66:67], v[10:11]
    v_pk_fma_f32 v[8:9], v[68:69], v[68:69], v[8:9]
    v_pk_fma_f32 v[10:11], v[70:71], v[70:71], v[10:11]
    v_pk_fma_f32 v[8:9], v[72:73], v[72:73], v[8:9]
    v_pk_fma_f32 v[10:11], v[74:75], v[74:75], v[10:11]
    v_pk_fma_f32 v[8:9], v[76:77], v[76:77], v[8:9]
    v_pk_fma_f32 v[10:11], v[78:79], v[78:79], v[10:11]
    v_pk_fma_f32 v[8:9], v[80:81], v[80:81], v[8:9]
    v_pk_fma_f32 v[10:11], v[82:83], v[82:83], v[10:11]
    v_pk_fma_f32 v[8:9], v[84:85], v[84:85], v[8:9]
    v_pk_fma_f32 v[10:11], v[86:87], v[86:87], v[10:11]
    v_pk_fma_f32 v[8:9], v[88:89], v[88:89], v[8:9]
    v_pk_fma_f32 v[10:11], v[90:91], v[90:91], v[10:11]
    v_pk_fma_f32 v[8:9], v[92:93], v[92:93], v[8:9]
    v_pk_fma_f32 v[10:11], v[94:95], v[94:95], v[10:11]
    v_pk_fma_f32 v[8:9], v[96:97], v[96:97], v[8:9]
    v_pk_fma_f32 v[10:11], v[98:99], v[98:99], v[10:11]
    v_pk_fma_f32 v[8:9], v[100:101], v[100:101], v[8:9]
    v_pk_fma_f32 v[10:11], v[102:103], v[102:103], v[10:11]
    v_pk_fma_f32 v[8:9], v[104:105], v[104:105], v[8:9]
    v_pk_fma_f32 v[10:11], v[106:107], v[106:107], v[10:11]
    v_pk_fma_f32 v[8:9], v[108:109], v[108:109], v[8:9]
    v_pk_fma_f32 v[10:11], v[110:111], v[110:111], v[10:11]
    v_pk_fma_f32 v[8:9], v[112:113], v[112:113], v[8:9]
    v_pk_fma_f32 v[10:11], v[114:115], v[114:115], v[10:11]
    v_pk_fma_f32 v[8:9], v[116:117], v[116:117], v[8:9]
    v_pk_fma_f32 v[10:11], v[118:119], v[118:119], v[10:11]
    v_pk_fma_f32 v[8:9], v[120:121], v[120:121], v[8:9]
    v_pk_fma_f32 v[10:11], v[122:123], v[122:123], v[10:11]
    v_pk_add_f32 v[8:9], v[8:9], v[10:11]
    v_add_f32 v8, v8, v9
    s_nop 1
    v_add_f32_dpp v8, v8, v8 row_ror:8 row_mask:0xf bank_mask:0xf
    v_mov_b32 v9, v8
    s_nop 1
    v_permlane16_swap_b32 v8, v9
    v_add_f32 v8, v8, v9
    v_mov_b32 v9, v8
    s_nop 1
    v_permlane32_swap_b32 v8, v9
    v_add_f32 v8, v8, v9
    v_mov_b32 v9, 0x3727c5ac
    v_fmac_f32 v9, 0x3ae38e39, v8
    v_rsq_f32 v12, v9
    s_nop 0
    v_mov_b32 v13, v12
    v_pk_mul_f32 v[52:53], v[52:53], v[12:13]
    v_pk_mul_f32 v[54:55], v[54:55], v[12:13]
    v_pk_mul_f32 v[56:57], v[56:57], v[12:13]
    v_pk_mul_f32 v[58:59], v[58:59], v[12:13]
    v_cvt_pk_bf16_f32 v16, v52, v53
    v_cvt_pk_bf16_f32 v17, v54, v55
    v_cvt_pk_bf16_f32 v18, v56, v57
    v_cvt_pk_bf16_f32 v19, v58, v59
    buffer_store_dwordx4 v[16:19], v4, s[4:7], s33 offen offset:0 sc1
    v_pk_mul_f32 v[60:61], v[60:61], v[12:13]
    v_pk_mul_f32 v[62:63], v[62:63], v[12:13]
    v_pk_mul_f32 v[64:65], v[64:65], v[12:13]
    v_pk_mul_f32 v[66:67], v[66:67], v[12:13]
    v_cvt_pk_bf16_f32 v20, v60, v61
    v_cvt_pk_bf16_f32 v21, v62, v63
    v_cvt_pk_bf16_f32 v22, v64, v65
    v_cvt_pk_bf16_f32 v23, v66, v67
    buffer_store_dwordx4 v[20:23], v4, s[4:7], s33 offen offset:2048 sc1
    v_pk_mul_f32 v[68:69], v[68:69], v[12:13]
    v_pk_mul_f32 v[70:71], v[70:71], v[12:13]
    v_pk_mul_f32 v[72:73], v[72:73], v[12:13]
    v_pk_mul_f32 v[74:75], v[74:75], v[12:13]
    v_cvt_pk_bf16_f32 v24, v68, v69
    v_cvt_pk_bf16_f32 v25, v70, v71
    v_cvt_pk_bf16_f32 v26, v72, v73
    v_cvt_pk_bf16_f32 v27, v74, v75
    s_add_u32 s33, s33, 4096
    buffer_store_dwordx4 v[24:27], v4, s[4:7], s33 offen offset:0 sc1
    v_pk_mul_f32 v[76:77], v[76:77], v[12:13]
    v_pk_mul_f32 v[78:79], v[78:79], v[12:13]
    v_pk_mul_f32 v[80:81], v[80:81], v[12:13]
    v_pk_mul_f32 v[82:83], v[82:83], v[12:13]
    v_cvt_pk_bf16_f32 v28, v76, v77
    v_cvt_pk_bf16_f32 v29, v78, v79
    v_cvt_pk_bf16_f32 v30, v80, v81
    v_cvt_pk_bf16_f32 v31, v82, v83
    buffer_store_dwordx4 v[28:31], v4, s[4:7], s33 offen offset:2048 sc1
    v_pk_mul_f32 v[84:85], v[84:85], v[12:13]
    v_pk_mul_f32 v[86:87], v[86:87], v[12:13]
    v_pk_mul_f32 v[88:89], v[88:89], v[12:13]
    v_pk_mul_f32 v[90:91], v[90:91], v[12:13]
    v_cvt_pk_bf16_f32 v32, v84, v85
    v_cvt_pk_bf16_f32 v33, v86, v87
    v_cvt_pk_bf16_f32 v34, v88, v89
    v_cvt_pk_bf16_f32 v35, v90, v91
    s_add_u32 s33, s33, 4096
    buffer_store_dwordx4 v[32:35], v4, s[4:7], s33 offen offset:0 sc1
    v_pk_mul_f32 v[92:93], v[92:93], v[12:13]
    v_pk_mul_f32 v[94:95], v[94:95], v[12:13]
    v_pk_mul_f32 v[96:97], v[96:97], v[12:13]
    v_pk_mul_f32 v[98:99], v[98:99], v[12:13]
    v_cvt_pk_bf16_f32 v36, v92, v93
    v_cvt_pk_bf16_f32 v37, v94, v95
    v_cvt_pk_bf16_f32 v38, v96, v97
    v_cvt_pk_bf16_f32 v39, v98, v99
    buffer_store_dwordx4 v[36:39], v4, s[4:7], s33 offen offset:2048 sc1
    v_pk_mul_f32 v[100:101], v[100:101], v[12:13]
    v_pk_mul_f32 v[102:103], v[102:103], v[12:13]
    v_pk_mul_f32 v[104:105], v[104:105], v[12:13]
    v_pk_mul_f32 v[106:107], v[106:107], v[12:13]
    v_cvt_pk_bf16_f32 v40, v100, v101
    v_cvt_pk_bf16_f32 v41, v102, v103
    v_cvt_pk_bf16_f32 v42, v104, v105
    v_cvt_pk_bf16_f32 v43, v106, v107
    s_add_u32 s33, s33, 4096
    buffer_store_dwordx4 v[40:43], v4, s[4:7], s33 offen offset:0 sc1
    v_pk_mul_f32 v[108:109], v[108:109], v[12:13]
    v_pk_mul_f32 v[110:111], v[110:111], v[12:13]
    v_pk_mul_f32 v[112:113], v[112:113], v[12:13]
    v_pk_mul_f32 v[114:115], v[114:115], v[12:13]
    v_cvt_pk_bf16_f32 v44, v108, v109
    v_cvt_pk_bf16_f32 v45, v110, v111
    v_cvt_pk_bf16_f32 v46, v112, v113
    v_cvt_pk_bf16_f32 v47, v114, v115
    buffer_store_dwordx4 v[44:47], v4, s[4:7], s33 offen offset:2048 sc1
    v_pk_mul_f32 v[116:117], v[116:117], v[12:13]
    v_pk_mul_f32 v[118:119], v[118:119], v[12:13]
    v_pk_mul_f32 v[120:121], v[120:121], v[12:13]
    v_pk_mul_f32 v[122:123], v[122:123], v[12:13]
    v_cvt_pk_bf16_f32 v48, v116, v117
    v_cvt_pk_bf16_f32 v49, v118, v119
    v_cvt_pk_bf16_f32 v50, v120, v121
    v_cvt_pk_bf16_f32 v51, v122, v123
    s_add_u32 s33, s33, 4096
    buffer_store_dwordx4 v[48:51], v4, s[4:7], s33 offen offset:0 sc1
    s_add_u32 s33, s33, 1163264
    buffer_load_dword v14, v6, s[8:11], 0 offen sc1
    s_waitcnt vmcnt(18)
    v_lshlrev_b32 v52, 16, v124
    v_and_b32 v53, 0xffff0000, v124
    v_lshlrev_b32 v54, 16, v125
    v_and_b32 v55, 0xffff0000, v125
    v_lshlrev_b32 v56, 16, v126
    v_and_b32 v57, 0xffff0000, v126
    v_lshlrev_b32 v58, 16, v127
    v_and_b32 v59, 0xffff0000, v127
    v_pk_add_f32 v[8:9], v[52:53], v[56:57]
    v_pk_add_f32 v[10:11], v[54:55], v[58:59]
    s_waitcnt vmcnt(17)
    v_lshlrev_b32 v60, 16, v128
    v_and_b32 v61, 0xffff0000, v128
    v_lshlrev_b32 v62, 16, v129
    v_and_b32 v63, 0xffff0000, v129
    v_lshlrev_b32 v64, 16, v130
    v_and_b32 v65, 0xffff0000, v130
    v_lshlrev_b32 v66, 16, v131
    v_and_b32 v67, 0xffff0000, v131
    v_pk_add_f32 v[8:9], v[8:9], v[60:61]
    v_pk_add_f32 v[10:11], v[10:11], v[62:63]
    v_pk_add_f32 v[8:9], v[8:9], v[64:65]
    v_pk_add_f32 v[10:11], v[10:11], v[66:67]
    s_waitcnt vmcnt(16)
    v_lshlrev_b32 v68, 16, v132
    v_and_b32 v69, 0xffff0000, v132
    v_lshlrev_b32 v70, 16, v133
    v_and_b32 v71, 0xffff0000, v133
    v_lshlrev_b32 v72, 16, v134
    v_and_b32 v73, 0xffff0000, v134
    v_lshlrev_b32 v74, 16, v135
    v_and_b32 v75, 0xffff0000, v135
    v_pk_add_f32 v[8:9], v[8:9], v[68:69]
    v_pk_add_f32 v[10:11], v[10:11], v[70:71]
    v_pk_add_f32 v[8:9], v[8:9], v[72:73]
    v_pk_add_f32 v[10:11], v[10:11], v[74:75]
    s_waitcnt vmcnt(15)
    v_lshlrev_b32 v76, 16, v136
    v_and_b32 v77, 0xffff0000, v136
    v_lshlrev_b32 v78, 16, v137
    v_and_b32 v79, 0xffff0000, v137
    v_lshlrev_b32 v80, 16, v138
    v_and_b32 v81, 0xffff0000, v138
    v_lshlrev_b32 v82, 16, v139
    v_and_b32 v83, 0xffff0000, v139
    v_pk_add_f32 v[8:9], v[8:9], v[76:77]
    v_pk_add_f32 v[10:11], v[10:11], v[78:79]
    v_pk_add_f32 v[8:9], v[8:9], v[80:81]
    v_pk_add_f32 v[10:11], v[10:11], v[82:83]
    s_waitcnt vmcnt(14)
    v_lshlrev_b32 v84, 16, v140
    v_and_b32 v85, 0xffff0000, v140
    v_lshlrev_b32 v86, 16, v141
    v_and_b32 v87, 0xffff0000, v141
    v_lshlrev_b32 v88, 16, v142
    v_and_b32 v89, 0xffff0000, v142
    v_lshlrev_b32 v90, 16, v143
    v_and_b32 v91, 0xffff0000, v143
    v_pk_add_f32 v[8:9], v[8:9], v[84:85]
    v_pk_add_f32 v[10:11], v[10:11], v[86:87]
    v_pk_add_f32 v[8:9], v[8:9], v[88:89]
    v_pk_add_f32 v[10:11], v[10:11], v[90:91]
    s_waitcnt vmcnt(13)
    v_lshlrev_b32 v92, 16, v144
    v_and_b32 v93, 0xffff0000, v144
    v_lshlrev_b32 v94, 16, v145
    v_and_b32 v95, 0xffff0000, v145
    v_lshlrev_b32 v96, 16, v146
    v_and_b32 v97, 0xffff0000, v146
    v_lshlrev_b32 v98, 16, v147
    v_and_b32 v99, 0xffff0000, v147
    v_pk_add_f32 v[8:9], v[8:9], v[92:93]
    v_pk_add_f32 v[10:11], v[10:11], v[94:95]
    v_pk_add_f32 v[8:9], v[8:9], v[96:97]
    v_pk_add_f32 v[10:11], v[10:11], v[98:99]
    s_waitcnt vmcnt(12)
    v_lshlrev_b32 v100, 16, v148
    v_and_b32 v101, 0xffff0000, v148
    v_lshlrev_b32 v102, 16, v149
    v_and_b32 v103, 0xffff0000, v149
    v_lshlrev_b32 v104, 16, v150
    v_and_b32 v105, 0xffff0000, v150
    v_lshlrev_b32 v106, 16, v151
    v_and_b32 v107, 0xffff0000, v151
    v_pk_add_f32 v[8:9], v[8:9], v[100:101]
    v_pk_add_f32 v[10:11], v[10:11], v[102:103]
    v_pk_add_f32 v[8:9], v[8:9], v[104:105]
    v_pk_add_f32 v[10:11], v[10:11], v[106:107]
    s_waitcnt vmcnt(11)
    v_lshlrev_b32 v108, 16, v152
    v_and_b32 v109, 0xffff0000, v152
    v_lshlrev_b32 v110, 16, v153
    v_and_b32 v111, 0xffff0000, v153
    v_lshlrev_b32 v112, 16, v154
    v_and_b32 v113, 0xffff0000, v154
    v_lshlrev_b32 v114, 16, v155
    v_and_b32 v115, 0xffff0000, v155
    v_pk_add_f32 v[8:9], v[8:9], v[108:109]
    v_pk_add_f32 v[10:11], v[10:11], v[110:111]
    v_pk_add_f32 v[8:9], v[8:9], v[112:113]
    v_pk_add_f32 v[10:11], v[10:11], v[114:115]
    s_waitcnt vmcnt(10)
    v_lshlrev_b32 v116, 16, v156
    v_and_b32 v117, 0xffff0000, v156
    v_lshlrev_b32 v118, 16, v157
    v_and_b32 v119, 0xffff0000, v157
    v_lshlrev_b32 v120, 16, v158
    v_and_b32 v121, 0xffff0000, v158
    v_lshlrev_b32 v122, 16, v159
    v_and_b32 v123, 0xffff0000, v159
    v_pk_add_f32 v[8:9], v[8:9], v[116:117]
    v_pk_add_f32 v[10:11], v[10:11], v[118:119]
    v_pk_add_f32 v[8:9], v[8:9], v[120:121]
    v_pk_add_f32 v[10:11], v[10:11], v[122:123]
    v_pk_add_f32 v[8:9], v[8:9], v[10:11]
    v_add_f32 v8, v8, v9
    s_nop 1
    v_add_f32_dpp v8, v8, v8 row_ror:8 row_mask:0xf bank_mask:0xf
    v_mov_b32 v9, v8
    s_nop 1
    v_permlane16_swap_b32 v8, v9
    v_add_f32 v8, v8, v9
    v_mov_b32 v9, v8
    s_nop 1
    v_permlane32_swap_b32 v8, v9
    v_add_f32 v8, v8, v9
    v_mul_f32 v12, 0xbae38e39, v8
    v_mov_b32 v13, v12
    v_pk_add_f32 v[52:53], v[52:53], v[12:13]
    v_pk_add_f32 v[54:55], v[54:55], v[12:13]
    v_pk_add_f32 v[56:57], v[56:57], v[12:13]
    v_pk_add_f32 v[58:59], v[58:59], v[12:13]
    v_pk_add_f32 v[60:61], v[60:61], v[12:13]
    v_pk_add_f32 v[62:63], v[62:63], v[12:13]
    v_pk_add_f32 v[64:65], v[64:65], v[12:13]
    v_pk_add_f32 v[66:67], v[66:67], v[12:13]
    v_pk_add_f32 v[68:69], v[68:69], v[12:13]
    v_pk_add_f32 v[70:71], v[70:71], v[12:13]
    v_pk_add_f32 v[72:73], v[72:73], v[12:13]
    v_pk_add_f32 v[74:75], v[74:75], v[12:13]
    v_pk_add_f32 v[76:77], v[76:77], v[12:13]
    v_pk_add_f32 v[78:79], v[78:79], v[12:13]
    v_pk_add_f32 v[80:81], v[80:81], v[12:13]
    v_pk_add_f32 v[82:83], v[82:83], v[12:13]
    v_pk_add_f32 v[84:85], v[84:85], v[12:13]
    v_pk_add_f32 v[86:87], v[86:87], v[12:13]
    v_pk_add_f32 v[88:89], v[88:89], v[12:13]
    v_pk_add_f32 v[90:91], v[90:91], v[12:13]
    v_pk_add_f32 v[92:93], v[92:93], v[12:13]
    v_pk_add_f32 v[94:95], v[94:95], v[12:13]
    v_pk_add_f32 v[96:97], v[96:97], v[12:13]
    v_pk_add_f32 v[98:99], v[98:99], v[12:13]
    v_pk_add_f32 v[100:101], v[100:101], v[12:13]
    v_pk_add_f32 v[102:103], v[102:103], v[12:13]
    v_pk_add_f32 v[104:105], v[104:105], v[12:13]
    v_pk_add_f32 v[106:107], v[106:107], v[12:13]
    v_pk_add_f32 v[108:109], v[108:109], v[12:13]
    v_pk_add_f32 v[110:111], v[110:111], v[12:13]
    v_pk_add_f32 v[112:113], v[112:113], v[12:13]
    v_pk_add_f32 v[114:115], v[114:115], v[12:13]
    v_pk_add_f32 v[116:117], v[116:117], v[12:13]
    v_pk_add_f32 v[118:119], v[118:119], v[12:13]
    v_pk_add_f32 v[120:121], v[120:121], v[12:13]
    v_pk_add_f32 v[122:123], v[122:123], v[12:13]
    v_pk_mul_f32 v[8:9], v[52:53], v[52:53]
    v_pk_mul_f32 v[10:11], v[54:55], v[54:55]
    v_pk_fma_f32 v[8:9], v[56:57], v[56:57], v[8:9]
    v_pk_fma_f32 v[10:11], v[58:59], v[58:59], v[10:11]
    v_pk_fma_f32 v[8:9], v[60:61], v[60:61], v[8:9]
    v_pk_fma_f32 v[10:11], v[62:63], v[62:63], v[10:11]
    v_pk_fma_f32 v[8:9], v[64:65], v[64:65], v[8:9]
    v_pk_fma_f32 v[10:11], v[66:67], v[66:67], v[10:11]
    v_pk_fma_f32 v[8:9], v[68:69], v[68:69], v[8:9]
    v_pk_fma_f32 v[10:11], v[70:71], v[70:71], v[10:11]
    v_pk_fma_f32 v[8:9], v[72:73], v[72:73], v[8:9]
    v_pk_fma_f32 v[10:11], v[74:75], v[74:75], v[10:11]
    v_pk_fma_f32 v[8:9], v[76:77], v[76:77], v[8:9]
    v_pk_fma_f32 v[10:11], v[78:79], v[78:79], v[10:11]
    v_pk_fma_f32 v[8:9], v[80:81], v[80:81], v[8:9]
    v_pk_fma_f32 v[10:11], v[82:83], v[82:83], v[10:11]
    v_pk_fma_f32 v[8:9], v[84:85], v[84:85], v[8:9]
    v_pk_fma_f32 v[10:11], v[86:87], v[86:87], v[10:11]
    v_pk_fma_f32 v[8:9], v[88:89], v[88:89], v[8:9]
    v_pk_fma_f32 v[10:11], v[90:91], v[90:91], v[10:11]
    v_pk_fma_f32 v[8:9], v[92:93], v[92:93], v[8:9]
    v_pk_fma_f32 v[10:11], v[94:95], v[94:95], v[10:11]
    v_pk_fma_f32 v[8:9], v[96:97], v[96:97], v[8:9]
    v_pk_fma_f32 v[10:11], v[98:99], v[98:99], v[10:11]
    v_pk_fma_f32 v[8:9], v[100:101], v[100:101], v[8:9]
    v_pk_fma_f32 v[10:11], v[102:103], v[102:103], v[10:11]
    v_pk_fma_f32 v[8:9], v[104:105], v[104:105], v[8:9]
    v_pk_fma_f32 v[10:11], v[106:107], v[106:107], v[10:11]
    v_pk_fma_f32 v[8:9], v[108:109], v[108:109], v[8:9]
    v_pk_fma_f32 v[10:11], v[110:111], v[110:111], v[10:11]
    v_pk_fma_f32 v[8:9], v[112:113], v[112:113], v[8:9]
    v_pk_fma_f32 v[10:11], v[114:115], v[114:115], v[10:11]
    v_pk_fma_f32 v[8:9], v[116:117], v[116:117], v[8:9]
    v_pk_fma_f32 v[10:11], v[118:119], v[118:119], v[10:11]
    v_pk_fma_f32 v[8:9], v[120:121], v[120:121], v[8:9]
    v_pk_fma_f32 v[10:11], v[122:123], v[122:123], v[10:11]
    v_pk_add_f32 v[8:9], v[8:9], v[10:11]
    v_add_f32 v8, v8, v9
    s_nop 1
    v_add_f32_dpp v8, v8, v8 row_ror:8 row_mask:0xf bank_mask:0xf
    v_mov_b32 v9, v8
    s_nop 1
    v_permlane16_swap_b32 v8, v9
    v_add_f32 v8, v8, v9
    v_mov_b32 v9, v8
    s_nop 1
    v_permlane32_swap_b32 v8, v9
    v_add_f32 v8, v8, v9
    v_mov_b32 v9, 0x3727c5ac
    v_fmac_f32 v9, 0x3ae38e39, v8
    v_rsq_f32 v12, v9
    s_nop 0
    v_mov_b32 v13, v12
    v_pk_mul_f32 v[52:53], v[52:53], v[12:13]
    v_pk_mul_f32 v[54:55], v[54:55], v[12:13]
    v_pk_mul_f32 v[56:57], v[56:57], v[12:13]
    v_pk_mul_f32 v[58:59], v[58:59], v[12:13]
    v_cvt_pk_bf16_f32 v124, v52, v53
    v_cvt_pk_bf16_f32 v125, v54, v55
    v_cvt_pk_bf16_f32 v126, v56, v57
    v_cvt_pk_bf16_f32 v127, v58, v59
    buffer_store_dwordx4 v[124:127], v4, s[4:7], s33 offen offset:0 sc1
    v_pk_mul_f32 v[60:61], v[60:61], v[12:13]
    v_pk_mul_f32 v[62:63], v[62:63], v[12:13]
    v_pk_mul_f32 v[64:65], v[64:65], v[12:13]
    v_pk_mul_f32 v[66:67], v[66:67], v[12:13]
    v_cvt_pk_bf16_f32 v128, v60, v61
    v_cvt_pk_bf16_f32 v129, v62, v63
    v_cvt_pk_bf16_f32 v130, v64, v65
    v_cvt_pk_bf16_f32 v131, v66, v67
    buffer_store_dwordx4 v[128:131], v4, s[4:7], s33 offen offset:2048 sc1
    v_pk_mul_f32 v[68:69], v[68:69], v[12:13]
    v_pk_mul_f32 v[70:71], v[70:71], v[12:13]
    v_pk_mul_f32 v[72:73], v[72:73], v[12:13]
    v_pk_mul_f32 v[74:75], v[74:75], v[12:13]
    v_cvt_pk_bf16_f32 v132, v68, v69
    v_cvt_pk_bf16_f32 v133, v70, v71
    v_cvt_pk_bf16_f32 v134, v72, v73
    v_cvt_pk_bf16_f32 v135, v74, v75
    s_add_u32 s33, s33, 4096
    buffer_store_dwordx4 v[132:135], v4, s[4:7], s33 offen offset:0 sc1
    v_pk_mul_f32 v[76:77], v[76:77], v[12:13]
    v_pk_mul_f32 v[78:79], v[78:79], v[12:13]
    v_pk_mul_f32 v[80:81], v[80:81], v[12:13]
    v_pk_mul_f32 v[82:83], v[82:83], v[12:13]
    v_cvt_pk_bf16_f32 v136, v76, v77
    v_cvt_pk_bf16_f32 v137, v78, v79
    v_cvt_pk_bf16_f32 v138, v80, v81
    v_cvt_pk_bf16_f32 v139, v82, v83
    buffer_store_dwordx4 v[136:139], v4, s[4:7], s33 offen offset:2048 sc1
    v_pk_mul_f32 v[84:85], v[84:85], v[12:13]
    v_pk_mul_f32 v[86:87], v[86:87], v[12:13]
    v_pk_mul_f32 v[88:89], v[88:89], v[12:13]
    v_pk_mul_f32 v[90:91], v[90:91], v[12:13]
    v_cvt_pk_bf16_f32 v140, v84, v85
    v_cvt_pk_bf16_f32 v141, v86, v87
    v_cvt_pk_bf16_f32 v142, v88, v89
    v_cvt_pk_bf16_f32 v143, v90, v91
    s_add_u32 s33, s33, 4096
    buffer_store_dwordx4 v[140:143], v4, s[4:7], s33 offen offset:0 sc1
    v_pk_mul_f32 v[92:93], v[92:93], v[12:13]
    v_pk_mul_f32 v[94:95], v[94:95], v[12:13]
    v_pk_mul_f32 v[96:97], v[96:97], v[12:13]
    v_pk_mul_f32 v[98:99], v[98:99], v[12:13]
    v_cvt_pk_bf16_f32 v144, v92, v93
    v_cvt_pk_bf16_f32 v145, v94, v95
    v_cvt_pk_bf16_f32 v146, v96, v97
    v_cvt_pk_bf16_f32 v147, v98, v99
    buffer_store_dwordx4 v[144:147], v4, s[4:7], s33 offen offset:2048 sc1
    v_pk_mul_f32 v[100:101], v[100:101], v[12:13]
    v_pk_mul_f32 v[102:103], v[102:103], v[12:13]
    v_pk_mul_f32 v[104:105], v[104:105], v[12:13]
    v_pk_mul_f32 v[106:107], v[106:107], v[12:13]
    v_cvt_pk_bf16_f32 v148, v100, v101
    v_cvt_pk_bf16_f32 v149, v102, v103
    v_cvt_pk_bf16_f32 v150, v104, v105
    v_cvt_pk_bf16_f32 v151, v106, v107
    s_add_u32 s33, s33, 4096
    buffer_store_dwordx4 v[148:151], v4, s[4:7], s33 offen offset:0 sc1
    v_pk_mul_f32 v[108:109], v[108:109], v[12:13]
    v_pk_mul_f32 v[110:111], v[110:111], v[12:13]
    v_pk_mul_f32 v[112:113], v[112:113], v[12:13]
    v_pk_mul_f32 v[114:115], v[114:115], v[12:13]
    v_cvt_pk_bf16_f32 v152, v108, v109
    v_cvt_pk_bf16_f32 v153, v110, v111
    v_cvt_pk_bf16_f32 v154, v112, v113
    v_cvt_pk_bf16_f32 v155, v114, v115
    buffer_store_dwordx4 v[152:155], v4, s[4:7], s33 offen offset:2048 sc1
    v_pk_mul_f32 v[116:117], v[116:117], v[12:13]
    v_pk_mul_f32 v[118:119], v[118:119], v[12:13]
    v_pk_mul_f32 v[120:121], v[120:121], v[12:13]
    v_pk_mul_f32 v[122:123], v[122:123], v[12:13]
    v_cvt_pk_bf16_f32 v156, v116, v117
    v_cvt_pk_bf16_f32 v157, v118, v119
    v_cvt_pk_bf16_f32 v158, v120, v121
    v_cvt_pk_bf16_f32 v159, v122, v123
    s_add_u32 s33, s33, 4096
    buffer_store_dwordx4 v[156:159], v4, s[4:7], s33 offen offset:0 sc1
    s_add_u32 s33, s33, 1163264
    s_add_u32 s36, s36, 3072
    s_lshl_b32 s36, s36, 7
    s_waitcnt vmcnt(0)
    v_cmp_gt_u32 vcc, 18, v14
    s_cbranch_vccz LN1_R
    v_mov_b32 v6, 244
    s_mov_b32 s27, 0
SP_34:
    buffer_load_dword v7, v6, s[8:11], 0 offen sc1
    s_waitcnt vmcnt(0)
    v_cmp_gt_u32 vcc, 18, v7
    s_cbranch_vccz SD_35
    s_add_u32 s27, s27, 1
    s_cmp_lt_u32 s27, 400000
    s_cbranch_scc1 SP_34
    s_movk_i32 s27, 1
    s_branch FAIL
SD_35:
LN1_R:
    v_mov_b32 v7, 1
    s_mov_b64 exec, 1
    buffer_store_dword v7, off, s[4:7], s36 sc1
    s_mov_b64 exec, -1
    s_sub_u32 s35, s26, 24
    s_cbranch_scc0 R_LN2
    s_endpgm
R_LN2:
    s_mov_b32 s20, s64
    s_mov_b32 s21, s65
    s_mov_b32 s22, 0x240000
    s_mov_b32 s23, 0x20000
    s_cmp_eq_u32 s24, 3
    s_cbranch_scc1 LN2_X
    v_and_b32 v7, 15, v1
    v_lshrrev_b32 v6, 4, v1
    v_lshlrev_b32 v6, 2, v6
    v_sub_u32 v7, v7, v6
    v_mov_b32 v5, 0x3f80
    v_mov_b32 v6, 0x3f800000
    v_mov_b32 v10, 0
    v_cmp_eq_u32 vcc, 0, v7
    s_nop 1
    v_cndmask_b32 v10, v10, v5, vcc
    v_cmp_eq_u32 vcc, 1, v7
    s_nop 1
    v_cndmask_b32 v10, v10, v6, vcc
    v_mov_b32 v11, 0
    v_cmp_eq_u32 vcc, 2, v7
    s_nop 1
    v_cndmask_b32 v11, v11, v5, vcc
    v_cmp_eq_u32 vcc, 3, v7
    s_nop 1
    v_cndmask_b32 v11, v11, v6, vcc
    v_and_b32 v7, 7, v1
    v_bfe_u32 v6, v1, 3, 1
    v_lshrrev_b32 v5, 4, v1
    v_mul_u32_u24 v3, 1152, v7
    v_lshl_add_u32 v3, v6, 6, v3
    v_lshl_add_u32 v3, v5, 4, v3
    v_lshl_add_u32 v7, v5, 4, v7
    v_lshlrev_b32 v6, 10, v6
    v_lshl_add_u32 v8, v7, 4, v6
    v_lshl_add_u32 v9, v7, 3, v6
    s_lshr_b32 s40, s35, 2
    s_and_b32 s36, s35, 3
    s_lshr_b32 s37, s36, 1
    s_and_b32 s38, s36, 1
    s_mul_i32 s32, s36, 9216
    s_mul_i32 s33, s24, 384
    s_add_u32 s32, s32, s33
    v_add_u32 v3, s32, v3
    s_mul_i32 s33, s24, 6144
    s_lshl_b32 s34, s38, 7
    s_add_u32 s34, s34, s33
    v_add_u32 v8, s34, v8
    s_lshl_b32 s34, s38, 6
    s_add_u32 s34, s34, s33
    s_add_u32 s34, s34, 4096
    v_add_u32 v9, s34, v9
    s_lshl_b32 s34, s37, 2
    s_add_u32 s34, s34, s24
    s_lshl_b32 s34, s34, 4
    s_add_u32 s34, s34, 3520
    v_min_u32 v4, 15, v1
    v_add_u32 v4, s34, v4
    v_lshlrev_b32 v4, 7, v4
    s_lshl_b32 s45, s40, 1
    s_add_u32 s45, s45, s38
    s_mul_i32 s45, s45, 3
    s_add_u32 s45, s45, s24
    s_lshl_b32 s34, s37, 5
    s_add_u32 s45, s45, s34
    s_add_u32 s45, s45, 3648
    s_lshl_b32 s45, s45, 7
    v_and_b32 v0, 7, v1
    v_lshlrev_b32 v0, 3, v0
    s_lshl_b32 s34, s24, 6
    s_mul_i32 s41, s37, 73728
    s_add_u32 s41, s41, 0x8000000
    s_mul_i32 s42, s37, 18432
    v_mov_b32 v6, 244
    s_mov_b32 s27, 0
SP_36:
    buffer_load_dword v7, v6, s[8:11], 0 offen sc1
    s_waitcnt vmcnt(0)
    v_cmp_gt_u32 vcc, 18, v7
    s_cbranch_vccz SD_37
    s_add_u32 s27, s27, 1
    s_cmp_lt_u32 s27, 400000
    s_cbranch_scc1 SP_36
    s_movk_i32 s27, 1
    s_branch FAIL
SD_37:
    v_add_u32 v6, s34, v0
LN2_L:
    s_mul_i32 s43, s40, 36864
    buffer_load_dwordx4 v[40:43], v3, s[20:23], s43 offen offset:0
    buffer_load_dwordx4 v[44:47], v3, s[20:23], s43 offen offset:128
    buffer_load_dwordx4 v[48:51], v3, s[20:23], s43 offen offset:256
    s_mul_i32 s44, s40, 147456
    s_add_u32 s44, s44, s41
    s_add_u32 s48, s40, 1
    s_mov_b32 s27, 0
    s_cmp_ge_u32 s40, 56
    s_cbranch_scc1 LN2_R
    s_mov_b32 s27, 0
SP_38:
    buffer_load_dword v5, v4, s[4:7], 0 offen sc1
    s_waitcnt vmcnt(0)
    v_cmp_gt_u32 vcc, s48, v5
    s_cbranch_vccz SD_39
    s_cmp_gt_u32 s48, 54
    s_cbranch_scc1 SP_38_n
    s_sleep 16
SP_38_n:
    s_add_u32 s27, s27, 1
    s_cmp_lt_u32 s27, 400000
    s_cbranch_scc1 SP_38
    s_movk_i32 s27, 21
    s_branch FAIL
SD_39:
    s_mov_b32 s48, 0
LN2_R:
    buffer_load_dword v5, v4, s[4:7], 0 offen sc1
    buffer_load_dwordx4 v[52:55], v8, s[4:7], s44 offen offset:0 sc1
    buffer_load_dwordx4 v[56:59], v8, s[4:7], s44 offen offset:2048 sc1
    buffer_load_dwordx2 v[60:61], v9, s[4:7], s44 offen offset:0 sc1
    buffer_load_dwordx2 v[62:63], v9, s[4:7], s44 offen offset:512 sc1
    s_add_u32 s44, s44, 18432
    buffer_load_dwordx4 v[64:67], v8, s[4:7], s44 offen offset:0 sc1
    buffer_load_dwordx4 v[68:71], v8, s[4:7], s44 offen offset:2048 sc1
    buffer_load_dwordx2 v[72:73], v9, s[4:7], s44 offen offset:0 sc1
    buffer_load_dwordx2 v[74:75], v9, s[4:7], s44 offen offset:512 sc1
    s_add_u32 s44, s44, 18432
    buffer_load_dwordx4 v[76:79], v8, s[4:7], s44 offen offset:0 sc1
    buffer_load_dwordx4 v[80:83], v8, s[4:7], s44 offen offset:2048 sc1
    buffer_load_dwordx2 v[84:85], v9, s[4:7], s44 offen offset:0 sc1
    buffer_load_dwordx2 v[86:87], v9, s[4:7], s44 offen offset:512 sc1
    s_add_u32 s44, s44, 18432
    buffer_load_dwordx4 v[88:91], v8, s[4:7], s44 offen offset:0 sc1
    buffer_load_dwordx4 v[92:95], v8, s[4:7], s44 offen offset:2048 sc1
    buffer_load_dwordx2 v[96:97], v9, s[4:7], s44 offen offset:0 sc1
    buffer_load_dwordx2 v[98:99], v9, s[4:7], s44 offen offset:512 sc1
    s_waitcnt vmcnt(19)
    v_mfma_f32_16x16x16_bf16 v[12:15], v[10:11], v[40:41], 0
    v_mfma_f32_16x16x16_bf16 v[16:19], v[10:11], v[42:43], 0
    s_waitcnt vmcnt(18)
    v_mfma_f32_16x16x16_bf16 v[20:23], v[10:11], v[44:45], 0
    v_mfma_f32_16x16x16_bf16 v[24:27], v[10:11], v[46:47], 0
    s_waitcnt vmcnt(17)
    v_mfma_f32_16x16x16_bf16 v[28:31], v[10:11], v[48:49], 0
    v_mfma_f32_16x16x16_bf16 v[32:35], v[10:11], v[50:51], 0
    s_waitcnt vmcnt(15)
    v_mfma_f32_16x16x16_bf16 v[12:15], v[10:11], v[52:53], v[12:15]
    v_mfma_f32_16x16x16_bf16 v[16:19], v[10:11], v[54:55], v[16:19]
    s_waitcnt vmcnt(14)
    v_mfma_f32_16x16x16_bf16 v[20:23], v[10:11], v[56:57], v[20:23]
    v_mfma_f32_16x16x16_bf16 v[24:27], v[10:11], v[58:59], v[24:27]
    s_waitcnt vmcnt(12)
    v_mfma_f32_16x16x16_bf16 v[28:31], v[10:11], v[60:61], v[28:31]
    v_mfma_f32_16x16x16_bf16 v[32:35], v[10:11], v[62:63], v[32:35]
    s_waitcnt vmcnt(11)
    v_mfma_f32_16x16x16_bf16 v[12:15], v[10:11], v[64:65], v[12:15]
    v_mfma_f32_16x16x16_bf16 v[16:19], v[10:11], v[66:67], v[16:19]
    s_waitcnt vmcnt(10)
    v_mfma_f32_16x16x16_bf16 v[20:23], v[10:11], v[68:69], v[20:23]
    v_mfma_f32_16x16x16_bf16 v[24:27], v[10:11], v[70:71], v[24:27]
    s_waitcnt vmcnt(8)
    v_mfma_f32_16x16x16_bf16 v[28:31], v[10:11], v[72:73], v[28:31]
    v_mfma_f32_16x16x16_bf16 v[32:35], v[10:11], v[74:75], v[32:35]
    s_waitcnt vmcnt(7)
    v_mfma_f32_16x16x16_bf16 v[12:15], v[10:11], v[76:77], v[12:15]
    v_mfma_f32_16x16x16_bf16 v[16:19], v[10:11], v[78:79], v[16:19]
    s_waitcnt vmcnt(6)
    v_mfma_f32_16x16x16_bf16 v[20:23], v[10:11], v[80:81], v[20:23]
    v_mfma_f32_16x16x16_bf16 v[24:27], v[10:11], v[82:83], v[24:27]
    s_waitcnt vmcnt(4)
    v_mfma_f32_16x16x16_bf16 v[28:31], v[10:11], v[84:85], v[28:31]
    v_mfma_f32_16x16x16_bf16 v[32:35], v[10:11], v[86:87], v[32:35]
    s_waitcnt vmcnt(3)
    v_mfma_f32_16x16x16_bf16 v[12:15], v[10:11], v[88:89], v[12:15]
    v_mfma_f32_16x16x16_bf16 v[16:19], v[10:11], v[90:91], v[16:19]
    s_waitcnt vmcnt(2)
    v_mfma_f32_16x16x16_bf16 v[20:23], v[10:11], v[92:93], v[20:23]
    v_mfma_f32_16x16x16_bf16 v[24:27], v[10:11], v[94:95], v[24:27]
    s_waitcnt vmcnt(0)
    v_mfma_f32_16x16x16_bf16 v[28:31], v[10:11], v[96:97], v[28:31]
    v_mfma_f32_16x16x16_bf16 v[32:35], v[10:11], v[98:99], v[32:35]
    s_add_u32 s43, s43, s42
    s_add_u32 s44, s43, 0x800000
    s_add_u32 s43, s43, 0xc00000
    s_add_u32 s46, s44, 4096
    s_add_u32 s47, s43, 4096
    v_pk_add_f32 v[52:53], v[12:13], v[18:19]
    v_pk_add_f32 v[54:55], v[14:15], v[20:21]
    v_pk_add_f32 v[56:57], v[16:17], v[22:23]
    v_pk_add_f32 v[52:53], v[52:53], v[24:25]
    v_pk_add_f32 v[54:55], v[54:55], v[26:27]
    v_pk_add_f32 v[56:57], v[56:57], v[28:29]
    v_pk_add_f32 v[52:53], v[52:53], v[30:31]
    v_pk_add_f32 v[54:55], v[54:55], v[32:33]
    v_pk_add_f32 v[56:57], v[56:57], v[34:35]
    v_pk_add_f32 v[52:53], v[52:53], v[54:55]
    v_pk_add_f32 v[52:53], v[52:53], v[56:57]
    v_add_f32 v52, v52, v53
    v_cmp_u_f32 vcc, v52, v52
    s_cbranch_vccz LN2_K
    s_cmp_eq_u32 s48, 0
    s_cbranch_scc1 LN2_K
    s_waitcnt vmcnt(0)
    v_cmp_ge_u32 vcc, s40, v5
    s_or_b32 s48, vcc_lo, vcc_hi
    s_mul_i32 s43, s40, 36864
    s_mul_i32 s44, s40, 147456
    s_add_u32 s44, s44, s41
    s_add_u32 s27, s27, 1
    s_cmp_lt_u32 s27, 400000
    s_cbranch_scc1 LN2_R
    s_movk_i32 s27, 23
    s_branch FAIL
LN2_K:
    v_cvt_pk_bf16_f32 v40, v12, v13
    v_cvt_pk_bf16_f32 v41, v14, v15
    v_cvt_pk_bf16_f32 v42, v16, v17
    v_cvt_pk_bf16_f32 v43, v18, v19
    v_cvt_pk_bf16_f32 v44, v20, v21
    v_cvt_pk_bf16_f32 v45, v22, v23
    v_cvt_pk_bf16_f32 v46, v24, v25
    v_cvt_pk_bf16_f32 v47, v26, v27
    v_cvt_pk_bf16_f32 v48, v28, v29
    v_cvt_pk_bf16_f32 v49, v30, v31
    v_cvt_pk_bf16_f32 v50, v32, v33
    v_cvt_pk_bf16_f32 v51, v34, v35
    v_add_f32_dpp v52, v52, v52 row_ror:8 row_mask:0xf bank_mask:0xf
    v_mov_b32 v53, v52
    s_nop 1
    v_permlane16_swap_b32 v52, v53
    v_add_f32 v52, v52, v53
    v_mov_b32 v53, v52
    s_nop 1
    v_permlane32_swap_b32 v52, v53
    v_add_f32 v52, v52, v53
    v_mul_f32 v60, 0x3baaaaab, v52
    v_mul_f32 v58, 0xbbaaaaab, v52
    v_mov_b32 v59, v58
    v_pk_add_f32 v[12:13], v[12:13], v[58:59]
    v_pk_add_f32 v[14:15], v[14:15], v[58:59]
    v_pk_add_f32 v[16:17], v[16:17], v[58:59]
    v_pk_add_f32 v[18:19], v[18:19], v[58:59]
    v_pk_add_f32 v[20:21], v[20:21], v[58:59]
    v_pk_add_f32 v[22:23], v[22:23], v[58:59]
    v_pk_add_f32 v[24:25], v[24:25], v[58:59]
    v_pk_add_f32 v[26:27], v[26:27], v[58:59]
    v_pk_add_f32 v[28:29], v[28:29], v[58:59]
    v_pk_add_f32 v[30:31], v[30:31], v[58:59]
    v_pk_add_f32 v[32:33], v[32:33], v[58:59]
    v_pk_add_f32 v[34:35], v[34:35], v[58:59]
    v_pk_mul_f32 v[52:53], v[12:13], v[12:13]
    v_pk_mul_f32 v[54:55], v[14:15], v[14:15]
    v_pk_mul_f32 v[56:57], v[16:17], v[16:17]
    v_pk_fma_f32 v[52:53], v[18:19], v[18:19], v[52:53]
    v_pk_fma_f32 v[54:55], v[20:21], v[20:21], v[54:55]
    v_pk_fma_f32 v[56:57], v[22:23], v[22:23], v[56:57]
    v_pk_fma_f32 v[52:53], v[24:25], v[24:25], v[52:53]
    v_pk_fma_f32 v[54:55], v[26:27], v[26:27], v[54:55]
    v_pk_fma_f32 v[56:57], v[28:29], v[28:29], v[56:57]
    v_pk_fma_f32 v[52:53], v[30:31], v[30:31], v[52:53]
    v_pk_fma_f32 v[54:55], v[32:33], v[32:33], v[54:55]
    v_pk_fma_f32 v[56:57], v[34:35], v[34:35], v[56:57]
    v_pk_add_f32 v[52:53], v[52:53], v[54:55]
    v_pk_add_f32 v[52:53], v[52:53], v[56:57]
    v_add_f32 v61, v52, v53
    s_nop 1
    v_add_f32_dpp v61, v61, v61 row_ror:8 row_mask:0xf bank_mask:0xf
    v_mov_b32 v53, v61
    s_nop 1
    v_permlane16_swap_b32 v61, v53
    v_add_f32 v61, v61, v53
    v_mov_b32 v53, v61
    s_nop 1
    v_permlane32_swap_b32 v61, v53
    v_add_f32 v61, v61, v53
    ds_write_b64 v6, v[60:61]
    buffer_store_dwordx4 v[40:43], v8, s[4:7], s44 offen offset:0 sc1
    buffer_store_dwordx4 v[44:47], v8, s[4:7], s44 offen offset:2048 sc1
    buffer_store_dwordx4 v[48:51], v8, s[4:7], s46 offen offset:0 sc1
    s_waitcnt lgkmcnt(0)
    s_barrier
    ds_read_b64 v[52:53], v0 offset:0
    ds_read_b64 v[54:55], v0 offset:64
    ds_read_b64 v[56:57], v0 offset:128
    v_xor_b32 v0, 256, v0
    v_xor_b32 v6, 256, v6
    s_waitcnt lgkmcnt(0)
    v_add_f32 v62, v52, v54
    v_add_f32 v63, v53, v55
    v_add_f32 v62, v62, v56
    v_add_f32 v63, v63, v57
    v_mul_f32 v62, 0x3eaaaaab, v62
    v_mul_f32 v63, 0x3baaaaab, v63
    v_sub_f32 v52, v52, v62
    v_sub_f32 v54, v54, v62
    v_sub_f32 v56, v56, v62
    v_fmac_f32 v63, v52, v52
    v_fmac_f32 v63, v54, v54
    v_fmac_f32 v63, v56, v56
    v_mov_b32 v52, 0x3727c5ac
    v_fmac_f32 v52, 0x3eaaaaab, v63
    v_rsq_f32 v52, v52
    v_sub_f32 v54, v60, v62
    v_mov_b32 v53, v52
    v_mul_f32 v54, v54, v52
    v_mov_b32 v55, v54
    v_pk_fma_f32 v[12:13], v[12:13], v[52:53], v[54:55]
    v_pk_fma_f32 v[14:15], v[14:15], v[52:53], v[54:55]
    v_pk_fma_f32 v[16:17], v[16:17], v[52:53], v[54:55]
    v_pk_fma_f32 v[18:19], v[18:19], v[52:53], v[54:55]
    v_cvt_pk_bf16_f32 v64, v12, v13
    v_cvt_pk_bf16_f32 v65, v14, v15
    v_cvt_pk_bf16_f32 v66, v16, v17
    v_cvt_pk_bf16_f32 v67, v18, v19
    buffer_store_dwordx4 v[64:67], v8, s[4:7], s43 offen offset:0 sc1
    v_pk_fma_f32 v[20:21], v[20:21], v[52:53], v[54:55]
    v_pk_fma_f32 v[22:23], v[22:23], v[52:53], v[54:55]
    v_pk_fma_f32 v[24:25], v[24:25], v[52:53], v[54:55]
    v_pk_fma_f32 v[26:27], v[26:27], v[52:53], v[54:55]
    v_cvt_pk_bf16_f32 v68, v20, v21
    v_cvt_pk_bf16_f32 v69, v22, v23
    v_cvt_pk_bf16_f32 v70, v24, v25
    v_cvt_pk_bf16_f32 v71, v26, v27
    buffer_store_dwordx4 v[68:71], v8, s[4:7], s43 offen offset:2048 sc1
    v_pk_fma_f32 v[28:29], v[28:29], v[52:53], v[54:55]
    v_pk_fma_f32 v[30:31], v[30:31], v[52:53], v[54:55]
    v_pk_fma_f32 v[32:33], v[32:33], v[52:53], v[54:55]
    v_pk_fma_f32 v[34:35], v[34:35], v[52:53], v[54:55]
    v_cvt_pk_bf16_f32 v72, v28, v29
    v_cvt_pk_bf16_f32 v73, v30, v31
    v_cvt_pk_bf16_f32 v74, v32, v33
    v_cvt_pk_bf16_f32 v75, v34, v35
    buffer_store_dwordx4 v[72:75], v8, s[4:7], s47 offen offset:0 sc1
    s_add_u32 s40, s40, 2
    s_waitcnt vmcnt(0)
    v_mov_b32 v7, s40
    s_mov_b64 exec, 1
    buffer_store_dword v7, off, s[4:7], s45 sc1
    s_mov_b64 exec, -1
    s_cmp_lt_u32 s40, 64
    s_cbranch_scc1 LN2_L
    s_branch LN2_Z
LN2_X:
    s_lshr_b32 s40, s35, 2
    s_and_b32 s36, s35, 3
    s_mul_i32 s36, s36, 9216
    v_lshlrev_b32 v3, 7, v1
    v_add_u32 v3, s36, v3
    v_add_u32 v4, 1024, v3
LN2_Y:
    s_add_u32 s40, s40, 2
    s_min_u32 s43, s40, 63
    s_mul_i32 s43, s43, 36864
    buffer_load_dword v5, v3, s[20:23], s43 offen
    buffer_load_dword v6, v4, s[20:23], s43 offen
    s_barrier
    s_waitcnt vmcnt(0)
    s_cmp_lt_u32 s40, 64
    s_cbranch_scc1 LN2_Y
    s_branch EXIT
LN2_Z:
    s_endpgm
R_AM:
    s_mov_b32 s16, s70
    s_mov_b32 s17, s71
    s_mov_b32 s18, 0x480000
    s_mov_b32 s19, 0x20000
    s_mov_b32 s20, s72
    s_mov_b32 s21, s73
    s_mov_b32 s22, 0x480000
    s_mov_b32 s23, 0x20000
    v_lshlrev_b32 v0, 4, v1
    s_lshl_b32 s36, s35, 2
    s_add_u32 s36, s36, s24
    s_mul_i32 s30, s24, 36864
    v_lshrrev_b32 v7, 2, v1
    v_and_b32 v5, 3, v1
    v_lshlrev_b32 v8, 13, v7
    v_lshl_add_u32 v8, v5, 4, v8
    s_lshl_b32 s33, s36, 6
    v_add_u32 v8, s33, v8
    s_mov_b32 s51, 0xff81ff81
    v_mov_b32 v16, s51
    v_mov_b32 v17, s51
    v_mov_b32 v18, s51
    v_mov_b32 v19, s51
    s_mul_i32 s33, s36, 4608
    s_add_u32 s33, s33, 0x300000
    buffer_store_dwordx4 v[16:19], v0, s[4:7], s33 offen offset:0 sc1
    buffer_store_dwordx4 v[16:19], v0, s[4:7], s33 offen offset:1024 sc1
    buffer_store_dwordx4 v[16:19], v0, s[4:7], s33 offen offset:2048 sc1
    buffer_store_dwordx4 v[16:19], v0, s[4:7], s33 offen offset:3072 sc1
    buffer_store_dwordx4 v[16:19], v0, s[4:7], s33 offen offset:3584 sc1
    s_add_u32 m0, s30, 0
    s_xor_b32 s31, s24, 0
    s_lshl_b32 s31, s31, 19
    buffer_load_dwordx4 v8, s[16:19], s31 offen lds
    s_add_u32 m0, s30, 1024
    s_add_u32 s31, s31, 131072
    buffer_load_dwordx4 v8, s[16:19], s31 offen lds
    s_add_u32 m0, s30, 2048
    s_add_u32 s31, s31, 131072
    buffer_load_dwordx4 v8, s[16:19], s31 offen lds
    s_add_u32 m0, s30, 3072
    s_add_u32 s31, s31, 131072
    buffer_load_dwordx4 v8, s[16:19], s31 offen lds
    s_add_u32 m0, s30, 4096
    s_xor_b32 s31, s24, 1
    s_lshl_b32 s31, s31, 19
    buffer_load_dwordx4 v8, s[16:19], s31 offen lds
    s_add_u32 m0, s30, 5120
    s_add_u32 s31, s31, 131072
    buffer_load_dwordx4 v8, s[16:19], s31 offen lds
    s_add_u32 m0, s30, 6144
    s_add_u32 s31, s31, 131072
    buffer_load_dwordx4 v8, s[16:19], s31 offen lds
    s_add_u32 m0, s30, 7168
    s_add_u32 s31, s31, 131072
    buffer_load_dwordx4 v8, s[16:19], s31 offen lds
    s_add_u32 m0, s30, 8192
    s_xor_b32 s31, s24, 2
    s_lshl_b32 s31, s31, 19
    buffer_load_dwordx4 v8, s[16:19], s31 offen lds
    s_add_u32 m0, s30, 9216
    s_add_u32 s31, s31, 131072
    buffer_load_dwordx4 v8, s[16:19], s31 offen lds
    s_add_u32 m0, s30, 10240
    s_add_u32 s31, s31, 131072
    buffer_load_dwordx4 v8, s[16:19], s31 offen lds
    s_add_u32 m0, s30, 11264
    s_add_u32 s31, s31, 131072
    buffer_load_dwordx4 v8, s[16:19], s31 offen lds
    s_add_u32 m0, s30, 12288
    s_xor_b32 s31, s24, 3
    s_lshl_b32 s31, s31, 19
    buffer_load_dwordx4 v8, s[16:19], s31 offen lds
    s_add_u32 m0, s30, 13312
    s_add_u32 s31, s31, 131072
    buffer_load_dwordx4 v8, s[16:19], s31 offen lds
    s_add_u32 m0, s30, 14336
    s_add_u32 s31, s31, 131072
    buffer_load_dwordx4 v8, s[16:19], s31 offen lds
    s_add_u32 m0, s30, 15360
    s_add_u32 s31, s31, 131072
    buffer_load_dwordx4 v8, s[16:19], s31 offen lds
    s_add_u32 m0, s30, 16384
    s_xor_b32 s31, s24, 4
    s_lshl_b32 s31, s31, 19
    buffer_load_dwordx4 v8, s[16:19], s31 offen lds
    s_add_u32 m0, s30, 17408
    s_add_u32 s31, s31, 131072
    buffer_load_dwordx4 v8, s[16:19], s31 offen lds
    s_add_u32 m0, s30, 18432
    s_add_u32 s31, s31, 131072
    buffer_load_dwordx4 v8, s[16:19], s31 offen lds
    s_add_u32 m0, s30, 19456
    s_add_u32 s31, s31, 131072
    buffer_load_dwordx4 v8, s[16:19], s31 offen lds
    s_add_u32 m0, s30, 20480
    s_xor_b32 s31, s24, 5
    s_lshl_b32 s31, s31, 19
    buffer_load_dwordx4 v8, s[16:19], s31 offen lds
    s_add_u32 m0, s30, 21504
    s_add_u32 s31, s31, 131072
    buffer_load_dwordx4 v8, s[16:19], s31 offen lds
    s_add_u32 m0, s30, 22528
    s_add_u32 s31, s31, 131072
    buffer_load_dwordx4 v8, s[16:19], s31 offen lds
    s_add_u32 m0, s30, 23552
    s_add_u32 s31, s31, 131072
    buffer_load_dwordx4 v8, s[16:19], s31 offen lds
    s_add_u32 m0, s30, 24576
    s_xor_b32 s31, s24, 6
    s_lshl_b32 s31, s31, 19
    buffer_load_dwordx4 v8, s[16:19], s31 offen lds
    s_add_u32 m0, s30, 25600
    s_add_u32 s31, s31, 131072
    buffer_load_dwordx4 v8, s[16:19], s31 offen lds
    s_add_u32 m0, s30, 26624
    s_add_u32 s31, s31, 131072
    buffer_load_dwordx4 v8, s[16:19], s31 offen lds
    s_add_u32 m0, s30, 27648
    s_add_u32 s31, s31, 131072
    buffer_load_dwordx4 v8, s[16:19], s31 offen lds
    s_add_u32 m0, s30, 28672
    s_xor_b32 s31, s24, 7
    s_lshl_b32 s31, s31, 19
    buffer_load_dwordx4 v8, s[16:19], s31 offen lds
    s_add_u32 m0, s30, 29696
    s_add_u32 s31, s31, 131072
    buffer_load_dwordx4 v8, s[16:19], s31 offen lds
    s_add_u32 m0, s30, 30720
    s_add_u32 s31, s31, 131072
    buffer_load_dwordx4 v8, s[16:19], s31 offen lds
    s_add_u32 m0, s30, 31744
    s_add_u32 s31, s31, 131072
    buffer_load_dwordx4 v8, s[16:19], s31 offen lds
    s_add_u32 m0, s30, 32768
    s_mov_b32 s31, 4194304
    buffer_load_dwordx4 v8, s[16:19], s31 offen lds
    s_add_u32 m0, s30, 33792
    s_add_u32 s31, s31, 131072
    buffer_load_dwordx4 v8, s[16:19], s31 offen lds
    s_add_u32 m0, s30, 34816
    s_add_u32 s31, s31, 131072
    buffer_load_dwordx4 v8, s[16:19], s31 offen lds
    s_add_u32 m0, s30, 35840
    s_add_u32 s31, s31, 131072
    buffer_load_dwordx4 v8, s[16:19], s31 offen lds
    v_lshrrev_b32 v3, 5, v1
    v_bfe_u32 v4, v1, 4, 1
    v_lshl_add_u32 v9, v3, 3, v4
    v_and_b32 v7, 3, v7
    v_lshl_add_u32 v9, v7, 1, v9
    v_lshlrev_b32 v9, 7, v9
    v_lshl_add_u32 v9, v5, 3, v9
    v_add_u32 v9, s30, v9
    s_waitcnt vmcnt(36)
    s_barrier
    s_cmp_lg_u32 s24, 0
    s_cbranch_scc1 AM_NA
    v_mov_b32 v3, 1
    v_mov_b32 v7, 36
    s_mov_b64 exec, 1
    buffer_atomic_add v3, v7, s[8:11], 0 offen sc1
    s_mov_b64 exec, -1
AM_NA:
    s_waitcnt vmcnt(32)
    ds_read_b64_tr_b16 a[0:1], v9 offset:0
    ds_read_b64_tr_b16 a[2:3], v9 offset:64
    ds_read_b64_tr_b16 a[4:5], v9 offset:2048
    ds_read_b64_tr_b16 a[6:7], v9 offset:2112
    ds_read_b64_tr_b16 a[8:9], v9 offset:32
    ds_read_b64_tr_b16 a[10:11], v9 offset:96
    ds_read_b64_tr_b16 a[12:13], v9 offset:2080
    ds_read_b64_tr_b16 a[14:15], v9 offset:2144
    s_waitcnt lgkmcnt(0)
    s_add_u32 m0, s30, 0
    s_xor_b32 s31, s24, 0
    s_lshl_b32 s31, s31, 19
    buffer_load_dwordx4 v8, s[20:23], s31 offen lds
    s_add_u32 m0, s30, 1024
    s_add_u32 s31, s31, 131072
    buffer_load_dwordx4 v8, s[20:23], s31 offen lds
    s_add_u32 m0, s30, 2048
    s_add_u32 s31, s31, 131072
    buffer_load_dwordx4 v8, s[20:23], s31 offen lds
    s_add_u32 m0, s30, 3072
    s_add_u32 s31, s31, 131072
    buffer_load_dwordx4 v8, s[20:23], s31 offen lds
    s_waitcnt vmcnt(32)
    ds_read_b64_tr_b16 a[16:17], v9 offset:4096
    ds_read_b64_tr_b16 a[18:19], v9 offset:4160
    ds_read_b64_tr_b16 a[20:21], v9 offset:6144
    ds_read_b64_tr_b16 a[22:23], v9 offset:6208
    ds_read_b64_tr_b16 a[24:25], v9 offset:4128
    ds_read_b64_tr_b16 a[26:27], v9 offset:4192
    ds_read_b64_tr_b16 a[28:29], v9 offset:6176
    ds_read_b64_tr_b16 a[30:31], v9 offset:6240
    s_waitcnt lgkmcnt(0)
    s_add_u32 m0, s30, 4096
    s_xor_b32 s31, s24, 1
    s_lshl_b32 s31, s31, 19
    buffer_load_dwordx4 v8, s[20:23], s31 offen lds
    s_add_u32 m0, s30, 5120
    s_add_u32 s31, s31, 131072
    buffer_load_dwordx4 v8, s[20:23], s31 offen lds
    s_add_u32 m0, s30, 6144
    s_add_u32 s31, s31, 131072
    buffer_load_dwordx4 v8, s[20:23], s31 offen lds
    s_add_u32 m0, s30, 7168
    s_add_u32 s31, s31, 131072
    buffer_load_dwordx4 v8, s[20:23], s31 offen lds
    s_waitcnt vmcnt(32)
    ds_read_b64_tr_b16 a[32:33], v9 offset:8192
    ds_read_b64_tr_b16 a[34:35], v9 offset:8256
    ds_read_b64_tr_b16 a[36:37], v9 offset:10240
    ds_read_b64_tr_b16 a[38:39], v9 offset:10304
    ds_read_b64_tr_b16 a[40:41], v9 offset:8224
    ds_read_b64_tr_b16 a[42:43], v9 offset:8288
    ds_read_b64_tr_b16 a[44:45], v9 offset:10272
    ds_read_b64_tr_b16 a[46:47], v9 offset:10336
    s_waitcnt lgkmcnt(0)
    s_add_u32 m0, s30, 8192
    s_xor_b32 s31, s24, 2
    s_lshl_b32 s31, s31, 19
    buffer_load_dwordx4 v8, s[20:23], s31 offen lds
    s_add_u32 m0, s30, 9216
    s_add_u32 s31, s31, 131072
    buffer_load_dwordx4 v8, s[20:23], s31 offen lds
    s_add_u32 m0, s30, 10240
    s_add_u32 s31, s31, 131072
    buffer_load_dwordx4 v8, s[20:23], s31 offen lds
    s_add_u32 m0, s30, 11264
    s_add_u32 s31, s31, 131072
    buffer_load_dwordx4 v8, s[20:23], s31 offen lds
    s_waitcnt vmcnt(32)
    ds_read_b64_tr_b16 a[48:49], v9 offset:12288
    ds_read_b64_tr_b16 a[50:51], v9 offset:12352
    ds_read_b64_tr_b16 a[52:53], v9 offset:14336
    ds_read_b64_tr_b16 a[54:55], v9 offset:14400
    ds_read_b64_tr_b16 a[56:57], v9 offset:12320
    ds_read_b64_tr_b16 a[58:59], v9 offset:12384
    ds_read_b64_tr_b16 a[60:61], v9 offset:14368
    ds_read_b64_tr_b16 a[62:63], v9 offset:14432
    s_waitcnt lgkmcnt(0)
    s_add_u32 m0, s30, 12288
    s_xor_b32 s31, s24, 3
    s_lshl_b32 s31, s31, 19
    buffer_load_dwordx4 v8, s[20:23], s31 offen lds
    s_add_u32 m0, s30, 13312
    s_add_u32 s31, s31, 131072
    buffer_load_dwordx4 v8, s[20:23], s31 offen lds
    s_add_u32 m0, s30, 14336
    s_add_u32 s31, s31, 131072
    buffer_load_dwordx4 v8, s[20:23], s31 offen lds
    s_add_u32 m0, s30, 15360
    s_add_u32 s31, s31, 131072
    buffer_load_dwordx4 v8, s[20:23], s31 offen lds
    s_waitcnt vmcnt(32)
    ds_read_b64_tr_b16 a[64:65], v9 offset:16384
    ds_read_b64_tr_b16 a[66:67], v9 offset:16448
    ds_read_b64_tr_b16 a[68:69], v9 offset:18432
    ds_read_b64_tr_b16 a[70:71], v9 offset:18496
    ds_read_b64_tr_b16 a[72:73], v9 offset:16416
    ds_read_b64_tr_b16 a[74:75], v9 offset:16480
    ds_read_b64_tr_b16 a[76:77], v9 offset:18464
    ds_read_b64_tr_b16 a[78:79], v9 offset:18528
    s_waitcnt lgkmcnt(0)
    s_add_u32 m0, s30, 16384
    s_xor_b32 s31, s24, 4
    s_lshl_b32 s31, s31, 19
    buffer_load_dwordx4 v8, s[20:23], s31 offen lds
    s_add_u32 m0, s30, 17408
    s_add_u32 s31, s31, 131072
    buffer_load_dwordx4 v8, s[20:23], s31 offen lds
    s_add_u32 m0, s30, 18432
    s_add_u32 s31, s31, 131072
    buffer_load_dwordx4 v8, s[20:23], s31 offen lds
    s_add_u32 m0, s30, 19456
    s_add_u32 s31, s31, 131072
    buffer_load_dwordx4 v8, s[20:23], s31 offen lds
    s_waitcnt vmcnt(32)
    ds_read_b64_tr_b16 a[80:81], v9 offset:20480
    ds_read_b64_tr_b16 a[82:83], v9 offset:20544
    ds_read_b64_tr_b16 a[84:85], v9 offset:22528
    ds_read_b64_tr_b16 a[86:87], v9 offset:22592
    ds_read_b64_tr_b16 a[88:89], v9 offset:20512
    ds_read_b64_tr_b16 a[90:91], v9 offset:20576
    ds_read_b64_tr_b16 a[92:93], v9 offset:22560
    ds_read_b64_tr_b16 a[94:95], v9 offset:22624
    s_waitcnt lgkmcnt(0)
    s_add_u32 m0, s30, 20480
    s_xor_b32 s31, s24, 5
    s_lshl_b32 s31, s31, 19
    buffer_load_dwordx4 v8, s[20:23], s31 offen lds
    s_add_u32 m0, s30, 21504
    s_add_u32 s31, s31, 131072
    buffer_load_dwordx4 v8, s[20:23], s31 offen lds
    s_add_u32 m0, s30, 22528
    s_add_u32 s31, s31, 131072
    buffer_load_dwordx4 v8, s[20:23], s31 offen lds
    s_add_u32 m0, s30, 23552
    s_add_u32 s31, s31, 131072
    buffer_load_dwordx4 v8, s[20:23], s31 offen lds
    s_waitcnt vmcnt(32)
    ds_read_b64_tr_b16 a[96:97], v9 offset:24576
    ds_read_b64_tr_b16 a[98:99], v9 offset:24640
    ds_read_b64_tr_b16 a[100:101], v9 offset:26624
    ds_read_b64_tr_b16 a[102:103], v9 offset:26688
    ds_read_b64_tr_b16 a[104:105], v9 offset:24608
    ds_read_b64_tr_b16 a[106:107], v9 offset:24672
    ds_read_b64_tr_b16 a[108:109], v9 offset:26656
    ds_read_b64_tr_b16 a[110:111], v9 offset:26720
    s_waitcnt lgkmcnt(0)
    s_add_u32 m0, s30, 24576
    s_xor_b32 s31, s24, 6
    s_lshl_b32 s31, s31, 19
    buffer_load_dwordx4 v8, s[20:23], s31 offen lds
    s_add_u32 m0, s30, 25600
    s_add_u32 s31, s31, 131072
    buffer_load_dwordx4 v8, s[20:23], s31 offen lds
    s_add_u32 m0, s30, 26624
    s_add_u32 s31, s31, 131072
    buffer_load_dwordx4 v8, s[20:23], s31 offen lds
    s_add_u32 m0, s30, 27648
    s_add_u32 s31, s31, 131072
    buffer_load_dwordx4 v8, s[20:23], s31 offen lds
    s_waitcnt vmcnt(32)
    ds_read_b64_tr_b16 a[112:113], v9 offset:28672
    ds_read_b64_tr_b16 a[114:115], v9 offset:28736
    ds_read_b64_tr_b16 a[116:117], v9 offset:30720
    ds_read_b64_tr_b16 a[118:119], v9 offset:30784
    ds_read_b64_tr_b16 a[120:121], v9 offset:28704
    ds_read_b64_tr_b16 a[122:123], v9 offset:28768
    ds_read_b64_tr_b16 a[124:125], v9 offset:30752
    ds_read_b64_tr_b16 a[126:127], v9 offset:30816
    s_waitcnt lgkmcnt(0)
    s_add_u32 m0, s30, 28672
    s_xor_b32 s31, s24, 7
    s_lshl_b32 s31, s31, 19
    buffer_load_dwordx4 v8, s[20:23], s31 offen lds
    s_add_u32 m0, s30, 29696
    s_add_u32 s31, s31, 131072
    buffer_load_dwordx4 v8, s[20:23], s31 offen lds
    s_add_u32 m0, s30, 30720
    s_add_u32 s31, s31, 131072
    buffer_load_dwordx4 v8, s[20:23], s31 offen lds
    s_add_u32 m0, s30, 31744
    s_add_u32 s31, s31, 131072
    buffer_load_dwordx4 v8, s[20:23], s31 offen lds
    s_waitcnt vmcnt(32)
    ds_read_b64_tr_b16 a[128:129], v9 offset:32768
    ds_read_b64_tr_b16 a[130:131], v9 offset:32832
    ds_read_b64_tr_b16 a[132:133], v9 offset:34816
    ds_read_b64_tr_b16 a[134:135], v9 offset:34880
    ds_read_b64_tr_b16 a[136:137], v9 offset:32800
    ds_read_b64_tr_b16 a[138:139], v9 offset:32864
    ds_read_b64_tr_b16 a[140:141], v9 offset:34848
    ds_read_b64_tr_b16 a[142:143], v9 offset:34912
    s_waitcnt lgkmcnt(0)
    s_add_u32 m0, s30, 32768
    s_mov_b32 s31, 4194304
    buffer_load_dwordx4 v8, s[20:23], s31 offen lds
    s_add_u32 m0, s30, 33792
    s_add_u32 s31, s31, 131072
    buffer_load_dwordx4 v8, s[20:23], s31 offen lds
    s_add_u32 m0, s30, 34816
    s_add_u32 s31, s31, 131072
    buffer_load_dwordx4 v8, s[20:23], s31 offen lds
    s_add_u32 m0, s30, 35840
    s_add_u32 s31, s31, 131072
    buffer_load_dwordx4 v8, s[20:23], s31 offen lds
    s_waitcnt vmcnt(32)
    ds_read_b64_tr_b16 a[144:145], v9 offset:0
    ds_read_b64_tr_b16 a[146:147], v9 offset:64
    ds_read_b64_tr_b16 a[148:149], v9 offset:2048
    ds_read_b64_tr_b16 a[150:151], v9 offset:2112
    ds_read_b64_tr_b16 a[152:153], v9 offset:32
    ds_read_b64_tr_b16 a[154:155], v9 offset:96
    ds_read_b64_tr_b16 a[156:157], v9 offset:2080
    ds_read_b64_tr_b16 a[158:159], v9 offset:2144
    s_waitcnt vmcnt(28)
    ds_read_b64_tr_b16 a[160:161], v9 offset:4096
    ds_read_b64_tr_b16 a[162:163], v9 offset:4160
    ds_read_b64_tr_b16 a[164:165], v9 offset:6144
    ds_read_b64_tr_b16 a[166:167], v9 offset:6208
    ds_read_b64_tr_b16 a[168:169], v9 offset:4128
    ds_read_b64_tr_b16 a[170:171], v9 offset:4192
    ds_read_b64_tr_b16 a[172:173], v9 offset:6176
    ds_read_b64_tr_b16 a[174:175], v9 offset:6240
    s_waitcnt vmcnt(24)
    ds_read_b64_tr_b16 a[176:177], v9 offset:8192
    ds_read_b64_tr_b16 a[178:179], v9 offset:8256
    ds_read_b64_tr_b16 a[180:181], v9 offset:10240
    ds_read_b64_tr_b16 a[182:183], v9 offset:10304
    ds_read_b64_tr_b16 a[184:185], v9 offset:8224
    ds_read_b64_tr_b16 a[186:187], v9 offset:8288
    ds_read_b64_tr_b16 a[188:189], v9 offset:10272
    ds_read_b64_tr_b16 a[190:191], v9 offset:10336
    s_waitcnt vmcnt(20)
    ds_read_b64_tr_b16 a[192:193], v9 offset:12288
    ds_read_b64_tr_b16 a[194:195], v9 offset:12352
    ds_read_b64_tr_b16 a[196:197], v9 offset:14336
    ds_read_b64_tr_b16 a[198:199], v9 offset:14400
    ds_read_b64_tr_b16 a[200:201], v9 offset:12320
    ds_read_b64_tr_b16 a[202:203], v9 offset:12384
    ds_read_b64_tr_b16 a[204:205], v9 offset:14368
    ds_read_b64_tr_b16 a[206:207], v9 offset:14432
    s_waitcnt vmcnt(16)
    ds_read_b64_tr_b16 a[208:209], v9 offset:16384
    ds_read_b64_tr_b16 a[210:211], v9 offset:16448
    ds_read_b64_tr_b16 a[212:213], v9 offset:18432
    ds_read_b64_tr_b16 a[214:215], v9 offset:18496
    ds_read_b64_tr_b16 a[216:217], v9 offset:16416
    ds_read_b64_tr_b16 a[218:219], v9 offset:16480
    ds_read_b64_tr_b16 a[220:221], v9 offset:18464
    ds_read_b64_tr_b16 a[222:223], v9 offset:18528
    s_waitcnt vmcnt(12)
    ds_read_b64_tr_b16 a[224:225], v9 offset:20480
    ds_read_b64_tr_b16 a[226:227], v9 offset:20544
    ds_read_b64_tr_b16 a[228:229], v9 offset:22528
    ds_read_b64_tr_b16 a[230:231], v9 offset:22592
    ds_read_b64_tr_b16 a[232:233], v9 offset:20512
    ds_read_b64_tr_b16 a[234:235], v9 offset:20576
    ds_read_b64_tr_b16 a[236:237], v9 offset:22560
    ds_read_b64_tr_b16 a[238:239], v9 offset:22624
    s_waitcnt vmcnt(8)
    ds_read_b64_tr_b16 a[240:241], v9 offset:24576
    ds_read_b64_tr_b16 a[242:243], v9 offset:24640
    ds_read_b64_tr_b16 a[244:245], v9 offset:26624
    ds_read_b64_tr_b16 a[246:247], v9 offset:26688
    ds_read_b64_tr_b16 a[248:249], v9 offset:24608
    ds_read_b64_tr_b16 a[250:251], v9 offset:24672
    ds_read_b64_tr_b16 a[252:253], v9 offset:26656
    ds_read_b64_tr_b16 a[254:255], v9 offset:26720
    s_waitcnt vmcnt(4)
    ds_read_b64_tr_b16 v[224:225], v9 offset:28672
    ds_read_b64_tr_b16 v[226:227], v9 offset:28736
    ds_read_b64_tr_b16 v[228:229], v9 offset:30720
    ds_read_b64_tr_b16 v[230:231], v9 offset:30784
    ds_read_b64_tr_b16 v[232:233], v9 offset:28704
    ds_read_b64_tr_b16 v[234:235], v9 offset:28768
    ds_read_b64_tr_b16 v[236:237], v9 offset:30752
    ds_read_b64_tr_b16 v[238:239], v9 offset:30816
    s_waitcnt vmcnt(0)
    ds_read_b64_tr_b16 v[240:241], v9 offset:32768
    ds_read_b64_tr_b16 v[242:243], v9 offset:32832
    ds_read_b64_tr_b16 v[244:245], v9 offset:34816
    ds_read_b64_tr_b16 v[246:247], v9 offset:34880
    ds_read_b64_tr_b16 v[248:249], v9 offset:32800
    ds_read_b64_tr_b16 v[250:251], v9 offset:32864
    ds_read_b64_tr_b16 v[252:253], v9 offset:34848
    ds_read_b64_tr_b16 v[254:255], v9 offset:34912
    v_and_b32 v7, 8, v1
    v_mov_b32 v6, 0x4444
    v_mov_b32 v3, 0xeeee
    v_cmp_ne_u32 vcc, 0, v7
    s_nop 1
    v_cndmask_b32 v6, v6, v3, vcc
    v_and_b32 v7, 7, v1
    v_lshlrev_b32 v4, 2, v4
    v_sub_u32 v7, v7, v4
    v_mov_b32 v5, 0x3f80
    v_mov_b32 v4, 0x3f800000
    v_mov_b32 v10, 0
    v_cmp_eq_u32 vcc, 0, v7
    s_nop 1
    v_cndmask_b32 v10, v10, v5, vcc
    v_cmp_eq_u32 vcc, 1, v7
    s_nop 1
    v_cndmask_b32 v10, v10, v4, vcc
    v_mov_b32 v11, 0
    v_cmp_eq_u32 vcc, 2, v7
    s_nop 1
    v_cndmask_b32 v11, v11, v5, vcc
    v_cmp_eq_u32 vcc, 3, v7
    s_nop 1
    v_cndmask_b32 v11, v11, v4, vcc
    v_and_b32 v7, 15, v1
    v_lshrrev_b32 v5, 4, v1
    v_lshlrev_b32 v5, 2, v5
    v_sub_u32 v7, v7, v5
    v_cmp_le_i32 s[52:53], 0, v7
    v_cmp_le_i32 s[54:55], 1, v7
    v_cmp_le_i32 s[56:57], 2, v7
    v_cmp_le_i32 s[58:59], 3, v7
    v_mov_b32 v3, 0xceabfb8f
    v_mov_b32 v134, 0
    v_mov_b32 v135, 0
    s_mov_b32 s50, 0x3e0293ee
    s_add_u32 s45, s36, 3392
    s_lshl_b32 s45, s45, 7
    s_lshl_b32 s41, s35, 21
    s_lshl_b32 s33, s24, 11
    s_add_u32 s41, s41, s33
    s_add_u32 s41, s41, 0x1000000
    s_add_u32 s46, s33, 8192
    s_lshl_b32 s42, s36, 10
    s_and_b32 s37, s24, 1
    s_lshl_b32 s33, s37, 17
    s_add_u32 s42, s42, s33
    s_add_u32 s42, s42, 0x5000000
    s_lshl_b32 s43, s24, 10
    v_add_u32 v8, s43, v0
    v_add_u32 v17, s43, v8
    v_xor_b32 v14, 1024, v8
    v_xor_b32 v18, 2048, v17
    v_xor_b32 v15, 2048, v8
    v_xor_b32 v19, 4096, v17
    v_xor_b32 v16, 3072, v8
    v_xor_b32 v20, 6144, v17
    s_mov_b32 s43, 0x300000
    s_and_b32 s44, s35, 8
    s_mul_i32 s44, s44, 3
    s_add_u32 s44, s44, s35
    s_and_b32 s44, s44, 0x27
    s_lshl_b32 s33, s24, 3
    s_add_u32 s44, s44, s33
    s_lshl_b32 s44, s44, 7
    s_mov_b32 s40, 0
    s_waitcnt lgkmcnt(0)
    v_and_b32 v9, 0x300, v0
    v_and_b32 v4, 7, v1
    v_lshl_add_u32 v9, v4, 5, v9
    v_and_b32 v4, 8, v1
    v_lshl_add_u32 v9, v4, 1, v9
    v_mov_b32 v4, 244
    s_mov_b32 s27, 0
SP_40:
    buffer_load_dword v5, v4, s[8:11], 0 offen sc1
    s_waitcnt vmcnt(0)
    v_cmp_gt_u32 vcc, 18, v5
    s_cbranch_vccz SD_41
    s_add_u32 s27, s27, 1
    s_cmp_lt_u32 s27, 400000
    s_cbranch_scc1 SP_40
    s_movk_i32 s27, 1
    s_branch FAIL
SD_41:
    v_mov_b32 v4, 36
    s_mov_b32 s27, 0
SP_42:
    buffer_load_ushort v5, v4, s[8:11], 0 offen sc1
    s_waitcnt vmcnt(0)
    v_cmp_gt_u32 vcc, 64, v5
    s_cbranch_vccz SD_43
    s_add_u32 s27, s27, 1
    s_cmp_lt_u32 s27, 400000
    s_cbranch_scc1 SP_42
    s_movk_i32 s27, 25
    s_branch FAIL
SD_43:
    v_and_b32 v4, 0x23, v1
    v_lshlrev_b32 v4, 2, v4
    s_lshl_b32 s33, s35, 8
    s_add_u32 s33, s33, 425984
    s_mov_b32 s27, 0
SP_44:
    buffer_load_dword v5, v4, s[4:7], s33 offen sc1
    s_waitcnt vmcnt(0)
    v_cmp_gt_u32 vcc, 2, v5
    s_cbranch_vccz SD_45
    s_add_u32 s27, s27, 1
    s_cmp_lt_u32 s27, 400000
    s_cbranch_scc1 SP_44
    s_movk_i32 s27, 24
    s_branch FAIL
SD_45:
    v_mov_b32 v4, s44
    s_barrier
    s_add_u32 s47, s41, s46
    s_lshl_b32 m0, s24, 11
    s_nop 0
    buffer_load_dwordx4 v0, s[4:7], s41 offen offset:0 sc1 lds
    buffer_load_dwordx4 v0, s[4:7], s41 offen offset:1024 sc1 lds
    s_add_u32 m0, m0, 8192
    s_xor_b32 s48, s47, 4096
    buffer_load_dwordx4 v0, s[4:7], s47 offen offset:0 sc1 lds
    buffer_load_dwordx4 v0, s[4:7], s47 offen offset:1024 sc1 lds
    buffer_load_dwordx4 v[72:75], v0, s[4:7], s47 offen offset:2048 sc1
    buffer_load_dwordx4 v[76:79], v0, s[4:7], s47 offen offset:3072 sc1
    buffer_load_dwordx4 v[80:83], v0, s[4:7], s48 offen offset:2048 sc1
    buffer_load_dwordx4 v[84:87], v0, s[4:7], s48 offen offset:3072 sc1
    s_add_u32 s41, s41, 32768
    s_lshl_b32 s47, s24, 10
    s_add_u32 s47, s47, s43
    s_add_u32 s48, s47, 4096
    buffer_load_dwordx4 v[212:215], v9, s[4:7], s47 offen sc1
    s_add_u32 s47, s43, 8192
    buffer_load_dwordx4 v[216:219], v9, s[4:7], s48 offen sc1
    buffer_load_dwordx4 v[220:223], v9, s[4:7], s47 offen sc1
    s_waitcnt vmcnt(0)
    s_cmp_eq_u32 s37, 0
    s_cbranch_scc1 AM0_L
AM1_L:
    s_barrier
    ds_read_b128 v[24:27], v17 offset:1024
    ds_read_b128 v[40:43], v17 offset:8192
    ds_read_b128 v[44:47], v17 offset:9216
    ds_read_b128 v[28:31], v18 offset:1024
    ds_read_b128 v[48:51], v18 offset:8192
    ds_read_b128 v[52:55], v18 offset:9216
    ds_read_b128 v[32:35], v19 offset:1024
    ds_read_b128 v[56:59], v19 offset:8192
    ds_read_b128 v[60:63], v19 offset:9216
    ds_read_b128 v[36:39], v20 offset:1024
    ds_read_b128 v[64:67], v20 offset:8192
    ds_read_b128 v[68:71], v20 offset:9216
    v_mov_b64 v[152:153], 0
    v_mov_b64 v[154:155], 0
    v_mov_b64 v[156:157], 0
    v_mov_b64 v[158:159], 0
    v_mov_b64 v[160:161], 0
    v_mov_b64 v[162:163], 0
    v_mov_b64 v[164:165], 0
    v_mov_b64 v[166:167], 0
    s_waitcnt lgkmcnt(9)
    v_mfma_f32_16x16x32_bf16 v[124:127], v[40:43], v[24:27], 0
    v_mfma_f32_16x16x32_bf16 v[128:131], v[44:47], v[24:27], 0
    s_waitcnt lgkmcnt(6)
    v_mfma_f32_16x16x32_bf16 v[124:127], v[48:51], v[28:31], v[124:127]
    v_mfma_f32_16x16x32_bf16 v[128:131], v[52:55], v[28:31], v[128:131]
    s_waitcnt lgkmcnt(3)
    v_mfma_f32_16x16x32_bf16 v[124:127], v[56:59], v[32:35], v[124:127]
    v_mfma_f32_16x16x32_bf16 v[128:131], v[60:63], v[32:35], v[128:131]
    s_waitcnt lgkmcnt(0)
    v_mfma_f32_16x16x32_bf16 v[124:127], v[64:67], v[36:39], v[124:127]
    v_mfma_f32_16x16x32_bf16 v[128:131], v[68:71], v[36:39], v[128:131]
    s_nop 3
    v_max3_f32 v12, v124, v125, v126
    s_nop 2
    v_cndmask_b32 v128, v3, v128, s[52:53]
    v_cndmask_b32 v129, v3, v129, s[54:55]
    v_cndmask_b32 v130, v3, v130, s[56:57]
    v_cndmask_b32 v131, v3, v131, s[58:59]
    v_max3_f32 v12, v12, v127, v128
    v_max3_f32 v12, v12, v129, v130
    v_max_f32 v12, v12, v131
    v_mov_b32 v13, v12
    s_nop 1
    v_permlane16_swap_b32 v12, v13
    v_max_f32 v12, v12, v13
    v_mov_b32 v13, v12
    s_nop 1
    v_permlane32_swap_b32 v12, v13
    v_max_f32 v12, v12, v13
    v_sub_f32 v124, v124, v12
    v_sub_f32 v125, v125, v12
    v_sub_f32 v126, v126, v12
    v_sub_f32 v127, v127, v12
    v_sub_f32 v128, v128, v12
    v_sub_f32 v129, v129, v12
    v_sub_f32 v130, v130, v12
    v_sub_f32 v131, v131, v12
    v_exp_f32 v124, v124
    v_exp_f32 v125, v125
    v_exp_f32 v126, v126
    v_exp_f32 v127, v127
    v_exp_f32 v128, v128
    v_exp_f32 v129, v129
    v_exp_f32 v130, v130
    v_exp_f32 v131, v131
    v_cvt_pk_bf16_f32 v132, v124, v125
    v_cvt_pk_bf16_f32 v133, v126, v127
    v_cvt_pk_bf16_f32 v134, v128, v129
    v_cvt_pk_bf16_f32 v135, v130, v131
    s_waitcnt vmcnt(5)
    s_nop 0
    v_mfma_f32_16x16x32_bf16 v[136:139], v[72:75], v[132:135], 0
    v_pk_add_f32 v[124:125], v[124:125], v[126:127]
    v_pk_add_f32 v[124:125], v[124:125], v[128:129]
    v_mfma_f32_16x16x32_bf16 v[140:143], v[76:79], v[132:135], 0
    v_pk_add_f32 v[124:125], v[124:125], v[130:131]
    v_add_f32 v13, v124, v125
    v_mfma_f32_16x16x32_bf16 v[144:147], v[80:83], v[132:135], 0
    v_mov_b32 v124, v13
    s_nop 1
    v_permlane16_swap_b32 v13, v124
    v_mfma_f32_16x16x32_bf16 v[148:151], v[84:87], v[132:135], 0
    v_add_f32 v13, v13, v124
    v_mov_b32 v124, v13
    s_nop 1
    v_permlane32_swap_b32 v13, v124
    v_add_f32 v13, v13, v124
    s_mov_b32 s27, 0
    s_waitcnt vmcnt(0)
    v_mov_b32 v7, s40
    s_mov_b64 exec, 1
    buffer_store_dword v7, off, s[4:7], s45 sc1
    s_mov_b64 exec, -1
    s_branch AM1_C
AM1_X:
    v_cmp_eq_u32 vcc, s51, v212
    v_cmp_eq_u32 s[38:39], s51, v213
    s_or_b64 vcc, vcc, s[38:39]
    v_cmp_eq_u32 s[38:39], s51, v214
    s_or_b64 vcc, vcc, s[38:39]
    v_cmp_eq_u32 s[38:39], s51, v215
    s_or_b64 vcc, vcc, s[38:39]
    v_cmp_eq_u32 s[38:39], s51, v216
    s_or_b64 vcc, vcc, s[38:39]
    v_cmp_eq_u32 s[38:39], s51, v217
    s_or_b64 vcc, vcc, s[38:39]
    v_cmp_eq_u32 s[38:39], s51, v218
    s_or_b64 vcc, vcc, s[38:39]
    v_cmp_eq_u32 s[38:39], s51, v219
    s_or_b64 vcc, vcc, s[38:39]
    v_cmp_eq_u32 s[38:39], s51, v220
    s_or_b64 vcc, vcc, s[38:39]
    v_cmp_eq_u32 s[38:39], s51, v221
    s_or_b64 vcc, vcc, s[38:39]
    v_cmp_eq_u32 s[38:39], s51, v222
    s_or_b64 vcc, vcc, s[38:39]
    v_cmp_eq_u32 s[38:39], s51, v223
    s_or_b64 vcc, vcc, s[38:39]
    s_cbranch_vccz AM1_K
    s_cmp_ge_u32 s40, 56
    s_cbranch_scc1 AM1_M
AM1_R:
    v_mov_b32 v5, 0
    s_mov_b64 exec, 1
    buffer_atomic_or v5, v4, s[4:7], s43 offen sc0 sc1
    s_mov_b64 exec, -1
    s_add_u32 s27, s27, 1
    s_cmp_ge_u32 s27, 400000
    s_cbranch_scc1 FAIL
    s_waitcnt vmcnt(0)
    v_readfirstlane_b32 s49, v5
    s_cmp_eq_u32 s49, s51
    s_cbranch_scc1 AM1_R
AM1_M:
    s_lshl_b32 s47, s24, 10
    s_add_u32 s47, s47, s43
    s_add_u32 s48, s47, 4096
    buffer_load_dwordx4 v[212:215], v9, s[4:7], s47 offen sc1
    s_add_u32 s47, s43, 8192
    buffer_load_dwordx4 v[216:219], v9, s[4:7], s48 offen sc1
    buffer_load_dwordx4 v[220:223], v9, s[4:7], s47 offen sc1
    s_add_u32 s27, s27, 1
    s_cmp_ge_u32 s27, 400000
    s_cbranch_scc1 FAIL
    s_waitcnt vmcnt(0)
AM1_C:
    ds_write_b128 v8, v[212:215] offset:16384
    v_maximum3_f32 v184, v212, v213, v214
    ds_write_b128 v8, v[216:219] offset:20480
    v_maximum3_f32 v184, v184, v215, v216
    v_maximum3_f32 v184, v184, v217, v218
    v_maximum3_f32 v184, v184, v219, v220
    v_maximum3_f32 v184, v184, v221, v222
    v_cmp_u_f32 vcc, v184, v223
    s_cbranch_vccnz AM1_X
AM1_K:
    v_smfmac_f32_16x16x64_bf16 v[152:155], v[220:223], a[128:135], v6
    s_waitcnt lgkmcnt(0)
    s_barrier
    ds_read_b128 v[92:95], v14 offset:16384
    v_smfmac_f32_16x16x64_bf16 v[156:159], v[220:223], a[136:143], v6
    ds_read_b128 v[108:111], v14 offset:20480
    ds_read_b128 v[96:99], v15 offset:16384
    ds_read_b128 v[112:115], v15 offset:20480
    v_mov_b64 v[88:89], v[212:213]
    v_smfmac_f32_16x16x64_bf16 v[152:155], v[212:215], a[0:7], v6
    ds_read_b128 v[100:103], v16 offset:16384
    ds_read_b128 v[116:119], v16 offset:20480
    s_add_u32 s40, s40, 1
    s_add_u32 s47, s41, s46
    s_lshl_b32 m0, s24, 11
    v_mov_b64 v[90:91], v[214:215]
    v_smfmac_f32_16x16x64_bf16 v[156:159], v[212:215], a[8:15], v6
    buffer_load_dwordx4 v0, s[4:7], s41 offen offset:0 sc1 lds
    v_mov_b64 v[104:105], v[216:217]
    v_smfmac_f32_16x16x64_bf16 v[152:155], v[216:219], a[64:71], v6
    v_mov_b64 v[106:107], v[218:219]
    v_smfmac_f32_16x16x64_bf16 v[156:159], v[216:219], a[72:79], v6
    v_smfmac_f32_16x16x64_bf16 v[160:163], v[220:223], v[240:247], v6
    buffer_load_dwordx4 v0, s[4:7], s41 offen offset:1024 sc1 lds
    v_smfmac_f32_16x16x64_bf16 v[164:167], v[220:223], v[248:255], v6
    s_waitcnt lgkmcnt(5)
    v_smfmac_f32_16x16x64_bf16 v[152:155], v[92:95], a[16:23], v6
    s_add_u32 m0, m0, 8192
    s_xor_b32 s48, s47, 4096
    v_smfmac_f32_16x16x64_bf16 v[156:159], v[92:95], a[24:31], v6
    buffer_load_dwordx4 v0, s[4:7], s47 offen offset:0 sc1 lds
    s_waitcnt lgkmcnt(4)
    v_smfmac_f32_16x16x64_bf16 v[152:155], v[108:111], a[80:87], v6
    v_smfmac_f32_16x16x64_bf16 v[156:159], v[108:111], a[88:95], v6
    s_waitcnt lgkmcnt(3)
    v_smfmac_f32_16x16x64_bf16 v[152:155], v[96:99], a[32:39], v6
    buffer_load_dwordx4 v0, s[4:7], s47 offen offset:1024 sc1 lds
    v_smfmac_f32_16x16x64_bf16 v[156:159], v[96:99], a[40:47], v6
    s_waitcnt lgkmcnt(2)
    v_smfmac_f32_16x16x64_bf16 v[152:155], v[112:115], a[96:103], v6
    v_smfmac_f32_16x16x64_bf16 v[156:159], v[112:115], a[104:111], v6
    buffer_load_dwordx4 v[72:75], v0, s[4:7], s47 offen offset:2048 sc1
    s_waitcnt lgkmcnt(1)
    v_smfmac_f32_16x16x64_bf16 v[152:155], v[100:103], a[48:55], v6
    s_waitcnt lgkmcnt(0)
    v_smfmac_f32_16x16x64_bf16 v[152:155], v[116:119], a[112:119], v6
    v_smfmac_f32_16x16x64_bf16 v[156:159], v[100:103], a[56:63], v6
    buffer_load_dwordx4 v[76:79], v0, s[4:7], s47 offen offset:3072 sc1
    v_smfmac_f32_16x16x64_bf16 v[156:159], v[116:119], a[120:127], v6
    v_smfmac_f32_16x16x64_bf16 v[160:163], v[88:91], a[144:151], v6
    v_cvt_pk_bf16_f32 v152, v152, v153
    v_smfmac_f32_16x16x64_bf16 v[164:167], v[88:91], a[152:159], v6
    v_cvt_pk_bf16_f32 v153, v154, v155
    buffer_load_dwordx4 v[80:83], v0, s[4:7], s48 offen offset:2048 sc1
    s_nop 0
    v_mfma_f32_16x16x16_bf16 v[168:171], v[152:153], v[10:11], 0
    v_cvt_pk_bf16_f32 v156, v156, v157
    v_cvt_pk_bf16_f32 v157, v158, v159
    v_smfmac_f32_16x16x64_bf16 v[160:163], v[104:107], a[208:215], v6
    s_nop 0
    v_mfma_f32_16x16x16_bf16 v[172:175], v[156:157], v[10:11], 0
    buffer_load_dwordx4 v[84:87], v0, s[4:7], s48 offen offset:3072 sc1
    v_smfmac_f32_16x16x64_bf16 v[164:167], v[104:107], a[216:223], v6
    v_cvt_pk_bf16_f32 v168, v168, v169
    v_cvt_pk_bf16_f32 v169, v170, v171
    v_smfmac_f32_16x16x64_bf16 v[160:163], v[92:95], a[160:167], v6
    v_cvt_pk_bf16_f32 v170, v172, v173
    v_cvt_pk_bf16_f32 v171, v174, v175
    s_add_u32 s41, s41, 32768
    s_add_u32 s43, s43, 9216
    s_lshl_b32 s47, s24, 10
    s_add_u32 s47, s47, s43
    s_add_u32 s48, s47, 4096
    v_smfmac_f32_16x16x64_bf16 v[164:167], v[92:95], a[168:175], v6
    ds_write_b128 v8, v[168:171] offset:24576
    buffer_load_dwordx4 v[212:215], v9, s[4:7], s47 offen sc1
    v_mfma_f32_16x16x32_bf16 v[184:187], v[168:171], v[24:27], 0
    v_smfmac_f32_16x16x64_bf16 v[160:163], v[108:111], a[224:231], v6
    s_add_u32 s47, s43, 8192
    v_smfmac_f32_16x16x64_bf16 v[164:167], v[108:111], a[232:239], v6
    buffer_load_dwordx4 v[216:219], v9, s[4:7], s48 offen sc1
    v_smfmac_f32_16x16x64_bf16 v[160:163], v[96:99], a[176:183], v6
    v_smfmac_f32_16x16x64_bf16 v[164:167], v[96:99], a[184:191], v6
    s_waitcnt lgkmcnt(0)
    s_barrier
    v_smfmac_f32_16x16x64_bf16 v[160:163], v[112:115], a[240:247], v6
    ds_read_b128 v[172:175], v14 offset:24576
    ds_read_b128 v[176:179], v15 offset:24576
    ds_read_b128 v[180:183], v16 offset:24576
    buffer_load_dwordx4 v[220:223], v9, s[4:7], s47 offen sc1
    v_smfmac_f32_16x16x64_bf16 v[164:167], v[112:115], a[248:255], v6
    v_smfmac_f32_16x16x64_bf16 v[160:163], v[100:103], a[192:199], v6
    v_smfmac_f32_16x16x64_bf16 v[160:163], v[116:119], v[224:231], v6
    s_waitcnt lgkmcnt(2)
    v_mfma_f32_16x16x32_bf16 v[184:187], v[172:175], v[28:31], v[184:187]
    s_waitcnt lgkmcnt(1)
    v_mfma_f32_16x16x32_bf16 v[184:187], v[176:179], v[32:35], v[184:187]
    v_smfmac_f32_16x16x64_bf16 v[164:167], v[100:103], a[200:207], v6
    v_cvt_pk_bf16_f32 v160, v160, v161
    s_waitcnt lgkmcnt(0)
    v_mfma_f32_16x16x32_bf16 v[184:187], v[180:183], v[36:39], v[184:187]
    v_cvt_pk_bf16_f32 v161, v162, v163
    v_smfmac_f32_16x16x64_bf16 v[164:167], v[116:119], v[232:239], v6
    s_nop 3
    v_max3_f32 v124, v184, v185, v186
    v_max_f32 v124, v124, v187
    v_mov_b32 v126, v124
    s_nop 0
    v_cvt_pk_bf16_f32 v162, v164, v165
    v_cvt_pk_bf16_f32 v163, v166, v167
    ds_write_b128 v8, v[160:163] offset:28672
    v_permlane16_swap_b32 v124, v126
    v_max_f32 v124, v124, v126
    v_mul_f32 v124, s50, v124
    v_max_f32 v124, v124, v12
    v_fma_f32 v184, v184, s50, -v124
    v_fma_f32 v185, v185, s50, -v124
    v_fma_f32 v186, v186, s50, -v124
    v_fma_f32 v187, v187, s50, -v124
    v_sub_f32 v126, v12, v124
    v_exp_f32 v184, v184
    v_exp_f32 v185, v185
    v_exp_f32 v186, v186
    v_exp_f32 v187, v187
    s_waitcnt lgkmcnt(0)
    s_barrier
    ds_read_b128 v[192:195], v14 offset:28672
    v_exp_f32 v126, v126
    v_cvt_pk_bf16_f32 v188, v184, v185
    v_cvt_pk_bf16_f32 v189, v186, v187
    v_pk_add_f32 v[184:185], v[184:185], v[186:187]
    v_add_f32 v124, v184, v185
    v_mfma_f32_16x16x16_bf16 v[196:199], v[160:161], v[188:189], 0
    v_mov_b32 v127, v124
    v_mfma_f32_16x16x16_bf16 v[200:203], v[162:163], v[188:189], 0
    s_nop 0
    v_permlane16_swap_b32 v124, v127
    v_add_f32 v124, v124, v127
    v_fmac_f32 v124, v126, v13
    v_rcp_f32 v124, v124
    s_waitcnt lgkmcnt(0)
    v_mfma_f32_16x16x16_bf16 v[204:207], v[192:193], v[188:189], 0
    v_mul_f32 v126, v126, v124
    v_mfma_f32_16x16x16_bf16 v[208:211], v[194:195], v[188:189], 0
    s_xor_b32 s47, s42, 1024
    v_pk_mul_f32 v[136:137], v[136:137], v[126:127] op_sel_hi:[1,0]
    v_pk_mul_f32 v[138:139], v[138:139], v[126:127] op_sel_hi:[1,0]
    v_pk_mul_f32 v[140:141], v[140:141], v[126:127] op_sel_hi:[1,0]
    v_pk_mul_f32 v[142:143], v[142:143], v[126:127] op_sel_hi:[1,0]
    v_pk_fma_f32 v[136:137], v[196:197], v[124:125], v[136:137] op_sel_hi:[1,0,1]
    v_pk_fma_f32 v[138:139], v[198:199], v[124:125], v[138:139] op_sel_hi:[1,0,1]
    v_pk_fma_f32 v[140:141], v[200:201], v[124:125], v[140:141] op_sel_hi:[1,0,1]
    v_pk_fma_f32 v[142:143], v[202:203], v[124:125], v[142:143] op_sel_hi:[1,0,1]
    v_cvt_pk_bf16_f32 v168, v136, v137
    v_cvt_pk_bf16_f32 v169, v138, v139
    v_cvt_pk_bf16_f32 v170, v140, v141
    v_cvt_pk_bf16_f32 v171, v142, v143
    buffer_store_dwordx4 v[168:171], v0, s[4:7], s42 offen sc1
    v_pk_mul_f32 v[144:145], v[144:145], v[126:127] op_sel_hi:[1,0]
    v_pk_mul_f32 v[146:147], v[146:147], v[126:127] op_sel_hi:[1,0]
    v_pk_mul_f32 v[148:149], v[148:149], v[126:127] op_sel_hi:[1,0]
    v_pk_mul_f32 v[150:151], v[150:151], v[126:127] op_sel_hi:[1,0]
    v_pk_fma_f32 v[144:145], v[204:205], v[124:125], v[144:145] op_sel_hi:[1,0,1]
    v_pk_fma_f32 v[146:147], v[206:207], v[124:125], v[146:147] op_sel_hi:[1,0,1]
    v_pk_fma_f32 v[148:149], v[208:209], v[124:125], v[148:149] op_sel_hi:[1,0,1]
    v_pk_fma_f32 v[150:151], v[210:211], v[124:125], v[150:151] op_sel_hi:[1,0,1]
    v_cvt_pk_bf16_f32 v172, v144, v145
    v_cvt_pk_bf16_f32 v173, v146, v147
    v_cvt_pk_bf16_f32 v174, v148, v149
    v_cvt_pk_bf16_f32 v175, v150, v151
    buffer_store_dwordx4 v[172:175], v0, s[4:7], s47 offen sc1
    s_add_u32 s42, s42, 262144
    s_waitcnt vmcnt(9)
    s_cmp_lt_u32 s40, 64
    s_cbranch_scc1 AM1_L
    s_branch AM_E
AM0_L:
    s_barrier
    ds_read_b128 v[24:27], v17 offset:0
    ds_read_b128 v[40:43], v17 offset:8192
    ds_read_b128 v[28:31], v18 offset:0
    ds_read_b128 v[48:51], v18 offset:8192
    ds_read_b128 v[32:35], v19 offset:0
    ds_read_b128 v[56:59], v19 offset:8192
    ds_read_b128 v[36:39], v20 offset:0
    ds_read_b128 v[64:67], v20 offset:8192
    v_mov_b64 v[152:153], 0
    v_mov_b64 v[154:155], 0
    v_mov_b64 v[156:157], 0
    v_mov_b64 v[158:159], 0
    v_mov_b64 v[160:161], 0
    v_mov_b64 v[162:163], 0
    v_mov_b64 v[164:165], 0
    v_mov_b64 v[166:167], 0
    s_waitcnt lgkmcnt(6)
    v_mfma_f32_16x16x32_bf16 v[124:127], v[40:43], v[24:27], 0
    s_waitcnt lgkmcnt(4)
    v_mfma_f32_16x16x32_bf16 v[124:127], v[48:51], v[28:31], v[124:127]
    s_waitcnt lgkmcnt(2)
    v_mfma_f32_16x16x32_bf16 v[124:127], v[56:59], v[32:35], v[124:127]
    s_waitcnt lgkmcnt(0)
    v_mfma_f32_16x16x32_bf16 v[124:127], v[64:67], v[36:39], v[124:127]
    s_nop 7
    v_cndmask_b32 v124, v3, v124, s[52:53]
    v_cndmask_b32 v125, v3, v125, s[54:55]
    v_cndmask_b32 v126, v3, v126, s[56:57]
    v_cndmask_b32 v127, v3, v127, s[58:59]
    v_max3_f32 v12, v124, v125, v126
    v_max_f32 v12, v12, v127
    v_mov_b32 v13, v12
    s_nop 1
    v_permlane16_swap_b32 v12, v13
    v_max_f32 v12, v12, v13
    v_mov_b32 v13, v12
    s_nop 1
    v_permlane32_swap_b32 v12, v13
    v_max_f32 v12, v12, v13
    v_sub_f32 v124, v124, v12
    v_sub_f32 v125, v125, v12
    v_sub_f32 v126, v126, v12
    v_sub_f32 v127, v127, v12
    v_exp_f32 v124, v124
    v_exp_f32 v125, v125
    v_exp_f32 v126, v126
    v_exp_f32 v127, v127
    v_cvt_pk_bf16_f32 v132, v124, v125
    v_cvt_pk_bf16_f32 v133, v126, v127
    s_waitcnt vmcnt(5)
    s_nop 0
    v_mfma_f32_16x16x32_bf16 v[136:139], v[72:75], v[132:135], 0
    v_pk_add_f32 v[124:125], v[124:125], v[126:127]
    v_add_f32 v13, v124, v125
    v_mfma_f32_16x16x32_bf16 v[140:143], v[76:79], v[132:135], 0
    v_mov_b32 v124, v13
    s_nop 1
    v_permlane16_swap_b32 v13, v124
    v_mfma_f32_16x16x32_bf16 v[144:147], v[80:83], v[132:135], 0
    v_add_f32 v13, v13, v124
    v_mov_b32 v124, v13
    v_mfma_f32_16x16x32_bf16 v[148:151], v[84:87], v[132:135], 0
    s_nop 0
    v_permlane32_swap_b32 v13, v124
    v_add_f32 v13, v13, v124
    s_mov_b32 s27, 0
    s_waitcnt vmcnt(0)
    v_mov_b32 v7, s40
    s_mov_b64 exec, 1
    buffer_store_dword v7, off, s[4:7], s45 sc1
    s_mov_b64 exec, -1
    s_branch AM0_C
AM0_X:
    v_cmp_eq_u32 vcc, s51, v212
    v_cmp_eq_u32 s[38:39], s51, v213
    s_or_b64 vcc, vcc, s[38:39]
    v_cmp_eq_u32 s[38:39], s51, v214
    s_or_b64 vcc, vcc, s[38:39]
    v_cmp_eq_u32 s[38:39], s51, v215
    s_or_b64 vcc, vcc, s[38:39]
    v_cmp_eq_u32 s[38:39], s51, v216
    s_or_b64 vcc, vcc, s[38:39]
    v_cmp_eq_u32 s[38:39], s51, v217
    s_or_b64 vcc, vcc, s[38:39]
    v_cmp_eq_u32 s[38:39], s51, v218
    s_or_b64 vcc, vcc, s[38:39]
    v_cmp_eq_u32 s[38:39], s51, v219
    s_or_b64 vcc, vcc, s[38:39]
    v_cmp_eq_u32 s[38:39], s51, v220
    s_or_b64 vcc, vcc, s[38:39]
    v_cmp_eq_u32 s[38:39], s51, v221
    s_or_b64 vcc, vcc, s[38:39]
    v_cmp_eq_u32 s[38:39], s51, v222
    s_or_b64 vcc, vcc, s[38:39]
    v_cmp_eq_u32 s[38:39], s51, v223
    s_or_b64 vcc, vcc, s[38:39]
    s_cbranch_vccz AM0_K
    s_cmp_ge_u32 s40, 56
    s_cbranch_scc1 AM0_M
AM0_R:
    v_mov_b32 v5, 0
    s_mov_b64 exec, 1
    buffer_atomic_or v5, v4, s[4:7], s43 offen sc0 sc1
    s_mov_b64 exec, -1
    s_add_u32 s27, s27, 1
    s_cmp_ge_u32 s27, 400000
    s_cbranch_scc1 FAIL
    s_waitcnt vmcnt(0)
    v_readfirstlane_b32 s49, v5
    s_cmp_eq_u32 s49, s51
    s_cbranch_scc1 AM0_R
AM0_M:
    s_lshl_b32 s47, s24, 10
    s_add_u32 s47, s47, s43
    s_add_u32 s48, s47, 4096
    buffer_load_dwordx4 v[212:215], v9, s[4:7], s47 offen sc1
    s_add_u32 s47, s43, 8192
    buffer_load_dwordx4 v[216:219], v9, s[4:7], s48 offen sc1
    buffer_load_dwordx4 v[220:223], v9, s[4:7], s47 offen sc1
    s_add_u32 s27, s27, 1
    s_cmp_ge_u32 s27, 400000
    s_cbranch_scc1 FAIL
    s_waitcnt vmcnt(0)
AM0_C:
    ds_write_b128 v8, v[212:215] offset:16384
    v_maximum3_f32 v184, v212, v213, v214
    ds_write_b128 v8, v[216:219] offset:20480
    v_maximum3_f32 v184, v184, v215, v216
    v_maximum3_f32 v184, v184, v217, v218
    v_maximum3_f32 v184, v184, v219, v220
    v_maximum3_f32 v184, v184, v221, v222
    v_cmp_u_f32 vcc, v184, v223
    s_cbranch_vccnz AM0_X
AM0_K:
    v_smfmac_f32_16x16x64_bf16 v[152:155], v[220:223], a[128:135], v6
    s_waitcnt lgkmcnt(0)
    s_barrier
    ds_read_b128 v[92:95], v14 offset:16384
    v_smfmac_f32_16x16x64_bf16 v[156:159], v[220:223], a[136:143], v6
    ds_read_b128 v[108:111], v14 offset:20480
    ds_read_b128 v[96:99], v15 offset:16384
    ds_read_b128 v[112:115], v15 offset:20480
    v_mov_b64 v[88:89], v[212:213]
    v_smfmac_f32_16x16x64_bf16 v[152:155], v[212:215], a[0:7], v6
    ds_read_b128 v[100:103], v16 offset:16384
    ds_read_b128 v[116:119], v16 offset:20480
    s_add_u32 s40, s40, 1
    s_add_u32 s47, s41, s46
    s_lshl_b32 m0, s24, 11
    v_mov_b64 v[90:91], v[214:215]
    v_smfmac_f32_16x16x64_bf16 v[156:159], v[212:215], a[8:15], v6
    buffer_load_dwordx4 v0, s[4:7], s41 offen offset:0 sc1 lds
    v_mov_b64 v[104:105], v[216:217]
    v_smfmac_f32_16x16x64_bf16 v[152:155], v[216:219], a[64:71], v6
    v_mov_b64 v[106:107], v[218:219]
    v_smfmac_f32_16x16x64_bf16 v[156:159], v[216:219], a[72:79], v6
    v_smfmac_f32_16x16x64_bf16 v[160:163], v[220:223], v[240:247], v6
    buffer_load_dwordx4 v0, s[4:7], s41 offen offset:1024 sc1 lds
    v_smfmac_f32_16x16x64_bf16 v[164:167], v[220:223], v[248:255], v6
    s_waitcnt lgkmcnt(5)
    v_smfmac_f32_16x16x64_bf16 v[152:155], v[92:95], a[16:23], v6
    s_add_u32 m0, m0, 8192
    s_xor_b32 s48, s47, 4096
    v_smfmac_f32_16x16x64_bf16 v[156:159], v[92:95], a[24:31], v6
    buffer_load_dwordx4 v0, s[4:7], s47 offen offset:0 sc1 lds
    s_waitcnt lgkmcnt(4)
    v_smfmac_f32_16x16x64_bf16 v[152:155], v[108:111], a[80:87], v6
    v_smfmac_f32_16x16x64_bf16 v[156:159], v[108:111], a[88:95], v6
    s_waitcnt lgkmcnt(3)
    v_smfmac_f32_16x16x64_bf16 v[152:155], v[96:99], a[32:39], v6
    buffer_load_dwordx4 v0, s[4:7], s47 offen offset:1024 sc1 lds
    v_smfmac_f32_16x16x64_bf16 v[156:159], v[96:99], a[40:47], v6
    s_waitcnt lgkmcnt(2)
    v_smfmac_f32_16x16x64_bf16 v[152:155], v[112:115], a[96:103], v6
    v_smfmac_f32_16x16x64_bf16 v[156:159], v[112:115], a[104:111], v6
    buffer_load_dwordx4 v[72:75], v0, s[4:7], s47 offen offset:2048 sc1
    s_waitcnt lgkmcnt(1)
    v_smfmac_f32_16x16x64_bf16 v[152:155], v[100:103], a[48:55], v6
    s_waitcnt lgkmcnt(0)
    v_smfmac_f32_16x16x64_bf16 v[152:155], v[116:119], a[112:119], v6
    v_smfmac_f32_16x16x64_bf16 v[156:159], v[100:103], a[56:63], v6
    buffer_load_dwordx4 v[76:79], v0, s[4:7], s47 offen offset:3072 sc1
    v_smfmac_f32_16x16x64_bf16 v[156:159], v[116:119], a[120:127], v6
    v_smfmac_f32_16x16x64_bf16 v[160:163], v[88:91], a[144:151], v6
    v_cvt_pk_bf16_f32 v152, v152, v153
    v_smfmac_f32_16x16x64_bf16 v[164:167], v[88:91], a[152:159], v6
    v_cvt_pk_bf16_f32 v153, v154, v155
    buffer_load_dwordx4 v[80:83], v0, s[4:7], s48 offen offset:2048 sc1
    s_nop 0
    v_mfma_f32_16x16x16_bf16 v[168:171], v[152:153], v[10:11], 0
    v_cvt_pk_bf16_f32 v156, v156, v157
    v_cvt_pk_bf16_f32 v157, v158, v159
    v_smfmac_f32_16x16x64_bf16 v[160:163], v[104:107], a[208:215], v6
    s_nop 0
    v_mfma_f32_16x16x16_bf16 v[172:175], v[156:157], v[10:11], 0
    buffer_load_dwordx4 v[84:87], v0, s[4:7], s48 offen offset:3072 sc1
    v_smfmac_f32_16x16x64_bf16 v[164:167], v[104:107], a[216:223], v6
    v_cvt_pk_bf16_f32 v168, v168, v169
    v_cvt_pk_bf16_f32 v169, v170, v171
    v_smfmac_f32_16x16x64_bf16 v[160:163], v[92:95], a[160:167], v6
    v_cvt_pk_bf16_f32 v170, v172, v173
    v_cvt_pk_bf16_f32 v171, v174, v175
    s_add_u32 s41, s41, 32768
    s_add_u32 s43, s43, 9216
    s_lshl_b32 s47, s24, 10
    s_add_u32 s47, s47, s43
    s_add_u32 s48, s47, 4096
    v_smfmac_f32_16x16x64_bf16 v[164:167], v[92:95], a[168:175], v6
    ds_write_b128 v8, v[168:171] offset:24576
    buffer_load_dwordx4 v[212:215], v9, s[4:7], s47 offen sc1
    v_mfma_f32_16x16x32_bf16 v[184:187], v[168:171], v[24:27], 0
    v_smfmac_f32_16x16x64_bf16 v[160:163], v[108:111], a[224:231], v6
    s_add_u32 s47, s43, 8192
    v_smfmac_f32_16x16x64_bf16 v[164:167], v[108:111], a[232:239], v6
    buffer_load_dwordx4 v[216:219], v9, s[4:7], s48 offen sc1
    v_smfmac_f32_16x16x64_bf16 v[160:163], v[96:99], a[176:183], v6
    v_smfmac_f32_16x16x64_bf16 v[164:167], v[96:99], a[184:191], v6
    s_waitcnt lgkmcnt(0)
    s_barrier
    v_smfmac_f32_16x16x64_bf16 v[160:163], v[112:115], a[240:247], v6
    ds_read_b128 v[172:175], v14 offset:24576
    ds_read_b128 v[176:179], v15 offset:24576
    ds_read_b128 v[180:183], v16 offset:24576
    buffer_load_dwordx4 v[220:223], v9, s[4:7], s47 offen sc1
    v_smfmac_f32_16x16x64_bf16 v[164:167], v[112:115], a[248:255], v6
    v_smfmac_f32_16x16x64_bf16 v[160:163], v[100:103], a[192:199], v6
    v_smfmac_f32_16x16x64_bf16 v[160:163], v[116:119], v[224:231], v6
    s_waitcnt lgkmcnt(2)
    v_mfma_f32_16x16x32_bf16 v[184:187], v[172:175], v[28:31], v[184:187]
    s_waitcnt lgkmcnt(1)
    v_mfma_f32_16x16x32_bf16 v[184:187], v[176:179], v[32:35], v[184:187]
    v_smfmac_f32_16x16x64_bf16 v[164:167], v[100:103], a[200:207], v6
    v_cvt_pk_bf16_f32 v160, v160, v161
    s_waitcnt lgkmcnt(0)
    v_mfma_f32_16x16x32_bf16 v[184:187], v[180:183], v[36:39], v[184:187]
    v_cvt_pk_bf16_f32 v161, v162, v163
    v_smfmac_f32_16x16x64_bf16 v[164:167], v[116:119], v[232:239], v6
    s_nop 3
    v_max3_f32 v124, v184, v185, v186
    v_max_f32 v124, v124, v187
    v_mov_b32 v126, v124
    s_nop 0
    v_cvt_pk_bf16_f32 v162, v164, v165
    v_cvt_pk_bf16_f32 v163, v166, v167
    ds_write_b128 v8, v[160:163] offset:28672
    v_permlane16_swap_b32 v124, v126
    v_max_f32 v124, v124, v126
    v_mul_f32 v124, s50, v124
    v_max_f32 v124, v124, v12
    v_fma_f32 v184, v184, s50, -v124
    v_fma_f32 v185, v185, s50, -v124
    v_fma_f32 v186, v186, s50, -v124
    v_fma_f32 v187, v187, s50, -v124
    v_sub_f32 v126, v12, v124
    v_exp_f32 v184, v184
    v_exp_f32 v185, v185
    v_exp_f32 v186, v186
    v_exp_f32 v187, v187
    s_waitcnt lgkmcnt(0)
    s_barrier
    ds_read_b128 v[192:195], v14 offset:28672
    v_exp_f32 v126, v126
    v_cvt_pk_bf16_f32 v188, v184, v185
    v_cvt_pk_bf16_f32 v189, v186, v187
    v_pk_add_f32 v[184:185], v[184:185], v[186:187]
    v_add_f32 v124, v184, v185
    v_mfma_f32_16x16x16_bf16 v[196:199], v[160:161], v[188:189], 0
    v_mov_b32 v127, v124
    v_mfma_f32_16x16x16_bf16 v[200:203], v[162:163], v[188:189], 0
    s_nop 0
    v_permlane16_swap_b32 v124, v127
    v_add_f32 v124, v124, v127
    v_fmac_f32 v124, v126, v13
    v_rcp_f32 v124, v124
    s_waitcnt lgkmcnt(0)
    v_mfma_f32_16x16x16_bf16 v[204:207], v[192:193], v[188:189], 0
    v_mul_f32 v126, v126, v124
    v_mfma_f32_16x16x16_bf16 v[208:211], v[194:195], v[188:189], 0
    s_xor_b32 s47, s42, 1024
    v_pk_mul_f32 v[136:137], v[136:137], v[126:127] op_sel_hi:[1,0]
    v_pk_mul_f32 v[138:139], v[138:139], v[126:127] op_sel_hi:[1,0]
    v_pk_mul_f32 v[140:141], v[140:141], v[126:127] op_sel_hi:[1,0]
    v_pk_mul_f32 v[142:143], v[142:143], v[126:127] op_sel_hi:[1,0]
    v_pk_fma_f32 v[136:137], v[196:197], v[124:125], v[136:137] op_sel_hi:[1,0,1]
    v_pk_fma_f32 v[138:139], v[198:199], v[124:125], v[138:139] op_sel_hi:[1,0,1]
    v_pk_fma_f32 v[140:141], v[200:201], v[124:125], v[140:141] op_sel_hi:[1,0,1]
    v_pk_fma_f32 v[142:143], v[202:203], v[124:125], v[142:143] op_sel_hi:[1,0,1]
    v_cvt_pk_bf16_f32 v168, v136, v137
    v_cvt_pk_bf16_f32 v169, v138, v139
    v_cvt_pk_bf16_f32 v170, v140, v141
    v_cvt_pk_bf16_f32 v171, v142, v143
    buffer_store_dwordx4 v[168:171], v0, s[4:7], s42 offen sc1
    v_pk_mul_f32 v[144:145], v[144:145], v[126:127] op_sel_hi:[1,0]
    v_pk_mul_f32 v[146:147], v[146:147], v[126:127] op_sel_hi:[1,0]
    v_pk_mul_f32 v[148:149], v[148:149], v[126:127] op_sel_hi:[1,0]
    v_pk_mul_f32 v[150:151], v[150:151], v[126:127] op_sel_hi:[1,0]
    v_pk_fma_f32 v[144:145], v[204:205], v[124:125], v[144:145] op_sel_hi:[1,0,1]
    v_pk_fma_f32 v[146:147], v[206:207], v[124:125], v[146:147] op_sel_hi:[1,0,1]
    v_pk_fma_f32 v[148:149], v[208:209], v[124:125], v[148:149] op_sel_hi:[1,0,1]
    v_pk_fma_f32 v[150:151], v[210:211], v[124:125], v[150:151] op_sel_hi:[1,0,1]
    v_cvt_pk_bf16_f32 v172, v144, v145
    v_cvt_pk_bf16_f32 v173, v146, v147
    v_cvt_pk_bf16_f32 v174, v148, v149
    v_cvt_pk_bf16_f32 v175, v150, v151
    buffer_store_dwordx4 v[172:175], v0, s[4:7], s47 offen sc1
    s_add_u32 s42, s42, 262144
    s_waitcnt vmcnt(9)
    s_cmp_lt_u32 s40, 64
    s_cbranch_scc1 AM0_L
AM_E:
    s_waitcnt vmcnt(0)
    v_mov_b32 v7, s40
    s_mov_b64 exec, 1
    buffer_store_dword v7, off, s[4:7], s45 sc1
    s_mov_b64 exec, -1
    s_endpgm
R_CHAIN:
    s_mov_b32 s12, s68
    s_mov_b32 s13, s69
    s_mov_b32 s14, 0x480000
    s_mov_b32 s15, 0x20000
    s_mov_b32 s16, s70
    s_mov_b32 s17, s71
    s_mov_b32 s18, 0x480000
    s_mov_b32 s19, 0x20000
    s_mov_b32 s20, s72
    s_mov_b32 s21, s73
    s_mov_b32 s22, 0x480000
    s_mov_b32 s23, 0x20000
    s_mov_b32 s92, s74
    s_mov_b32 s93, s75
    s_mov_b32 s94, 0x480000
    s_mov_b32 s95, 0x20000
    s_mov_b32 s96, s66
    s_mov_b32 s97, s67
    s_mov_b32 s98, 0x2400
    s_mov_b32 s99, 0x20000
    s_mul_i32 s47, s24, 36864
    s_add_u32 s47, s47, 16384
    v_mov_b32 v60, v1
    v_lshrrev_b32 v67, 3, v60
    v_and_b32 v64, 7, v60
    v_lshrrev_b32 v65, 5, v60
    v_lshlrev_b32 v73, 1, v65
    v_xor_b32 v73, v73, v64
    v_lshlrev_b32 v70, 13, v67
    v_lshl_add_u32 v70, v73, 4, v70
    s_lshr_b32 s32, s24, 1
    s_lshl_b32 s48, s26, 1
    s_add_u32 s48, s48, s32
    s_lshl_b32 s48, s48, 7
    v_add_u32 v70, s48, v70
    v_xor_b32 v78, 64, v70
    v_mul_u32_u24 v71, 1152, v67
    v_lshl_add_u32 v71, v64, 4, v71
    s_mul_i32 s48, s26, 147456
    v_add_u32 v71, s48, v71
    s_and_b32 s54, s24, 1
    s_lshl_b32 s32, s32, 7
    s_lshl_b32 s45, s24, 7
    s_lshl_b32 s55, s54, 18
    s_add_u32 s55, s55, 4194304
    s_add_u32 m0, s47, 0
    s_nop 0
    buffer_load_dwordx4 v70, s[12:15], s55 offen lds
    s_add_u32 s55, s55, 65536
    s_add_u32 m0, s47, 1024
    s_nop 0
    buffer_load_dwordx4 v78, s[12:15], s55 offen lds
    s_add_u32 s55, s55, 65536
    s_add_u32 m0, s47, 2048
    s_nop 0
    buffer_load_dwordx4 v70, s[12:15], s55 offen lds
    s_add_u32 s55, s55, 65536
    s_add_u32 m0, s47, 3072
    s_nop 0
    buffer_load_dwordx4 v78, s[12:15], s55 offen lds
    s_lshl_b32 s55, s54, 18
    s_add_u32 s55, s55, 4194304
    s_add_u32 m0, s47, 4096
    s_nop 0
    buffer_load_dwordx4 v70, s[20:23], s55 offen lds
    s_add_u32 s55, s55, 65536
    s_add_u32 m0, s47, 5120
    s_nop 0
    buffer_load_dwordx4 v78, s[20:23], s55 offen lds
    s_add_u32 s55, s55, 65536
    s_add_u32 m0, s47, 6144
    s_nop 0
    buffer_load_dwordx4 v70, s[20:23], s55 offen lds
    s_add_u32 s55, s55, 65536
    s_add_u32 m0, s47, 7168
    s_nop 0
    buffer_load_dwordx4 v78, s[20:23], s55 offen lds
    s_xor_b32 s55, s24, 1
    s_mul_i32 s55, s55, 36864
    s_add_u32 s55, s55, s45
    s_add_u32 s55, s55, 256
    s_add_u32 m0, s47, 8192
    s_nop 0
    buffer_load_dwordx4 v71, s[92:95], s55 offen lds
    s_add_u32 s55, s55, 9216
    s_add_u32 m0, s47, 9216
    s_nop 0
    buffer_load_dwordx4 v71, s[92:95], s55 offen lds
    s_add_u32 s55, s55, 9216
    s_add_u32 m0, s47, 10240
    s_nop 0
    buffer_load_dwordx4 v71, s[92:95], s55 offen lds
    s_add_u32 s55, s55, 9216
    s_add_u32 m0, s47, 11264
    s_nop 0
    buffer_load_dwordx4 v71, s[92:95], s55 offen lds
    v_and_b32 v69, 3, v60
    v_and_b32 v61, 1, v60
    v_bfe_u32 v74, v60, 1, 1
    v_bfe_u32 v68, v60, 2, 1
    s_mov_b32 s40, 0x55555555
    s_mov_b32 s41, s40
    s_mov_b32 s42, 15
    s_mov_b32 s43, 15
    s_mov_b32 s44, 0x3e0293ee
    s_mov_b32 s30, 0xff81ff81
    v_lshrrev_b32 v62, 4, v60
    v_bfe_u32 v63, v60, 3, 1
    v_bfe_u32 v66, v60, 4, 1
    v_bfe_u32 v59, v60, 2, 2
    v_lshlrev_b32 v3, 4, v60
    v_add_u32 v0, s47, v3
    v_mov_b32 v1, 0xeeee
    v_mov_b32 v58, 0x4444
    v_cndmask_b32 v1, v1, v58, s[40:41]
    v_mul_u32_u24 v58, 4608, v67
    v_lshl_add_u32 v58, v64, 4, v58
    v_lshl_or_b32 v1, v58, 16, v1
    v_mul_u32_u24 v4, 192, v62
    v_and_b32 v57, 15, v60
    v_lshl_add_u32 v4, v57, 3, v4
    v_mul_u32_u24 v5, 192, v69
    v_lshrrev_b32 v57, 2, v60
    v_lshl_add_u32 v5, v57, 3, v5
    v_lshlrev_b32 v8, 8, v68
    v_lshl_add_u32 v8, v67, 5, v8
    v_lshl_add_u32 v8, v69, 1, v8
    v_mul_u32_u24 v9, 3968, v63
    v_add_u32 v9, v9, v3
    ds_write_b64 v3, v[8:9] offset:13568
    v_and_b32 v12, -16, v4
    v_mul_u32_u24 v13, 768, v61
    v_add_u32 v13, v13, v12
    v_lshrrev_b32 v14, 1, v58
    v_mul_u32_u24 v15, 1152, v67
    v_lshl_add_u32 v15, v69, 3, v15
    v_lshl_add_u32 v15, v68, 2, v15
    ds_write_b128 v3, v[12:15] offset:14592
    v_mov_b32 v16, 0
    v_mov_b32 v17, 0
    v_mov_b32 v18, 0
    v_mov_b32 v19, 0
    ds_write_b128 v3, v[16:19] offset:10240
    ds_write_b128 v3, v[16:19] offset:10496
    v_mov_b32 v56, 0x3f80
    v_mov_b32 v57, 0x3f800000
    v_lshl_add_u32 v58, v59, 1, v61
    v_lshl_add_u32 v58, v74, 3, v58
    v_mov_b32 v8, 0
    v_cmp_eq_u32 vcc, 0, v58
    s_nop 1
    v_cndmask_b32 v8, v8, v56, vcc
    v_cmp_eq_u32 vcc, 1, v58
    s_nop 1
    v_cndmask_b32 v8, v8, v57, vcc
    v_mov_b32 v9, 0
    v_cmp_eq_u32 vcc, 2, v58
    s_nop 1
    v_cndmask_b32 v9, v9, v56, vcc
    v_cmp_eq_u32 vcc, 3, v58
    s_nop 1
    v_cndmask_b32 v9, v9, v57, vcc
    v_mov_b32 v10, 0
    v_cmp_eq_u32 vcc, 4, v58
    s_nop 1
    v_cndmask_b32 v10, v10, v56, vcc
    v_cmp_eq_u32 vcc, 5, v58
    s_nop 1
    v_cndmask_b32 v10, v10, v57, vcc
    v_mov_b32 v11, 0
    v_cmp_eq_u32 vcc, 6, v58
    s_nop 1
    v_cndmask_b32 v11, v11, v56, vcc
    v_cmp_eq_u32 vcc, 7, v58
    s_nop 1
    v_cndmask_b32 v11, v11, v57, vcc
    ds_write_b128 v3, v[8:11] offset:11520
    v_lshl_add_u32 v58, v61, 1, v68
    v_lshl_add_u32 v58, v63, 2, v58
    v_lshl_add_u32 v58, v74, 3, v58
    v_mov_b32 v8, 0
    v_cmp_eq_u32 vcc, 0, v58
    s_nop 1
    v_cndmask_b32 v8, v8, v56, vcc
    v_cmp_eq_u32 vcc, 1, v58
    s_nop 1
    v_cndmask_b32 v8, v8, v57, vcc
    v_mov_b32 v9, 0
    v_cmp_eq_u32 vcc, 2, v58
    s_nop 1
    v_cndmask_b32 v9, v9, v56, vcc
    v_cmp_eq_u32 vcc, 3, v58
    s_nop 1
    v_cndmask_b32 v9, v9, v57, vcc
    v_mov_b32 v10, 0
    v_cmp_eq_u32 vcc, 4, v58
    s_nop 1
    v_cndmask_b32 v10, v10, v56, vcc
    v_cmp_eq_u32 vcc, 5, v58
    s_nop 1
    v_cndmask_b32 v10, v10, v57, vcc
    v_mov_b32 v11, 0
    v_cmp_eq_u32 vcc, 6, v58
    s_nop 1
    v_cndmask_b32 v11, v11, v56, vcc
    v_cmp_eq_u32 vcc, 7, v58
    s_nop 1
    v_cndmask_b32 v11, v11, v57, vcc
    ds_write_b128 v3, v[8:11] offset:12544
    s_lshr_b32 s48, s26, 3
    s_and_b32 s49, s26, 1
    s_bfe_u32 s36, s26, 0x20001
    s_lshl_b32 s36, s36, 6
    v_lshlrev_b32 v58, 5, v66
    s_cmp_lg_u32 s24, 0
    s_cbranch_scc1 C_I1
    s_lshl_b32 s48, s48, 9
    s_lshl_b32 s49, s49, 8
    s_add_u32 s36, s36, 0
    v_lshl_add_u32 v58, v65, 2, v58
    v_lshl_add_u32 v58, v69, 3, v58
    v_and_b32 v7, 0, v59
    v_mul_u32_u24 v7, 9216, v7
    v_add_u32 v7, v7, v58
    s_mul_i32 s51, s26, 2304
    s_add_u32 s51, s51, 0x200000
    buffer_store_dwordx4 v[16:19], v3, s[4:7], s51 offen offset:0 sc1
    buffer_store_dwordx4 v[16:19], v3, s[4:7], s51 offen offset:1024 sc1
    s_branch C_I4
C_I1:
    s_cmp_lg_u32 s24, 1
    s_cbranch_scc1 C_I2
    s_lshl_b32 s48, s48, 10
    s_lshl_b32 s49, s49, 8
    s_add_u32 s36, s36, 2048
    v_lshl_add_u32 v58, v65, 9, v58
    v_lshl_add_u32 v58, v64, 2, v58
    v_mov_b32 v7, v58
    s_mul_i32 s51, s26, 4608
    s_add_u32 s51, s51, 0x228000
    buffer_store_dwordx4 v[16:19], v3, s[4:7], s51 offen offset:0 sc1
    buffer_store_dwordx4 v[16:19], v3, s[4:7], s51 offen offset:1024 sc1
    buffer_store_dwordx4 v[16:19], v3, s[4:7], s51 offen offset:2048 sc1
    buffer_store_dwordx4 v[16:19], v3, s[4:7], s51 offen offset:3072 sc1
    s_branch C_I4
C_I2:
    s_cmp_lg_u32 s24, 2
    s_cbranch_scc1 C_I3
    s_lshl_b32 s48, s48, 9
    s_lshl_b32 s49, s49, 8
    s_add_u32 s36, s36, 6144
    v_lshl_add_u32 v58, v65, 2, v58
    v_lshl_add_u32 v58, v69, 3, v58
    v_mov_b32 v7, v58
    s_mul_i32 s51, s26, 2304
    s_add_u32 s51, s51, 0x214000
    buffer_store_dwordx4 v[16:19], v3, s[4:7], s51 offen offset:0 sc1
    buffer_store_dwordx4 v[16:19], v3, s[4:7], s51 offen offset:1024 sc1
    s_branch C_I4
C_I3:
    s_lshl_b32 s48, s48, 8
    s_lshl_b32 s49, s49, 4
    s_add_u32 s36, s36, 8192
    v_lshl_add_u32 v58, v65, 2, v58
    v_lshl_add_u32 v58, v61, 3, v58
    v_mov_b32 v7, v58
    s_mul_i32 s51, s26, 1152
    s_add_u32 s51, s51, 0x250000
    buffer_store_dwordx4 v[16:19], v3, s[4:7], s51 offen offset:0 sc1
C_I4:
    s_add_u32 s36, s36, s48
    s_add_u32 s36, s36, s49
    v_add_u32 v58, s36, v58
    v_bfe_u32 v57, v58, 5, 3
    v_mul_u32_u24 v57, 1152, v57
    v_lshrrev_b32 v56, 8, v58
    v_lshl_add_u32 v57, v56, 5, v57
    v_and_b32 v56, 16, v58
    v_add_u32 v57, v57, v56
    v_bfe_u32 v56, v58, 2, 2
    v_lshl_add_u32 v58, v56, 1, v57
    buffer_load_ushort v57, v58, s[96:99], 0 offen
    buffer_load_ushort v56, v58, s[96:99], 0 offen offset:8
    s_add_u32 s39, s36, 0x300000
    s_add_u32 s36, s36, 0x100000
    v_mov_b32 v72, s30
    s_add_u32 s37, s36, 0x8000
    buffer_store_dword v72, v7, s[4:7], s37 offen sc1
    s_add_u32 s37, s36, 0x10000
    buffer_store_dword v72, v7, s[4:7], s37 offen sc1
    s_add_u32 s37, s36, 0x18000
    buffer_store_dword v72, v7, s[4:7], s37 offen sc1
    s_lshl_b32 s38, s26, 21
    s_add_u32 s38, s38, 0x1002000
    s_add_u32 s50, s38, 8192
    s_lshl_b32 s48, s24, 12
    s_add_u32 s46, s38, s48
    s_lshl_b32 s53, s26, 8
    s_add_u32 s53, s53, 425984
    v_lshl_add_u32 v58, v65, 3, v66
    v_lshl_add_u32 v58, v59, 1, v58
    v_lshlrev_b32 v58, 8, v58
    v_lshl_add_u32 v58, v69, 3, v58
    v_xor_b32 v73, s54, v59
    v_lshl_add_u32 v73, v73, 5, v58
    s_lshl_b32 s48, s54, 1
    v_xor_b32 v77, s48, v59
    v_lshl_add_u32 v77, v77, 5, v58
    v_lshl_add_u32 v58, v66, 4, v68
    v_lshl_add_u32 v58, v65, 2, v58
    v_lshlrev_b32 v58, 7, v58
    v_lshl_add_u32 v74, v63, 3, v58
    v_lshl_add_u32 v74, v69, 4, v74
    s_lshl_b32 s48, s54, 6
    v_add_u32 v76, s48, v74
    v_mul_u32_u24 v75, 36864, v63
    v_add_u32 v75, v75, v58
    v_lshl_add_u32 v75, v69, 3, v75
    s_lshl_b32 s48, s24, 5
    v_add_u32 v75, s48, v75
    s_xor_b32 s33, s24, 1
    s_mul_i32 s33, s33, 36864
    s_add_u32 s33, s33, 16384
    s_min_u32 s34, s33, s47
    s_max_u32 s35, s33, s47
    s_waitcnt vmcnt(14)
    s_barrier
    v_add_u32 v62, s34, v73
    v_xor_b32 v63, 64, v62
    v_add_u32 v64, s35, v73
    v_xor_b32 v65, 64, v64
    ds_read_b64_tr_b16 a[104:105], v62 offset:0
    ds_read_b64_tr_b16 a[106:107], v62 offset:128
    ds_read_b64_tr_b16 a[108:109], v64 offset:0
    ds_read_b64_tr_b16 a[110:111], v64 offset:128
    ds_read_b64_tr_b16 a[112:113], v63 offset:0
    ds_read_b64_tr_b16 a[114:115], v63 offset:128
    ds_read_b64_tr_b16 a[116:117], v65 offset:0
    ds_read_b64_tr_b16 a[118:119], v65 offset:128
    s_waitcnt lgkmcnt(0)
    s_xor_b32 s55, s24, 2
    s_mul_i32 s55, s55, 36864
    s_add_u32 s55, s55, s45
    s_add_u32 s55, s55, 256
    s_add_u32 m0, s47, 12288
    s_waitcnt vmcnt(13)
    buffer_load_dwordx4 v71, s[92:95], s55 offen lds
    s_add_u32 s55, s55, 9216
    s_add_u32 m0, s47, 13312
    s_waitcnt vmcnt(13)
    buffer_load_dwordx4 v71, s[92:95], s55 offen lds
    s_add_u32 s55, s55, 9216
    s_add_u32 m0, s47, 14336
    s_waitcnt vmcnt(13)
    buffer_load_dwordx4 v71, s[92:95], s55 offen lds
    s_add_u32 s55, s55, 9216
    s_add_u32 m0, s47, 15360
    s_waitcnt vmcnt(13)
    buffer_load_dwordx4 v71, s[92:95], s55 offen lds
    s_barrier
    v_add_u32 v62, s34, v77
    v_xor_b32 v63, 32, v62
    v_add_u32 v64, s35, v77
    v_xor_b32 v65, 32, v64
    ds_read_b64_tr_b16 v[136:137], v62 offset:4096
    ds_read_b64_tr_b16 v[138:139], v62 offset:4224
    ds_read_b64_tr_b16 v[140:141], v64 offset:4096
    ds_read_b64_tr_b16 v[142:143], v64 offset:4224
    ds_read_b64_tr_b16 v[144:145], v63 offset:4096
    ds_read_b64_tr_b16 v[146:147], v63 offset:4224
    ds_read_b64_tr_b16 v[148:149], v65 offset:4096
    ds_read_b64_tr_b16 v[150:151], v65 offset:4224
    s_waitcnt lgkmcnt(0)
    s_xor_b32 s55, s24, 0
    s_mul_i32 s55, s55, 36864
    s_add_u32 s55, s55, 1024
    s_add_u32 m0, s47, 16384
    s_waitcnt vmcnt(13)
    buffer_load_dwordx4 v71, s[92:95], s55 offen lds
    s_add_u32 s55, s55, 9216
    s_add_u32 m0, s47, 17408
    s_waitcnt vmcnt(13)
    buffer_load_dwordx4 v71, s[92:95], s55 offen lds
    s_add_u32 s55, s55, 9216
    s_add_u32 m0, s47, 18432
    s_waitcnt vmcnt(13)
    buffer_load_dwordx4 v71, s[92:95], s55 offen lds
    s_add_u32 s55, s55, 9216
    s_add_u32 m0, s47, 19456
    s_waitcnt vmcnt(13)
    buffer_load_dwordx4 v71, s[92:95], s55 offen lds
    s_barrier
    v_add_u32 v62, s47, v74
    v_add_u32 v63, s33, v74
    ds_read_b64_tr_b16 v[152:153], v62 offset:8192
    ds_read_b64_tr_b16 v[154:155], v62 offset:8448
    ds_read_b64_tr_b16 v[156:157], v62 offset:9216
    ds_read_b64_tr_b16 v[158:159], v62 offset:9472
    ds_read_b64_tr_b16 v[160:161], v62 offset:8256
    ds_read_b64_tr_b16 v[162:163], v62 offset:8512
    ds_read_b64_tr_b16 v[164:165], v62 offset:9280
    ds_read_b64_tr_b16 v[166:167], v62 offset:9536
    s_waitcnt lgkmcnt(0)
    s_xor_b32 s55, s24, 0
    s_lshl_b32 s55, s55, 19
    s_add_u32 s55, s55, 1048576
    s_add_u32 m0, s47, 20480
    s_waitcnt vmcnt(7)
    buffer_load_dwordx4 v70, s[12:15], s55 offen lds
    s_add_u32 s55, s55, 65536
    s_add_u32 m0, s47, 21504
    s_waitcnt vmcnt(7)
    buffer_load_dwordx4 v78, s[12:15], s55 offen lds
    s_add_u32 s55, s55, 65536
    s_add_u32 m0, s47, 22528
    s_waitcnt vmcnt(7)
    buffer_load_dwordx4 v70, s[12:15], s55 offen lds
    s_add_u32 s55, s55, 65536
    s_add_u32 m0, s47, 23552
    s_waitcnt vmcnt(7)
    buffer_load_dwordx4 v78, s[12:15], s55 offen lds
    s_barrier
    v_lshl_or_b32 v6, v56, 16, v57
    v_cmp_ne_u32 vcc, v72, v6
    s_nop 1
    v_cndmask_b32 v6, -1, v6, vcc
    buffer_store_dword v6, v7, s[4:7], s36 offen sc1
    v_add_u32 v62, s47, v74
    v_add_u32 v63, s33, v74
    ds_read_b64_tr_b16 v[168:169], v62 offset:12288
    ds_read_b64_tr_b16 v[170:171], v62 offset:12544
    ds_read_b64_tr_b16 v[172:173], v62 offset:13312
    ds_read_b64_tr_b16 v[174:175], v62 offset:13568
    ds_read_b64_tr_b16 v[176:177], v62 offset:12352
    ds_read_b64_tr_b16 v[178:179], v62 offset:12608
    ds_read_b64_tr_b16 v[180:181], v62 offset:13376
    ds_read_b64_tr_b16 v[182:183], v62 offset:13632
    s_waitcnt lgkmcnt(0)
    s_xor_b32 s55, s24, 0
    s_lshl_b32 s55, s55, 19
    s_add_u32 s55, s55, 1310720
    s_add_u32 m0, s47, 24576
    s_waitcnt vmcnt(8)
    buffer_load_dwordx4 v70, s[12:15], s55 offen lds
    s_add_u32 s55, s55, 65536
    s_add_u32 m0, s47, 25600
    s_waitcnt vmcnt(8)
    buffer_load_dwordx4 v78, s[12:15], s55 offen lds
    s_add_u32 s55, s55, 65536
    s_add_u32 m0, s47, 26624
    s_waitcnt vmcnt(8)
    buffer_load_dwordx4 v70, s[12:15], s55 offen lds
    s_add_u32 s55, s55, 65536
    s_add_u32 m0, s47, 27648
    s_waitcnt vmcnt(8)
    buffer_load_dwordx4 v78, s[12:15], s55 offen lds
    s_barrier
    v_add_u32 v62, 16384, v75
    v_add_u32 v63, 90112, v75
    ds_read_b64_tr_b16 v[240:241], v62 offset:16384
    ds_read_b64_tr_b16 v[242:243], v62 offset:16640
    ds_read_b64_tr_b16 v[244:245], v62 offset:17408
    ds_read_b64_tr_b16 v[246:247], v62 offset:17664
    ds_read_b64_tr_b16 v[248:249], v63 offset:16384
    ds_read_b64_tr_b16 v[250:251], v63 offset:16640
    ds_read_b64_tr_b16 v[252:253], v63 offset:17408
    ds_read_b64_tr_b16 v[254:255], v63 offset:17664
    s_waitcnt lgkmcnt(0)
    s_xor_b32 s55, s24, 2
    s_lshl_b32 s55, s55, 19
    s_add_u32 s55, s55, 1048576
    s_add_u32 m0, s47, 28672
    s_waitcnt vmcnt(8)
    buffer_load_dwordx4 v70, s[12:15], s55 offen lds
    s_add_u32 s55, s55, 65536
    s_add_u32 m0, s47, 29696
    s_waitcnt vmcnt(8)
    buffer_load_dwordx4 v78, s[12:15], s55 offen lds
    s_add_u32 s55, s55, 65536
    s_add_u32 m0, s47, 30720
    s_waitcnt vmcnt(8)
    buffer_load_dwordx4 v70, s[12:15], s55 offen lds
    s_add_u32 s55, s55, 65536
    s_add_u32 m0, s47, 31744
    s_waitcnt vmcnt(8)
    buffer_load_dwordx4 v78, s[12:15], s55 offen lds
    s_xor_b32 s55, s24, 2
    s_lshl_b32 s55, s55, 19
    s_add_u32 s55, s55, 1310720
    s_add_u32 m0, s47, 32768
    s_waitcnt vmcnt(7)
    buffer_load_dwordx4 v70, s[12:15], s55 offen lds
    s_add_u32 s55, s55, 65536
    s_add_u32 m0, s47, 33792
    s_waitcnt vmcnt(7)
    buffer_load_dwordx4 v78, s[12:15], s55 offen lds
    s_add_u32 s55, s55, 65536
    s_add_u32 m0, s47, 34816
    s_waitcnt vmcnt(7)
    buffer_load_dwordx4 v70, s[12:15], s55 offen lds
    s_add_u32 s55, s55, 65536
    s_add_u32 m0, s47, 35840
    s_waitcnt vmcnt(7)
    buffer_load_dwordx4 v78, s[12:15], s55 offen lds
    s_barrier
    s_cmp_lg_u32 s24, 0
    s_cbranch_scc1 C_NA
    s_cmp_eq_u32 s28, 0
    s_cselect_b32 s48, 1, 0x10001
    v_mov_b32 v72, s48
    v_mov_b32 v61, 36
    s_mov_b64 exec, 1
    buffer_atomic_add v72, v61, s[8:11], 0 offen sc1
    s_mov_b64 exec, -1
C_NA:
    v_add_u32 v62, s47, v73
    v_xor_b32 v63, 64, v62
    v_add_u32 v64, s33, v73
    v_xor_b32 v65, 64, v64
    ds_read_b64_tr_b16 a[16:17], v62 offset:20480
    ds_read_b64_tr_b16 a[18:19], v62 offset:20608
    ds_read_b64_tr_b16 a[20:21], v62 offset:24576
    ds_read_b64_tr_b16 a[22:23], v62 offset:24704
    ds_read_b64_tr_b16 a[24:25], v63 offset:20480
    ds_read_b64_tr_b16 a[26:27], v63 offset:20608
    ds_read_b64_tr_b16 a[28:29], v63 offset:24576
    ds_read_b64_tr_b16 a[30:31], v63 offset:24704
    s_waitcnt lgkmcnt(4)
    ds_read_b64_tr_b16 a[32:33], v64 offset:20480
    ds_read_b64_tr_b16 a[34:35], v64 offset:20608
    ds_read_b64_tr_b16 a[36:37], v64 offset:24576
    ds_read_b64_tr_b16 a[38:39], v64 offset:24704
    ds_read_b64_tr_b16 a[40:41], v65 offset:20480
    ds_read_b64_tr_b16 a[42:43], v65 offset:20608
    ds_read_b64_tr_b16 a[44:45], v65 offset:24576
    ds_read_b64_tr_b16 a[46:47], v65 offset:24704
    s_waitcnt lgkmcnt(0)
    s_xor_b32 s55, s24, 0
    s_lshl_b32 s55, s55, 19
    s_add_u32 s55, s55, 1048576
    s_add_u32 m0, s47, 0
    s_waitcnt vmcnt(7)
    buffer_load_dwordx4 v70, s[16:19], s55 offen lds
    s_add_u32 s55, s55, 65536
    s_add_u32 m0, s47, 1024
    s_waitcnt vmcnt(7)
    buffer_load_dwordx4 v78, s[16:19], s55 offen lds
    s_add_u32 s55, s55, 65536
    s_add_u32 m0, s47, 2048
    s_waitcnt vmcnt(7)
    buffer_load_dwordx4 v70, s[16:19], s55 offen lds
    s_add_u32 s55, s55, 65536
    s_add_u32 m0, s47, 3072
    s_waitcnt vmcnt(7)
    buffer_load_dwordx4 v78, s[16:19], s55 offen lds
    s_xor_b32 s55, s24, 0
    s_lshl_b32 s55, s55, 19
    s_add_u32 s55, s55, 1310720
    s_add_u32 m0, s47, 4096
    s_waitcnt vmcnt(7)
    buffer_load_dwordx4 v70, s[16:19], s55 offen lds
    s_add_u32 s55, s55, 65536
    s_add_u32 m0, s47, 5120
    s_waitcnt vmcnt(7)
    buffer_load_dwordx4 v78, s[16:19], s55 offen lds
    s_add_u32 s55, s55, 65536
    s_add_u32 m0, s47, 6144
    s_waitcnt vmcnt(7)
    buffer_load_dwordx4 v70, s[16:19], s55 offen lds
    s_add_u32 s55, s55, 65536
    s_add_u32 m0, s47, 7168
    s_waitcnt vmcnt(7)
    buffer_load_dwordx4 v78, s[16:19], s55 offen lds
    s_barrier
    v_add_u32 v62, s47, v73
    v_xor_b32 v63, 64, v62
    v_add_u32 v64, s33, v73
    v_xor_b32 v65, 64, v64
    ds_read_b64_tr_b16 a[48:49], v62 offset:28672
    ds_read_b64_tr_b16 a[50:51], v62 offset:28800
    ds_read_b64_tr_b16 a[52:53], v62 offset:32768
    ds_read_b64_tr_b16 a[54:55], v62 offset:32896
    ds_read_b64_tr_b16 a[56:57], v63 offset:28672
    ds_read_b64_tr_b16 a[58:59], v63 offset:28800
    ds_read_b64_tr_b16 a[60:61], v63 offset:32768
    ds_read_b64_tr_b16 a[62:63], v63 offset:32896
    s_waitcnt lgkmcnt(4)
    ds_read_b64_tr_b16 a[64:65], v64 offset:28672
    ds_read_b64_tr_b16 a[66:67], v64 offset:28800
    ds_read_b64_tr_b16 a[68:69], v64 offset:32768
    ds_read_b64_tr_b16 a[70:71], v64 offset:32896
    ds_read_b64_tr_b16 a[72:73], v65 offset:28672
    ds_read_b64_tr_b16 a[74:75], v65 offset:28800
    ds_read_b64_tr_b16 a[76:77], v65 offset:32768
    ds_read_b64_tr_b16 a[78:79], v65 offset:32896
    s_waitcnt lgkmcnt(0)
    s_lshl_b32 s55, s54, 19
    s_add_u32 s55, s55, 3145728
    s_add_u32 m0, s47, 8192
    s_waitcnt vmcnt(7)
    buffer_load_dwordx4 v70, s[16:19], s55 offen lds
    s_add_u32 s55, s55, 65536
    s_add_u32 m0, s47, 9216
    s_waitcnt vmcnt(7)
    buffer_load_dwordx4 v78, s[16:19], s55 offen lds
    s_add_u32 s55, s55, 65536
    s_add_u32 m0, s47, 10240
    s_waitcnt vmcnt(7)
    buffer_load_dwordx4 v70, s[16:19], s55 offen lds
    s_add_u32 s55, s55, 65536
    s_add_u32 m0, s47, 11264
    s_waitcnt vmcnt(7)
    buffer_load_dwordx4 v78, s[16:19], s55 offen lds
    s_lshl_b32 s55, s54, 19
    s_add_u32 s55, s55, 3407872
    s_add_u32 m0, s47, 12288
    s_waitcnt vmcnt(7)
    buffer_load_dwordx4 v70, s[16:19], s55 offen lds
    s_add_u32 s55, s55, 65536
    s_add_u32 m0, s47, 13312
    s_waitcnt vmcnt(7)
    buffer_load_dwordx4 v78, s[16:19], s55 offen lds
    s_add_u32 s55, s55, 65536
    s_add_u32 m0, s47, 14336
    s_waitcnt vmcnt(7)
    buffer_load_dwordx4 v70, s[16:19], s55 offen lds
    s_add_u32 s55, s55, 65536
    s_add_u32 m0, s47, 15360
    s_waitcnt vmcnt(7)
    buffer_load_dwordx4 v78, s[16:19], s55 offen lds
    s_barrier
    v_add_u32 v62, s47, v73
    v_xor_b32 v63, 64, v62
    v_add_u32 v64, s33, v73
    v_xor_b32 v65, 64, v64
    ds_read_b64_tr_b16 a[120:121], v62 offset:0
    ds_read_b64_tr_b16 a[122:123], v62 offset:128
    ds_read_b64_tr_b16 a[124:125], v62 offset:4096
    ds_read_b64_tr_b16 a[126:127], v62 offset:4224
    ds_read_b64_tr_b16 a[128:129], v63 offset:0
    ds_read_b64_tr_b16 a[130:131], v63 offset:128
    ds_read_b64_tr_b16 a[132:133], v63 offset:4096
    ds_read_b64_tr_b16 a[134:135], v63 offset:4224
    s_waitcnt lgkmcnt(4)
    ds_read_b64_tr_b16 a[136:137], v64 offset:0
    ds_read_b64_tr_b16 a[138:139], v64 offset:128
    ds_read_b64_tr_b16 a[140:141], v64 offset:4096
    ds_read_b64_tr_b16 a[142:143], v64 offset:4224
    ds_read_b64_tr_b16 a[144:145], v65 offset:0
    ds_read_b64_tr_b16 a[146:147], v65 offset:128
    ds_read_b64_tr_b16 a[148:149], v65 offset:4096
    ds_read_b64_tr_b16 a[150:151], v65 offset:4224
    s_waitcnt lgkmcnt(0)
    s_lshl_b32 s55, s54, 19
    s_add_u32 s55, s55, 3145728
    s_add_u32 m0, s47, 16384
    s_waitcnt vmcnt(7)
    buffer_load_dwordx4 v70, s[20:23], s55 offen lds
    s_add_u32 s55, s55, 65536
    s_add_u32 m0, s47, 17408
    s_waitcnt vmcnt(7)
    buffer_load_dwordx4 v78, s[20:23], s55 offen lds
    s_add_u32 s55, s55, 65536
    s_add_u32 m0, s47, 18432
    s_waitcnt vmcnt(7)
    buffer_load_dwordx4 v70, s[20:23], s55 offen lds
    s_add_u32 s55, s55, 65536
    s_add_u32 m0, s47, 19456
    s_waitcnt vmcnt(7)
    buffer_load_dwordx4 v78, s[20:23], s55 offen lds
    s_lshl_b32 s55, s54, 19
    s_add_u32 s55, s55, 3407872
    s_add_u32 m0, s47, 20480
    s_waitcnt vmcnt(7)
    buffer_load_dwordx4 v70, s[20:23], s55 offen lds
    s_add_u32 s55, s55, 65536
    s_add_u32 m0, s47, 21504
    s_waitcnt vmcnt(7)
    buffer_load_dwordx4 v78, s[20:23], s55 offen lds
    s_add_u32 s55, s55, 65536
    s_add_u32 m0, s47, 22528
    s_waitcnt vmcnt(7)
    buffer_load_dwordx4 v70, s[20:23], s55 offen lds
    s_add_u32 s55, s55, 65536
    s_add_u32 m0, s47, 23552
    s_waitcnt vmcnt(7)
    buffer_load_dwordx4 v78, s[20:23], s55 offen lds
    s_barrier
    v_add_u32 v62, s34, v73
    v_xor_b32 v63, 64, v62
    v_add_u32 v64, s35, v73
    v_xor_b32 v65, 64, v64
    ds_read_b64_tr_b16 a[176:177], v62 offset:8192
    ds_read_b64_tr_b16 a[178:179], v62 offset:8320
    ds_read_b64_tr_b16 a[180:181], v62 offset:12288
    ds_read_b64_tr_b16 a[182:183], v62 offset:12416
    ds_read_b64_tr_b16 a[184:185], v63 offset:8192
    ds_read_b64_tr_b16 a[186:187], v63 offset:8320
    ds_read_b64_tr_b16 a[188:189], v63 offset:12288
    ds_read_b64_tr_b16 a[190:191], v63 offset:12416
    s_waitcnt lgkmcnt(4)
    ds_read_b64_tr_b16 a[192:193], v64 offset:8192
    ds_read_b64_tr_b16 a[194:195], v64 offset:8320
    ds_read_b64_tr_b16 a[196:197], v64 offset:12288
    ds_read_b64_tr_b16 a[198:199], v64 offset:12416
    ds_read_b64_tr_b16 a[200:201], v65 offset:8192
    ds_read_b64_tr_b16 a[202:203], v65 offset:8320
    ds_read_b64_tr_b16 a[204:205], v65 offset:12288
    ds_read_b64_tr_b16 a[206:207], v65 offset:12416
    s_waitcnt lgkmcnt(0)
    s_xor_b32 s55, s24, 2
    s_mul_i32 s55, s55, 36864
    s_add_u32 s55, s55, s32
    s_add_u32 s55, s55, 0
    s_add_u32 m0, s47, 24576
    s_waitcnt vmcnt(7)
    buffer_load_dwordx4 v71, s[92:95], s55 offen lds
    s_add_u32 s55, s55, 9216
    s_add_u32 m0, s47, 25600
    s_waitcnt vmcnt(7)
    buffer_load_dwordx4 v71, s[92:95], s55 offen lds
    s_add_u32 s55, s55, 9216
    s_add_u32 m0, s47, 26624
    s_waitcnt vmcnt(7)
    buffer_load_dwordx4 v71, s[92:95], s55 offen lds
    s_add_u32 s55, s55, 9216
    s_add_u32 m0, s47, 27648
    s_waitcnt vmcnt(7)
    buffer_load_dwordx4 v71, s[92:95], s55 offen lds
    s_xor_b32 s55, s24, 2
    s_mul_i32 s55, s55, 36864
    s_add_u32 s55, s55, s32
    s_add_u32 s55, s55, 768
    s_add_u32 m0, s47, 28672
    s_waitcnt vmcnt(7)
    buffer_load_dwordx4 v71, s[92:95], s55 offen lds
    s_add_u32 s55, s55, 9216
    s_add_u32 m0, s47, 29696
    s_waitcnt vmcnt(7)
    buffer_load_dwordx4 v71, s[92:95], s55 offen lds
    s_add_u32 s55, s55, 9216
    s_add_u32 m0, s47, 30720
    s_waitcnt vmcnt(7)
    buffer_load_dwordx4 v71, s[92:95], s55 offen lds
    s_add_u32 s55, s55, 9216
    s_add_u32 m0, s47, 31744
    s_waitcnt vmcnt(7)
    buffer_load_dwordx4 v71, s[92:95], s55 offen lds
    s_barrier
    v_add_u32 v62, s34, v77
    v_xor_b32 v63, 32, v62
    v_add_u32 v64, s35, v77
    v_xor_b32 v65, 32, v64
    ds_read_b64_tr_b16 v[104:105], v62 offset:16384
    ds_read_b64_tr_b16 v[106:107], v62 offset:16512
    ds_read_b64_tr_b16 v[108:109], v62 offset:20480
    ds_read_b64_tr_b16 v[110:111], v62 offset:20608
    ds_read_b64_tr_b16 v[112:113], v63 offset:16384
    ds_read_b64_tr_b16 v[114:115], v63 offset:16512
    ds_read_b64_tr_b16 v[116:117], v63 offset:20480
    ds_read_b64_tr_b16 v[118:119], v63 offset:20608
    s_waitcnt lgkmcnt(4)
    ds_read_b64_tr_b16 v[120:121], v64 offset:16384
    ds_read_b64_tr_b16 v[122:123], v64 offset:16512
    ds_read_b64_tr_b16 v[124:125], v64 offset:20480
    ds_read_b64_tr_b16 v[126:127], v64 offset:20608
    ds_read_b64_tr_b16 v[128:129], v65 offset:16384
    ds_read_b64_tr_b16 v[130:131], v65 offset:16512
    ds_read_b64_tr_b16 v[132:133], v65 offset:20480
    ds_read_b64_tr_b16 v[134:135], v65 offset:20608
    s_waitcnt lgkmcnt(0)
    s_lshl_b32 s55, s54, 19
    s_add_u32 s55, s55, 3145728
    s_add_u32 m0, s47, 32768
    s_waitcnt vmcnt(7)
    buffer_load_dwordx4 v70, s[12:15], s55 offen lds
    s_add_u32 s55, s55, 65536
    s_add_u32 m0, s47, 33792
    s_waitcnt vmcnt(7)
    buffer_load_dwordx4 v78, s[12:15], s55 offen lds
    s_add_u32 s55, s55, 65536
    s_add_u32 m0, s47, 34816
    s_waitcnt vmcnt(7)
    buffer_load_dwordx4 v70, s[12:15], s55 offen lds
    s_add_u32 s55, s55, 65536
    s_add_u32 m0, s47, 35840
    s_waitcnt vmcnt(7)
    buffer_load_dwordx4 v78, s[12:15], s55 offen lds
    s_lshl_b32 s55, s54, 19
    s_add_u32 s55, s55, 3407872
    s_add_u32 m0, s47, 0
    s_waitcnt vmcnt(7)
    buffer_load_dwordx4 v70, s[12:15], s55 offen lds
    s_add_u32 s55, s55, 65536
    s_add_u32 m0, s47, 1024
    s_waitcnt vmcnt(7)
    buffer_load_dwordx4 v78, s[12:15], s55 offen lds
    s_add_u32 s55, s55, 65536
    s_add_u32 m0, s47, 2048
    s_waitcnt vmcnt(7)
    buffer_load_dwordx4 v70, s[12:15], s55 offen lds
    s_add_u32 s55, s55, 65536
    s_add_u32 m0, s47, 3072
    s_waitcnt vmcnt(7)
    buffer_load_dwordx4 v78, s[12:15], s55 offen lds
    s_barrier
    v_mov_b32 v58, 244
    buffer_load_dword v56, v58, s[8:11], 0 offen sc1
    v_add_u32 v62, s47, v76
    v_add_u32 v63, s33, v76
    ds_read_b64_tr_b16 v[208:209], v62 offset:24576
    ds_read_b64_tr_b16 v[210:211], v62 offset:24832
    ds_read_b64_tr_b16 v[212:213], v62 offset:25600
    ds_read_b64_tr_b16 v[214:215], v62 offset:25856
    ds_read_b64_tr_b16 v[216:217], v62 offset:28672
    ds_read_b64_tr_b16 v[218:219], v62 offset:28928
    ds_read_b64_tr_b16 v[220:221], v62 offset:29696
    ds_read_b64_tr_b16 v[222:223], v62 offset:29952
    s_waitcnt lgkmcnt(4)
    ds_read_b64_tr_b16 v[224:225], v63 offset:24576
    ds_read_b64_tr_b16 v[226:227], v63 offset:24832
    ds_read_b64_tr_b16 v[228:229], v63 offset:25600
    ds_read_b64_tr_b16 v[230:231], v63 offset:25856
    ds_read_b64_tr_b16 v[232:233], v63 offset:28672
    ds_read_b64_tr_b16 v[234:235], v63 offset:28928
    ds_read_b64_tr_b16 v[236:237], v63 offset:29696
    ds_read_b64_tr_b16 v[238:239], v63 offset:29952
    s_waitcnt lgkmcnt(0)
    s_xor_b32 s55, s24, 2
    s_lshl_b32 s55, s55, 19
    s_add_u32 s55, s55, 1048576
    s_add_u32 m0, s47, 4096
    s_waitcnt vmcnt(8)
    buffer_load_dwordx4 v70, s[16:19], s55 offen lds
    s_add_u32 s55, s55, 65536
    s_add_u32 m0, s47, 5120
    s_waitcnt vmcnt(8)
    buffer_load_dwordx4 v78, s[16:19], s55 offen lds
    s_add_u32 s55, s55, 65536
    s_add_u32 m0, s47, 6144
    s_waitcnt vmcnt(8)
    buffer_load_dwordx4 v70, s[16:19], s55 offen lds
    s_add_u32 s55, s55, 65536
    s_add_u32 m0, s47, 7168
    s_waitcnt vmcnt(8)
    buffer_load_dwordx4 v78, s[16:19], s55 offen lds
    s_xor_b32 s55, s24, 2
    s_lshl_b32 s55, s55, 19
    s_add_u32 s55, s55, 1310720
    s_add_u32 m0, s47, 8192
    s_waitcnt vmcnt(8)
    buffer_load_dwordx4 v70, s[16:19], s55 offen lds
    s_add_u32 s55, s55, 65536
    s_add_u32 m0, s47, 9216
    s_waitcnt vmcnt(8)
    buffer_load_dwordx4 v78, s[16:19], s55 offen lds
    s_add_u32 s55, s55, 65536
    s_add_u32 m0, s47, 10240
    s_waitcnt vmcnt(8)
    buffer_load_dwordx4 v70, s[16:19], s55 offen lds
    s_add_u32 s55, s55, 65536
    s_add_u32 m0, s47, 11264
    s_waitcnt vmcnt(8)
    buffer_load_dwordx4 v78, s[16:19], s55 offen lds
    s_barrier
    v_add_u32 v62, s34, v73
    v_xor_b32 v63, 64, v62
    v_add_u32 v64, s35, v73
    v_xor_b32 v65, 64, v64
    ds_read_b64_tr_b16 v[192:193], v62 offset:32768
    ds_read_b64_tr_b16 v[194:195], v62 offset:32896
    ds_read_b64_tr_b16 v[196:197], v62 offset:0
    ds_read_b64_tr_b16 v[198:199], v62 offset:128
    ds_read_b64_tr_b16 a[80:81], v63 offset:32768
    ds_read_b64_tr_b16 a[82:83], v63 offset:32896
    ds_read_b64_tr_b16 a[84:85], v63 offset:0
    ds_read_b64_tr_b16 a[86:87], v63 offset:128
    s_waitcnt lgkmcnt(4)
    ds_read_b64_tr_b16 a[88:89], v64 offset:32768
    ds_read_b64_tr_b16 a[90:91], v64 offset:32896
    ds_read_b64_tr_b16 a[92:93], v64 offset:0
    ds_read_b64_tr_b16 a[94:95], v64 offset:128
    ds_read_b64_tr_b16 a[96:97], v65 offset:32768
    ds_read_b64_tr_b16 a[98:99], v65 offset:32896
    ds_read_b64_tr_b16 a[100:101], v65 offset:0
    ds_read_b64_tr_b16 a[102:103], v65 offset:128
    s_waitcnt lgkmcnt(0)
    s_lshl_b32 s55, s54, 19
    s_add_u32 s55, s55, 0
    s_add_u32 m0, s47, 12288
    s_waitcnt vmcnt(7)
    buffer_load_dwordx4 v70, s[20:23], s55 offen lds
    s_add_u32 s55, s55, 65536
    s_add_u32 m0, s47, 13312
    s_waitcnt vmcnt(7)
    buffer_load_dwordx4 v78, s[20:23], s55 offen lds
    s_add_u32 s55, s55, 65536
    s_add_u32 m0, s47, 14336
    s_waitcnt vmcnt(7)
    buffer_load_dwordx4 v70, s[20:23], s55 offen lds
    s_add_u32 s55, s55, 65536
    s_add_u32 m0, s47, 15360
    s_waitcnt vmcnt(7)
    buffer_load_dwordx4 v78, s[20:23], s55 offen lds
    s_lshl_b32 s55, s54, 19
    s_add_u32 s55, s55, 262144
    s_add_u32 m0, s47, 16384
    s_waitcnt vmcnt(7)
    buffer_load_dwordx4 v70, s[20:23], s55 offen lds
    s_add_u32 s55, s55, 65536
    s_add_u32 m0, s47, 17408
    s_waitcnt vmcnt(7)
    buffer_load_dwordx4 v78, s[20:23], s55 offen lds
    s_add_u32 s55, s55, 65536
    s_add_u32 m0, s47, 18432
    s_waitcnt vmcnt(7)
    buffer_load_dwordx4 v70, s[20:23], s55 offen lds
    s_add_u32 s55, s55, 65536
    s_add_u32 m0, s47, 19456
    s_waitcnt vmcnt(7)
    buffer_load_dwordx4 v78, s[20:23], s55 offen lds
    s_barrier
    v_add_u32 v62, s47, v73
    v_xor_b32 v63, 64, v62
    v_add_u32 v64, s33, v73
    v_xor_b32 v65, 64, v64
    ds_read_b64_tr_b16 v[200:201], v62 offset:4096
    ds_read_b64_tr_b16 v[202:203], v62 offset:4224
    ds_read_b64_tr_b16 v[204:205], v62 offset:8192
    ds_read_b64_tr_b16 v[206:207], v62 offset:8320
    ds_read_b64_tr_b16 a[152:153], v63 offset:4096
    ds_read_b64_tr_b16 a[154:155], v63 offset:4224
    ds_read_b64_tr_b16 a[156:157], v63 offset:8192
    ds_read_b64_tr_b16 a[158:159], v63 offset:8320
    s_waitcnt lgkmcnt(4)
    ds_read_b64_tr_b16 a[160:161], v64 offset:4096
    ds_read_b64_tr_b16 a[162:163], v64 offset:4224
    ds_read_b64_tr_b16 a[164:165], v64 offset:8192
    ds_read_b64_tr_b16 a[166:167], v64 offset:8320
    ds_read_b64_tr_b16 a[168:169], v65 offset:4096
    ds_read_b64_tr_b16 a[170:171], v65 offset:4224
    ds_read_b64_tr_b16 a[172:173], v65 offset:8192
    ds_read_b64_tr_b16 a[174:175], v65 offset:8320
    s_waitcnt lgkmcnt(0)
    s_xor_b32 s55, s24, 2
    s_lshl_b32 s55, s55, 19
    s_add_u32 s55, s55, 1048576
    s_add_u32 m0, s47, 20480
    s_waitcnt vmcnt(7)
    buffer_load_dwordx4 v70, s[20:23], s55 offen lds
    s_add_u32 s55, s55, 65536
    s_add_u32 m0, s47, 21504
    s_waitcnt vmcnt(7)
    buffer_load_dwordx4 v78, s[20:23], s55 offen lds
    s_add_u32 s55, s55, 65536
    s_add_u32 m0, s47, 22528
    s_waitcnt vmcnt(7)
    buffer_load_dwordx4 v70, s[20:23], s55 offen lds
    s_add_u32 s55, s55, 65536
    s_add_u32 m0, s47, 23552
    s_waitcnt vmcnt(7)
    buffer_load_dwordx4 v78, s[20:23], s55 offen lds
    s_xor_b32 s55, s24, 2
    s_lshl_b32 s55, s55, 19
    s_add_u32 s55, s55, 1310720
    s_add_u32 m0, s47, 24576
    s_waitcnt vmcnt(7)
    buffer_load_dwordx4 v70, s[20:23], s55 offen lds
    s_add_u32 s55, s55, 65536
    s_add_u32 m0, s47, 25600
    s_waitcnt vmcnt(7)
    buffer_load_dwordx4 v78, s[20:23], s55 offen lds
    s_add_u32 s55, s55, 65536
    s_add_u32 m0, s47, 26624
    s_waitcnt vmcnt(7)
    buffer_load_dwordx4 v70, s[20:23], s55 offen lds
    s_add_u32 s55, s55, 65536
    s_add_u32 m0, s47, 27648
    s_waitcnt vmcnt(7)
    buffer_load_dwordx4 v78, s[20:23], s55 offen lds
    s_barrier
    v_add_u32 v62, s47, v77
    v_xor_b32 v63, 32, v62
    v_add_u32 v64, s33, v77
    v_xor_b32 v65, 32, v64
    ds_read_b64_tr_b16 a[216:217], v62 offset:12288
    ds_read_b64_tr_b16 a[218:219], v62 offset:12416
    ds_read_b64_tr_b16 a[220:221], v62 offset:16384
    ds_read_b64_tr_b16 a[222:223], v62 offset:16512
    ds_read_b64_tr_b16 a[224:225], v63 offset:12288
    ds_read_b64_tr_b16 a[226:227], v63 offset:12416
    ds_read_b64_tr_b16 a[228:229], v63 offset:16384
    ds_read_b64_tr_b16 a[230:231], v63 offset:16512
    s_waitcnt lgkmcnt(4)
    ds_read_b64_tr_b16 a[232:233], v64 offset:12288
    ds_read_b64_tr_b16 a[234:235], v64 offset:12416
    ds_read_b64_tr_b16 a[236:237], v64 offset:16384
    ds_read_b64_tr_b16 a[238:239], v64 offset:16512
    ds_read_b64_tr_b16 v[8:9], v65 offset:12288
    ds_read_b64_tr_b16 v[10:11], v65 offset:12416
    ds_read_b64_tr_b16 v[12:13], v65 offset:16384
    ds_read_b64_tr_b16 v[14:15], v65 offset:16512
    s_waitcnt lgkmcnt(0)
    s_lshl_b32 s55, s54, 18
    s_add_u32 s55, s55, 4194304
    s_add_u32 m0, s47, 28672
    s_waitcnt vmcnt(7)
    buffer_load_dwordx4 v70, s[16:19], s55 offen lds
    s_add_u32 s55, s55, 65536
    s_add_u32 m0, s47, 29696
    s_waitcnt vmcnt(7)
    buffer_load_dwordx4 v78, s[16:19], s55 offen lds
    s_add_u32 s55, s55, 65536
    s_add_u32 m0, s47, 30720
    s_waitcnt vmcnt(7)
    buffer_load_dwordx4 v70, s[16:19], s55 offen lds
    s_add_u32 s55, s55, 65536
    s_add_u32 m0, s47, 31744
    s_waitcnt vmcnt(7)
    buffer_load_dwordx4 v78, s[16:19], s55 offen lds
    s_xor_b32 s55, s24, 3
    s_mul_i32 s55, s55, 36864
    s_add_u32 s55, s55, s45
    s_add_u32 s55, s55, 256
    s_add_u32 m0, s47, 32768
    s_waitcnt vmcnt(7)
    buffer_load_dwordx4 v71, s[92:95], s55 offen lds
    s_add_u32 s55, s55, 9216
    s_add_u32 m0, s47, 33792
    s_waitcnt vmcnt(7)
    buffer_load_dwordx4 v71, s[92:95], s55 offen lds
    s_add_u32 s55, s55, 9216
    s_add_u32 m0, s47, 34816
    s_waitcnt vmcnt(7)
    buffer_load_dwordx4 v71, s[92:95], s55 offen lds
    s_add_u32 s55, s55, 9216
    s_add_u32 m0, s47, 35840
    s_waitcnt vmcnt(7)
    buffer_load_dwordx4 v71, s[92:95], s55 offen lds
    s_barrier
    v_add_u32 v62, s47, v77
    v_xor_b32 v63, 32, v62
    v_add_u32 v64, s33, v77
    v_xor_b32 v65, 32, v64
    ds_read_b64_tr_b16 v[80:81], v62 offset:20480
    ds_read_b64_tr_b16 v[82:83], v62 offset:20608
    ds_read_b64_tr_b16 v[84:85], v62 offset:24576
    ds_read_b64_tr_b16 v[86:87], v62 offset:24704
    ds_read_b64_tr_b16 v[88:89], v63 offset:20480
    ds_read_b64_tr_b16 v[90:91], v63 offset:20608
    ds_read_b64_tr_b16 v[92:93], v63 offset:24576
    ds_read_b64_tr_b16 v[94:95], v63 offset:24704
    s_waitcnt lgkmcnt(4)
    ds_read_b64_tr_b16 v[96:97], v64 offset:20480
    ds_read_b64_tr_b16 v[98:99], v64 offset:20608
    ds_read_b64_tr_b16 v[100:101], v64 offset:24576
    ds_read_b64_tr_b16 v[102:103], v64 offset:24704
    ds_read_b64_tr_b16 v[16:17], v65 offset:20480
    ds_read_b64_tr_b16 v[18:19], v65 offset:20608
    ds_read_b64_tr_b16 v[20:21], v65 offset:24576
    ds_read_b64_tr_b16 v[22:23], v65 offset:24704
    s_waitcnt lgkmcnt(0)
    s_lshl_b32 s55, s54, 19
    s_add_u32 s55, s55, 0
    s_add_u32 m0, s47, 0
    s_waitcnt vmcnt(7)
    buffer_load_dwordx4 v70, s[12:15], s55 offen lds
    s_add_u32 s55, s55, 65536
    s_add_u32 m0, s47, 1024
    s_waitcnt vmcnt(7)
    buffer_load_dwordx4 v78, s[12:15], s55 offen lds
    s_add_u32 s55, s55, 65536
    s_add_u32 m0, s47, 2048
    s_waitcnt vmcnt(7)
    buffer_load_dwordx4 v70, s[12:15], s55 offen lds
    s_add_u32 s55, s55, 65536
    s_add_u32 m0, s47, 3072
    s_waitcnt vmcnt(7)
    buffer_load_dwordx4 v78, s[12:15], s55 offen lds
    s_barrier
    v_add_u32 v62, s34, v73
    v_xor_b32 v63, 64, v62
    v_add_u32 v64, s35, v73
    v_xor_b32 v65, 64, v64
    ds_read_b64_tr_b16 v[24:25], v62 offset:28672
    ds_read_b64_tr_b16 v[26:27], v62 offset:28800
    ds_read_b64_tr_b16 v[28:29], v64 offset:28672
    ds_read_b64_tr_b16 v[30:31], v64 offset:28800
    ds_read_b64_tr_b16 a[208:209], v63 offset:28672
    ds_read_b64_tr_b16 a[210:211], v63 offset:28800
    ds_read_b64_tr_b16 a[212:213], v65 offset:28672
    ds_read_b64_tr_b16 a[214:215], v65 offset:28800
    s_waitcnt lgkmcnt(0)
    s_lshl_b32 s55, s54, 19
    s_add_u32 s55, s55, 262144
    s_add_u32 m0, s47, 4096
    s_waitcnt vmcnt(7)
    buffer_load_dwordx4 v70, s[12:15], s55 offen lds
    s_add_u32 s55, s55, 65536
    s_add_u32 m0, s47, 5120
    s_waitcnt vmcnt(7)
    buffer_load_dwordx4 v78, s[12:15], s55 offen lds
    s_add_u32 s55, s55, 65536
    s_add_u32 m0, s47, 6144
    s_waitcnt vmcnt(7)
    buffer_load_dwordx4 v70, s[12:15], s55 offen lds
    s_add_u32 s55, s55, 65536
    s_add_u32 m0, s47, 7168
    s_waitcnt vmcnt(7)
    buffer_load_dwordx4 v78, s[12:15], s55 offen lds
    s_barrier
    v_add_u32 v62, s47, v74
    v_add_u32 v63, s33, v74
    ds_read_b64_tr_b16 v[32:33], v62 offset:32768
    ds_read_b64_tr_b16 v[34:35], v62 offset:33024
    ds_read_b64_tr_b16 v[36:37], v62 offset:33792
    ds_read_b64_tr_b16 v[38:39], v62 offset:34048
    ds_read_b64_tr_b16 v[184:185], v62 offset:32832
    ds_read_b64_tr_b16 v[186:187], v62 offset:33088
    ds_read_b64_tr_b16 v[188:189], v62 offset:33856
    ds_read_b64_tr_b16 v[190:191], v62 offset:34112
    s_waitcnt lgkmcnt(0)
    s_xor_b32 s55, s24, 0
    s_lshl_b32 s55, s55, 19
    s_add_u32 s55, s55, 1048576
    s_add_u32 m0, s47, 8192
    s_waitcnt vmcnt(7)
    buffer_load_dwordx4 v70, s[20:23], s55 offen lds
    s_add_u32 s55, s55, 65536
    s_add_u32 m0, s47, 9216
    s_waitcnt vmcnt(7)
    buffer_load_dwordx4 v78, s[20:23], s55 offen lds
    s_add_u32 s55, s55, 65536
    s_add_u32 m0, s47, 10240
    s_waitcnt vmcnt(7)
    buffer_load_dwordx4 v70, s[20:23], s55 offen lds
    s_add_u32 s55, s55, 65536
    s_add_u32 m0, s47, 11264
    s_waitcnt vmcnt(7)
    buffer_load_dwordx4 v78, s[20:23], s55 offen lds
    s_xor_b32 s55, s24, 0
    s_lshl_b32 s55, s55, 19
    s_add_u32 s55, s55, 1310720
    s_add_u32 m0, s47, 12288
    s_waitcnt vmcnt(7)
    buffer_load_dwordx4 v70, s[20:23], s55 offen lds
    s_add_u32 s55, s55, 65536
    s_add_u32 m0, s47, 13312
    s_waitcnt vmcnt(7)
    buffer_load_dwordx4 v78, s[20:23], s55 offen lds
    s_add_u32 s55, s55, 65536
    s_add_u32 m0, s47, 14336
    s_waitcnt vmcnt(7)
    buffer_load_dwordx4 v70, s[20:23], s55 offen lds
    s_add_u32 s55, s55, 65536
    s_add_u32 m0, s47, 15360
    s_waitcnt vmcnt(7)
    buffer_load_dwordx4 v78, s[20:23], s55 offen lds
    s_barrier
    v_add_u32 v62, s47, v73
    v_xor_b32 v63, 64, v62
    v_add_u32 v64, s33, v73
    v_xor_b32 v65, 64, v64
    ds_read_b64_tr_b16 v[40:41], v62 offset:0
    ds_read_b64_tr_b16 v[42:43], v62 offset:128
    ds_read_b64_tr_b16 v[44:45], v62 offset:4096
    ds_read_b64_tr_b16 v[46:47], v62 offset:4224
    ds_read_b64_tr_b16 v[48:49], v63 offset:0
    ds_read_b64_tr_b16 v[50:51], v63 offset:128
    ds_read_b64_tr_b16 v[52:53], v63 offset:4096
    ds_read_b64_tr_b16 v[54:55], v63 offset:4224
    s_waitcnt lgkmcnt(4)
    ds_read_b64_tr_b16 a[0:1], v64 offset:0
    ds_read_b64_tr_b16 a[2:3], v64 offset:128
    ds_read_b64_tr_b16 a[4:5], v64 offset:4096
    ds_read_b64_tr_b16 a[6:7], v64 offset:4224
    ds_read_b64_tr_b16 a[8:9], v65 offset:0
    ds_read_b64_tr_b16 a[10:11], v65 offset:128
    ds_read_b64_tr_b16 a[12:13], v65 offset:4096
    ds_read_b64_tr_b16 a[14:15], v65 offset:4224
    s_waitcnt lgkmcnt(0)
    s_xor_b32 s55, s24, 0
    s_mul_i32 s55, s55, 36864
    s_add_u32 s55, s55, s32
    s_add_u32 s55, s55, 0
    s_add_u32 m0, s47, 16384
    s_waitcnt vmcnt(7)
    buffer_load_dwordx4 v71, s[92:95], s55 offen lds
    s_add_u32 s55, s55, 9216
    s_add_u32 m0, s47, 17408
    s_waitcnt vmcnt(7)
    buffer_load_dwordx4 v71, s[92:95], s55 offen lds
    s_add_u32 s55, s55, 9216
    s_add_u32 m0, s47, 18432
    s_waitcnt vmcnt(7)
    buffer_load_dwordx4 v71, s[92:95], s55 offen lds
    s_add_u32 s55, s55, 9216
    s_add_u32 m0, s47, 19456
    s_waitcnt vmcnt(7)
    buffer_load_dwordx4 v71, s[92:95], s55 offen lds
    s_xor_b32 s55, s24, 0
    s_mul_i32 s55, s55, 36864
    s_add_u32 s55, s55, s32
    s_add_u32 s55, s55, 768
    s_add_u32 m0, s47, 20480
    s_waitcnt vmcnt(7)
    buffer_load_dwordx4 v71, s[92:95], s55 offen lds
    s_add_u32 s55, s55, 9216
    s_add_u32 m0, s47, 21504
    s_waitcnt vmcnt(7)
    buffer_load_dwordx4 v71, s[92:95], s55 offen lds
    s_add_u32 s55, s55, 9216
    s_add_u32 m0, s47, 22528
    s_waitcnt vmcnt(7)
    buffer_load_dwordx4 v71, s[92:95], s55 offen lds
    s_add_u32 s55, s55, 9216
    s_add_u32 m0, s47, 23552
    s_waitcnt vmcnt(7)
    buffer_load_dwordx4 v71, s[92:95], s55 offen lds
    s_barrier
    v_readfirstlane_b32 s29, v56
    v_mov_b32 v57, 36
    v_and_b32 v58, 0x23, v60
    v_lshlrev_b32 v58, 2, v58
    buffer_load_dword v57, v57, s[8:11], 0 offen sc1
    buffer_load_dword v58, v58, s[4:7], s53 offen sc1
    ds_write_b128 v0, v[192:195] offset:0
    ds_write_b128 v0, v[196:199] offset:1024
    ds_write_b128 v0, v[200:203] offset:2048
    ds_write_b128 v0, v[204:207] offset:3072
    ds_write_b128 v0, v[8:11] offset:4096
    ds_write_b128 v0, v[12:15] offset:5120
    ds_write_b128 v0, v[16:19] offset:6144
    ds_write_b128 v0, v[20:23] offset:7168
    s_waitcnt lgkmcnt(0)
    v_add_u32 v62, s47, v77
    v_xor_b32 v63, 32, v62
    v_add_u32 v64, s33, v77
    v_xor_b32 v65, 32, v64
    ds_read_b64_tr_b16 v[8:9], v62 offset:8192
    ds_read_b64_tr_b16 v[10:11], v62 offset:8320
    ds_read_b64_tr_b16 v[12:13], v62 offset:12288
    ds_read_b64_tr_b16 v[14:15], v62 offset:12416
    ds_read_b64_tr_b16 v[16:17], v63 offset:8192
    ds_read_b64_tr_b16 v[18:19], v63 offset:8320
    ds_read_b64_tr_b16 v[20:21], v63 offset:12288
    ds_read_b64_tr_b16 v[22:23], v63 offset:12416
    s_waitcnt lgkmcnt(4)
    ds_read_b64_tr_b16 a[240:241], v64 offset:8192
    ds_read_b64_tr_b16 a[242:243], v64 offset:8320
    ds_read_b64_tr_b16 a[244:245], v64 offset:12288
    ds_read_b64_tr_b16 a[246:247], v64 offset:12416
    ds_read_b64_tr_b16 a[248:249], v65 offset:8192
    ds_read_b64_tr_b16 a[250:251], v65 offset:8320
    ds_read_b64_tr_b16 a[252:253], v65 offset:12288
    ds_read_b64_tr_b16 a[254:255], v65 offset:12416
    s_waitcnt lgkmcnt(0)
    s_xor_b32 s55, s24, 0
    s_mul_i32 s55, s55, 36864
    s_add_u32 s55, s55, s45
    s_add_u32 s55, s55, 256
    s_add_u32 m0, s47, 24576
    s_waitcnt vmcnt(9)
    buffer_load_dwordx4 v71, s[92:95], s55 offen lds
    s_add_u32 s55, s55, 9216
    s_add_u32 m0, s47, 25600
    s_waitcnt vmcnt(9)
    buffer_load_dwordx4 v71, s[92:95], s55 offen lds
    s_add_u32 s55, s55, 9216
    s_add_u32 m0, s47, 26624
    s_waitcnt vmcnt(9)
    buffer_load_dwordx4 v71, s[92:95], s55 offen lds
    s_add_u32 s55, s55, 9216
    s_add_u32 m0, s47, 27648
    s_waitcnt vmcnt(9)
    buffer_load_dwordx4 v71, s[92:95], s55 offen lds
    s_lshl_b32 s55, s54, 19
    s_add_u32 s55, s55, 0
    s_add_u32 m0, s47, 28672
    s_waitcnt vmcnt(9)
    buffer_load_dwordx4 v70, s[16:19], s55 offen lds
    s_add_u32 s55, s55, 65536
    s_add_u32 m0, s47, 29696
    s_waitcnt vmcnt(9)
    buffer_load_dwordx4 v78, s[16:19], s55 offen lds
    s_add_u32 s55, s55, 65536
    s_add_u32 m0, s47, 30720
    s_waitcnt vmcnt(9)
    buffer_load_dwordx4 v70, s[16:19], s55 offen lds
    s_add_u32 s55, s55, 65536
    s_add_u32 m0, s47, 31744
    s_waitcnt vmcnt(9)
    buffer_load_dwordx4 v78, s[16:19], s55 offen lds
    s_barrier
    ds_write_b128 v0, v[24:27] offset:8192
    ds_write_b128 v0, v[28:31] offset:9216
    ds_write_b128 v0, v[32:35] offset:10240
    ds_write_b128 v0, v[36:39] offset:11264
    ds_write_b128 v0, v[40:43] offset:12288
    ds_write_b128 v0, v[44:47] offset:13312
    ds_write_b128 v0, v[48:51] offset:14336
    ds_write_b128 v0, v[52:55] offset:15360
    s_waitcnt lgkmcnt(0)
    v_add_u32 v62, s47, v76
    v_add_u32 v63, s33, v76
    ds_read_b64_tr_b16 v[24:25], v62 offset:16384
    ds_read_b64_tr_b16 v[26:27], v62 offset:16640
    ds_read_b64_tr_b16 v[28:29], v62 offset:17408
    ds_read_b64_tr_b16 v[30:31], v62 offset:17664
    ds_read_b64_tr_b16 v[32:33], v62 offset:20480
    ds_read_b64_tr_b16 v[34:35], v62 offset:20736
    ds_read_b64_tr_b16 v[36:37], v62 offset:21504
    ds_read_b64_tr_b16 v[38:39], v62 offset:21760
    s_waitcnt lgkmcnt(4)
    ds_read_b64_tr_b16 v[192:193], v63 offset:16384
    ds_read_b64_tr_b16 v[194:195], v63 offset:16640
    ds_read_b64_tr_b16 v[196:197], v63 offset:17408
    ds_read_b64_tr_b16 v[198:199], v63 offset:17664
    ds_read_b64_tr_b16 v[200:201], v63 offset:20480
    ds_read_b64_tr_b16 v[202:203], v63 offset:20736
    ds_read_b64_tr_b16 v[204:205], v63 offset:21504
    ds_read_b64_tr_b16 v[206:207], v63 offset:21760
    s_waitcnt lgkmcnt(0)
    s_lshl_b32 s55, s54, 19
    s_add_u32 s55, s55, 262144
    s_add_u32 m0, s47, 32768
    s_waitcnt vmcnt(7)
    buffer_load_dwordx4 v70, s[16:19], s55 offen lds
    s_add_u32 s55, s55, 65536
    s_add_u32 m0, s47, 33792
    s_waitcnt vmcnt(7)
    buffer_load_dwordx4 v78, s[16:19], s55 offen lds
    s_add_u32 s55, s55, 65536
    s_add_u32 m0, s47, 34816
    s_waitcnt vmcnt(7)
    buffer_load_dwordx4 v70, s[16:19], s55 offen lds
    s_add_u32 s55, s55, 65536
    s_add_u32 m0, s47, 35840
    s_waitcnt vmcnt(7)
    buffer_load_dwordx4 v78, s[16:19], s55 offen lds
    v_readfirstlane_b32 s54, v57
    v_cmp_gt_u32 vcc, 2, v58
    s_and_b32 s48, s54, 0xffff
    s_cmp_ge_u32 s48, 64
    s_cselect_b32 s29, s29, 0
    s_cmp_eq_u64 vcc, 0
    s_cselect_b32 s48, 2, 1
    s_cmp_ge_u32 s29, 18
    s_cselect_b32 s29, s48, 0
    s_cbranch_scc1 C_W0
    s_waitcnt vmcnt(0)
    s_branch C_W1
C_W0:
    buffer_load_dwordx4 v[66:69], v3, s[4:7], s51 offen offset:0 sc1
    buffer_load_dwordx4 v[66:69], v3, s[4:7], s51 offen offset:1024 sc1
    buffer_load_dwordx4 v[66:69], v3, s[4:7], s51 offen offset:2048 sc1
    buffer_load_dwordx4 v[66:69], v3, s[4:7], s51 offen offset:3072 sc1
    s_add_u32 s48, s36, 0x0
    buffer_load_dword v66, v7, s[4:7], s48 offen sc1
    s_add_u32 s48, s36, 0x8000
    buffer_load_dword v66, v7, s[4:7], s48 offen sc1
    s_add_u32 s48, s36, 0x10000
    buffer_load_dword v66, v7, s[4:7], s48 offen sc1
    s_add_u32 s48, s36, 0x18000
    buffer_load_dword v66, v7, s[4:7], s48 offen sc1
    buffer_load_dwordx4 v[66:69], v3, s[4:7], s46 offen offset:0 sc1
    buffer_load_dwordx4 v[66:69], v3, s[4:7], s46 offen offset:1024 sc1
    buffer_load_dwordx4 v[66:69], v3, s[4:7], s46 offen offset:2048 sc1
    buffer_load_dwordx4 v[66:69], v3, s[4:7], s46 offen offset:3072 sc1
C_W1:
    s_barrier
    ds_write_b128 v0, v[8:11] offset:16384
    ds_write_b128 v0, v[12:15] offset:17408
    ds_write_b128 v0, v[16:19] offset:18432
    ds_write_b128 v0, v[20:23] offset:19456
    ds_write_b128 v0, v[24:27] offset:20480
    ds_write_b128 v0, v[28:31] offset:21504
    ds_write_b128 v0, v[32:35] offset:22528
    ds_write_b128 v0, v[36:39] offset:23552
    s_waitcnt lgkmcnt(0)
    v_add_u32 v62, s47, v74
    v_add_u32 v63, s33, v74
    ds_read_b64_tr_b16 v[40:41], v62 offset:24576
    ds_read_b64_tr_b16 v[42:43], v62 offset:24832
    ds_read_b64_tr_b16 v[44:45], v62 offset:25600
    ds_read_b64_tr_b16 v[46:47], v62 offset:25856
    ds_read_b64_tr_b16 v[48:49], v62 offset:24640
    ds_read_b64_tr_b16 v[50:51], v62 offset:24896
    ds_read_b64_tr_b16 v[52:53], v62 offset:25664
    ds_read_b64_tr_b16 v[54:55], v62 offset:25920
    s_waitcnt vmcnt(12) lgkmcnt(0)
    s_barrier
    ds_write_b128 v0, v[40:43] offset:24576
    ds_write_b128 v0, v[44:47] offset:25600
    ds_write_b128 v0, v[48:51] offset:26624
    ds_write_b128 v0, v[52:55] offset:27648
    s_waitcnt lgkmcnt(0)
    v_add_u32 v62, s47, v73
    v_xor_b32 v63, 64, v62
    v_add_u32 v64, s33, v73
    v_xor_b32 v65, 64, v64
    ds_read_b64_tr_b16 v[8:9], v62 offset:28672
    ds_read_b64_tr_b16 v[10:11], v62 offset:28800
    ds_read_b64_tr_b16 v[12:13], v62 offset:32768
    ds_read_b64_tr_b16 v[14:15], v62 offset:32896
    ds_read_b64_tr_b16 v[16:17], v63 offset:28672
    ds_read_b64_tr_b16 v[18:19], v63 offset:28800
    ds_read_b64_tr_b16 v[20:21], v63 offset:32768
    ds_read_b64_tr_b16 v[22:23], v63 offset:32896
    s_waitcnt lgkmcnt(4)
    ds_read_b64_tr_b16 v[24:25], v64 offset:28672
    ds_read_b64_tr_b16 v[26:27], v64 offset:28800
    ds_read_b64_tr_b16 v[28:29], v64 offset:32768
    ds_read_b64_tr_b16 v[30:31], v64 offset:32896
    ds_read_b64_tr_b16 v[32:33], v65 offset:28672
    ds_read_b64_tr_b16 v[34:35], v65 offset:28800
    ds_read_b64_tr_b16 v[36:37], v65 offset:32768
    ds_read_b64_tr_b16 v[38:39], v65 offset:32896
    s_waitcnt lgkmcnt(0)
    s_barrier
    ds_write_b128 v0, v[8:11] offset:28672
    ds_write_b128 v0, v[12:15] offset:29696
    ds_write_b128 v0, v[16:19] offset:30720
    ds_write_b128 v0, v[20:23] offset:31744
    ds_write_b128 v0, v[24:27] offset:32768
    ds_write_b128 v0, v[28:31] offset:33792
    ds_write_b128 v0, v[32:35] offset:34816
    ds_write_b128 v0, v[36:39] offset:35840
    s_waitcnt lgkmcnt(0)
    s_mul_i32 s48, s24, 18432
    s_mul_i32 s49, s26, 64
    s_add_u32 s48, s48, s49
    s_add_u32 s12, s48, 0x200000
    s_mul_i32 s48, s24, 36864
    s_mul_i32 s49, s26, 128
    s_add_u32 s48, s48, s49
    s_add_u32 s13, s48, 0x228000
    s_mul_i32 s48, s24, 18432
    s_mul_i32 s49, s26, 64
    s_add_u32 s48, s48, s49
    s_add_u32 s14, s48, 0x214000
    s_mul_i32 s48, s24, 9216
    s_mul_i32 s49, s26, 32
    s_add_u32 s48, s48, s49
    s_add_u32 s15, s48, 0x250000
    s_mov_b32 s17, 0x4e800000
    s_mov_b32 s19, 0x100000
    s_mov_b32 s20, 0x3f803f80
    s_mov_b32 s21, s20
    s_mov_b32 s22, 0x000f000f
    s_mov_b32 s23, s22
    s_and_b32 s16, s26, 0
    s_mul_i32 s16, s16, 9216
    s_mov_b32 s96, s30
    s_mov_b32 s97, s96
    s_cmp_eq_u32 s29, 2
    s_cbranch_scc1 C_GO
    s_cmp_eq_u32 s29, 1
    s_cbranch_scc1 C_QF
    v_mov_b32 v8, 244
    s_mov_b32 s27, 0
SP_46:
    buffer_load_dword v9, v8, s[8:11], 0 offen sc1
    s_waitcnt vmcnt(0)
    v_cmp_gt_u32 vcc, 18, v9
    s_cbranch_vccz SD_47
    s_add_u32 s27, s27, 1
    s_cmp_lt_u32 s27, 400000
    s_cbranch_scc1 SP_46
    s_movk_i32 s27, 1
    s_branch FAIL
SD_47:
    v_mov_b32 v8, 36
    s_mov_b32 s27, 0
CB_48:
    buffer_load_dword v9, v8, s[8:11], 0 offen sc1
    s_waitcnt vmcnt(0)
    v_readfirstlane_b32 s54, v9
    s_and_b32 s48, s54, 0xffff
    s_cmp_ge_u32 s48, 64
    s_cbranch_scc1 CB_48_ok
    s_add_u32 s27, s27, 1
    s_cmp_lt_u32 s27, 400000
    s_cbranch_scc1 CB_48
    s_movk_i32 s27, 8
    s_branch FAIL
CB_48_ok:
    buffer_load_dwordx4 v[8:11], v3, s[4:7], s51 offen offset:0 sc1
    buffer_load_dwordx4 v[8:11], v3, s[4:7], s51 offen offset:1024 sc1
    buffer_load_dwordx4 v[8:11], v3, s[4:7], s51 offen offset:2048 sc1
    buffer_load_dwordx4 v[8:11], v3, s[4:7], s51 offen offset:3072 sc1
    s_add_u32 s48, s36, 0x0
    buffer_load_dword v8, v7, s[4:7], s48 offen sc1
    s_add_u32 s48, s36, 0x8000
    buffer_load_dword v8, v7, s[4:7], s48 offen sc1
    s_add_u32 s48, s36, 0x10000
    buffer_load_dword v8, v7, s[4:7], s48 offen sc1
    s_add_u32 s48, s36, 0x18000
    buffer_load_dword v8, v7, s[4:7], s48 offen sc1
    buffer_load_dwordx4 v[8:11], v3, s[4:7], s46 offen offset:0 sc1
    buffer_load_dwordx4 v[8:11], v3, s[4:7], s46 offen offset:1024 sc1
    buffer_load_dwordx4 v[8:11], v3, s[4:7], s46 offen offset:2048 sc1
    buffer_load_dwordx4 v[8:11], v3, s[4:7], s46 offen offset:3072 sc1
    s_waitcnt vmcnt(0)
C_QF:
    v_and_b32 v8, 0x23, v60
    v_lshlrev_b32 v8, 2, v8
    s_mov_b32 s27, 0
SP_49:
    buffer_load_dword v12, v8, s[4:7], s53 offen sc1
    s_waitcnt vmcnt(0)
    v_cmp_gt_u32 vcc, 2, v12
    s_cbranch_vccz SD_50
    s_add_u32 s27, s27, 1
    s_cmp_lt_u32 s27, 400000
    s_cbranch_scc1 SP_49
    s_movk_i32 s27, 9
    s_branch FAIL
SD_50:
C_GO:
    s_waitcnt vmcnt(0)
    s_barrier
    s_mov_b32 s32, 0
    s_mov_b32 s27, 10
    s_mov_b32 s31, 0
    s_lshr_b32 s54, s54, 16
    s_cselect_b32 s48, 4, 0
    s_add_u32 s48, s48, s24
    s_cmp_eq_u32 s48, 0
    s_cbranch_scc1 CF0_IN
    s_cmp_eq_u32 s48, 1
    s_cbranch_scc1 CF1_IN
    s_cmp_eq_u32 s48, 2
    s_cbranch_scc1 CF2_IN
    s_cmp_eq_u32 s48, 3
    s_cbranch_scc1 CF3_IN
    s_cmp_eq_u32 s48, 4
    s_cbranch_scc1 CM0_IN
    s_cmp_eq_u32 s48, 5
    s_cbranch_scc1 CM1_IN
    s_cmp_eq_u32 s48, 6
    s_cbranch_scc1 CM2_IN
    s_cmp_eq_u32 s48, 7
    s_cbranch_scc1 CM3_IN
    s_endpgm
CF0_IN:
    s_add_u32 s45, s38, 32768
    s_add_u32 s34, s19, 2048
    s_add_u32 s35, s19, 6144
    s_add_u32 s33, s19, s16
    buffer_load_dwordx4 v[8:11], v3, s[4:7], s33 offen offset:0 sc1
    buffer_load_dwordx4 v[12:15], v3, s[4:7], s33 offen offset:1024 sc1
    s_mov_b32 s29, 0
    s_mov_b32 m0, 4096
    s_mov_b32 s18, 1
CF0_FF:
    ds_read_b128 v[72:75], v0 offset:12288
    ds_read_b128 v[76:79], v0 offset:13312
    ds_read_b128 v[64:67], v0 offset:28672
    ds_read_b128 v[68:71], v0 offset:29696
    ds_read_b128 v[24:27], v0 offset:14336
    ds_read_b128 v[28:31], v0 offset:15360
    ds_read_b128 v[32:35], v0 offset:30720
    ds_read_b128 v[36:39], v0 offset:31744
    v_mov_b64 v[40:41], 0
    v_mov_b64 v[42:43], 0
    v_mov_b64 v[44:45], 0
    v_mov_b64 v[46:47], 0
    v_mov_b64 v[48:49], 0
    v_mov_b64 v[50:51], 0
    v_mov_b64 v[52:53], 0
    v_mov_b64 v[54:55], 0
    v_mov_b64 v[56:57], 0
    v_mov_b64 v[58:59], 0
    v_mov_b64 v[60:61], 0
    v_mov_b64 v[62:63], 0
    s_waitcnt vmcnt(0) lgkmcnt(0)
    buffer_load_dwordx4 v[16:19], v3, s[4:7], s34 offen offset:0 sc1
    buffer_load_dwordx4 v[20:23], v3, s[4:7], s34 offen offset:1024 sc1
    s_branch CF0_A
CF0_T:
    buffer_load_dwordx4 v[8:11], v3, s[4:7], s33 offen offset:0 sc1
    buffer_load_dwordx4 v[12:15], v3, s[4:7], s33 offen offset:1024 sc1
    s_waitcnt vmcnt(8)
    v_maximum3_f32 v2, v8, v9, v10
    v_maximum3_f32 v2, v2, v11, v12
    v_maximum3_f32 v2, v2, v13, v14
    v_cmp_u_f32 vcc, v2, v15
    s_cbranch_vccz CF0_FX
    buffer_load_dwordx4 v[8:11], v3, s[4:7], s33 offen offset:0 sc1
    buffer_load_dwordx4 v[12:15], v3, s[4:7], s33 offen offset:1024 sc1
    s_waitcnt vmcnt(8)
    v_maximum3_f32 v2, v8, v9, v10
    v_maximum3_f32 v2, v2, v11, v12
    v_maximum3_f32 v2, v2, v13, v14
    v_cmp_u_f32 vcc, v2, v15
    s_cbranch_vccz CF0_FX
CF0_FE:
    buffer_load_dwordx4 v[8:11], v3, s[4:7], s33 offen offset:0 sc1
    buffer_load_dwordx4 v[12:15], v3, s[4:7], s33 offen offset:1024 sc1
    s_waitcnt vmcnt(8)
    v_maximum3_f32 v2, v8, v9, v10
    v_maximum3_f32 v2, v2, v11, v12
    ds_write_b128 v3, v[8:11] offset:7168
    v_maximum3_f32 v2, v2, v13, v14
    v_cmp_u_f32 vcc, v2, v15
    ds_write_b128 v3, v[12:15] offset:8192
    s_cbranch_vccz CF0_CE
    buffer_load_dwordx4 v[8:11], v3, s[4:7], s33 offen offset:0 sc1
    buffer_load_dwordx4 v[12:15], v3, s[4:7], s33 offen offset:1024 sc1
    s_waitcnt vmcnt(8)
    v_maximum3_f32 v2, v8, v9, v10
    v_maximum3_f32 v2, v2, v11, v12
    ds_write_b128 v3, v[8:11] offset:7168
    v_maximum3_f32 v2, v2, v13, v14
    v_cmp_u_f32 vcc, v2, v15
    ds_write_b128 v3, v[12:15] offset:8192
    s_cbranch_vccz CF0_CE
    buffer_load_dwordx4 v[8:11], v3, s[4:7], s33 offen offset:0 sc1
    buffer_load_dwordx4 v[12:15], v3, s[4:7], s33 offen offset:1024 sc1
    s_waitcnt vmcnt(8)
    v_maximum3_f32 v2, v8, v9, v10
    v_maximum3_f32 v2, v2, v11, v12
    ds_write_b128 v3, v[8:11] offset:7168
    v_maximum3_f32 v2, v2, v13, v14
    v_cmp_u_f32 vcc, v2, v15
    ds_write_b128 v3, v[12:15] offset:8192
    s_cbranch_vccz CF0_CE
    buffer_load_dwordx4 v[8:11], v3, s[4:7], s33 offen offset:0 sc1
    buffer_load_dwordx4 v[12:15], v3, s[4:7], s33 offen offset:1024 sc1
    s_waitcnt vmcnt(8)
    v_maximum3_f32 v2, v8, v9, v10
    v_maximum3_f32 v2, v2, v11, v12
    ds_write_b128 v3, v[8:11] offset:7168
    v_maximum3_f32 v2, v2, v13, v14
    v_cmp_u_f32 vcc, v2, v15
    ds_write_b128 v3, v[12:15] offset:8192
    s_cbranch_vccz CF0_CE
    buffer_load_dwordx4 v[8:11], v3, s[4:7], s33 offen offset:0 sc1
    buffer_load_dwordx4 v[12:15], v3, s[4:7], s33 offen offset:1024 sc1
    s_waitcnt vmcnt(8)
    v_maximum3_f32 v2, v8, v9, v10
    v_maximum3_f32 v2, v2, v11, v12
    ds_write_b128 v3, v[8:11] offset:7168
    v_maximum3_f32 v2, v2, v13, v14
    v_cmp_u_f32 vcc, v2, v15
    ds_write_b128 v3, v[12:15] offset:8192
    s_cbranch_vccz CF0_CE
    buffer_load_dwordx4 v[8:11], v3, s[4:7], s33 offen offset:0 sc1
    buffer_load_dwordx4 v[12:15], v3, s[4:7], s33 offen offset:1024 sc1
    s_waitcnt vmcnt(8)
    v_maximum3_f32 v2, v8, v9, v10
    v_maximum3_f32 v2, v2, v11, v12
    ds_write_b128 v3, v[8:11] offset:7168
    v_maximum3_f32 v2, v2, v13, v14
    v_cmp_u_f32 vcc, v2, v15
    ds_write_b128 v3, v[12:15] offset:8192
    s_cbranch_vccz CF0_CE
    s_add_u32 s29, s29, 1
    s_cmp_lt_u32 s29, 8
    s_cbranch_scc1 EX_51
    v_cmp_eq_u32 vcc, s30, v8
    v_cmp_eq_u32 s[48:49], s30, v9
    s_or_b64 vcc, vcc, s[48:49]
    v_cmp_eq_u32 s[48:49], s30, v10
    s_or_b64 vcc, vcc, s[48:49]
    v_cmp_eq_u32 s[48:49], s30, v11
    s_or_b64 vcc, vcc, s[48:49]
    v_cmp_eq_u32 s[48:49], s30, v12
    s_or_b64 vcc, vcc, s[48:49]
    v_cmp_eq_u32 s[48:49], s30, v13
    s_or_b64 vcc, vcc, s[48:49]
    v_cmp_eq_u32 s[48:49], s30, v14
    s_or_b64 vcc, vcc, s[48:49]
    v_cmp_eq_u32 s[48:49], s30, v15
    s_or_b64 vcc, vcc, s[48:49]
    s_cbranch_vccz CF0_FX
EX_51:
    s_add_u32 s31, s31, 1
    s_cmp_ge_u32 s31, 400000
    s_cbranch_scc1 FAIL
    s_branch CF0_FE
CF0_FX:
    s_waitcnt vmcnt(8)
    v_maximum3_f32 v2, v8, v9, v10
    v_maximum3_f32 v2, v2, v11, v12
    ds_write_b128 v3, v[8:11] offset:7168
    v_maximum3_f32 v2, v2, v13, v14
    v_cmp_u_f32 vcc, v2, v15
    ds_write_b128 v3, v[12:15] offset:8192
CF0_CE:
    s_barrier
    buffer_load_dwordx4 v[16:19], v3, s[4:7], s34 offen offset:0 sc1
    v_mov_b64 v[48:49], 0
    v_mov_b64 v[50:51], 0
    v_mov_b64 v[52:53], 0
    v_mov_b64 v[54:55], 0
    v_mov_b64 v[56:57], 0
    v_mov_b64 v[58:59], 0
    v_mov_b64 v[40:41], 0
    v_mov_b64 v[42:43], 0
    s_waitcnt lgkmcnt(0)
    s_barrier
    buffer_load_dwordx4 v[20:23], v3, s[4:7], s34 offen offset:1024 sc1
    s_cmp_eq_u32 s32, 63
    s_cbranch_scc1 CF0_LAST
CF0_A:
    v_smfmac_f32_16x16x64_bf16 v[40:43], v[8:11], v[72:79], v1
    v_smfmac_f32_16x16x64_bf16 v[48:51], v[8:11], v[64:71], v1
    ds_read_b128 v[64:67], v0 offset:32768
    v_smfmac_f32_16x16x64_bf16 v[44:47], v[8:11], v[24:31], v1
    ds_read_b128 v[68:71], v0 offset:33792
    v_mov_b32 v2, s30
    v_smfmac_f32_16x16x64_bf16 v[52:55], v[8:11], v[32:39], v1
    buffer_store_dword v2, v7, s[4:7], s37 offen
    ds_read_b128 v[24:27], v0 offset:34816
    v_smfmac_f32_16x16x64_bf16 v[56:59], v[8:11], a[216:223], v1
    ds_read_b128 v[28:31], v0 offset:35840
    v_smfmac_f32_16x16x64_bf16 v[60:63], v[8:11], a[224:231], v1
    ds_read_b128 v[32:35], v0 offset:4096
    v_smfmac_f32_16x16x64_bf16 v[40:43], v[12:15], a[0:7], v1
    ds_read_b128 v[36:39], v0 offset:5120
    s_waitcnt lgkmcnt(4)
    v_smfmac_f32_16x16x64_bf16 v[48:51], v[12:15], v[64:71], v1
    v_smfmac_f32_16x16x64_bf16 v[44:47], v[12:15], a[8:15], v1
    s_waitcnt lgkmcnt(2)
    v_smfmac_f32_16x16x64_bf16 v[52:55], v[12:15], v[24:31], v1
    buffer_load_dwordx4 v[72:75], v3, s[4:7], s46 offen offset:2048 sc1
    ds_read_b128 v[24:27], v0 offset:16384
    v_smfmac_f32_16x16x64_bf16 v[56:59], v[12:15], a[232:239], v1
    buffer_load_dwordx4 v[76:79], v3, s[4:7], s46 offen offset:3072 sc1
    ds_read_b128 v[28:31], v0 offset:17408
    s_waitcnt lgkmcnt(2)
    v_smfmac_f32_16x16x64_bf16 v[60:63], v[12:15], v[32:39], v1
    ds_read_b128 v[32:35], v0 offset:18432
    ds_read_b128 v[36:39], v0 offset:19456
    s_waitcnt vmcnt(4)
    v_smfmac_f32_16x16x64_bf16 v[40:43], v[16:19], a[16:23], v1
    ds_write_b128 v3, v[16:19] offset:0
    v_and_b32 v64, 128, v3
    v_smfmac_f32_16x16x64_bf16 v[48:51], v[16:19], a[120:127], v1
    v_mad_u32_u24 v64, v64, 31, v3
    v_smfmac_f32_16x16x64_bf16 v[44:47], v[16:19], a[24:31], v1
    buffer_load_dwordx4 v[68:71], v64, s[4:7], s50 offen offset:0 sc1
    v_maximum3_f32 v2, v16, v17, v18
    v_smfmac_f32_16x16x64_bf16 v[52:55], v[16:19], a[128:135], v1
    buffer_load_dwordx4 v[64:67], v64, s[4:7], s38 offen offset:0 sc1
    s_waitcnt lgkmcnt(3)
    v_cmp_u_f32 vcc, v2, v19
    v_smfmac_f32_16x16x64_bf16 v[56:59], v[16:19], v[24:31], v1
    s_waitcnt lgkmcnt(1)
    v_smfmac_f32_16x16x64_bf16 v[60:63], v[16:19], v[32:39], v1
    s_cbranch_vccnz CF0_FB
CF0_CB:
    s_waitcnt lgkmcnt(0)
    s_barrier
    s_waitcnt vmcnt(5)
    v_smfmac_f32_16x16x64_bf16 v[40:43], v[20:23], a[32:39], v1
    s_mov_b64 exec, s[22:23]
    buffer_store_dword v6, v7, s[4:7], s39 offen sc1
    s_mov_b64 exec, -1
    ds_read_b128 v[8:11], v3 offset:2048
    v_smfmac_f32_16x16x64_bf16 v[48:51], v[20:23], a[136:143], v1
    ds_read_b128 v[12:15], v3 offset:3072
    v_smfmac_f32_16x16x64_bf16 v[44:47], v[20:23], a[40:47], v1
    ds_read_b128 v[32:35], v0 offset:0
    s_mov_b32 s37, s36
    v_smfmac_f32_16x16x64_bf16 v[52:55], v[20:23], a[144:151], v1
    s_barrier
    ds_read_b128 v[36:39], v0 offset:1024
    s_waitcnt lgkmcnt(3)
    v_smfmac_f32_16x16x64_bf16 v[40:43], v[8:11], a[48:55], v1
    ds_read_b128 v[28:31], v3 offset:4096
    s_add_u32 s36, s36, 0x8000
    v_smfmac_f32_16x16x64_bf16 v[44:47], v[8:11], a[56:63], v1
    ds_read_b128 v[24:27], v3 offset:6144
    s_bitset0_b32 s36, 17
    s_waitcnt lgkmcnt(4)
    v_smfmac_f32_16x16x64_bf16 v[40:43], v[12:15], a[64:71], v1
    ds_read_b128 v[16:19], v3 offset:5120
    s_add_u32 s32, s32, 1
    v_smfmac_f32_16x16x64_bf16 v[44:47], v[12:15], a[72:79], v1
    ds_read_b32 v2, v3 offset:13568
    s_waitcnt lgkmcnt(3)
    v_smfmac_f32_16x16x64_bf16 v[40:43], v[28:31], v[32:39], v1
    ds_read_b128 v[32:35], v0 offset:2048
    s_add_u32 s39, s39, 9216
    v_smfmac_f32_16x16x64_bf16 v[44:47], v[28:31], a[80:87], v1
    ds_read_b128 v[36:39], v0 offset:3072
    s_mov_b32 s29, 0
    s_waitcnt lgkmcnt(4)
    v_smfmac_f32_16x16x64_bf16 v[40:43], v[24:27], a[104:111], v1
    s_waitcnt lgkmcnt(3)
    v_smfmac_f32_16x16x64_bf16 v[40:43], v[16:19], a[88:95], v1
    v_smfmac_f32_16x16x64_bf16 v[44:47], v[24:27], a[112:119], v1
    v_smfmac_f32_16x16x64_bf16 v[44:47], v[16:19], a[96:103], v1
    s_waitcnt lgkmcnt(0)
    v_add_f32 v40, v40, v41
    v_smfmac_f32_16x16x64_bf16 v[48:51], v[8:11], v[32:39], v1
    ds_read_b128 v[32:35], v0 offset:8192
    v_add_f32 v42, v42, v43
    v_smfmac_f32_16x16x64_bf16 v[52:55], v[8:11], a[152:159], v1
    ds_read_b128 v[36:39], v0 offset:9216
    v_add_f32 v44, v44, v45
    v_add_f32 v46, v46, v47
    v_cvt_pk_bf16_f32 v40, v40, v44
    v_cvt_pk_bf16_f32 v41, v42, v46
    v_smfmac_f32_16x16x64_bf16 v[48:51], v[12:15], a[160:167], v1
    ds_write_b64 v4, v[40:41] offset:7168
    v_cmp_u_f32 vcc, v40, v41
    v_smfmac_f32_16x16x64_bf16 v[52:55], v[12:15], a[168:175], v1
    v_smfmac_f32_16x16x64_bf16 v[48:51], v[28:31], a[176:183], v1
    s_cbranch_vccnz CF0_RE
CF0_RJ:
    v_smfmac_f32_16x16x64_bf16 v[52:55], v[28:31], a[184:191], v1
    s_add_u32 s19, s19, 0x8000
    s_waitcnt lgkmcnt(1)
    v_smfmac_f32_16x16x64_bf16 v[48:51], v[24:27], v[32:39], v1
    s_waitcnt lgkmcnt(0)
    s_barrier
    v_smfmac_f32_16x16x64_bf16 v[48:51], v[16:19], a[192:199], v1
    ds_read_b64_tr_b16 v[40:41], v5 offset:7168
    ds_read_b64_tr_b16 v[42:43], v5 offset:7936
    v_smfmac_f32_16x16x64_bf16 v[52:55], v[24:27], a[208:215], v1
    ds_read_b64_tr_b16 v[44:45], v5 offset:8704
    ds_read_b64_tr_b16 v[46:47], v5 offset:9472
    v_smfmac_f32_16x16x64_bf16 v[52:55], v[16:19], a[200:207], v1
    ds_read_b128 v[32:35], v0 offset:6144
    v_add_f32 v48, v48, v49
    v_smfmac_f32_16x16x64_bf16 v[56:59], v[8:11], v[80:87], v1
    ds_read_b128 v[36:39], v0 offset:7168
    s_waitcnt vmcnt(1) lgkmcnt(4)
    v_add_f32 v50, v50, v51
    v_mfma_f32_16x16x32_bf16 v[64:67], v[40:43], v[64:67], 0
    s_waitcnt lgkmcnt(2)
    v_add_f32 v52, v52, v53
    v_add_f32 v54, v54, v55
    v_mfma_f32_16x16x32_bf16 v[64:67], v[44:47], v[68:71], v[64:67]
    v_cvt_pk_bf16_f32 v48, v48, v52
    v_cvt_pk_bf16_f32 v49, v50, v54
    v_smfmac_f32_16x16x64_bf16 v[60:63], v[8:11], v[88:95], v1
    ds_write_b64 v4, v[48:49] offset:0
    s_bitset0_b32 s19, 17
    v_smfmac_f32_16x16x64_bf16 v[56:59], v[12:15], v[96:103], v1
    s_add_u32 s34, s19, 2048
    s_waitcnt lgkmcnt(1)
    v_add_f32_dpp v64, v65, v64 row_ror:8 row_mask:0xf bank_mask:0xf
    v_add_f32_dpp v64, v66, v67 row_ror:8 row_mask:0xf bank_mask:0xc
    v_exp_f32 v64, v64
    s_nop 0
    v_cvt_pk_bf16_f32 v64, v64, v64
    v_smfmac_f32_16x16x64_bf16 v[60:63], v[12:15], v[32:39], v1
    ds_write_b16 v2, v64 offset:10496
    v_smfmac_f32_16x16x64_bf16 v[56:59], v[16:19], v[120:127], v1
    ds_read_b128 v[8:11], v0 offset:20480
    s_add_u32 s35, s19, 6144
    v_mov_b64 v[32:33], s[20:21]
    v_smfmac_f32_16x16x64_bf16 v[60:63], v[16:19], v[128:135], v1
    ds_read_b128 v[12:15], v0 offset:21504
    s_add_u32 s33, s19, s16
    v_mov_b64 v[34:35], s[20:21]
    v_smfmac_f32_16x16x64_bf16 v[56:59], v[20:23], a[240:247], v1
    s_waitcnt lgkmcnt(2)
    s_barrier
    v_smfmac_f32_16x16x64_bf16 v[60:63], v[20:23], a[248:255], v1
    ds_read_b64_tr_b16 v[48:49], v5 offset:0
    ds_read_b64_tr_b16 v[50:51], v5 offset:768
    v_smfmac_f32_16x16x64_bf16 v[56:59], v[24:27], v[136:143], v1
    ds_read_b64_tr_b16 v[52:53], v5 offset:1536
    ds_read_b64_tr_b16 v[54:55], v5 offset:2304
    v_smfmac_f32_16x16x64_bf16 v[56:59], v[28:31], v[104:111], v1
    ds_read_b128 v[64:67], v3 offset:10496
    v_mov_b64 v[36:37], 0
    v_smfmac_f32_16x16x64_bf16 v[60:63], v[24:27], v[144:151], v1
    ds_read_b128 v[68:71], v3 offset:10480
    s_waitcnt lgkmcnt(4)
    v_mov_b64 v[38:39], 0
    v_mfma_f32_16x16x32_bf16 v[48:51], v[48:51], v[40:43], 0
    ds_read_b128 v[16:19], v0 offset:24576
    s_waitcnt lgkmcnt(3)
    v_add_f32 v56, v56, v57
    v_add_f32 v58, v58, v59
    v_mfma_f32_16x16x32_bf16 v[48:51], v[52:55], v[44:47], v[48:51]
    ds_read_b128 v[20:23], v0 offset:25600
    v_cvt_pk_bf16_f32 v56, v56, v58
    v_smfmac_f32_16x16x64_bf16 v[60:63], v[28:31], v[112:119], v1
    ds_read_b128 v[24:27], v0 offset:26624
    s_waitcnt lgkmcnt(4)
    v_mfma_f32_16x16x32_bf16 v[52:55], v[32:35], v[64:67], 0
    ds_read_b128 v[28:31], v0 offset:27648
    v_add_f32_dpp v48, v49, v48 quad_perm:[1,0,3,2] row_mask:0xf bank_mask:0xf
    v_add_f32_dpp v50, v51, v50 quad_perm:[1,0,3,2] row_mask:0xf bank_mask:0xf
    v_mfma_f32_16x16x32_bf16 v[72:75], v[72:75], v[64:67], 0
    s_waitcnt lgkmcnt(4)
    v_mul_f32 v48, s44, v48
    v_mul_f32 v50, s44, v50
    v_exp_f32 v48, v48
    v_exp_f32 v50, v50
    v_add_f32 v60, v60, v61
    v_cvt_pk_bf16_f32 v48, v48, v50
    v_cndmask_b32 v48, 0, v48, s[40:41]
    v_mfma_f32_16x16x32_bf16 v[72:75], v[76:79], v[68:71], v[72:75]
    ds_read_b128 v[64:67], v0 offset:22528
    v_mov_b32_dpp v49, v48 quad_perm:[1,0,3,2] row_mask:0xf bank_mask:0xf
    v_add_f32 v62, v62, v63
    v_cvt_pk_bf16_f32 v57, v60, v62
    v_mfma_f32_16x16x16_bf16 v[52:55], v[32:33], v[48:49], v[52:55]
    ds_read_b128 v[32:35], v3 offset:14592
    ds_read_b128 v[68:71], v0 offset:23552
    v_mov_b64 v[40:41], 0
    v_mfma_f32_16x16x16_bf16 v[72:75], v[56:57], v[48:49], v[72:75]
    v_mov_b64 v[42:43], 0
    v_mov_b64 v[44:45], 0
    v_mov_b64 v[46:47], 0
    v_mov_b64 v[60:61], 0
    v_rcp_f32_dpp v53, v52 quad_perm:[0,0,2,2] row_mask:0xf bank_mask:0xf
    v_mov_b64 v[62:63], 0
    v_max_u32 v52, v52, v53
    v_cmp_lt_u32 vcc, s17, v52
    v_mul_f32 v72, v72, v53
    v_mul_f32 v73, v73, v53
    v_mul_f32 v74, v74, v53
    v_mul_f32 v75, v75, v53
    v_cvt_pk_bf16_f32 v72, v72, v73
    v_cvt_pk_bf16_f32 v73, v74, v75
    ds_write_b64 v4, v[72:73] offset:4096
    v_mov_b32_dpp v76, v72 quad_perm:[0,0,2,2] row_mask:0xf bank_mask:0xf
    v_mov_b32_dpp v77, v73 quad_perm:[0,0,2,2] row_mask:0xf bank_mask:0xf
    v_mov_b32_dpp v78, v72 quad_perm:[1,1,3,3] row_mask:0xf bank_mask:0xf
    v_mov_b32_dpp v79, v73 quad_perm:[1,1,3,3] row_mask:0xf bank_mask:0xf
    s_cbranch_vccnz CF0_SLOW
CF0_FAST:
    s_nop 0
    v_smfmac_f32_16x16x64_bf16 v[40:43], v[76:79], v[8:15], v1
    s_waitcnt lgkmcnt(6)
    v_smfmac_f32_16x16x64_bf16 v[44:47], v[76:79], v[16:23], v1
    s_waitcnt lgkmcnt(0)
    s_barrier
    ds_read_b128 v[48:51], v32 offset:4864
    ds_read_b128 v[52:55], v32 offset:5632
    ds_read_b128 v[56:59], v32 offset:6400
    v_smfmac_f32_16x16x64_bf16 v[60:63], v[76:79], v[24:31], v1
    s_add_u32 s38, s38, 32768
    s_add_u32 s50, s50, 32768
    v_smfmac_f32_16x16x64_bf16 v[36:39], v[76:79], v[64:71], v1
    s_add_u32 s46, s46, 32768
    ds_read_b128 v[24:27], v0 offset:10240
    s_waitcnt lgkmcnt(3)
    v_lshrrev_b32 v32, 16, v1
    v_smfmac_f32_16x16x64_bf16 v[40:43], v[48:51], v[192:199], v1
    ds_read_b128 v[28:31], v0 offset:11264
    s_waitcnt lgkmcnt(3)
    v_smfmac_f32_16x16x64_bf16 v[40:43], v[52:55], v[208:215], v1
    ds_read_b128 v[72:75], v33 offset:4096
    s_waitcnt lgkmcnt(3)
    v_smfmac_f32_16x16x64_bf16 v[40:43], v[56:59], v[224:231], v1
    ds_read_b128 v[76:79], v33 offset:5632
    v_smfmac_f32_16x16x64_bf16 v[44:47], v[48:51], v[152:159], v1
    ds_read_b128 v[64:67], v0 offset:28672
    v_smfmac_f32_16x16x64_bf16 v[44:47], v[52:55], v[168:175], v1
    ds_read_b128 v[68:71], v0 offset:29696
    v_cvt_pk_bf16_f32 v40, v40, v41
    v_cvt_pk_bf16_f32 v41, v42, v43
    v_bfi_b32 v40, 1, s32, v40
    buffer_store_dwordx2 v[40:41], v34, s[4:7], s12 offen
    s_waitcnt lgkmcnt(4)
    v_smfmac_f32_16x16x64_bf16 v[44:47], v[56:59], v[24:31], v1
    v_mov_b64 v[40:41], 0
    v_smfmac_f32_16x16x64_bf16 v[60:63], v[48:51], v[160:167], v1
    ds_read_b128 v[24:27], v0 offset:14336
    v_mov_b64 v[42:43], 0
    v_smfmac_f32_16x16x64_bf16 v[60:63], v[52:55], v[176:183], v1
    ds_read_b128 v[28:31], v0 offset:15360
    v_cvt_pk_bf16_f32 v44, v44, v45
    v_smfmac_f32_16x16x64_bf16 v[60:63], v[56:59], v[184:191], v1
    buffer_load_dwordx4 v[8:11], v3, s[4:7], s51 offen offset:0 sc1
    buffer_load_dwordx4 v[12:15], v3, s[4:7], s51 offen offset:1024 sc1
    s_waitcnt lgkmcnt(4)
    v_cvt_pk_bf16_f32 v45, v46, v47
    v_smfmac_f32_16x16x64_bf16 v[40:43], v[72:75], v[240:247], v1
    v_bfi_b32 v44, 1, s32, v44
    v_smfmac_f32_16x16x64_bf16 v[40:43], v[76:79], v[248:255], v1
    ds_read_b128 v[72:75], v0 offset:12288
    buffer_load_dwordx4 v[16:19], v3, s[4:7], s51 offen offset:0 sc1
    buffer_load_dwordx4 v[20:23], v3, s[4:7], s51 offen offset:1024 sc1
    v_cvt_pk_bf16_f32 v46, v60, v61
    v_cvt_pk_bf16_f32 v47, v62, v63
    buffer_store_dwordx4 v[44:47], v32, s[4:7], s13 offen
    v_smfmac_f32_16x16x64_bf16 v[36:39], v[48:51], v[200:207], v1
    ds_read_b128 v[76:79], v0 offset:13312
    v_smfmac_f32_16x16x64_bf16 v[36:39], v[52:55], v[216:223], v1
    ds_read_b128 v[44:47], v3 offset:11520
    buffer_load_dwordx4 v[48:51], v3, s[4:7], s51 offen offset:0 sc1
    buffer_load_dwordx4 v[52:55], v3, s[4:7], s51 offen offset:1024 sc1
    v_add_f32 v40, v40, v41
    v_smfmac_f32_16x16x64_bf16 v[36:39], v[56:59], v[232:239], v1
    v_add_f32 v42, v42, v43
    v_cvt_pk_bf16_f32 v40, v40, v42
    v_bfi_b32 v40, 1, s32, v40
    buffer_store_dword v40, v35, s[4:7], s15 offen
    s_nop 3
    v_cvt_pk_bf16_f32 v36, v36, v37
    v_cvt_pk_bf16_f32 v37, v38, v39
    v_bfi_b32 v36, 1, s32, v36
    buffer_store_dwordx2 v[36:37], v34, s[4:7], s14 offen
    buffer_load_dwordx4 v[40:43], v3, s[4:7], s51 offen offset:0 sc1
    buffer_load_dwordx4 v[56:59], v3, s[4:7], s51 offen offset:1024 sc1
    s_waitcnt lgkmcnt(0)
CF0_R0:
    s_waitcnt vmcnt(10)
    v_mfma_f32_16x16x32_bf16 v[60:63], v[44:47], v[8:11], 0
    v_bitop3_b32 v2, v8, v10, s32 bitop3:0x7e
    s_waitcnt vmcnt(9)
    v_mfma_f32_16x16x32_bf16 v[60:63], v[44:47], v[12:15], v[60:63]
    v_bitop3_b32 v6, v12, v14, s32 bitop3:0x7e
    v_bitop3_b32 v2, v2, v6, 1 bitop3:0xa8
    v_cmp_ne_u32 vcc, 0, v2
    v_mov_b64 v[8:9], s[96:97]
    v_mov_b64 v[10:11], s[96:97]
    v_mov_b64 v[12:13], s[96:97]
    v_mov_b64 v[14:15], s[96:97]
    s_nop 0
    v_add_f32_dpp v60, v60, v60 row_ror:8 row_mask:0xf bank_mask:0xf
    v_add_f32_dpp v61, v61, v61 row_ror:8 row_mask:0xf bank_mask:0xf
    s_cbranch_vccz CF0_RC
CF0_R1:
    s_waitcnt vmcnt(8)
    v_mfma_f32_16x16x32_bf16 v[60:63], v[44:47], v[16:19], 0
    v_bitop3_b32 v2, v16, v18, s32 bitop3:0x7e
    s_waitcnt vmcnt(7)
    v_mfma_f32_16x16x32_bf16 v[60:63], v[44:47], v[20:23], v[60:63]
    v_bitop3_b32 v6, v20, v22, s32 bitop3:0x7e
    v_bitop3_b32 v2, v2, v6, 1 bitop3:0xa8
    v_cmp_ne_u32 vcc, 0, v2
    s_nop 4
    v_add_f32_dpp v60, v60, v60 row_ror:8 row_mask:0xf bank_mask:0xf
    v_add_f32_dpp v61, v61, v61 row_ror:8 row_mask:0xf bank_mask:0xf
    s_cbranch_vccz CF0_RC
CF0_R2:
    buffer_load_dwordx4 v[16:19], v3, s[4:7], s51 offen offset:0 sc1
    buffer_load_dwordx4 v[20:23], v3, s[4:7], s51 offen offset:1024 sc1
    s_waitcnt vmcnt(7)
    v_mfma_f32_16x16x32_bf16 v[60:63], v[44:47], v[48:51], 0
    v_bitop3_b32 v2, v48, v50, s32 bitop3:0x7e
    s_waitcnt vmcnt(6)
    v_mfma_f32_16x16x32_bf16 v[60:63], v[44:47], v[52:55], v[60:63]
    v_bitop3_b32 v6, v52, v54, s32 bitop3:0x7e
    v_bitop3_b32 v2, v2, v6, 1 bitop3:0xa8
    v_cmp_ne_u32 vcc, 0, v2
    s_nop 4
    v_add_f32_dpp v60, v60, v60 row_ror:8 row_mask:0xf bank_mask:0xf
    v_add_f32_dpp v61, v61, v61 row_ror:8 row_mask:0xf bank_mask:0xf
    s_cbranch_vccnz CF0_R3
CF0_RC:
    s_barrier
    s_nop 0
    v_add_f32_dpp v60, v60, v60 row_ror:4 row_mask:0xf bank_mask:0xf
    v_add_f32_dpp v61, v61, v61 row_ror:4 row_mask:0xf bank_mask:0xf
    v_cvt_pk_bf16_f32 v6, v60, v61
    buffer_store_dword v6, v7, s[4:7], s36 offen
    buffer_load_dwordx4 v[8:11], v3, s[4:7], s33 offen offset:0 sc1
    buffer_load_dwordx4 v[12:15], v3, s[4:7], s33 offen offset:1024 sc1
    s_barrier
    ds_read_b128 v[32:35], v0 offset:30720
    ds_read_b128 v[36:39], v0 offset:31744
    v_mov_b64 v[44:45], 0
    v_mov_b64 v[46:47], 0
    v_mov_b64 v[60:61], 0
    v_mov_b64 v[62:63], 0
    s_branch CF0_T
CF0_FB:
    s_add_u32 s29, s29, 1
    s_cmp_lt_u32 s29, 8
    s_cbranch_scc1 EX_52
    v_cmp_eq_u32 vcc, s30, v16
    v_cmp_eq_u32 s[48:49], s30, v17
    s_or_b64 vcc, vcc, s[48:49]
    v_cmp_eq_u32 s[48:49], s30, v18
    s_or_b64 vcc, vcc, s[48:49]
    v_cmp_eq_u32 s[48:49], s30, v19
    s_or_b64 vcc, vcc, s[48:49]
    s_cbranch_vccz CF0_CB
EX_52:
    s_add_u32 s31, s31, 1
    s_cmp_ge_u32 s31, 400000
    s_cbranch_scc1 FAIL
    s_waitcnt vmcnt(0)
    s_branch CF0_FF
CF0_RE:
    s_waitcnt vmcnt(0) lgkmcnt(0)
    v_mov_b64 v[40:41], 0
    v_mov_b64 v[42:43], 0
    v_mov_b64 v[44:45], 0
    v_mov_b64 v[46:47], 0
    s_nop 1
    v_mov_b64 v[48:49], 0
    v_mov_b64 v[50:51], 0
    v_mov_b64 v[52:53], 0
    v_mov_b64 v[54:55], 0
    v_mov_b64 v[56:57], 0
    v_mov_b64 v[58:59], 0
    v_mov_b64 v[60:61], 0
    v_mov_b64 v[62:63], 0
    s_add_u32 s31, s31, 1
    s_cmp_ge_u32 s31, 400000
    s_cbranch_scc1 FAIL
CF0_L0:
    buffer_load_dwordx4 v[8:11], v3, s[4:7], s33 offen offset:0 sc1
    s_add_u32 s31, s31, 1
    s_cmp_ge_u32 s31, 400000
    s_cbranch_scc1 FAIL
    s_waitcnt vmcnt(0)
    v_cmp_eq_u32 vcc, s30, v8
    v_cmp_eq_u32 s[48:49], s30, v9
    s_or_b64 vcc, vcc, s[48:49]
    v_cmp_eq_u32 s[48:49], s30, v10
    s_or_b64 vcc, vcc, s[48:49]
    v_cmp_eq_u32 s[48:49], s30, v11
    s_or_b64 vcc, vcc, s[48:49]
    s_cbranch_vccnz CF0_L0
    ds_read_b128 v[32:35], v0 offset:12288
    ds_read_b128 v[36:39], v0 offset:13312
    s_waitcnt lgkmcnt(0)
    v_smfmac_f32_16x16x64_bf16 v[40:43], v[8:11], v[32:39], v1
    ds_read_b128 v[32:35], v0 offset:28672
    ds_read_b128 v[36:39], v0 offset:29696
    s_waitcnt lgkmcnt(0)
    v_smfmac_f32_16x16x64_bf16 v[48:51], v[8:11], v[32:39], v1
    ds_read_b128 v[32:35], v0 offset:14336
    ds_read_b128 v[36:39], v0 offset:15360
    s_waitcnt lgkmcnt(0)
    v_smfmac_f32_16x16x64_bf16 v[44:47], v[8:11], v[32:39], v1
    ds_read_b128 v[32:35], v0 offset:30720
    ds_read_b128 v[36:39], v0 offset:31744
    s_waitcnt lgkmcnt(0)
    v_smfmac_f32_16x16x64_bf16 v[52:55], v[8:11], v[32:39], v1
    v_smfmac_f32_16x16x64_bf16 v[56:59], v[8:11], a[216:223], v1
    v_smfmac_f32_16x16x64_bf16 v[60:63], v[8:11], a[224:231], v1
CF0_L1:
    buffer_load_dwordx4 v[12:15], v3, s[4:7], s33 offen offset:1024 sc1
    s_add_u32 s31, s31, 1
    s_cmp_ge_u32 s31, 400000
    s_cbranch_scc1 FAIL
    s_waitcnt vmcnt(0)
    v_cmp_eq_u32 vcc, s30, v12
    v_cmp_eq_u32 s[48:49], s30, v13
    s_or_b64 vcc, vcc, s[48:49]
    v_cmp_eq_u32 s[48:49], s30, v14
    s_or_b64 vcc, vcc, s[48:49]
    v_cmp_eq_u32 s[48:49], s30, v15
    s_or_b64 vcc, vcc, s[48:49]
    s_cbranch_vccnz CF0_L1
    v_smfmac_f32_16x16x64_bf16 v[40:43], v[12:15], a[0:7], v1
    ds_read_b128 v[32:35], v0 offset:32768
    ds_read_b128 v[36:39], v0 offset:33792
    s_waitcnt lgkmcnt(0)
    v_smfmac_f32_16x16x64_bf16 v[48:51], v[12:15], v[32:39], v1
    v_smfmac_f32_16x16x64_bf16 v[44:47], v[12:15], a[8:15], v1
    ds_read_b128 v[32:35], v0 offset:34816
    ds_read_b128 v[36:39], v0 offset:35840
    s_waitcnt lgkmcnt(0)
    v_smfmac_f32_16x16x64_bf16 v[52:55], v[12:15], v[32:39], v1
    v_smfmac_f32_16x16x64_bf16 v[56:59], v[12:15], a[232:239], v1
    ds_read_b128 v[32:35], v0 offset:4096
    ds_read_b128 v[36:39], v0 offset:5120
    s_waitcnt lgkmcnt(0)
    v_smfmac_f32_16x16x64_bf16 v[60:63], v[12:15], v[32:39], v1
CF0_L2:
    buffer_load_dwordx4 v[16:19], v3, s[4:7], s34 offen offset:0 sc1
    s_add_u32 s31, s31, 1
    s_cmp_ge_u32 s31, 400000
    s_cbranch_scc1 FAIL
    s_waitcnt vmcnt(0)
    v_cmp_eq_u32 vcc, s30, v16
    v_cmp_eq_u32 s[48:49], s30, v17
    s_or_b64 vcc, vcc, s[48:49]
    v_cmp_eq_u32 s[48:49], s30, v18
    s_or_b64 vcc, vcc, s[48:49]
    v_cmp_eq_u32 s[48:49], s30, v19
    s_or_b64 vcc, vcc, s[48:49]
    s_cbranch_vccnz CF0_L2
    v_smfmac_f32_16x16x64_bf16 v[40:43], v[16:19], a[16:23], v1
    v_smfmac_f32_16x16x64_bf16 v[48:51], v[16:19], a[120:127], v1
    v_smfmac_f32_16x16x64_bf16 v[44:47], v[16:19], a[24:31], v1
    v_smfmac_f32_16x16x64_bf16 v[52:55], v[16:19], a[128:135], v1
    ds_read_b128 v[32:35], v0 offset:16384
    ds_read_b128 v[36:39], v0 offset:17408
    s_waitcnt lgkmcnt(0)
    v_smfmac_f32_16x16x64_bf16 v[56:59], v[16:19], v[32:39], v1
    ds_read_b128 v[32:35], v0 offset:18432
    ds_read_b128 v[36:39], v0 offset:19456
    s_waitcnt lgkmcnt(0)
    v_smfmac_f32_16x16x64_bf16 v[60:63], v[16:19], v[32:39], v1
CF0_L3:
    buffer_load_dwordx4 v[20:23], v3, s[4:7], s34 offen offset:1024 sc1
    s_add_u32 s31, s31, 1
    s_cmp_ge_u32 s31, 400000
    s_cbranch_scc1 FAIL
    s_waitcnt vmcnt(0)
    v_cmp_eq_u32 vcc, s30, v20
    v_cmp_eq_u32 s[48:49], s30, v21
    s_or_b64 vcc, vcc, s[48:49]
    v_cmp_eq_u32 s[48:49], s30, v22
    s_or_b64 vcc, vcc, s[48:49]
    v_cmp_eq_u32 s[48:49], s30, v23
    s_or_b64 vcc, vcc, s[48:49]
    s_cbranch_vccnz CF0_L3
    v_smfmac_f32_16x16x64_bf16 v[40:43], v[20:23], a[32:39], v1
    v_smfmac_f32_16x16x64_bf16 v[48:51], v[20:23], a[136:143], v1
    v_smfmac_f32_16x16x64_bf16 v[44:47], v[20:23], a[40:47], v1
    v_smfmac_f32_16x16x64_bf16 v[52:55], v[20:23], a[144:151], v1
CF0_L4:
    buffer_load_dwordx4 v[8:11], v3, s[4:7], s34 offen offset:2048 sc1
    s_add_u32 s31, s31, 1
    s_cmp_ge_u32 s31, 400000
    s_cbranch_scc1 FAIL
    s_waitcnt vmcnt(0)
    v_cmp_eq_u32 vcc, s30, v8
    v_cmp_eq_u32 s[48:49], s30, v9
    s_or_b64 vcc, vcc, s[48:49]
    v_cmp_eq_u32 s[48:49], s30, v10
    s_or_b64 vcc, vcc, s[48:49]
    v_cmp_eq_u32 s[48:49], s30, v11
    s_or_b64 vcc, vcc, s[48:49]
    s_cbranch_vccnz CF0_L4
    v_smfmac_f32_16x16x64_bf16 v[40:43], v[8:11], a[48:55], v1
    v_smfmac_f32_16x16x64_bf16 v[44:47], v[8:11], a[56:63], v1
CF0_L5:
    buffer_load_dwordx4 v[12:15], v3, s[4:7], s34 offen offset:3072 sc1
    s_add_u32 s31, s31, 1
    s_cmp_ge_u32 s31, 400000
    s_cbranch_scc1 FAIL
    s_waitcnt vmcnt(0)
    v_cmp_eq_u32 vcc, s30, v12
    v_cmp_eq_u32 s[48:49], s30, v13
    s_or_b64 vcc, vcc, s[48:49]
    v_cmp_eq_u32 s[48:49], s30, v14
    s_or_b64 vcc, vcc, s[48:49]
    v_cmp_eq_u32 s[48:49], s30, v15
    s_or_b64 vcc, vcc, s[48:49]
    s_cbranch_vccnz CF0_L5
    v_smfmac_f32_16x16x64_bf16 v[40:43], v[12:15], a[64:71], v1
    v_smfmac_f32_16x16x64_bf16 v[44:47], v[12:15], a[72:79], v1
CF0_L6:
    buffer_load_dwordx4 v[28:31], v3, s[4:7], s35 offen offset:0 sc1
    s_add_u32 s31, s31, 1
    s_cmp_ge_u32 s31, 400000
    s_cbranch_scc1 FAIL
    s_waitcnt vmcnt(0)
    v_cmp_eq_u32 vcc, s30, v28
    v_cmp_eq_u32 s[48:49], s30, v29
    s_or_b64 vcc, vcc, s[48:49]
    v_cmp_eq_u32 s[48:49], s30, v30
    s_or_b64 vcc, vcc, s[48:49]
    v_cmp_eq_u32 s[48:49], s30, v31
    s_or_b64 vcc, vcc, s[48:49]
    s_cbranch_vccnz CF0_L6
    ds_read_b128 v[32:35], v0 offset:0
    ds_read_b128 v[36:39], v0 offset:1024
    s_waitcnt lgkmcnt(0)
    v_smfmac_f32_16x16x64_bf16 v[40:43], v[28:31], v[32:39], v1
    v_smfmac_f32_16x16x64_bf16 v[44:47], v[28:31], a[80:87], v1
CF0_L8:
    buffer_load_dwordx4 v[24:27], v3, s[4:7], s35 offen offset:2048 sc1
    s_add_u32 s31, s31, 1
    s_cmp_ge_u32 s31, 400000
    s_cbranch_scc1 FAIL
    s_waitcnt vmcnt(0)
    v_cmp_eq_u32 vcc, s30, v24
    v_cmp_eq_u32 s[48:49], s30, v25
    s_or_b64 vcc, vcc, s[48:49]
    v_cmp_eq_u32 s[48:49], s30, v26
    s_or_b64 vcc, vcc, s[48:49]
    v_cmp_eq_u32 s[48:49], s30, v27
    s_or_b64 vcc, vcc, s[48:49]
    s_cbranch_vccnz CF0_L8
    v_smfmac_f32_16x16x64_bf16 v[40:43], v[24:27], a[104:111], v1
CF0_L7:
    buffer_load_dwordx4 v[16:19], v3, s[4:7], s35 offen offset:1024 sc1
    s_add_u32 s31, s31, 1
    s_cmp_ge_u32 s31, 400000
    s_cbranch_scc1 FAIL
    s_waitcnt vmcnt(0)
    v_cmp_eq_u32 vcc, s30, v16
    v_cmp_eq_u32 s[48:49], s30, v17
    s_or_b64 vcc, vcc, s[48:49]
    v_cmp_eq_u32 s[48:49], s30, v18
    s_or_b64 vcc, vcc, s[48:49]
    v_cmp_eq_u32 s[48:49], s30, v19
    s_or_b64 vcc, vcc, s[48:49]
    s_cbranch_vccnz CF0_L7
    v_smfmac_f32_16x16x64_bf16 v[40:43], v[16:19], a[88:95], v1
    v_smfmac_f32_16x16x64_bf16 v[44:47], v[24:27], a[112:119], v1
    v_smfmac_f32_16x16x64_bf16 v[44:47], v[16:19], a[96:103], v1
    ds_read_b128 v[32:35], v0 offset:2048
    ds_read_b128 v[36:39], v0 offset:3072
    s_waitcnt lgkmcnt(0)
    v_smfmac_f32_16x16x64_bf16 v[48:51], v[8:11], v[32:39], v1
    v_smfmac_f32_16x16x64_bf16 v[52:55], v[8:11], a[152:159], v1
    v_smfmac_f32_16x16x64_bf16 v[48:51], v[12:15], a[160:167], v1
    v_smfmac_f32_16x16x64_bf16 v[52:55], v[12:15], a[168:175], v1
    v_smfmac_f32_16x16x64_bf16 v[48:51], v[28:31], a[176:183], v1
    ds_read_b128 v[32:35], v0 offset:8192
    ds_read_b128 v[36:39], v0 offset:9216
    v_add_f32 v40, v40, v41
    v_add_f32 v42, v42, v43
    v_add_f32 v44, v44, v45
    v_add_f32 v46, v46, v47
    v_cvt_pk_bf16_f32 v40, v40, v44
    v_cvt_pk_bf16_f32 v41, v42, v46
    ds_write_b64 v4, v[40:41] offset:7168
    s_waitcnt lgkmcnt(0)
    s_branch CF0_RJ
CF0_SLOW:
    ds_read_b64_tr_b16 v[40:41], v5 offset:7168
    ds_read_b64_tr_b16 v[48:49], v5 offset:0
    ds_read_b64_tr_b16 v[42:43], v5 offset:7936
    ds_read_b64_tr_b16 v[50:51], v5 offset:768
    ds_read_b64_tr_b16 v[44:45], v5 offset:8704
    ds_read_b64_tr_b16 v[52:53], v5 offset:1536
    ds_read_b64_tr_b16 v[46:47], v5 offset:9472
    ds_read_b64_tr_b16 v[54:55], v5 offset:2304
    s_waitcnt vmcnt(0) lgkmcnt(0)
    v_and_b32 v64, 128, v3
    v_mad_u32_u24 v64, v64, 31, v3
    buffer_load_dwordx4 v[68:71], v64, s[4:7], s50 offen offset:0 sc1
    buffer_load_dwordx4 v[76:79], v3, s[4:7], s46 offen offset:3072 sc1
    buffer_load_dwordx4 v[64:67], v64, s[4:7], s38 offen offset:0 sc1
    buffer_load_dwordx4 v[72:75], v3, s[4:7], s46 offen offset:2048 sc1
    v_mfma_f32_16x16x32_bf16 v[48:51], v[48:51], v[40:43], 0
    v_mfma_f32_16x16x32_bf16 v[48:51], v[52:55], v[44:47], v[48:51]
    v_lshrrev_b32 v38, 2, v3
    v_and_b32 v38, 0xe0, v38
    v_and_b32 v39, 0xe0, v3
    s_nop 4
    v_add_f32_dpp v48, v49, v48 quad_perm:[1,0,3,2] row_mask:0xf bank_mask:0xf
    v_add_f32_dpp v50, v51, v50 quad_perm:[1,0,3,2] row_mask:0xf bank_mask:0xf
    v_mul_f32 v48, s44, v48
    v_mul_f32 v50, s44, v50
    v_mov_b64 v[32:33], s[20:21]
    v_mov_b64 v[34:35], s[20:21]
    s_waitcnt vmcnt(0)
    ds_read_b32 v2, v3 offset:13568
    v_mfma_f32_16x16x32_bf16 v[64:67], v[40:43], v[64:67], 0
    v_mfma_f32_16x16x32_bf16 v[64:67], v[44:47], v[68:71], v[64:67]
    v_max_f32 v37, v48, v50
    v_mov_b32 v36, v37
    s_nop 1
    v_permlane16_swap_b32 v36, v37
    v_max_f32 v37, v36, v37
    v_mov_b32 v36, v37
    s_nop 1
    v_permlane32_swap_b32 v36, v37
    v_max_f32 v37, v36, v37
    v_add_f32_dpp v64, v65, v64 row_ror:8 row_mask:0xf bank_mask:0xf
    v_add_f32_dpp v64, v66, v67 row_ror:8 row_mask:0xf bank_mask:0xc
    s_nop 1
    v_max_f32_dpp v36, v64, v64 quad_perm:[1,0,3,2] row_mask:0xf bank_mask:0xf
    s_nop 1
    v_max_f32_dpp v36, v36, v36 quad_perm:[2,3,0,1] row_mask:0xf bank_mask:0xf
    s_nop 1
    v_max_f32_dpp v36, v36, v36 row_half_mirror row_mask:0xf bank_mask:0xf
    ds_write_b32 v38, v36 offset:15616
    s_mov_b64 exec, s[40:41]
    ds_write_b32 v39, v37 offset:15632
    s_mov_b64 exec, -1
    s_waitcnt lgkmcnt(0)
    s_barrier
    ds_read_b128 v[40:43], v38 offset:15616
    ds_read_b32 v36, v38 offset:15632
    ds_read_b128 v[44:47], v39 offset:15616
    ds_read_b32 v37, v39 offset:15632
    s_waitcnt lgkmcnt(0)
    v_max3_f32 v36, v36, v40, v41
    v_max3_f32 v36, v36, v42, v43
    v_max3_f32 v37, v37, v44, v45
    v_max3_f32 v37, v37, v46, v47
    v_sub_f32 v64, v64, v36
    v_exp_f32 v64, v64
    v_sub_f32 v48, v48, v37
    v_exp_f32 v48, v48
    v_sub_f32 v50, v50, v37
    v_exp_f32 v50, v50
    v_cvt_pk_bf16_f32 v64, v64, v64
    ds_write_b16 v2, v64 offset:10496
    v_cvt_pk_bf16_f32 v48, v48, v50
    v_cndmask_b32 v48, 0, v48, s[40:41]
    s_nop 1
    v_mov_b32_dpp v49, v48 quad_perm:[1,0,3,2] row_mask:0xf bank_mask:0xf
    s_waitcnt lgkmcnt(0)
    s_barrier
    ds_read_b128 v[64:67], v3 offset:10496
    ds_read_b128 v[68:71], v3 offset:10480
    s_waitcnt lgkmcnt(0)
    v_mfma_f32_16x16x32_bf16 v[72:75], v[72:75], v[64:67], 0
    v_mfma_f32_16x16x32_bf16 v[72:75], v[76:79], v[68:71], v[72:75]
    v_mfma_f32_16x16x32_bf16 v[52:55], v[32:35], v[64:67], 0
    s_nop 5
    v_mfma_f32_16x16x16_bf16 v[52:55], v[32:33], v[48:49], v[52:55]
    v_mfma_f32_16x16x16_bf16 v[72:75], v[56:57], v[48:49], v[72:75]
    ds_read_b128 v[64:67], v0 offset:22528
    ds_read_b128 v[68:71], v0 offset:23552
    ds_read_b128 v[32:35], v3 offset:14592
    v_mov_b64 v[36:37], 0
    v_mov_b64 v[38:39], 0
    v_mov_b64 v[40:41], 0
    v_mov_b64 v[42:43], 0
    v_mov_b64 v[44:45], 0
    v_mov_b64 v[46:47], 0
    v_rcp_f32_dpp v53, v52 quad_perm:[0,0,2,2] row_mask:0xf bank_mask:0xf
    s_nop 0
    v_mul_f32 v72, v72, v53
    v_mul_f32 v73, v73, v53
    v_mul_f32 v74, v74, v53
    v_mul_f32 v75, v75, v53
    v_cvt_pk_bf16_f32 v72, v72, v73
    v_cvt_pk_bf16_f32 v73, v74, v75
    ds_write_b64 v4, v[72:73] offset:4096
    v_mov_b32_dpp v76, v72 quad_perm:[0,0,2,2] row_mask:0xf bank_mask:0xf
    v_mov_b32_dpp v77, v73 quad_perm:[0,0,2,2] row_mask:0xf bank_mask:0xf
    v_mov_b32_dpp v78, v72 quad_perm:[1,1,3,3] row_mask:0xf bank_mask:0xf
    v_mov_b32_dpp v79, v73 quad_perm:[1,1,3,3] row_mask:0xf bank_mask:0xf
    s_waitcnt lgkmcnt(0)
    s_branch CF0_FAST
CF0_R3:
    buffer_load_dwordx4 v[48:51], v3, s[4:7], s51 offen offset:0 sc1
    buffer_load_dwordx4 v[52:55], v3, s[4:7], s51 offen offset:1024 sc1
    s_waitcnt vmcnt(5)
    v_mfma_f32_16x16x32_bf16 v[60:63], v[44:47], v[40:43], 0
    v_bitop3_b32 v2, v40, v42, s32 bitop3:0x7e
    s_waitcnt vmcnt(4)
    v_mfma_f32_16x16x32_bf16 v[60:63], v[44:47], v[56:59], v[60:63]
    v_bitop3_b32 v6, v56, v58, s32 bitop3:0x7e
    v_bitop3_b32 v2, v2, v6, 1 bitop3:0xa8
    v_cmp_ne_u32 vcc, 0, v2
    s_nop 4
    v_add_f32_dpp v60, v60, v60 row_ror:8 row_mask:0xf bank_mask:0xf
    v_add_f32_dpp v61, v61, v61 row_ror:8 row_mask:0xf bank_mask:0xf
    s_cbranch_vccz CF0_RC
CF0_R4:
    buffer_load_dwordx4 v[40:43], v3, s[4:7], s51 offen offset:0 sc1
    buffer_load_dwordx4 v[56:59], v3, s[4:7], s51 offen offset:1024 sc1
    s_waitcnt vmcnt(5)
    v_mfma_f32_16x16x32_bf16 v[60:63], v[44:47], v[16:19], 0
    v_bitop3_b32 v2, v16, v18, s32 bitop3:0x7e
    s_waitcnt vmcnt(4)
    v_mfma_f32_16x16x32_bf16 v[60:63], v[44:47], v[20:23], v[60:63]
    v_bitop3_b32 v6, v20, v22, s32 bitop3:0x7e
    v_bitop3_b32 v2, v2, v6, 1 bitop3:0xa8
    v_cmp_ne_u32 vcc, 0, v2
    s_nop 4
    v_add_f32_dpp v60, v60, v60 row_ror:8 row_mask:0xf bank_mask:0xf
    v_add_f32_dpp v61, v61, v61 row_ror:8 row_mask:0xf bank_mask:0xf
    s_cbranch_vccz CF0_RC
CF0_R5:
    buffer_load_dwordx4 v[16:19], v3, s[4:7], s51 offen offset:0 sc1
    buffer_load_dwordx4 v[20:23], v3, s[4:7], s51 offen offset:1024 sc1
    s_waitcnt vmcnt(5)
    v_mfma_f32_16x16x32_bf16 v[60:63], v[44:47], v[48:51], 0
    v_bitop3_b32 v2, v48, v50, s32 bitop3:0x7e
    s_waitcnt vmcnt(4)
    v_mfma_f32_16x16x32_bf16 v[60:63], v[44:47], v[52:55], v[60:63]
    v_bitop3_b32 v6, v52, v54, s32 bitop3:0x7e
    v_bitop3_b32 v2, v2, v6, 1 bitop3:0xa8
    v_cmp_ne_u32 vcc, 0, v2
    s_nop 4
    v_add_f32_dpp v60, v60, v60 row_ror:8 row_mask:0xf bank_mask:0xf
    v_add_f32_dpp v61, v61, v61 row_ror:8 row_mask:0xf bank_mask:0xf
    s_cbranch_vccz CF0_RC
CF0_R6:
    buffer_load_dwordx4 v[48:51], v3, s[4:7], s51 offen offset:0 sc1
    buffer_load_dwordx4 v[52:55], v3, s[4:7], s51 offen offset:1024 sc1
    s_waitcnt vmcnt(5)
    v_mfma_f32_16x16x32_bf16 v[60:63], v[44:47], v[40:43], 0
    v_bitop3_b32 v2, v40, v42, s32 bitop3:0x7e
    s_waitcnt vmcnt(4)
    v_mfma_f32_16x16x32_bf16 v[60:63], v[44:47], v[56:59], v[60:63]
    v_bitop3_b32 v6, v56, v58, s32 bitop3:0x7e
    v_bitop3_b32 v2, v2, v6, 1 bitop3:0xa8
    v_cmp_ne_u32 vcc, 0, v2
    s_nop 4
    v_add_f32_dpp v60, v60, v60 row_ror:8 row_mask:0xf bank_mask:0xf
    v_add_f32_dpp v61, v61, v61 row_ror:8 row_mask:0xf bank_mask:0xf
    s_cbranch_vccz CF0_RC
    s_add_u32 s31, s31, 1
    s_cmp_ge_u32 s31, 400000
    s_cbranch_scc1 FAIL
    s_branch CF0_R4
CF0_RB:
    s_barrier
    s_branch CF0_RC
CF0_LAST:
    s_mov_b64 exec, s[22:23]
    buffer_store_dword v6, v7, s[4:7], s39 offen sc1
    s_mov_b64 exec, -1
    s_waitcnt vmcnt(0)
    s_branch C_END
CF1_IN:
    s_add_u32 s45, s38, 32768
    s_add_u32 s34, s19, 2048
    s_add_u32 s35, s19, 6144
    buffer_load_dwordx4 v[8:11], v3, s[4:7], s19 offen offset:1024 sc1
    buffer_load_dwordx4 v[12:15], v3, s[4:7], s19 offen offset:0 sc1
    s_mov_b32 s29, 0
    s_mov_b32 m0, 4096
    s_mov_b32 s18, 1
CF1_FF:
    ds_read_b128 v[72:75], v0 offset:12288
    ds_read_b128 v[76:79], v0 offset:13312
    ds_read_b128 v[64:67], v0 offset:28672
    ds_read_b128 v[68:71], v0 offset:29696
    ds_read_b128 v[24:27], v0 offset:14336
    ds_read_b128 v[28:31], v0 offset:15360
    ds_read_b128 v[32:35], v0 offset:30720
    ds_read_b128 v[36:39], v0 offset:31744
    v_mov_b64 v[40:41], 0
    v_mov_b64 v[42:43], 0
    v_mov_b64 v[44:45], 0
    v_mov_b64 v[46:47], 0
    v_mov_b64 v[48:49], 0
    v_mov_b64 v[50:51], 0
    v_mov_b64 v[52:53], 0
    v_mov_b64 v[54:55], 0
    v_mov_b64 v[56:57], 0
    v_mov_b64 v[58:59], 0
    v_mov_b64 v[60:61], 0
    v_mov_b64 v[62:63], 0
    s_waitcnt vmcnt(0) lgkmcnt(0)
    buffer_load_dwordx4 v[16:19], v3, s[4:7], s34 offen offset:1024 sc1
    buffer_load_dwordx4 v[20:23], v3, s[4:7], s34 offen offset:0 sc1
    s_branch CF1_A
CF1_T:
    s_barrier
    buffer_load_dwordx4 v[48:51], v3, s[4:7], s51 offen offset:0 sc1
    buffer_load_dwordx4 v[52:55], v3, s[4:7], s51 offen offset:1024 sc1
    buffer_load_dwordx4 v[40:43], v3, s[4:7], s51 offen offset:2048 sc1
    buffer_load_dwordx4 v[56:59], v3, s[4:7], s51 offen offset:3072 sc1
    s_barrier
    s_waitcnt vmcnt(3)
    v_mfma_f32_16x16x32_bf16 v[60:63], v[44:47], v[48:51], 0
    s_waitcnt vmcnt(2)
    v_mfma_f32_16x16x32_bf16 v[60:63], v[44:47], v[52:55], v[60:63]
    v_bitop3_b32 v2, v48, v52, s32 bitop3:0x7e
    s_waitcnt vmcnt(1)
    v_mfma_f32_16x16x32_bf16 v[60:63], v[44:47], v[40:43], v[60:63]
    s_waitcnt vmcnt(0)
    v_mfma_f32_16x16x32_bf16 v[60:63], v[44:47], v[56:59], v[60:63]
    v_bitop3_b32 v6, v40, v56, s32 bitop3:0x7e
    v_bitop3_b32 v2, v2, v6, 1 bitop3:0xa8
    v_cmp_ne_u32 vcc, 0, v2
    v_mov_b64 v[48:49], 0
    v_mov_b64 v[50:51], 0
    v_mov_b64 v[52:53], 0
    v_mov_b64 v[54:55], 0
    s_nop 0
    v_add_f32_dpp v60, v60, v60 row_ror:8 row_mask:0xf bank_mask:0xf
    v_add_f32_dpp v61, v61, v61 row_ror:8 row_mask:0xf bank_mask:0xf
    v_cvt_pk_bf16_f32 v6, v60, v61
    s_cbranch_vccnz CF1_R1
CF1_RC:
    buffer_store_dword v6, v7, s[4:7], s36 offen
    v_mov_b64 v[44:45], 0
    v_mov_b64 v[46:47], 0
    v_mov_b64 v[60:61], 0
    v_mov_b64 v[62:63], 0
    v_mov_b64 v[40:41], 0
    v_mov_b64 v[42:43], 0
    v_mov_b64 v[56:57], 0
    v_mov_b64 v[58:59], 0
    s_barrier
    buffer_load_dwordx4 v[16:19], v3, s[4:7], s34 offen offset:1024 sc1
    s_barrier
    ds_read_b128 v[8:11], v3 offset:8192
    ds_read_b128 v[12:15], v3 offset:7168
    buffer_load_dwordx4 v[20:23], v3, s[4:7], s34 offen offset:0 sc1
    s_cmp_eq_u32 s32, s18
    s_cbranch_scc1 CF1_SP
CF1_A:
    s_waitcnt lgkmcnt(1)
    v_smfmac_f32_16x16x64_bf16 v[40:43], v[8:11], v[72:79], v1
    v_smfmac_f32_16x16x64_bf16 v[48:51], v[8:11], v[64:71], v1
    ds_read_b128 v[64:67], v0 offset:32768
    v_smfmac_f32_16x16x64_bf16 v[44:47], v[8:11], v[24:31], v1
    ds_read_b128 v[68:71], v0 offset:33792
    v_mov_b32 v2, s30
    v_smfmac_f32_16x16x64_bf16 v[52:55], v[8:11], v[32:39], v1
    buffer_store_dword v2, v7, s[4:7], s37 offen
    ds_read_b128 v[24:27], v0 offset:34816
    v_smfmac_f32_16x16x64_bf16 v[56:59], v[8:11], a[216:223], v1
    ds_read_b128 v[28:31], v0 offset:35840
    v_smfmac_f32_16x16x64_bf16 v[60:63], v[8:11], a[224:231], v1
    buffer_load_dwordx4 v3, s[4:7], s35 offen offset:0 sc1 lds
    ds_read_b128 v[32:35], v0 offset:4096
    s_waitcnt lgkmcnt(5)
    v_smfmac_f32_16x16x64_bf16 v[40:43], v[12:15], a[0:7], v1
    ds_read_b128 v[36:39], v0 offset:5120
    s_waitcnt lgkmcnt(4)
    v_smfmac_f32_16x16x64_bf16 v[48:51], v[12:15], v[64:71], v1
    v_smfmac_f32_16x16x64_bf16 v[44:47], v[12:15], a[8:15], v1
    s_waitcnt lgkmcnt(2)
    v_smfmac_f32_16x16x64_bf16 v[52:55], v[12:15], v[24:31], v1
    buffer_load_dwordx4 v[72:75], v3, s[4:7], s46 offen offset:2048 sc1
    ds_read_b128 v[24:27], v0 offset:16384
    v_smfmac_f32_16x16x64_bf16 v[56:59], v[12:15], a[232:239], v1
    buffer_load_dwordx4 v[76:79], v3, s[4:7], s46 offen offset:3072 sc1
    ds_read_b128 v[28:31], v0 offset:17408
    s_waitcnt lgkmcnt(2)
    v_smfmac_f32_16x16x64_bf16 v[60:63], v[12:15], v[32:39], v1
    ds_read_b128 v[32:35], v0 offset:18432
    ds_read_b128 v[36:39], v0 offset:19456
    s_waitcnt vmcnt(5)
    v_smfmac_f32_16x16x64_bf16 v[40:43], v[16:19], a[16:23], v1
    ds_write_b128 v3, v[16:19] offset:1024
    v_and_b32 v64, 128, v3
    v_smfmac_f32_16x16x64_bf16 v[48:51], v[16:19], a[120:127], v1
    v_mad_u32_u24 v64, v64, 31, v3
    v_smfmac_f32_16x16x64_bf16 v[44:47], v[16:19], a[24:31], v1
    buffer_load_dwordx4 v[68:71], v64, s[4:7], s50 offen offset:128 sc1
    v_maximum3_f32 v2, v16, v17, v18
    v_smfmac_f32_16x16x64_bf16 v[52:55], v[16:19], a[128:135], v1
    buffer_load_dwordx4 v[64:67], v64, s[4:7], s38 offen offset:128 sc1
    s_waitcnt lgkmcnt(3)
    v_cmp_u_f32 vcc, v2, v19
    v_smfmac_f32_16x16x64_bf16 v[56:59], v[16:19], v[24:31], v1
    s_waitcnt lgkmcnt(1)
    v_smfmac_f32_16x16x64_bf16 v[60:63], v[16:19], v[32:39], v1
    s_cbranch_vccnz CF1_FB
CF1_CB:
    s_waitcnt lgkmcnt(0)
    s_barrier
    s_waitcnt vmcnt(6)
    v_smfmac_f32_16x16x64_bf16 v[40:43], v[20:23], a[32:39], v1
    buffer_store_dword v6, v7, s[4:7], s39 offen sc1
    ds_read_b128 v[8:11], v3 offset:3072
    v_lshlrev_b32 v6, 3, v3
    v_smfmac_f32_16x16x64_bf16 v[48:51], v[20:23], a[136:143], v1
    buffer_load_dword v6, v6, s[4:7], s45 offen sc1
    ds_read_b128 v[12:15], v3 offset:2048
    v_smfmac_f32_16x16x64_bf16 v[44:47], v[20:23], a[40:47], v1
    ds_read_b128 v[32:35], v0 offset:0
    s_mov_b32 s37, s36
    v_smfmac_f32_16x16x64_bf16 v[52:55], v[20:23], a[144:151], v1
    s_waitcnt vmcnt(6)
    s_barrier
    ds_read_b128 v[36:39], v0 offset:1024
    s_waitcnt lgkmcnt(3)
    v_smfmac_f32_16x16x64_bf16 v[40:43], v[8:11], a[48:55], v1
    ds_read_b128 v[28:31], v3 offset:4096
    s_add_u32 s36, s36, 0x8000
    v_smfmac_f32_16x16x64_bf16 v[44:47], v[8:11], a[56:63], v1
    ds_read_b128 v[24:27], v3 offset:6144
    s_bitset0_b32 s36, 17
    s_waitcnt lgkmcnt(4)
    v_smfmac_f32_16x16x64_bf16 v[40:43], v[12:15], a[64:71], v1
    ds_read_b128 v[16:19], v3 offset:5120
    s_add_u32 s32, s32, 1
    v_smfmac_f32_16x16x64_bf16 v[44:47], v[12:15], a[72:79], v1
    ds_read_b32 v2, v3 offset:13568
    s_waitcnt lgkmcnt(3)
    v_smfmac_f32_16x16x64_bf16 v[40:43], v[28:31], v[32:39], v1
    ds_read_b128 v[32:35], v0 offset:2048
    s_add_u32 s39, s39, 9216
    v_smfmac_f32_16x16x64_bf16 v[44:47], v[28:31], a[80:87], v1
    ds_read_b128 v[36:39], v0 offset:3072
    s_mov_b32 s29, 0
    s_waitcnt lgkmcnt(4)
    v_smfmac_f32_16x16x64_bf16 v[40:43], v[24:27], a[104:111], v1
    s_add_u32 s45, s45, 32768
    s_waitcnt lgkmcnt(3)
    v_smfmac_f32_16x16x64_bf16 v[40:43], v[16:19], a[88:95], v1
    v_smfmac_f32_16x16x64_bf16 v[44:47], v[24:27], a[112:119], v1
    v_smfmac_f32_16x16x64_bf16 v[44:47], v[16:19], a[96:103], v1
    s_waitcnt lgkmcnt(0)
    v_add_f32 v40, v40, v41
    v_smfmac_f32_16x16x64_bf16 v[48:51], v[8:11], v[32:39], v1
    ds_read_b128 v[32:35], v0 offset:8192
    v_add_f32 v42, v42, v43
    v_smfmac_f32_16x16x64_bf16 v[52:55], v[8:11], a[152:159], v1
    ds_read_b128 v[36:39], v0 offset:9216
    v_add_f32 v44, v44, v45
    v_add_f32 v46, v46, v47
    v_cvt_pk_bf16_f32 v40, v40, v44
    v_cvt_pk_bf16_f32 v41, v42, v46
    v_smfmac_f32_16x16x64_bf16 v[48:51], v[12:15], a[160:167], v1
    ds_write_b64 v4, v[40:41] offset:7936
    v_cmp_u_f32 vcc, v40, v41
    v_smfmac_f32_16x16x64_bf16 v[52:55], v[12:15], a[168:175], v1
    v_smfmac_f32_16x16x64_bf16 v[48:51], v[28:31], a[176:183], v1
    s_cbranch_vccnz CF1_RE
CF1_RJ:
    v_smfmac_f32_16x16x64_bf16 v[52:55], v[28:31], a[184:191], v1
    s_add_u32 s19, s19, 0x8000
    s_waitcnt lgkmcnt(1)
    v_smfmac_f32_16x16x64_bf16 v[48:51], v[24:27], v[32:39], v1
    s_waitcnt lgkmcnt(0)
    s_barrier
    v_smfmac_f32_16x16x64_bf16 v[48:51], v[16:19], a[192:199], v1
    ds_read_b64_tr_b16 v[40:41], v5 offset:7168
    ds_read_b64_tr_b16 v[42:43], v5 offset:7936
    v_smfmac_f32_16x16x64_bf16 v[52:55], v[24:27], a[208:215], v1
    ds_read_b64_tr_b16 v[44:45], v5 offset:8704
    ds_read_b64_tr_b16 v[46:47], v5 offset:9472
    v_smfmac_f32_16x16x64_bf16 v[52:55], v[16:19], a[200:207], v1
    ds_read_b128 v[32:35], v0 offset:6144
    v_add_f32 v48, v48, v49
    v_smfmac_f32_16x16x64_bf16 v[56:59], v[8:11], v[80:87], v1
    ds_read_b128 v[36:39], v0 offset:7168
    s_waitcnt vmcnt(2) lgkmcnt(4)
    v_add_f32 v50, v50, v51
    v_mfma_f32_16x16x32_bf16 v[64:67], v[40:43], v[64:67], 0
    s_waitcnt lgkmcnt(2)
    v_add_f32 v52, v52, v53
    v_add_f32 v54, v54, v55
    v_mfma_f32_16x16x32_bf16 v[64:67], v[44:47], v[68:71], v[64:67]
    v_cvt_pk_bf16_f32 v48, v48, v52
    v_cvt_pk_bf16_f32 v49, v50, v54
    v_smfmac_f32_16x16x64_bf16 v[60:63], v[8:11], v[88:95], v1
    ds_write_b64 v4, v[48:49] offset:768
    s_bitset0_b32 s19, 17
    v_smfmac_f32_16x16x64_bf16 v[56:59], v[12:15], v[96:103], v1
    s_add_u32 s34, s19, 2048
    s_waitcnt lgkmcnt(1)
    v_add_f32_dpp v64, v65, v64 row_ror:8 row_mask:0xf bank_mask:0xf
    v_add_f32_dpp v64, v66, v67 row_ror:8 row_mask:0xf bank_mask:0xc
    v_exp_f32 v64, v64
    s_nop 0
    v_cvt_pk_bf16_f32 v64, v64, v64
    v_smfmac_f32_16x16x64_bf16 v[60:63], v[12:15], v[32:39], v1
    ds_write_b16 v2, v64 offset:11008
    v_smfmac_f32_16x16x64_bf16 v[56:59], v[16:19], v[120:127], v1
    ds_read_b128 v[8:11], v0 offset:20480
    s_add_u32 s35, s19, 6144
    v_mov_b64 v[32:33], s[20:21]
    v_smfmac_f32_16x16x64_bf16 v[60:63], v[16:19], v[128:135], v1
    ds_read_b128 v[12:15], v0 offset:21504
    v_mov_b64 v[34:35], s[20:21]
    v_smfmac_f32_16x16x64_bf16 v[56:59], v[20:23], a[240:247], v1
    s_waitcnt lgkmcnt(2)
    s_barrier
    v_smfmac_f32_16x16x64_bf16 v[60:63], v[20:23], a[248:255], v1
    ds_read_b64_tr_b16 v[48:49], v5 offset:0
    ds_read_b64_tr_b16 v[50:51], v5 offset:768
    v_smfmac_f32_16x16x64_bf16 v[56:59], v[24:27], v[136:143], v1
    ds_read_b64_tr_b16 v[52:53], v5 offset:1536
    ds_read_b64_tr_b16 v[54:55], v5 offset:2304
    v_smfmac_f32_16x16x64_bf16 v[56:59], v[28:31], v[104:111], v1
    ds_read_b128 v[64:67], v3 offset:10496
    v_mov_b64 v[36:37], 0
    v_smfmac_f32_16x16x64_bf16 v[60:63], v[24:27], v[144:151], v1
    ds_read_b128 v[68:71], v3 offset:10480
    s_waitcnt lgkmcnt(4)
    v_mov_b64 v[38:39], 0
    v_mfma_f32_16x16x32_bf16 v[48:51], v[48:51], v[40:43], 0
    ds_read_b128 v[16:19], v0 offset:24576
    s_waitcnt lgkmcnt(3)
    v_add_f32 v56, v56, v57
    v_add_f32 v58, v58, v59
    v_mfma_f32_16x16x32_bf16 v[48:51], v[52:55], v[44:47], v[48:51]
    ds_read_b128 v[20:23], v0 offset:25600
    v_cvt_pk_bf16_f32 v56, v56, v58
    v_smfmac_f32_16x16x64_bf16 v[60:63], v[28:31], v[112:119], v1
    ds_read_b128 v[24:27], v0 offset:26624
    s_waitcnt lgkmcnt(4)
    v_mfma_f32_16x16x32_bf16 v[52:55], v[32:35], v[64:67], 0
    ds_read_b128 v[28:31], v0 offset:27648
    v_add_f32_dpp v48, v49, v48 quad_perm:[1,0,3,2] row_mask:0xf bank_mask:0xf
    v_add_f32_dpp v50, v51, v50 quad_perm:[1,0,3,2] row_mask:0xf bank_mask:0xf
    v_mfma_f32_16x16x32_bf16 v[72:75], v[72:75], v[64:67], 0
    s_waitcnt lgkmcnt(4)
    v_mul_f32 v48, s44, v48
    v_mul_f32 v50, s44, v50
    v_exp_f32 v48, v48
    v_exp_f32 v50, v50
    v_add_f32 v60, v60, v61
    v_cvt_pk_bf16_f32 v48, v48, v50
    v_cndmask_b32 v48, 0, v48, s[40:41]
    v_mfma_f32_16x16x32_bf16 v[72:75], v[76:79], v[68:71], v[72:75]
    ds_read_b128 v[64:67], v0 offset:22528
    v_mov_b32_dpp v49, v48 quad_perm:[1,0,3,2] row_mask:0xf bank_mask:0xf
    v_add_f32 v62, v62, v63
    v_cvt_pk_bf16_f32 v57, v60, v62
    v_mfma_f32_16x16x16_bf16 v[52:55], v[32:33], v[48:49], v[52:55]
    ds_read_b128 v[32:35], v3 offset:14592
    ds_read_b128 v[68:71], v0 offset:23552
    v_mov_b64 v[40:41], 0
    v_mfma_f32_16x16x16_bf16 v[72:75], v[56:57], v[48:49], v[72:75]
    v_mov_b64 v[42:43], 0
    v_mov_b64 v[44:45], 0
    v_mov_b64 v[46:47], 0
    v_mov_b64 v[60:61], 0
    v_rcp_f32_dpp v53, v52 quad_perm:[0,0,2,2] row_mask:0xf bank_mask:0xf
    v_mov_b64 v[62:63], 0
    v_max_u32 v52, v52, v53
    v_cmp_lt_u32 vcc, s17, v52
    v_mul_f32 v72, v72, v53
    v_mul_f32 v73, v73, v53
    v_mul_f32 v74, v74, v53
    v_mul_f32 v75, v75, v53
    v_cvt_pk_bf16_f32 v72, v72, v73
    v_cvt_pk_bf16_f32 v73, v74, v75
    ds_write_b64 v4, v[72:73] offset:4864
    v_mov_b32_dpp v76, v72 quad_perm:[0,0,2,2] row_mask:0xf bank_mask:0xf
    v_mov_b32_dpp v77, v73 quad_perm:[0,0,2,2] row_mask:0xf bank_mask:0xf
    v_mov_b32_dpp v78, v72 quad_perm:[1,1,3,3] row_mask:0xf bank_mask:0xf
    v_mov_b32_dpp v79, v73 quad_perm:[1,1,3,3] row_mask:0xf bank_mask:0xf
    s_cbranch_vccnz CF1_SLOW
CF1_FAST:
    s_nop 0
    v_smfmac_f32_16x16x64_bf16 v[40:43], v[76:79], v[8:15], v1
    s_waitcnt lgkmcnt(6)
    v_smfmac_f32_16x16x64_bf16 v[44:47], v[76:79], v[16:23], v1
    s_waitcnt lgkmcnt(0)
    s_barrier
    ds_read_b128 v[48:51], v32 offset:4096
    ds_read_b128 v[52:55], v32 offset:6400
    ds_read_b128 v[56:59], v32 offset:5632
    v_smfmac_f32_16x16x64_bf16 v[60:63], v[76:79], v[24:31], v1
    s_add_u32 s38, s38, 32768
    s_add_u32 s50, s50, 32768
    v_smfmac_f32_16x16x64_bf16 v[36:39], v[76:79], v[64:71], v1
    s_add_u32 s46, s46, 32768
    ds_read_b128 v[24:27], v0 offset:10240
    s_waitcnt lgkmcnt(3)
    v_lshrrev_b32 v32, 16, v1
    v_smfmac_f32_16x16x64_bf16 v[40:43], v[48:51], v[192:199], v1
    ds_read_b128 v[28:31], v0 offset:11264
    s_waitcnt lgkmcnt(3)
    v_smfmac_f32_16x16x64_bf16 v[40:43], v[52:55], v[208:215], v1
    ds_read_b128 v[72:75], v33 offset:4096
    s_waitcnt lgkmcnt(3)
    v_smfmac_f32_16x16x64_bf16 v[40:43], v[56:59], v[224:231], v1
    ds_read_b128 v[76:79], v33 offset:5632
    v_smfmac_f32_16x16x64_bf16 v[44:47], v[48:51], v[152:159], v1
    ds_read_b128 v[64:67], v0 offset:28672
    v_smfmac_f32_16x16x64_bf16 v[44:47], v[52:55], v[168:175], v1
    ds_read_b128 v[68:71], v0 offset:29696
    v_cvt_pk_bf16_f32 v40, v40, v41
    v_cvt_pk_bf16_f32 v41, v42, v43
    v_bfi_b32 v40, 1, s32, v40
    buffer_store_dwordx2 v[40:41], v34, s[4:7], s12 offen
    s_waitcnt lgkmcnt(4)
    v_smfmac_f32_16x16x64_bf16 v[44:47], v[56:59], v[24:31], v1
    v_mov_b64 v[40:41], 0
    v_smfmac_f32_16x16x64_bf16 v[60:63], v[48:51], v[160:167], v1
    ds_read_b128 v[24:27], v0 offset:14336
    v_mov_b64 v[42:43], 0
    v_smfmac_f32_16x16x64_bf16 v[60:63], v[52:55], v[176:183], v1
    ds_read_b128 v[28:31], v0 offset:15360
    v_cvt_pk_bf16_f32 v44, v44, v45
    v_smfmac_f32_16x16x64_bf16 v[60:63], v[56:59], v[184:191], v1
    s_waitcnt lgkmcnt(4)
    v_cvt_pk_bf16_f32 v45, v46, v47
    v_smfmac_f32_16x16x64_bf16 v[40:43], v[72:75], v[240:247], v1
    v_bfi_b32 v44, 1, s32, v44
    v_smfmac_f32_16x16x64_bf16 v[40:43], v[76:79], v[248:255], v1
    ds_read_b128 v[72:75], v0 offset:12288
    v_cvt_pk_bf16_f32 v46, v60, v61
    v_cvt_pk_bf16_f32 v47, v62, v63
    buffer_store_dwordx4 v[44:47], v32, s[4:7], s13 offen
    v_smfmac_f32_16x16x64_bf16 v[36:39], v[48:51], v[200:207], v1
    ds_read_b128 v[76:79], v0 offset:13312
    v_smfmac_f32_16x16x64_bf16 v[36:39], v[52:55], v[216:223], v1
    ds_read_b128 v[44:47], v3 offset:11520
    v_add_f32 v40, v40, v41
    v_smfmac_f32_16x16x64_bf16 v[36:39], v[56:59], v[232:239], v1
    v_add_f32 v42, v42, v43
    v_cvt_pk_bf16_f32 v40, v40, v42
    v_bfi_b32 v40, 1, s32, v40
    buffer_store_dword v40, v35, s[4:7], s15 offen
    s_nop 3
    v_cvt_pk_bf16_f32 v36, v36, v37
    v_cvt_pk_bf16_f32 v37, v38, v39
    v_bfi_b32 v36, 1, s32, v36
    buffer_store_dwordx2 v[36:37], v34, s[4:7], s14 offen
    ds_read_b128 v[32:35], v0 offset:30720
    ds_read_b128 v[36:39], v0 offset:31744
    s_waitcnt lgkmcnt(0)
    s_branch CF1_T
CF1_FB:
    s_add_u32 s29, s29, 1
    s_cmp_lt_u32 s29, 8
    s_cbranch_scc1 EX_53
    v_cmp_eq_u32 vcc, s30, v16
    v_cmp_eq_u32 s[48:49], s30, v17
    s_or_b64 vcc, vcc, s[48:49]
    v_cmp_eq_u32 s[48:49], s30, v18
    s_or_b64 vcc, vcc, s[48:49]
    v_cmp_eq_u32 s[48:49], s30, v19
    s_or_b64 vcc, vcc, s[48:49]
    s_cbranch_vccz CF1_CB
EX_53:
    s_add_u32 s31, s31, 1
    s_cmp_ge_u32 s31, 400000
    s_cbranch_scc1 FAIL
    s_waitcnt vmcnt(0)
    s_branch CF1_FF
CF1_RE:
    s_waitcnt vmcnt(0) lgkmcnt(0)
    v_mov_b64 v[40:41], 0
    v_mov_b64 v[42:43], 0
    v_mov_b64 v[44:45], 0
    v_mov_b64 v[46:47], 0
    s_nop 1
    v_mov_b64 v[48:49], 0
    v_mov_b64 v[50:51], 0
    v_mov_b64 v[52:53], 0
    v_mov_b64 v[54:55], 0
    v_mov_b64 v[56:57], 0
    v_mov_b64 v[58:59], 0
    v_mov_b64 v[60:61], 0
    v_mov_b64 v[62:63], 0
    s_add_u32 s31, s31, 1
    s_cmp_ge_u32 s31, 400000
    s_cbranch_scc1 FAIL
CF1_L0:
    buffer_load_dwordx4 v[8:11], v3, s[4:7], s19 offen offset:1024 sc1
    s_add_u32 s31, s31, 1
    s_cmp_ge_u32 s31, 400000
    s_cbranch_scc1 FAIL
    s_waitcnt vmcnt(0)
    v_cmp_eq_u32 vcc, s30, v8
    v_cmp_eq_u32 s[48:49], s30, v9
    s_or_b64 vcc, vcc, s[48:49]
    v_cmp_eq_u32 s[48:49], s30, v10
    s_or_b64 vcc, vcc, s[48:49]
    v_cmp_eq_u32 s[48:49], s30, v11
    s_or_b64 vcc, vcc, s[48:49]
    s_cbranch_vccnz CF1_L0
    ds_read_b128 v[32:35], v0 offset:12288
    ds_read_b128 v[36:39], v0 offset:13312
    s_waitcnt lgkmcnt(0)
    v_smfmac_f32_16x16x64_bf16 v[40:43], v[8:11], v[32:39], v1
    ds_read_b128 v[32:35], v0 offset:28672
    ds_read_b128 v[36:39], v0 offset:29696
    s_waitcnt lgkmcnt(0)
    v_smfmac_f32_16x16x64_bf16 v[48:51], v[8:11], v[32:39], v1
    ds_read_b128 v[32:35], v0 offset:14336
    ds_read_b128 v[36:39], v0 offset:15360
    s_waitcnt lgkmcnt(0)
    v_smfmac_f32_16x16x64_bf16 v[44:47], v[8:11], v[32:39], v1
    ds_read_b128 v[32:35], v0 offset:30720
    ds_read_b128 v[36:39], v0 offset:31744
    s_waitcnt lgkmcnt(0)
    v_smfmac_f32_16x16x64_bf16 v[52:55], v[8:11], v[32:39], v1
    v_smfmac_f32_16x16x64_bf16 v[56:59], v[8:11], a[216:223], v1
    v_smfmac_f32_16x16x64_bf16 v[60:63], v[8:11], a[224:231], v1
CF1_L1:
    buffer_load_dwordx4 v[12:15], v3, s[4:7], s19 offen offset:0 sc1
    s_add_u32 s31, s31, 1
    s_cmp_ge_u32 s31, 400000
    s_cbranch_scc1 FAIL
    s_waitcnt vmcnt(0)
    v_cmp_eq_u32 vcc, s30, v12
    v_cmp_eq_u32 s[48:49], s30, v13
    s_or_b64 vcc, vcc, s[48:49]
    v_cmp_eq_u32 s[48:49], s30, v14
    s_or_b64 vcc, vcc, s[48:49]
    v_cmp_eq_u32 s[48:49], s30, v15
    s_or_b64 vcc, vcc, s[48:49]
    s_cbranch_vccnz CF1_L1
    v_smfmac_f32_16x16x64_bf16 v[40:43], v[12:15], a[0:7], v1
    ds_read_b128 v[32:35], v0 offset:32768
    ds_read_b128 v[36:39], v0 offset:33792
    s_waitcnt lgkmcnt(0)
    v_smfmac_f32_16x16x64_bf16 v[48:51], v[12:15], v[32:39], v1
    v_smfmac_f32_16x16x64_bf16 v[44:47], v[12:15], a[8:15], v1
    ds_read_b128 v[32:35], v0 offset:34816
    ds_read_b128 v[36:39], v0 offset:35840
    s_waitcnt lgkmcnt(0)
    v_smfmac_f32_16x16x64_bf16 v[52:55], v[12:15], v[32:39], v1
    v_smfmac_f32_16x16x64_bf16 v[56:59], v[12:15], a[232:239], v1
    ds_read_b128 v[32:35], v0 offset:4096
    ds_read_b128 v[36:39], v0 offset:5120
    s_waitcnt lgkmcnt(0)
    v_smfmac_f32_16x16x64_bf16 v[60:63], v[12:15], v[32:39], v1
CF1_L2:
    buffer_load_dwordx4 v[16:19], v3, s[4:7], s34 offen offset:1024 sc1
    s_add_u32 s31, s31, 1
    s_cmp_ge_u32 s31, 400000
    s_cbranch_scc1 FAIL
    s_waitcnt vmcnt(0)
    v_cmp_eq_u32 vcc, s30, v16
    v_cmp_eq_u32 s[48:49], s30, v17
    s_or_b64 vcc, vcc, s[48:49]
    v_cmp_eq_u32 s[48:49], s30, v18
    s_or_b64 vcc, vcc, s[48:49]
    v_cmp_eq_u32 s[48:49], s30, v19
    s_or_b64 vcc, vcc, s[48:49]
    s_cbranch_vccnz CF1_L2
    v_smfmac_f32_16x16x64_bf16 v[40:43], v[16:19], a[16:23], v1
    v_smfmac_f32_16x16x64_bf16 v[48:51], v[16:19], a[120:127], v1
    v_smfmac_f32_16x16x64_bf16 v[44:47], v[16:19], a[24:31], v1
    v_smfmac_f32_16x16x64_bf16 v[52:55], v[16:19], a[128:135], v1
    ds_read_b128 v[32:35], v0 offset:16384
    ds_read_b128 v[36:39], v0 offset:17408
    s_waitcnt lgkmcnt(0)
    v_smfmac_f32_16x16x64_bf16 v[56:59], v[16:19], v[32:39], v1
    ds_read_b128 v[32:35], v0 offset:18432
    ds_read_b128 v[36:39], v0 offset:19456
    s_waitcnt lgkmcnt(0)
    v_smfmac_f32_16x16x64_bf16 v[60:63], v[16:19], v[32:39], v1
CF1_L3:
    buffer_load_dwordx4 v[20:23], v3, s[4:7], s34 offen offset:0 sc1
    s_add_u32 s31, s31, 1
    s_cmp_ge_u32 s31, 400000
    s_cbranch_scc1 FAIL
    s_waitcnt vmcnt(0)
    v_cmp_eq_u32 vcc, s30, v20
    v_cmp_eq_u32 s[48:49], s30, v21
    s_or_b64 vcc, vcc, s[48:49]
    v_cmp_eq_u32 s[48:49], s30, v22
    s_or_b64 vcc, vcc, s[48:49]
    v_cmp_eq_u32 s[48:49], s30, v23
    s_or_b64 vcc, vcc, s[48:49]
    s_cbranch_vccnz CF1_L3
    v_smfmac_f32_16x16x64_bf16 v[40:43], v[20:23], a[32:39], v1
    v_smfmac_f32_16x16x64_bf16 v[48:51], v[20:23], a[136:143], v1
    v_smfmac_f32_16x16x64_bf16 v[44:47], v[20:23], a[40:47], v1
    v_smfmac_f32_16x16x64_bf16 v[52:55], v[20:23], a[144:151], v1
CF1_L4:
    buffer_load_dwordx4 v[8:11], v3, s[4:7], s34 offen offset:3072 sc1
    s_add_u32 s31, s31, 1
    s_cmp_ge_u32 s31, 400000
    s_cbranch_scc1 FAIL
    s_waitcnt vmcnt(0)
    v_cmp_eq_u32 vcc, s30, v8
    v_cmp_eq_u32 s[48:49], s30, v9
    s_or_b64 vcc, vcc, s[48:49]
    v_cmp_eq_u32 s[48:49], s30, v10
    s_or_b64 vcc, vcc, s[48:49]
    v_cmp_eq_u32 s[48:49], s30, v11
    s_or_b64 vcc, vcc, s[48:49]
    s_cbranch_vccnz CF1_L4
    v_smfmac_f32_16x16x64_bf16 v[40:43], v[8:11], a[48:55], v1
    v_smfmac_f32_16x16x64_bf16 v[44:47], v[8:11], a[56:63], v1
CF1_L5:
    buffer_load_dwordx4 v[12:15], v3, s[4:7], s34 offen offset:2048 sc1
    s_add_u32 s31, s31, 1
    s_cmp_ge_u32 s31, 400000
    s_cbranch_scc1 FAIL
    s_waitcnt vmcnt(0)
    v_cmp_eq_u32 vcc, s30, v12
    v_cmp_eq_u32 s[48:49], s30, v13
    s_or_b64 vcc, vcc, s[48:49]
    v_cmp_eq_u32 s[48:49], s30, v14
    s_or_b64 vcc, vcc, s[48:49]
    v_cmp_eq_u32 s[48:49], s30, v15
    s_or_b64 vcc, vcc, s[48:49]
    s_cbranch_vccnz CF1_L5
    v_smfmac_f32_16x16x64_bf16 v[40:43], v[12:15], a[64:71], v1
    v_smfmac_f32_16x16x64_bf16 v[44:47], v[12:15], a[72:79], v1
CF1_L6:
    buffer_load_dwordx4 v[28:31], v3, s[4:7], s35 offen offset:0 sc1
    s_add_u32 s31, s31, 1
    s_cmp_ge_u32 s31, 400000
    s_cbranch_scc1 FAIL
    s_waitcnt vmcnt(0)
    v_cmp_eq_u32 vcc, s30, v28
    v_cmp_eq_u32 s[48:49], s30, v29
    s_or_b64 vcc, vcc, s[48:49]
    v_cmp_eq_u32 s[48:49], s30, v30
    s_or_b64 vcc, vcc, s[48:49]
    v_cmp_eq_u32 s[48:49], s30, v31
    s_or_b64 vcc, vcc, s[48:49]
    s_cbranch_vccnz CF1_L6
    ds_read_b128 v[32:35], v0 offset:0
    ds_read_b128 v[36:39], v0 offset:1024
    s_waitcnt lgkmcnt(0)
    v_smfmac_f32_16x16x64_bf16 v[40:43], v[28:31], v[32:39], v1
    v_smfmac_f32_16x16x64_bf16 v[44:47], v[28:31], a[80:87], v1
CF1_L8:
    buffer_load_dwordx4 v[24:27], v3, s[4:7], s35 offen offset:2048 sc1
    s_add_u32 s31, s31, 1
    s_cmp_ge_u32 s31, 400000
    s_cbranch_scc1 FAIL
    s_waitcnt vmcnt(0)
    v_cmp_eq_u32 vcc, s30, v24
    v_cmp_eq_u32 s[48:49], s30, v25
    s_or_b64 vcc, vcc, s[48:49]
    v_cmp_eq_u32 s[48:49], s30, v26
    s_or_b64 vcc, vcc, s[48:49]
    v_cmp_eq_u32 s[48:49], s30, v27
    s_or_b64 vcc, vcc, s[48:49]
    s_cbranch_vccnz CF1_L8
    v_smfmac_f32_16x16x64_bf16 v[40:43], v[24:27], a[104:111], v1
CF1_L7:
    buffer_load_dwordx4 v[16:19], v3, s[4:7], s35 offen offset:1024 sc1
    s_add_u32 s31, s31, 1
    s_cmp_ge_u32 s31, 400000
    s_cbranch_scc1 FAIL
    s_waitcnt vmcnt(0)
    v_cmp_eq_u32 vcc, s30, v16
    v_cmp_eq_u32 s[48:49], s30, v17
    s_or_b64 vcc, vcc, s[48:49]
    v_cmp_eq_u32 s[48:49], s30, v18
    s_or_b64 vcc, vcc, s[48:49]
    v_cmp_eq_u32 s[48:49], s30, v19
    s_or_b64 vcc, vcc, s[48:49]
    s_cbranch_vccnz CF1_L7
    v_smfmac_f32_16x16x64_bf16 v[40:43], v[16:19], a[88:95], v1
    v_smfmac_f32_16x16x64_bf16 v[44:47], v[24:27], a[112:119], v1
    v_smfmac_f32_16x16x64_bf16 v[44:47], v[16:19], a[96:103], v1
    ds_read_b128 v[32:35], v0 offset:2048
    ds_read_b128 v[36:39], v0 offset:3072
    s_waitcnt lgkmcnt(0)
    v_smfmac_f32_16x16x64_bf16 v[48:51], v[8:11], v[32:39], v1
    v_smfmac_f32_16x16x64_bf16 v[52:55], v[8:11], a[152:159], v1
    v_smfmac_f32_16x16x64_bf16 v[48:51], v[12:15], a[160:167], v1
    v_smfmac_f32_16x16x64_bf16 v[52:55], v[12:15], a[168:175], v1
    v_smfmac_f32_16x16x64_bf16 v[48:51], v[28:31], a[176:183], v1
    ds_read_b128 v[32:35], v0 offset:8192
    ds_read_b128 v[36:39], v0 offset:9216
    v_add_f32 v40, v40, v41
    v_add_f32 v42, v42, v43
    v_add_f32 v44, v44, v45
    v_add_f32 v46, v46, v47
    v_cvt_pk_bf16_f32 v40, v40, v44
    v_cvt_pk_bf16_f32 v41, v42, v46
    ds_write_b64 v4, v[40:41] offset:7936
    s_waitcnt lgkmcnt(0)
    s_branch CF1_RJ
CF1_SLOW:
    ds_read_b64_tr_b16 v[40:41], v5 offset:7168
    ds_read_b64_tr_b16 v[48:49], v5 offset:0
    ds_read_b64_tr_b16 v[42:43], v5 offset:7936
    ds_read_b64_tr_b16 v[50:51], v5 offset:768
    ds_read_b64_tr_b16 v[44:45], v5 offset:8704
    ds_read_b64_tr_b16 v[52:53], v5 offset:1536
    ds_read_b64_tr_b16 v[46:47], v5 offset:9472
    ds_read_b64_tr_b16 v[54:55], v5 offset:2304
    s_waitcnt vmcnt(0) lgkmcnt(0)
    v_and_b32 v64, 128, v3
    v_mad_u32_u24 v64, v64, 31, v3
    buffer_load_dwordx4 v[68:71], v64, s[4:7], s50 offen offset:128 sc1
    buffer_load_dwordx4 v[76:79], v3, s[4:7], s46 offen offset:3072 sc1
    buffer_load_dwordx4 v[64:67], v64, s[4:7], s38 offen offset:128 sc1
    buffer_load_dwordx4 v[72:75], v3, s[4:7], s46 offen offset:2048 sc1
    v_mfma_f32_16x16x32_bf16 v[48:51], v[48:51], v[40:43], 0
    v_mfma_f32_16x16x32_bf16 v[48:51], v[52:55], v[44:47], v[48:51]
    v_lshrrev_b32 v38, 2, v3
    v_and_b32 v38, 0xe0, v38
    v_and_b32 v39, 0xe0, v3
    s_nop 4
    v_add_f32_dpp v48, v49, v48 quad_perm:[1,0,3,2] row_mask:0xf bank_mask:0xf
    v_add_f32_dpp v50, v51, v50 quad_perm:[1,0,3,2] row_mask:0xf bank_mask:0xf
    v_mul_f32 v48, s44, v48
    v_mul_f32 v50, s44, v50
    v_mov_b64 v[32:33], s[20:21]
    v_mov_b64 v[34:35], s[20:21]
    s_waitcnt vmcnt(0)
    ds_read_b32 v2, v3 offset:13568
    v_mfma_f32_16x16x32_bf16 v[64:67], v[40:43], v[64:67], 0
    v_mfma_f32_16x16x32_bf16 v[64:67], v[44:47], v[68:71], v[64:67]
    v_max_f32 v37, v48, v50
    v_mov_b32 v36, v37
    s_nop 1
    v_permlane16_swap_b32 v36, v37
    v_max_f32 v37, v36, v37
    v_mov_b32 v36, v37
    s_nop 1
    v_permlane32_swap_b32 v36, v37
    v_max_f32 v37, v36, v37
    v_add_f32_dpp v64, v65, v64 row_ror:8 row_mask:0xf bank_mask:0xf
    v_add_f32_dpp v64, v66, v67 row_ror:8 row_mask:0xf bank_mask:0xc
    s_nop 1
    v_max_f32_dpp v36, v64, v64 quad_perm:[1,0,3,2] row_mask:0xf bank_mask:0xf
    s_nop 1
    v_max_f32_dpp v36, v36, v36 quad_perm:[2,3,0,1] row_mask:0xf bank_mask:0xf
    s_nop 1
    v_max_f32_dpp v36, v36, v36 row_half_mirror row_mask:0xf bank_mask:0xf
    ds_write_b32 v38, v36 offset:15620
    s_mov_b64 exec, s[40:41]
    ds_write_b32 v39, v37 offset:15632
    s_mov_b64 exec, -1
    s_waitcnt lgkmcnt(0)
    s_barrier
    ds_read_b128 v[40:43], v38 offset:15616
    ds_read_b32 v36, v38 offset:15632
    ds_read_b128 v[44:47], v39 offset:15616
    ds_read_b32 v37, v39 offset:15632
    s_waitcnt lgkmcnt(0)
    v_max3_f32 v36, v36, v40, v41
    v_max3_f32 v36, v36, v42, v43
    v_max3_f32 v37, v37, v44, v45
    v_max3_f32 v37, v37, v46, v47
    v_sub_f32 v64, v64, v36
    v_exp_f32 v64, v64
    v_sub_f32 v48, v48, v37
    v_exp_f32 v48, v48
    v_sub_f32 v50, v50, v37
    v_exp_f32 v50, v50
    v_cvt_pk_bf16_f32 v64, v64, v64
    ds_write_b16 v2, v64 offset:11008
    v_cvt_pk_bf16_f32 v48, v48, v50
    v_cndmask_b32 v48, 0, v48, s[40:41]
    s_nop 1
    v_mov_b32_dpp v49, v48 quad_perm:[1,0,3,2] row_mask:0xf bank_mask:0xf
    s_waitcnt lgkmcnt(0)
    s_barrier
    ds_read_b128 v[64:67], v3 offset:10496
    ds_read_b128 v[68:71], v3 offset:10480
    s_waitcnt lgkmcnt(0)
    v_mfma_f32_16x16x32_bf16 v[72:75], v[72:75], v[64:67], 0
    v_mfma_f32_16x16x32_bf16 v[72:75], v[76:79], v[68:71], v[72:75]
    v_mfma_f32_16x16x32_bf16 v[52:55], v[32:35], v[64:67], 0
    s_nop 5
    v_mfma_f32_16x16x16_bf16 v[52:55], v[32:33], v[48:49], v[52:55]
    v_mfma_f32_16x16x16_bf16 v[72:75], v[56:57], v[48:49], v[72:75]
    ds_read_b128 v[64:67], v0 offset:22528
    ds_read_b128 v[68:71], v0 offset:23552
    ds_read_b128 v[32:35], v3 offset:14592
    v_mov_b64 v[36:37], 0
    v_mov_b64 v[38:39], 0
    v_mov_b64 v[40:41], 0
    v_mov_b64 v[42:43], 0
    v_mov_b64 v[44:45], 0
    v_mov_b64 v[46:47], 0
    v_rcp_f32_dpp v53, v52 quad_perm:[0,0,2,2] row_mask:0xf bank_mask:0xf
    s_nop 0
    v_mul_f32 v72, v72, v53
    v_mul_f32 v73, v73, v53
    v_mul_f32 v74, v74, v53
    v_mul_f32 v75, v75, v53
    v_cvt_pk_bf16_f32 v72, v72, v73
    v_cvt_pk_bf16_f32 v73, v74, v75
    ds_write_b64 v4, v[72:73] offset:4864
    v_mov_b32_dpp v76, v72 quad_perm:[0,0,2,2] row_mask:0xf bank_mask:0xf
    v_mov_b32_dpp v77, v73 quad_perm:[0,0,2,2] row_mask:0xf bank_mask:0xf
    v_mov_b32_dpp v78, v72 quad_perm:[1,1,3,3] row_mask:0xf bank_mask:0xf
    v_mov_b32_dpp v79, v73 quad_perm:[1,1,3,3] row_mask:0xf bank_mask:0xf
    s_waitcnt lgkmcnt(0)
    s_branch CF1_FAST
CF1_SP:
    s_cmp_eq_u32 s32, 63
    s_cbranch_scc1 CF1_LAST
    s_add_u32 s18, s18, 1
    s_cmp_gt_u32 s18, 1
    s_cselect_b32 s18, 63, s18
    s_waitcnt vmcnt(0)
CF1_SQ:
    buffer_load_dwordx4 v[16:19], v3, s[4:7], s35 offen offset:0 sc1
    s_add_u32 s31, s31, 1
    s_cmp_ge_u32 s31, 400000
    s_cbranch_scc1 FAIL
    s_waitcnt vmcnt(0)
    v_cmp_eq_u32 vcc, s30, v16
    v_cmp_eq_u32 s[48:49], s30, v17
    s_or_b64 vcc, vcc, s[48:49]
    v_cmp_eq_u32 s[48:49], s30, v18
    s_or_b64 vcc, vcc, s[48:49]
    v_cmp_eq_u32 s[48:49], s30, v19
    s_or_b64 vcc, vcc, s[48:49]
    s_cbranch_vccnz CF1_SQ
    buffer_load_dwordx4 v[16:19], v3, s[4:7], s34 offen offset:1024 sc1
    buffer_load_dwordx4 v[20:23], v3, s[4:7], s34 offen offset:0 sc1
    s_branch CF1_A
CF1_R1:
    buffer_load_dwordx4 v[48:51], v3, s[4:7], s51 offen offset:0 sc1
    buffer_load_dwordx4 v[52:55], v3, s[4:7], s51 offen offset:1024 sc1
    buffer_load_dwordx4 v[40:43], v3, s[4:7], s51 offen offset:2048 sc1
    buffer_load_dwordx4 v[56:59], v3, s[4:7], s51 offen offset:3072 sc1
    s_add_u32 s31, s31, 1
    s_cmp_ge_u32 s31, 400000
    s_cbranch_scc1 FAIL
    s_waitcnt vmcnt(3)
    v_mfma_f32_16x16x32_bf16 v[60:63], v[44:47], v[48:51], 0
    s_waitcnt vmcnt(2)
    v_mfma_f32_16x16x32_bf16 v[60:63], v[44:47], v[52:55], v[60:63]
    v_bitop3_b32 v2, v48, v52, s32 bitop3:0x7e
    s_waitcnt vmcnt(1)
    v_mfma_f32_16x16x32_bf16 v[60:63], v[44:47], v[40:43], v[60:63]
    s_waitcnt vmcnt(0)
    v_mfma_f32_16x16x32_bf16 v[60:63], v[44:47], v[56:59], v[60:63]
    v_bitop3_b32 v6, v40, v56, s32 bitop3:0x7e
    v_bitop3_b32 v2, v2, v6, 1 bitop3:0xa8
    v_cmp_ne_u32 vcc, 0, v2
    v_mov_b64 v[48:49], 0
    v_mov_b64 v[50:51], 0
    v_mov_b64 v[52:53], 0
    v_mov_b64 v[54:55], 0
    s_nop 0
    v_add_f32_dpp v60, v60, v60 row_ror:8 row_mask:0xf bank_mask:0xf
    v_add_f32_dpp v61, v61, v61 row_ror:8 row_mask:0xf bank_mask:0xf
    v_cvt_pk_bf16_f32 v6, v60, v61
    s_cbranch_vccz CF1_RC
    s_branch CF1_R1
CF1_LAST:
    buffer_store_dword v6, v7, s[4:7], s39 offen sc1
    s_waitcnt vmcnt(0)
    s_branch C_END
CF2_IN:
    s_add_u32 s45, s38, 40960
    s_add_u32 s34, s19, 2048
    s_add_u32 s35, s19, 6144
    buffer_load_dwordx4 v[8:11], v3, s[4:7], s19 offen offset:0 sc1
    buffer_load_dwordx4 v[12:15], v3, s[4:7], s19 offen offset:1024 sc1
    s_mov_b32 s29, 0
    s_mov_b32 m0, 4096
    s_mov_b32 s18, 1
CF2_FF:
    ds_read_b128 v[72:75], v0 offset:12288
    ds_read_b128 v[76:79], v0 offset:13312
    ds_read_b128 v[64:67], v0 offset:28672
    ds_read_b128 v[68:71], v0 offset:29696
    ds_read_b128 v[24:27], v0 offset:14336
    ds_read_b128 v[28:31], v0 offset:15360
    ds_read_b128 v[32:35], v0 offset:30720
    ds_read_b128 v[36:39], v0 offset:31744
    v_mov_b64 v[40:41], 0
    v_mov_b64 v[42:43], 0
    v_mov_b64 v[44:45], 0
    v_mov_b64 v[46:47], 0
    v_mov_b64 v[48:49], 0
    v_mov_b64 v[50:51], 0
    v_mov_b64 v[52:53], 0
    v_mov_b64 v[54:55], 0
    v_mov_b64 v[56:57], 0
    v_mov_b64 v[58:59], 0
    v_mov_b64 v[60:61], 0
    v_mov_b64 v[62:63], 0
    s_waitcnt vmcnt(0) lgkmcnt(0)
    buffer_load_dwordx4 v[16:19], v3, s[4:7], s34 offen offset:2048 sc1
    buffer_load_dwordx4 v[20:23], v3, s[4:7], s34 offen offset:3072 sc1
    s_branch CF2_A
CF2_T:
    s_barrier
    s_barrier
    buffer_load_dwordx4 v[48:51], v3, s[4:7], s51 offen offset:0 sc1
    buffer_load_dwordx4 v[52:55], v3, s[4:7], s51 offen offset:1024 sc1
    s_waitcnt vmcnt(1)
    v_mfma_f32_16x16x32_bf16 v[60:63], v[44:47], v[48:51], 0
    v_bitop3_b32 v2, v48, v50, s32 bitop3:0x7e
    s_waitcnt vmcnt(0)
    v_mfma_f32_16x16x32_bf16 v[60:63], v[44:47], v[52:55], v[60:63]
    v_bitop3_b32 v6, v52, v54, s32 bitop3:0x7e
    v_bitop3_b32 v2, v2, v6, 1 bitop3:0xa8
    v_cmp_ne_u32 vcc, 0, v2
    v_mov_b64 v[48:49], 0
    v_mov_b64 v[50:51], 0
    v_mov_b64 v[52:53], 0
    v_mov_b64 v[54:55], 0
    s_nop 0
    v_add_f32_dpp v60, v60, v60 row_ror:8 row_mask:0xf bank_mask:0xf
    v_add_f32_dpp v61, v61, v61 row_ror:8 row_mask:0xf bank_mask:0xf
    s_nop 0
    v_add_f32_dpp v60, v60, v60 row_ror:4 row_mask:0xf bank_mask:0xf
    v_add_f32_dpp v61, v61, v61 row_ror:4 row_mask:0xf bank_mask:0xf
    v_cvt_pk_bf16_f32 v6, v60, v61
    s_cbranch_vccnz CF2_R1
CF2_RC:
    buffer_store_dword v6, v7, s[4:7], s36 offen
    v_mov_b64 v[44:45], 0
    v_mov_b64 v[46:47], 0
    v_mov_b64 v[60:61], 0
    v_mov_b64 v[62:63], 0
    s_barrier
    buffer_load_dwordx4 v[16:19], v3, s[4:7], s34 offen offset:2048 sc1
    s_barrier
    ds_read_b128 v[8:11], v3 offset:7168
    ds_read_b128 v[12:15], v3 offset:8192
    buffer_load_dwordx4 v[20:23], v3, s[4:7], s34 offen offset:3072 sc1
    s_cmp_eq_u32 s32, s18
    s_cbranch_scc1 CF2_SP
CF2_A:
    s_waitcnt lgkmcnt(1)
    v_smfmac_f32_16x16x64_bf16 v[40:43], v[8:11], v[72:79], v1
    v_smfmac_f32_16x16x64_bf16 v[48:51], v[8:11], v[64:71], v1
    ds_read_b128 v[64:67], v0 offset:32768
    v_smfmac_f32_16x16x64_bf16 v[44:47], v[8:11], v[24:31], v1
    ds_read_b128 v[68:71], v0 offset:33792
    v_mov_b32 v2, s30
    v_smfmac_f32_16x16x64_bf16 v[52:55], v[8:11], v[32:39], v1
    buffer_store_dword v2, v7, s[4:7], s37 offen
    ds_read_b128 v[24:27], v0 offset:34816
    v_smfmac_f32_16x16x64_bf16 v[56:59], v[8:11], a[216:223], v1
    ds_read_b128 v[28:31], v0 offset:35840
    v_smfmac_f32_16x16x64_bf16 v[60:63], v[8:11], a[224:231], v1
    buffer_load_dwordx4 v3, s[4:7], s35 offen offset:1024 sc1 lds
    ds_read_b128 v[32:35], v0 offset:4096
    s_waitcnt lgkmcnt(5)
    v_smfmac_f32_16x16x64_bf16 v[40:43], v[12:15], a[0:7], v1
    ds_read_b128 v[36:39], v0 offset:5120
    s_waitcnt lgkmcnt(4)
    v_smfmac_f32_16x16x64_bf16 v[48:51], v[12:15], v[64:71], v1
    v_smfmac_f32_16x16x64_bf16 v[44:47], v[12:15], a[8:15], v1
    s_waitcnt lgkmcnt(2)
    v_smfmac_f32_16x16x64_bf16 v[52:55], v[12:15], v[24:31], v1
    buffer_load_dwordx4 v[72:75], v3, s[4:7], s46 offen offset:2048 sc1
    ds_read_b128 v[24:27], v0 offset:16384
    v_smfmac_f32_16x16x64_bf16 v[56:59], v[12:15], a[232:239], v1
    buffer_load_dwordx4 v[76:79], v3, s[4:7], s46 offen offset:3072 sc1
    ds_read_b128 v[28:31], v0 offset:17408
    s_waitcnt lgkmcnt(2)
    v_smfmac_f32_16x16x64_bf16 v[60:63], v[12:15], v[32:39], v1
    ds_read_b128 v[32:35], v0 offset:18432
    ds_read_b128 v[36:39], v0 offset:19456
    s_waitcnt vmcnt(5)
    v_smfmac_f32_16x16x64_bf16 v[40:43], v[16:19], a[16:23], v1
    ds_write_b128 v3, v[16:19] offset:2048
    v_and_b32 v64, 128, v3
    v_smfmac_f32_16x16x64_bf16 v[48:51], v[16:19], a[120:127], v1
    v_mad_u32_u24 v64, v64, 31, v3
    v_smfmac_f32_16x16x64_bf16 v[44:47], v[16:19], a[24:31], v1
    buffer_load_dwordx4 v[68:71], v64, s[4:7], s50 offen offset:1024 sc1
    v_maximum3_f32 v2, v16, v17, v18
    v_smfmac_f32_16x16x64_bf16 v[52:55], v[16:19], a[128:135], v1
    buffer_load_dwordx4 v[64:67], v64, s[4:7], s38 offen offset:1024 sc1
    s_waitcnt lgkmcnt(3)
    v_cmp_u_f32 vcc, v2, v19
    v_smfmac_f32_16x16x64_bf16 v[56:59], v[16:19], v[24:31], v1
    s_waitcnt lgkmcnt(1)
    v_smfmac_f32_16x16x64_bf16 v[60:63], v[16:19], v[32:39], v1
    s_cbranch_vccnz CF2_FB
CF2_CB:
    s_waitcnt lgkmcnt(0)
    s_barrier
    s_waitcnt vmcnt(6)
    v_smfmac_f32_16x16x64_bf16 v[40:43], v[20:23], a[32:39], v1
    buffer_store_dword v6, v7, s[4:7], s39 offen sc1
    ds_read_b128 v[8:11], v3 offset:0
    v_lshlrev_b32 v6, 3, v3
    v_smfmac_f32_16x16x64_bf16 v[48:51], v[20:23], a[136:143], v1
    buffer_load_dword v6, v6, s[4:7], s45 offen sc1
    ds_read_b128 v[12:15], v3 offset:1024
    v_smfmac_f32_16x16x64_bf16 v[44:47], v[20:23], a[40:47], v1
    ds_read_b128 v[32:35], v0 offset:0
    s_mov_b32 s37, s36
    v_smfmac_f32_16x16x64_bf16 v[52:55], v[20:23], a[144:151], v1
    s_waitcnt vmcnt(6)
    s_barrier
    ds_read_b128 v[36:39], v0 offset:1024
    s_waitcnt lgkmcnt(3)
    v_smfmac_f32_16x16x64_bf16 v[40:43], v[8:11], a[48:55], v1
    ds_read_b128 v[28:31], v3 offset:4096
    s_add_u32 s36, s36, 0x8000
    v_smfmac_f32_16x16x64_bf16 v[44:47], v[8:11], a[56:63], v1
    ds_read_b128 v[24:27], v3 offset:6144
    s_bitset0_b32 s36, 17
    s_waitcnt lgkmcnt(4)
    v_smfmac_f32_16x16x64_bf16 v[40:43], v[12:15], a[64:71], v1
    ds_read_b128 v[16:19], v3 offset:5120
    s_add_u32 s32, s32, 1
    v_smfmac_f32_16x16x64_bf16 v[44:47], v[12:15], a[72:79], v1
    ds_read_b32 v2, v3 offset:13568
    s_waitcnt lgkmcnt(3)
    v_smfmac_f32_16x16x64_bf16 v[40:43], v[28:31], v[32:39], v1
    ds_read_b128 v[32:35], v0 offset:2048
    s_add_u32 s39, s39, 9216
    v_smfmac_f32_16x16x64_bf16 v[44:47], v[28:31], a[80:87], v1
    ds_read_b128 v[36:39], v0 offset:3072
    s_mov_b32 s29, 0
    s_waitcnt lgkmcnt(4)
    v_smfmac_f32_16x16x64_bf16 v[40:43], v[24:27], a[104:111], v1
    s_add_u32 s45, s45, 32768
    s_waitcnt lgkmcnt(3)
    v_smfmac_f32_16x16x64_bf16 v[40:43], v[16:19], a[88:95], v1
    v_smfmac_f32_16x16x64_bf16 v[44:47], v[24:27], a[112:119], v1
    v_smfmac_f32_16x16x64_bf16 v[44:47], v[16:19], a[96:103], v1
    s_waitcnt lgkmcnt(0)
    v_add_f32 v40, v40, v41
    v_smfmac_f32_16x16x64_bf16 v[48:51], v[8:11], v[32:39], v1
    ds_read_b128 v[32:35], v0 offset:8192
    v_add_f32 v42, v42, v43
    v_smfmac_f32_16x16x64_bf16 v[52:55], v[8:11], a[152:159], v1
    ds_read_b128 v[36:39], v0 offset:9216
    v_add_f32 v44, v44, v45
    v_add_f32 v46, v46, v47
    v_cvt_pk_bf16_f32 v40, v40, v44
    v_cvt_pk_bf16_f32 v41, v42, v46
    v_smfmac_f32_16x16x64_bf16 v[48:51], v[12:15], a[160:167], v1
    ds_write_b64 v4, v[40:41] offset:8704
    v_cmp_u_f32 vcc, v40, v41
    v_smfmac_f32_16x16x64_bf16 v[52:55], v[12:15], a[168:175], v1
    v_smfmac_f32_16x16x64_bf16 v[48:51], v[28:31], a[176:183], v1
    s_cbranch_vccnz CF2_RE
CF2_RJ:
    v_smfmac_f32_16x16x64_bf16 v[52:55], v[28:31], a[184:191], v1
    s_add_u32 s19, s19, 0x8000
    s_waitcnt lgkmcnt(1)
    v_smfmac_f32_16x16x64_bf16 v[48:51], v[24:27], v[32:39], v1
    s_waitcnt lgkmcnt(0)
    s_barrier
    v_smfmac_f32_16x16x64_bf16 v[48:51], v[16:19], a[192:199], v1
    ds_read_b64_tr_b16 v[40:41], v5 offset:7168
    ds_read_b64_tr_b16 v[42:43], v5 offset:7936
    v_smfmac_f32_16x16x64_bf16 v[52:55], v[24:27], a[208:215], v1
    ds_read_b64_tr_b16 v[44:45], v5 offset:8704
    ds_read_b64_tr_b16 v[46:47], v5 offset:9472
    v_smfmac_f32_16x16x64_bf16 v[52:55], v[16:19], a[200:207], v1
    ds_read_b128 v[32:35], v0 offset:6144
    v_add_f32 v48, v48, v49
    v_smfmac_f32_16x16x64_bf16 v[56:59], v[8:11], v[80:87], v1
    ds_read_b128 v[36:39], v0 offset:7168
    s_waitcnt vmcnt(2) lgkmcnt(4)
    v_add_f32 v50, v50, v51
    v_mfma_f32_16x16x32_bf16 v[64:67], v[40:43], v[64:67], 0
    s_waitcnt lgkmcnt(2)
    v_add_f32 v52, v52, v53
    v_add_f32 v54, v54, v55
    v_mfma_f32_16x16x32_bf16 v[64:67], v[44:47], v[68:71], v[64:67]
    v_cvt_pk_bf16_f32 v48, v48, v52
    v_cvt_pk_bf16_f32 v49, v50, v54
    v_smfmac_f32_16x16x64_bf16 v[60:63], v[8:11], v[88:95], v1
    ds_write_b64 v4, v[48:49] offset:1536
    s_bitset0_b32 s19, 17
    v_smfmac_f32_16x16x64_bf16 v[56:59], v[12:15], v[96:103], v1
    s_add_u32 s34, s19, 2048
    s_waitcnt lgkmcnt(1)
    v_add_f32_dpp v64, v65, v64 row_ror:8 row_mask:0xf bank_mask:0xf
    v_add_f32_dpp v64, v66, v67 row_ror:8 row_mask:0xf bank_mask:0xc
    v_exp_f32 v64, v64
    s_nop 0
    v_cvt_pk_bf16_f32 v64, v64, v64
    v_smfmac_f32_16x16x64_bf16 v[60:63], v[12:15], v[32:39], v1
    ds_write_b16 v2, v64 offset:10504
    v_smfmac_f32_16x16x64_bf16 v[56:59], v[16:19], v[120:127], v1
    ds_read_b128 v[8:11], v0 offset:20480
    s_add_u32 s35, s19, 6144
    v_mov_b64 v[32:33], s[20:21]
    v_smfmac_f32_16x16x64_bf16 v[60:63], v[16:19], v[128:135], v1
    ds_read_b128 v[12:15], v0 offset:21504
    v_mov_b64 v[34:35], s[20:21]
    v_smfmac_f32_16x16x64_bf16 v[56:59], v[20:23], a[240:247], v1
    s_waitcnt lgkmcnt(2)
    s_barrier
    v_smfmac_f32_16x16x64_bf16 v[60:63], v[20:23], a[248:255], v1
    ds_read_b64_tr_b16 v[48:49], v5 offset:0
    ds_read_b64_tr_b16 v[50:51], v5 offset:768
    v_smfmac_f32_16x16x64_bf16 v[56:59], v[24:27], v[136:143], v1
    ds_read_b64_tr_b16 v[52:53], v5 offset:1536
    ds_read_b64_tr_b16 v[54:55], v5 offset:2304
    v_smfmac_f32_16x16x64_bf16 v[56:59], v[28:31], v[104:111], v1
    ds_read_b128 v[64:67], v3 offset:10496
    v_mov_b64 v[36:37], 0
    v_smfmac_f32_16x16x64_bf16 v[60:63], v[24:27], v[144:151], v1
    ds_read_b128 v[68:71], v3 offset:10480
    s_waitcnt lgkmcnt(4)
    v_mov_b64 v[38:39], 0
    v_mfma_f32_16x16x32_bf16 v[48:51], v[48:51], v[40:43], 0
    ds_read_b128 v[16:19], v0 offset:24576
    s_waitcnt lgkmcnt(3)
    v_add_f32 v56, v56, v57
    v_add_f32 v58, v58, v59
    v_mfma_f32_16x16x32_bf16 v[48:51], v[52:55], v[44:47], v[48:51]
    ds_read_b128 v[20:23], v0 offset:25600
    v_cvt_pk_bf16_f32 v56, v56, v58
    v_smfmac_f32_16x16x64_bf16 v[60:63], v[28:31], v[112:119], v1
    ds_read_b128 v[24:27], v0 offset:26624
    s_waitcnt lgkmcnt(4)
    v_mfma_f32_16x16x32_bf16 v[52:55], v[32:35], v[64:67], 0
    ds_read_b128 v[28:31], v0 offset:27648
    v_add_f32_dpp v48, v49, v48 quad_perm:[1,0,3,2] row_mask:0xf bank_mask:0xf
    v_add_f32_dpp v50, v51, v50 quad_perm:[1,0,3,2] row_mask:0xf bank_mask:0xf
    v_mfma_f32_16x16x32_bf16 v[72:75], v[72:75], v[64:67], 0
    s_waitcnt lgkmcnt(4)
    v_mul_f32 v48, s44, v48
    v_mul_f32 v50, s44, v50
    v_exp_f32 v48, v48
    v_exp_f32 v50, v50
    v_add_f32 v60, v60, v61
    v_cvt_pk_bf16_f32 v48, v48, v50
    v_cndmask_b32 v48, 0, v48, s[40:41]
    v_mfma_f32_16x16x32_bf16 v[72:75], v[76:79], v[68:71], v[72:75]
    ds_read_b128 v[64:67], v0 offset:22528
    v_mov_b32_dpp v49, v48 quad_perm:[1,0,3,2] row_mask:0xf bank_mask:0xf
    v_add_f32 v62, v62, v63
    v_cvt_pk_bf16_f32 v57, v60, v62
    v_mfma_f32_16x16x16_bf16 v[52:55], v[32:33], v[48:49], v[52:55]
    ds_read_b128 v[32:35], v3 offset:14592
    ds_read_b128 v[68:71], v0 offset:23552
    v_mov_b64 v[40:41], 0
    v_mfma_f32_16x16x16_bf16 v[72:75], v[56:57], v[48:49], v[72:75]
    v_mov_b64 v[42:43], 0
    v_mov_b64 v[44:45], 0
    v_mov_b64 v[46:47], 0
    v_mov_b64 v[60:61], 0
    v_rcp_f32_dpp v53, v52 quad_perm:[0,0,2,2] row_mask:0xf bank_mask:0xf
    v_mov_b64 v[62:63], 0
    v_max_u32 v52, v52, v53
    v_cmp_lt_u32 vcc, s17, v52
    v_mul_f32 v72, v72, v53
    v_mul_f32 v73, v73, v53
    v_mul_f32 v74, v74, v53
    v_mul_f32 v75, v75, v53
    v_cvt_pk_bf16_f32 v72, v72, v73
    v_cvt_pk_bf16_f32 v73, v74, v75
    ds_write_b64 v4, v[72:73] offset:5632
    v_mov_b32_dpp v76, v72 quad_perm:[0,0,2,2] row_mask:0xf bank_mask:0xf
    v_mov_b32_dpp v77, v73 quad_perm:[0,0,2,2] row_mask:0xf bank_mask:0xf
    v_mov_b32_dpp v78, v72 quad_perm:[1,1,3,3] row_mask:0xf bank_mask:0xf
    v_mov_b32_dpp v79, v73 quad_perm:[1,1,3,3] row_mask:0xf bank_mask:0xf
    s_cbranch_vccnz CF2_SLOW
CF2_FAST:
    s_nop 0
    v_smfmac_f32_16x16x64_bf16 v[40:43], v[76:79], v[8:15], v1
    s_waitcnt lgkmcnt(6)
    v_smfmac_f32_16x16x64_bf16 v[44:47], v[76:79], v[16:23], v1
    s_waitcnt lgkmcnt(0)
    s_barrier
    ds_read_b128 v[48:51], v32 offset:6400
    ds_read_b128 v[52:55], v32 offset:4096
    ds_read_b128 v[56:59], v32 offset:4864
    v_smfmac_f32_16x16x64_bf16 v[60:63], v[76:79], v[24:31], v1
    s_add_u32 s38, s38, 32768
    s_add_u32 s50, s50, 32768
    v_smfmac_f32_16x16x64_bf16 v[36:39], v[76:79], v[64:71], v1
    s_add_u32 s46, s46, 32768
    ds_read_b128 v[24:27], v0 offset:10240
    s_waitcnt lgkmcnt(3)
    v_lshrrev_b32 v32, 16, v1
    v_smfmac_f32_16x16x64_bf16 v[40:43], v[48:51], v[192:199], v1
    ds_read_b128 v[28:31], v0 offset:11264
    s_waitcnt lgkmcnt(3)
    v_smfmac_f32_16x16x64_bf16 v[40:43], v[52:55], v[208:215], v1
    ds_read_b128 v[72:75], v33 offset:4096
    s_waitcnt lgkmcnt(3)
    v_smfmac_f32_16x16x64_bf16 v[40:43], v[56:59], v[224:231], v1
    ds_read_b128 v[76:79], v33 offset:5632
    v_smfmac_f32_16x16x64_bf16 v[44:47], v[48:51], v[152:159], v1
    ds_read_b128 v[64:67], v0 offset:28672
    v_smfmac_f32_16x16x64_bf16 v[44:47], v[52:55], v[168:175], v1
    ds_read_b128 v[68:71], v0 offset:29696
    v_cvt_pk_bf16_f32 v40, v40, v41
    v_cvt_pk_bf16_f32 v41, v42, v43
    v_bfi_b32 v40, 1, s32, v40
    buffer_store_dwordx2 v[40:41], v34, s[4:7], s12 offen
    s_waitcnt lgkmcnt(4)
    v_smfmac_f32_16x16x64_bf16 v[44:47], v[56:59], v[24:31], v1
    v_mov_b64 v[40:41], 0
    v_smfmac_f32_16x16x64_bf16 v[60:63], v[48:51], v[160:167], v1
    ds_read_b128 v[24:27], v0 offset:14336
    v_mov_b64 v[42:43], 0
    v_smfmac_f32_16x16x64_bf16 v[60:63], v[52:55], v[176:183], v1
    ds_read_b128 v[28:31], v0 offset:15360
    v_cvt_pk_bf16_f32 v44, v44, v45
    v_smfmac_f32_16x16x64_bf16 v[60:63], v[56:59], v[184:191], v1
    s_waitcnt lgkmcnt(4)
    v_cvt_pk_bf16_f32 v45, v46, v47
    v_smfmac_f32_16x16x64_bf16 v[40:43], v[72:75], v[240:247], v1
    v_bfi_b32 v44, 1, s32, v44
    v_smfmac_f32_16x16x64_bf16 v[40:43], v[76:79], v[248:255], v1
    ds_read_b128 v[72:75], v0 offset:12288
    v_cvt_pk_bf16_f32 v46, v60, v61
    v_cvt_pk_bf16_f32 v47, v62, v63
    buffer_store_dwordx4 v[44:47], v32, s[4:7], s13 offen
    v_smfmac_f32_16x16x64_bf16 v[36:39], v[48:51], v[200:207], v1
    ds_read_b128 v[76:79], v0 offset:13312
    v_smfmac_f32_16x16x64_bf16 v[36:39], v[52:55], v[216:223], v1
    ds_read_b128 v[44:47], v3 offset:11520
    v_add_f32 v40, v40, v41
    v_smfmac_f32_16x16x64_bf16 v[36:39], v[56:59], v[232:239], v1
    v_add_f32 v42, v42, v43
    v_cvt_pk_bf16_f32 v40, v40, v42
    v_bfi_b32 v40, 1, s32, v40
    buffer_store_dword v40, v35, s[4:7], s15 offen
    s_nop 3
    v_cvt_pk_bf16_f32 v36, v36, v37
    v_cvt_pk_bf16_f32 v37, v38, v39
    v_bfi_b32 v36, 1, s32, v36
    buffer_store_dwordx2 v[36:37], v34, s[4:7], s14 offen
    ds_read_b128 v[32:35], v0 offset:30720
    ds_read_b128 v[36:39], v0 offset:31744
    v_mov_b64 v[40:41], 0
    v_mov_b64 v[42:43], 0
    v_mov_b64 v[56:57], 0
    v_mov_b64 v[58:59], 0
    s_waitcnt lgkmcnt(0)
    s_branch CF2_T
CF2_FB:
    s_add_u32 s29, s29, 1
    s_cmp_lt_u32 s29, 8
    s_cbranch_scc1 EX_54
    v_cmp_eq_u32 vcc, s30, v16
    v_cmp_eq_u32 s[48:49], s30, v17
    s_or_b64 vcc, vcc, s[48:49]
    v_cmp_eq_u32 s[48:49], s30, v18
    s_or_b64 vcc, vcc, s[48:49]
    v_cmp_eq_u32 s[48:49], s30, v19
    s_or_b64 vcc, vcc, s[48:49]
    s_cbranch_vccz CF2_CB
EX_54:
    s_add_u32 s31, s31, 1
    s_cmp_ge_u32 s31, 400000
    s_cbranch_scc1 FAIL
    s_waitcnt vmcnt(0)
    s_branch CF2_FF
CF2_RE:
    s_waitcnt vmcnt(0) lgkmcnt(0)
    v_mov_b64 v[40:41], 0
    v_mov_b64 v[42:43], 0
    v_mov_b64 v[44:45], 0
    v_mov_b64 v[46:47], 0
    s_nop 1
    v_mov_b64 v[48:49], 0
    v_mov_b64 v[50:51], 0
    v_mov_b64 v[52:53], 0
    v_mov_b64 v[54:55], 0
    v_mov_b64 v[56:57], 0
    v_mov_b64 v[58:59], 0
    v_mov_b64 v[60:61], 0
    v_mov_b64 v[62:63], 0
    s_add_u32 s31, s31, 1
    s_cmp_ge_u32 s31, 400000
    s_cbranch_scc1 FAIL
CF2_L0:
    buffer_load_dwordx4 v[8:11], v3, s[4:7], s19 offen offset:0 sc1
    s_add_u32 s31, s31, 1
    s_cmp_ge_u32 s31, 400000
    s_cbranch_scc1 FAIL
    s_waitcnt vmcnt(0)
    v_cmp_eq_u32 vcc, s30, v8
    v_cmp_eq_u32 s[48:49], s30, v9
    s_or_b64 vcc, vcc, s[48:49]
    v_cmp_eq_u32 s[48:49], s30, v10
    s_or_b64 vcc, vcc, s[48:49]
    v_cmp_eq_u32 s[48:49], s30, v11
    s_or_b64 vcc, vcc, s[48:49]
    s_cbranch_vccnz CF2_L0
    ds_read_b128 v[32:35], v0 offset:12288
    ds_read_b128 v[36:39], v0 offset:13312
    s_waitcnt lgkmcnt(0)
    v_smfmac_f32_16x16x64_bf16 v[40:43], v[8:11], v[32:39], v1
    ds_read_b128 v[32:35], v0 offset:28672
    ds_read_b128 v[36:39], v0 offset:29696
    s_waitcnt lgkmcnt(0)
    v_smfmac_f32_16x16x64_bf16 v[48:51], v[8:11], v[32:39], v1
    ds_read_b128 v[32:35], v0 offset:14336
    ds_read_b128 v[36:39], v0 offset:15360
    s_waitcnt lgkmcnt(0)
    v_smfmac_f32_16x16x64_bf16 v[44:47], v[8:11], v[32:39], v1
    ds_read_b128 v[32:35], v0 offset:30720
    ds_read_b128 v[36:39], v0 offset:31744
    s_waitcnt lgkmcnt(0)
    v_smfmac_f32_16x16x64_bf16 v[52:55], v[8:11], v[32:39], v1
    v_smfmac_f32_16x16x64_bf16 v[56:59], v[8:11], a[216:223], v1
    v_smfmac_f32_16x16x64_bf16 v[60:63], v[8:11], a[224:231], v1
CF2_L1:
    buffer_load_dwordx4 v[12:15], v3, s[4:7], s19 offen offset:1024 sc1
    s_add_u32 s31, s31, 1
    s_cmp_ge_u32 s31, 400000
    s_cbranch_scc1 FAIL
    s_waitcnt vmcnt(0)
    v_cmp_eq_u32 vcc, s30, v12
    v_cmp_eq_u32 s[48:49], s30, v13
    s_or_b64 vcc, vcc, s[48:49]
    v_cmp_eq_u32 s[48:49], s30, v14
    s_or_b64 vcc, vcc, s[48:49]
    v_cmp_eq_u32 s[48:49], s30, v15
    s_or_b64 vcc, vcc, s[48:49]
    s_cbranch_vccnz CF2_L1
    v_smfmac_f32_16x16x64_bf16 v[40:43], v[12:15], a[0:7], v1
    ds_read_b128 v[32:35], v0 offset:32768
    ds_read_b128 v[36:39], v0 offset:33792
    s_waitcnt lgkmcnt(0)
    v_smfmac_f32_16x16x64_bf16 v[48:51], v[12:15], v[32:39], v1
    v_smfmac_f32_16x16x64_bf16 v[44:47], v[12:15], a[8:15], v1
    ds_read_b128 v[32:35], v0 offset:34816
    ds_read_b128 v[36:39], v0 offset:35840
    s_waitcnt lgkmcnt(0)
    v_smfmac_f32_16x16x64_bf16 v[52:55], v[12:15], v[32:39], v1
    v_smfmac_f32_16x16x64_bf16 v[56:59], v[12:15], a[232:239], v1
    ds_read_b128 v[32:35], v0 offset:4096
    ds_read_b128 v[36:39], v0 offset:5120
    s_waitcnt lgkmcnt(0)
    v_smfmac_f32_16x16x64_bf16 v[60:63], v[12:15], v[32:39], v1
CF2_L2:
    buffer_load_dwordx4 v[16:19], v3, s[4:7], s34 offen offset:2048 sc1
    s_add_u32 s31, s31, 1
    s_cmp_ge_u32 s31, 400000
    s_cbranch_scc1 FAIL
    s_waitcnt vmcnt(0)
    v_cmp_eq_u32 vcc, s30, v16
    v_cmp_eq_u32 s[48:49], s30, v17
    s_or_b64 vcc, vcc, s[48:49]
    v_cmp_eq_u32 s[48:49], s30, v18
    s_or_b64 vcc, vcc, s[48:49]
    v_cmp_eq_u32 s[48:49], s30, v19
    s_or_b64 vcc, vcc, s[48:49]
    s_cbranch_vccnz CF2_L2
    v_smfmac_f32_16x16x64_bf16 v[40:43], v[16:19], a[16:23], v1
    v_smfmac_f32_16x16x64_bf16 v[48:51], v[16:19], a[120:127], v1
    v_smfmac_f32_16x16x64_bf16 v[44:47], v[16:19], a[24:31], v1
    v_smfmac_f32_16x16x64_bf16 v[52:55], v[16:19], a[128:135], v1
    ds_read_b128 v[32:35], v0 offset:16384
    ds_read_b128 v[36:39], v0 offset:17408
    s_waitcnt lgkmcnt(0)
    v_smfmac_f32_16x16x64_bf16 v[56:59], v[16:19], v[32:39], v1
    ds_read_b128 v[32:35], v0 offset:18432
    ds_read_b128 v[36:39], v0 offset:19456
    s_waitcnt lgkmcnt(0)
    v_smfmac_f32_16x16x64_bf16 v[60:63], v[16:19], v[32:39], v1
CF2_L3:
    buffer_load_dwordx4 v[20:23], v3, s[4:7], s34 offen offset:3072 sc1
    s_add_u32 s31, s31, 1
    s_cmp_ge_u32 s31, 400000
    s_cbranch_scc1 FAIL
    s_waitcnt vmcnt(0)
    v_cmp_eq_u32 vcc, s30, v20
    v_cmp_eq_u32 s[48:49], s30, v21
    s_or_b64 vcc, vcc, s[48:49]
    v_cmp_eq_u32 s[48:49], s30, v22
    s_or_b64 vcc, vcc, s[48:49]
    v_cmp_eq_u32 s[48:49], s30, v23
    s_or_b64 vcc, vcc, s[48:49]
    s_cbranch_vccnz CF2_L3
    v_smfmac_f32_16x16x64_bf16 v[40:43], v[20:23], a[32:39], v1
    v_smfmac_f32_16x16x64_bf16 v[48:51], v[20:23], a[136:143], v1
    v_smfmac_f32_16x16x64_bf16 v[44:47], v[20:23], a[40:47], v1
    v_smfmac_f32_16x16x64_bf16 v[52:55], v[20:23], a[144:151], v1
CF2_L4:
    buffer_load_dwordx4 v[8:11], v3, s[4:7], s34 offen offset:0 sc1
    s_add_u32 s31, s31, 1
    s_cmp_ge_u32 s31, 400000
    s_cbranch_scc1 FAIL
    s_waitcnt vmcnt(0)
    v_cmp_eq_u32 vcc, s30, v8
    v_cmp_eq_u32 s[48:49], s30, v9
    s_or_b64 vcc, vcc, s[48:49]
    v_cmp_eq_u32 s[48:49], s30, v10
    s_or_b64 vcc, vcc, s[48:49]
    v_cmp_eq_u32 s[48:49], s30, v11
    s_or_b64 vcc, vcc, s[48:49]
    s_cbranch_vccnz CF2_L4
    v_smfmac_f32_16x16x64_bf16 v[40:43], v[8:11], a[48:55], v1
    v_smfmac_f32_16x16x64_bf16 v[44:47], v[8:11], a[56:63], v1
CF2_L5:
    buffer_load_dwordx4 v[12:15], v3, s[4:7], s34 offen offset:1024 sc1
    s_add_u32 s31, s31, 1
    s_cmp_ge_u32 s31, 400000
    s_cbranch_scc1 FAIL
    s_waitcnt vmcnt(0)
    v_cmp_eq_u32 vcc, s30, v12
    v_cmp_eq_u32 s[48:49], s30, v13
    s_or_b64 vcc, vcc, s[48:49]
    v_cmp_eq_u32 s[48:49], s30, v14
    s_or_b64 vcc, vcc, s[48:49]
    v_cmp_eq_u32 s[48:49], s30, v15
    s_or_b64 vcc, vcc, s[48:49]
    s_cbranch_vccnz CF2_L5
    v_smfmac_f32_16x16x64_bf16 v[40:43], v[12:15], a[64:71], v1
    v_smfmac_f32_16x16x64_bf16 v[44:47], v[12:15], a[72:79], v1
CF2_L6:
    buffer_load_dwordx4 v[28:31], v3, s[4:7], s35 offen offset:0 sc1
    s_add_u32 s31, s31, 1
    s_cmp_ge_u32 s31, 400000
    s_cbranch_scc1 FAIL
    s_waitcnt vmcnt(0)
    v_cmp_eq_u32 vcc, s30, v28
    v_cmp_eq_u32 s[48:49], s30, v29
    s_or_b64 vcc, vcc, s[48:49]
    v_cmp_eq_u32 s[48:49], s30, v30
    s_or_b64 vcc, vcc, s[48:49]
    v_cmp_eq_u32 s[48:49], s30, v31
    s_or_b64 vcc, vcc, s[48:49]
    s_cbranch_vccnz CF2_L6
    ds_read_b128 v[32:35], v0 offset:0
    ds_read_b128 v[36:39], v0 offset:1024
    s_waitcnt lgkmcnt(0)
    v_smfmac_f32_16x16x64_bf16 v[40:43], v[28:31], v[32:39], v1
    v_smfmac_f32_16x16x64_bf16 v[44:47], v[28:31], a[80:87], v1
CF2_L8:
    buffer_load_dwordx4 v[24:27], v3, s[4:7], s35 offen offset:2048 sc1
    s_add_u32 s31, s31, 1
    s_cmp_ge_u32 s31, 400000
    s_cbranch_scc1 FAIL
    s_waitcnt vmcnt(0)
    v_cmp_eq_u32 vcc, s30, v24
    v_cmp_eq_u32 s[48:49], s30, v25
    s_or_b64 vcc, vcc, s[48:49]
    v_cmp_eq_u32 s[48:49], s30, v26
    s_or_b64 vcc, vcc, s[48:49]
    v_cmp_eq_u32 s[48:49], s30, v27
    s_or_b64 vcc, vcc, s[48:49]
    s_cbranch_vccnz CF2_L8
    v_smfmac_f32_16x16x64_bf16 v[40:43], v[24:27], a[104:111], v1
CF2_L7:
    buffer_load_dwordx4 v[16:19], v3, s[4:7], s35 offen offset:1024 sc1
    s_add_u32 s31, s31, 1
    s_cmp_ge_u32 s31, 400000
    s_cbranch_scc1 FAIL
    s_waitcnt vmcnt(0)
    v_cmp_eq_u32 vcc, s30, v16
    v_cmp_eq_u32 s[48:49], s30, v17
    s_or_b64 vcc, vcc, s[48:49]
    v_cmp_eq_u32 s[48:49], s30, v18
    s_or_b64 vcc, vcc, s[48:49]
    v_cmp_eq_u32 s[48:49], s30, v19
    s_or_b64 vcc, vcc, s[48:49]
    s_cbranch_vccnz CF2_L7
    v_smfmac_f32_16x16x64_bf16 v[40:43], v[16:19], a[88:95], v1
    v_smfmac_f32_16x16x64_bf16 v[44:47], v[24:27], a[112:119], v1
    v_smfmac_f32_16x16x64_bf16 v[44:47], v[16:19], a[96:103], v1
    ds_read_b128 v[32:35], v0 offset:2048
    ds_read_b128 v[36:39], v0 offset:3072
    s_waitcnt lgkmcnt(0)
    v_smfmac_f32_16x16x64_bf16 v[48:51], v[8:11], v[32:39], v1
    v_smfmac_f32_16x16x64_bf16 v[52:55], v[8:11], a[152:159], v1
    v_smfmac_f32_16x16x64_bf16 v[48:51], v[12:15], a[160:167], v1
    v_smfmac_f32_16x16x64_bf16 v[52:55], v[12:15], a[168:175], v1
    v_smfmac_f32_16x16x64_bf16 v[48:51], v[28:31], a[176:183], v1
    ds_read_b128 v[32:35], v0 offset:8192
    ds_read_b128 v[36:39], v0 offset:9216
    v_add_f32 v40, v40, v41
    v_add_f32 v42, v42, v43
    v_add_f32 v44, v44, v45
    v_add_f32 v46, v46, v47
    v_cvt_pk_bf16_f32 v40, v40, v44
    v_cvt_pk_bf16_f32 v41, v42, v46
    ds_write_b64 v4, v[40:41] offset:8704
    s_waitcnt lgkmcnt(0)
    s_branch CF2_RJ
CF2_SLOW:
    ds_read_b64_tr_b16 v[40:41], v5 offset:7168
    ds_read_b64_tr_b16 v[48:49], v5 offset:0
    ds_read_b64_tr_b16 v[42:43], v5 offset:7936
    ds_read_b64_tr_b16 v[50:51], v5 offset:768
    ds_read_b64_tr_b16 v[44:45], v5 offset:8704
    ds_read_b64_tr_b16 v[52:53], v5 offset:1536
    ds_read_b64_tr_b16 v[46:47], v5 offset:9472
    ds_read_b64_tr_b16 v[54:55], v5 offset:2304
    s_waitcnt vmcnt(0) lgkmcnt(0)
    v_and_b32 v64, 128, v3
    v_mad_u32_u24 v64, v64, 31, v3
    buffer_load_dwordx4 v[68:71], v64, s[4:7], s50 offen offset:1024 sc1
    buffer_load_dwordx4 v[76:79], v3, s[4:7], s46 offen offset:3072 sc1
    buffer_load_dwordx4 v[64:67], v64, s[4:7], s38 offen offset:1024 sc1
    buffer_load_dwordx4 v[72:75], v3, s[4:7], s46 offen offset:2048 sc1
    v_mfma_f32_16x16x32_bf16 v[48:51], v[48:51], v[40:43], 0
    v_mfma_f32_16x16x32_bf16 v[48:51], v[52:55], v[44:47], v[48:51]
    v_lshrrev_b32 v38, 2, v3
    v_and_b32 v38, 0xe0, v38
    v_and_b32 v39, 0xe0, v3
    s_nop 4
    v_add_f32_dpp v48, v49, v48 quad_perm:[1,0,3,2] row_mask:0xf bank_mask:0xf
    v_add_f32_dpp v50, v51, v50 quad_perm:[1,0,3,2] row_mask:0xf bank_mask:0xf
    v_mul_f32 v48, s44, v48
    v_mul_f32 v50, s44, v50
    v_mov_b64 v[32:33], s[20:21]
    v_mov_b64 v[34:35], s[20:21]
    s_waitcnt vmcnt(0)
    ds_read_b32 v2, v3 offset:13568
    v_mfma_f32_16x16x32_bf16 v[64:67], v[40:43], v[64:67], 0
    v_mfma_f32_16x16x32_bf16 v[64:67], v[44:47], v[68:71], v[64:67]
    v_max_f32 v37, v48, v50
    v_mov_b32 v36, v37
    s_nop 1
    v_permlane16_swap_b32 v36, v37
    v_max_f32 v37, v36, v37
    v_mov_b32 v36, v37
    s_nop 1
    v_permlane32_swap_b32 v36, v37
    v_max_f32 v37, v36, v37
    v_add_f32_dpp v64, v65, v64 row_ror:8 row_mask:0xf bank_mask:0xf
    v_add_f32_dpp v64, v66, v67 row_ror:8 row_mask:0xf bank_mask:0xc
    s_nop 1
    v_max_f32_dpp v36, v64, v64 quad_perm:[1,0,3,2] row_mask:0xf bank_mask:0xf
    s_nop 1
    v_max_f32_dpp v36, v36, v36 quad_perm:[2,3,0,1] row_mask:0xf bank_mask:0xf
    s_nop 1
    v_max_f32_dpp v36, v36, v36 row_half_mirror row_mask:0xf bank_mask:0xf
    ds_write_b32 v38, v36 offset:15624
    s_mov_b64 exec, s[40:41]
    ds_write_b32 v39, v37 offset:15632
    s_mov_b64 exec, -1
    s_waitcnt lgkmcnt(0)
    s_barrier
    ds_read_b128 v[40:43], v38 offset:15616
    ds_read_b32 v36, v38 offset:15632
    ds_read_b128 v[44:47], v39 offset:15616
    ds_read_b32 v37, v39 offset:15632
    s_waitcnt lgkmcnt(0)
    v_max3_f32 v36, v36, v40, v41
    v_max3_f32 v36, v36, v42, v43
    v_max3_f32 v37, v37, v44, v45
    v_max3_f32 v37, v37, v46, v47
    v_sub_f32 v64, v64, v36
    v_exp_f32 v64, v64
    v_sub_f32 v48, v48, v37
    v_exp_f32 v48, v48
    v_sub_f32 v50, v50, v37
    v_exp_f32 v50, v50
    v_cvt_pk_bf16_f32 v64, v64, v64
    ds_write_b16 v2, v64 offset:10504
    v_cvt_pk_bf16_f32 v48, v48, v50
    v_cndmask_b32 v48, 0, v48, s[40:41]
    s_nop 1
    v_mov_b32_dpp v49, v48 quad_perm:[1,0,3,2] row_mask:0xf bank_mask:0xf
    s_waitcnt lgkmcnt(0)
    s_barrier
    ds_read_b128 v[64:67], v3 offset:10496
    ds_read_b128 v[68:71], v3 offset:10480
    s_waitcnt lgkmcnt(0)
    v_mfma_f32_16x16x32_bf16 v[72:75], v[72:75], v[64:67], 0
    v_mfma_f32_16x16x32_bf16 v[72:75], v[76:79], v[68:71], v[72:75]
    v_mfma_f32_16x16x32_bf16 v[52:55], v[32:35], v[64:67], 0
    s_nop 5
    v_mfma_f32_16x16x16_bf16 v[52:55], v[32:33], v[48:49], v[52:55]
    v_mfma_f32_16x16x16_bf16 v[72:75], v[56:57], v[48:49], v[72:75]
    ds_read_b128 v[64:67], v0 offset:22528
    ds_read_b128 v[68:71], v0 offset:23552
    ds_read_b128 v[32:35], v3 offset:14592
    v_mov_b64 v[36:37], 0
    v_mov_b64 v[38:39], 0
    v_mov_b64 v[40:41], 0
    v_mov_b64 v[42:43], 0
    v_mov_b64 v[44:45], 0
    v_mov_b64 v[46:47], 0
    v_rcp_f32_dpp v53, v52 quad_perm:[0,0,2,2] row_mask:0xf bank_mask:0xf
    s_nop 0
    v_mul_f32 v72, v72, v53
    v_mul_f32 v73, v73, v53
    v_mul_f32 v74, v74, v53
    v_mul_f32 v75, v75, v53
    v_cvt_pk_bf16_f32 v72, v72, v73
    v_cvt_pk_bf16_f32 v73, v74, v75
    ds_write_b64 v4, v[72:73] offset:5632
    v_mov_b32_dpp v76, v72 quad_perm:[0,0,2,2] row_mask:0xf bank_mask:0xf
    v_mov_b32_dpp v77, v73 quad_perm:[0,0,2,2] row_mask:0xf bank_mask:0xf
    v_mov_b32_dpp v78, v72 quad_perm:[1,1,3,3] row_mask:0xf bank_mask:0xf
    v_mov_b32_dpp v79, v73 quad_perm:[1,1,3,3] row_mask:0xf bank_mask:0xf
    s_waitcnt lgkmcnt(0)
    s_branch CF2_FAST
CF2_SP:
    s_cmp_eq_u32 s32, 63
    s_cbranch_scc1 CF2_LAST
    s_add_u32 s18, s18, 1
    s_cmp_gt_u32 s18, 1
    s_cselect_b32 s18, 63, s18
    s_waitcnt vmcnt(0)
CF2_SQ:
    buffer_load_dwordx4 v[16:19], v3, s[4:7], s35 offen offset:1024 sc1
    s_add_u32 s31, s31, 1
    s_cmp_ge_u32 s31, 400000
    s_cbranch_scc1 FAIL
    s_waitcnt vmcnt(0)
    v_cmp_eq_u32 vcc, s30, v16
    v_cmp_eq_u32 s[48:49], s30, v17
    s_or_b64 vcc, vcc, s[48:49]
    v_cmp_eq_u32 s[48:49], s30, v18
    s_or_b64 vcc, vcc, s[48:49]
    v_cmp_eq_u32 s[48:49], s30, v19
    s_or_b64 vcc, vcc, s[48:49]
    s_cbranch_vccnz CF2_SQ
    buffer_load_dwordx4 v[16:19], v3, s[4:7], s34 offen offset:2048 sc1
    buffer_load_dwordx4 v[20:23], v3, s[4:7], s34 offen offset:3072 sc1
    s_branch CF2_A
CF2_R1:
    buffer_load_dwordx4 v[48:51], v3, s[4:7], s51 offen offset:0 sc1
    buffer_load_dwordx4 v[52:55], v3, s[4:7], s51 offen offset:1024 sc1
    s_add_u32 s31, s31, 1
    s_cmp_ge_u32 s31, 400000
    s_cbranch_scc1 FAIL
    s_waitcnt vmcnt(1)
    v_mfma_f32_16x16x32_bf16 v[60:63], v[44:47], v[48:51], 0
    v_bitop3_b32 v2, v48, v50, s32 bitop3:0x7e
    s_waitcnt vmcnt(0)
    v_mfma_f32_16x16x32_bf16 v[60:63], v[44:47], v[52:55], v[60:63]
    v_bitop3_b32 v6, v52, v54, s32 bitop3:0x7e
    v_bitop3_b32 v2, v2, v6, 1 bitop3:0xa8
    v_cmp_ne_u32 vcc, 0, v2
    v_mov_b64 v[48:49], 0
    v_mov_b64 v[50:51], 0
    v_mov_b64 v[52:53], 0
    v_mov_b64 v[54:55], 0
    s_nop 0
    v_add_f32_dpp v60, v60, v60 row_ror:8 row_mask:0xf bank_mask:0xf
    v_add_f32_dpp v61, v61, v61 row_ror:8 row_mask:0xf bank_mask:0xf
    s_nop 0
    v_add_f32_dpp v60, v60, v60 row_ror:4 row_mask:0xf bank_mask:0xf
    v_add_f32_dpp v61, v61, v61 row_ror:4 row_mask:0xf bank_mask:0xf
    v_cvt_pk_bf16_f32 v6, v60, v61
    s_cbranch_vccz CF2_RC
    s_branch CF2_R1
CF2_LAST:
    buffer_store_dword v6, v7, s[4:7], s39 offen sc1
    s_waitcnt vmcnt(0)
    s_branch C_END
CF3_IN:
    s_add_u32 s45, s38, 32768
    s_add_u32 s34, s19, 2048
    s_add_u32 s35, s19, 6144
    buffer_load_dwordx4 v[8:11], v3, s[4:7], s19 offen offset:1024 sc1
    buffer_load_dwordx4 v[12:15], v3, s[4:7], s19 offen offset:0 sc1
    s_mov_b32 s29, 0
    s_mov_b32 m0, 4096
    s_mov_b32 s18, 1
CF3_FF:
    ds_read_b128 v[72:75], v0 offset:12288
    ds_read_b128 v[76:79], v0 offset:13312
    ds_read_b128 v[64:67], v0 offset:28672
    ds_read_b128 v[68:71], v0 offset:29696
    ds_read_b128 v[24:27], v0 offset:14336
    ds_read_b128 v[28:31], v0 offset:15360
    ds_read_b128 v[32:35], v0 offset:30720
    ds_read_b128 v[36:39], v0 offset:31744
    v_mov_b64 v[40:41], 0
    v_mov_b64 v[42:43], 0
    v_mov_b64 v[44:45], 0
    v_mov_b64 v[46:47], 0
    v_mov_b64 v[48:49], 0
    v_mov_b64 v[50:51], 0
    v_mov_b64 v[52:53], 0
    v_mov_b64 v[54:55], 0
    v_mov_b64 v[56:57], 0
    v_mov_b64 v[58:59], 0
    v_mov_b64 v[60:61], 0
    v_mov_b64 v[62:63], 0
    s_waitcnt vmcnt(0) lgkmcnt(0)
    buffer_load_dwordx4 v[16:19], v3, s[4:7], s34 offen offset:3072 sc1
    buffer_load_dwordx4 v[20:23], v3, s[4:7], s34 offen offset:2048 sc1
    s_branch CF3_A
CF3_T:
    s_barrier
    s_barrier
    buffer_load_dwordx4 v[48:51], v3, s[4:7], s51 offen offset:0 sc1
    s_waitcnt vmcnt(0)
    v_mfma_f32_16x16x32_bf16 v[60:63], v[44:47], v[48:51], 0
    v_bitop3_b32 v2, v48, v49, s32 bitop3:0x7e
    v_bitop3_b32 v6, v50, v51, s32 bitop3:0x7e
    v_bitop3_b32 v2, v2, v6, 1 bitop3:0xa8
    v_cmp_ne_u32 vcc, 0, v2
    v_mov_b64 v[48:49], 0
    v_mov_b64 v[50:51], 0
    s_nop 1
    v_add_f32_dpp v60, v60, v60 row_ror:8 row_mask:0xf bank_mask:0xf
    v_add_f32_dpp v61, v61, v61 row_ror:8 row_mask:0xf bank_mask:0xf
    s_nop 0
    v_add_f32_dpp v60, v60, v60 row_ror:4 row_mask:0xf bank_mask:0xf
    v_add_f32_dpp v61, v61, v61 row_ror:4 row_mask:0xf bank_mask:0xf
    s_nop 0
    v_add_f32_dpp v60, v60, v60 row_ror:2 row_mask:0xf bank_mask:0xf
    v_add_f32_dpp v61, v61, v61 row_ror:2 row_mask:0xf bank_mask:0xf
    v_cvt_pk_bf16_f32 v6, v60, v61
    s_cbranch_vccnz CF3_R1
CF3_RC:
    buffer_store_dword v6, v7, s[4:7], s36 offen
    v_mov_b64 v[44:45], 0
    v_mov_b64 v[46:47], 0
    v_mov_b64 v[60:61], 0
    v_mov_b64 v[62:63], 0
    s_barrier
    buffer_load_dwordx4 v[16:19], v3, s[4:7], s34 offen offset:3072 sc1
    s_barrier
    ds_read_b128 v[8:11], v3 offset:8192
    ds_read_b128 v[12:15], v3 offset:7168
    buffer_load_dwordx4 v[20:23], v3, s[4:7], s34 offen offset:2048 sc1
    s_cmp_eq_u32 s32, s18
    s_cbranch_scc1 CF3_SP
CF3_A:
    s_waitcnt lgkmcnt(1)
    v_smfmac_f32_16x16x64_bf16 v[40:43], v[8:11], v[72:79], v1
    v_smfmac_f32_16x16x64_bf16 v[48:51], v[8:11], v[64:71], v1
    ds_read_b128 v[64:67], v0 offset:32768
    v_smfmac_f32_16x16x64_bf16 v[44:47], v[8:11], v[24:31], v1
    ds_read_b128 v[68:71], v0 offset:33792
    v_mov_b32 v2, s30
    v_smfmac_f32_16x16x64_bf16 v[52:55], v[8:11], v[32:39], v1
    buffer_store_dword v2, v7, s[4:7], s37 offen
    ds_read_b128 v[24:27], v0 offset:34816
    v_smfmac_f32_16x16x64_bf16 v[56:59], v[8:11], a[216:223], v1
    ds_read_b128 v[28:31], v0 offset:35840
    v_smfmac_f32_16x16x64_bf16 v[60:63], v[8:11], a[224:231], v1
    buffer_load_dwordx4 v3, s[4:7], s35 offen offset:2048 sc1 lds
    ds_read_b128 v[32:35], v0 offset:4096
    s_waitcnt lgkmcnt(5)
    v_smfmac_f32_16x16x64_bf16 v[40:43], v[12:15], a[0:7], v1
    ds_read_b128 v[36:39], v0 offset:5120
    s_waitcnt lgkmcnt(4)
    v_smfmac_f32_16x16x64_bf16 v[48:51], v[12:15], v[64:71], v1
    v_smfmac_f32_16x16x64_bf16 v[44:47], v[12:15], a[8:15], v1
    s_waitcnt lgkmcnt(2)
    v_smfmac_f32_16x16x64_bf16 v[52:55], v[12:15], v[24:31], v1
    buffer_load_dwordx4 v[72:75], v3, s[4:7], s46 offen offset:2048 sc1
    ds_read_b128 v[24:27], v0 offset:16384
    v_smfmac_f32_16x16x64_bf16 v[56:59], v[12:15], a[232:239], v1
    buffer_load_dwordx4 v[76:79], v3, s[4:7], s46 offen offset:3072 sc1
    ds_read_b128 v[28:31], v0 offset:17408
    s_waitcnt lgkmcnt(2)
    v_smfmac_f32_16x16x64_bf16 v[60:63], v[12:15], v[32:39], v1
    ds_read_b128 v[32:35], v0 offset:18432
    ds_read_b128 v[36:39], v0 offset:19456
    s_waitcnt vmcnt(5)
    v_smfmac_f32_16x16x64_bf16 v[40:43], v[16:19], a[16:23], v1
    ds_write_b128 v3, v[16:19] offset:3072
    v_and_b32 v64, 128, v3
    v_smfmac_f32_16x16x64_bf16 v[48:51], v[16:19], a[120:127], v1
    v_mad_u32_u24 v64, v64, 31, v3
    v_smfmac_f32_16x16x64_bf16 v[44:47], v[16:19], a[24:31], v1
    buffer_load_dwordx4 v[68:71], v64, s[4:7], s50 offen offset:1152 sc1
    v_maximum3_f32 v2, v16, v17, v18
    v_smfmac_f32_16x16x64_bf16 v[52:55], v[16:19], a[128:135], v1
    buffer_load_dwordx4 v[64:67], v64, s[4:7], s38 offen offset:1152 sc1
    s_waitcnt lgkmcnt(3)
    v_cmp_u_f32 vcc, v2, v19
    v_smfmac_f32_16x16x64_bf16 v[56:59], v[16:19], v[24:31], v1
    s_waitcnt lgkmcnt(1)
    v_smfmac_f32_16x16x64_bf16 v[60:63], v[16:19], v[32:39], v1
    s_cbranch_vccnz CF3_FB
CF3_CB:
    s_waitcnt lgkmcnt(0)
    s_barrier
    s_waitcnt vmcnt(6)
    v_smfmac_f32_16x16x64_bf16 v[40:43], v[20:23], a[32:39], v1
    buffer_store_dword v6, v7, s[4:7], s39 offen sc1
    ds_read_b128 v[8:11], v3 offset:1024
    v_lshrrev_b32 v6, 2, v3
    v_smfmac_f32_16x16x64_bf16 v[48:51], v[20:23], a[136:143], v1
    buffer_load_dword v6, v6, s[4:7], s53 offen sc1
    ds_read_b128 v[12:15], v3 offset:0
    v_smfmac_f32_16x16x64_bf16 v[44:47], v[20:23], a[40:47], v1
    ds_read_b128 v[32:35], v0 offset:0
    s_mov_b32 s37, s36
    v_smfmac_f32_16x16x64_bf16 v[52:55], v[20:23], a[144:151], v1
    s_waitcnt vmcnt(6)
    s_barrier
    ds_read_b128 v[36:39], v0 offset:1024
    s_waitcnt lgkmcnt(3)
    v_smfmac_f32_16x16x64_bf16 v[40:43], v[8:11], a[48:55], v1
    ds_read_b128 v[28:31], v3 offset:4096
    s_add_u32 s36, s36, 0x8000
    v_smfmac_f32_16x16x64_bf16 v[44:47], v[8:11], a[56:63], v1
    ds_read_b128 v[24:27], v3 offset:6144
    s_bitset0_b32 s36, 17
    s_waitcnt lgkmcnt(4)
    v_smfmac_f32_16x16x64_bf16 v[40:43], v[12:15], a[64:71], v1
    ds_read_b128 v[16:19], v3 offset:5120
    s_add_u32 s32, s32, 1
    v_smfmac_f32_16x16x64_bf16 v[44:47], v[12:15], a[72:79], v1
    ds_read_b32 v2, v3 offset:13568
    s_waitcnt lgkmcnt(3)
    v_smfmac_f32_16x16x64_bf16 v[40:43], v[28:31], v[32:39], v1
    ds_read_b128 v[32:35], v0 offset:2048
    s_add_u32 s39, s39, 9216
    v_smfmac_f32_16x16x64_bf16 v[44:47], v[28:31], a[80:87], v1
    ds_read_b128 v[36:39], v0 offset:3072
    s_mov_b32 s29, 0
    s_waitcnt lgkmcnt(4)
    v_smfmac_f32_16x16x64_bf16 v[40:43], v[24:27], a[104:111], v1
    s_waitcnt lgkmcnt(3)
    v_smfmac_f32_16x16x64_bf16 v[40:43], v[16:19], a[88:95], v1
    v_smfmac_f32_16x16x64_bf16 v[44:47], v[24:27], a[112:119], v1
    v_smfmac_f32_16x16x64_bf16 v[44:47], v[16:19], a[96:103], v1
    s_waitcnt lgkmcnt(0)
    v_add_f32 v40, v40, v41
    v_smfmac_f32_16x16x64_bf16 v[48:51], v[8:11], v[32:39], v1
    ds_read_b128 v[32:35], v0 offset:8192
    v_add_f32 v42, v42, v43
    v_smfmac_f32_16x16x64_bf16 v[52:55], v[8:11], a[152:159], v1
    ds_read_b128 v[36:39], v0 offset:9216
    v_add_f32 v44, v44, v45
    v_add_f32 v46, v46, v47
    v_cvt_pk_bf16_f32 v40, v40, v44
    v_cvt_pk_bf16_f32 v41, v42, v46
    v_smfmac_f32_16x16x64_bf16 v[48:51], v[12:15], a[160:167], v1
    ds_write_b64 v4, v[40:41] offset:9472
    v_cmp_u_f32 vcc, v40, v41
    v_smfmac_f32_16x16x64_bf16 v[52:55], v[12:15], a[168:175], v1
    v_smfmac_f32_16x16x64_bf16 v[48:51], v[28:31], a[176:183], v1
    s_cbranch_vccnz CF3_RE
CF3_RJ:
    v_smfmac_f32_16x16x64_bf16 v[52:55], v[28:31], a[184:191], v1
    s_add_u32 s19, s19, 0x8000
    s_waitcnt lgkmcnt(1)
    v_smfmac_f32_16x16x64_bf16 v[48:51], v[24:27], v[32:39], v1
    s_waitcnt lgkmcnt(0)
    s_barrier
    v_smfmac_f32_16x16x64_bf16 v[48:51], v[16:19], a[192:199], v1
    ds_read_b64_tr_b16 v[40:41], v5 offset:7168
    ds_read_b64_tr_b16 v[42:43], v5 offset:7936
    v_smfmac_f32_16x16x64_bf16 v[52:55], v[24:27], a[208:215], v1
    ds_read_b64_tr_b16 v[44:45], v5 offset:8704
    ds_read_b64_tr_b16 v[46:47], v5 offset:9472
    v_smfmac_f32_16x16x64_bf16 v[52:55], v[16:19], a[200:207], v1
    ds_read_b128 v[32:35], v0 offset:6144
    v_add_f32 v48, v48, v49
    v_smfmac_f32_16x16x64_bf16 v[56:59], v[8:11], v[80:87], v1
    ds_read_b128 v[36:39], v0 offset:7168
    s_waitcnt vmcnt(2) lgkmcnt(4)
    v_add_f32 v50, v50, v51
    v_mfma_f32_16x16x32_bf16 v[64:67], v[40:43], v[64:67], 0
    s_waitcnt lgkmcnt(2)
    v_add_f32 v52, v52, v53
    v_add_f32 v54, v54, v55
    v_mfma_f32_16x16x32_bf16 v[64:67], v[44:47], v[68:71], v[64:67]
    v_cvt_pk_bf16_f32 v48, v48, v52
    v_cvt_pk_bf16_f32 v49, v50, v54
    v_smfmac_f32_16x16x64_bf16 v[60:63], v[8:11], v[88:95], v1
    ds_write_b64 v4, v[48:49] offset:2304
    s_bitset0_b32 s19, 17
    v_smfmac_f32_16x16x64_bf16 v[56:59], v[12:15], v[96:103], v1
    s_add_u32 s34, s19, 2048
    s_waitcnt lgkmcnt(1)
    v_add_f32_dpp v64, v65, v64 row_ror:8 row_mask:0xf bank_mask:0xf
    v_add_f32_dpp v64, v66, v67 row_ror:8 row_mask:0xf bank_mask:0xc
    v_exp_f32 v64, v64
    s_nop 0
    v_cvt_pk_bf16_f32 v64, v64, v64
    v_smfmac_f32_16x16x64_bf16 v[60:63], v[12:15], v[32:39], v1
    ds_write_b16 v2, v64 offset:11016
    v_smfmac_f32_16x16x64_bf16 v[56:59], v[16:19], v[120:127], v1
    ds_read_b128 v[8:11], v0 offset:20480
    s_add_u32 s35, s19, 6144
    v_mov_b64 v[32:33], s[20:21]
    v_smfmac_f32_16x16x64_bf16 v[60:63], v[16:19], v[128:135], v1
    ds_read_b128 v[12:15], v0 offset:21504
    v_mov_b64 v[34:35], s[20:21]
    v_smfmac_f32_16x16x64_bf16 v[56:59], v[20:23], a[240:247], v1
    s_waitcnt lgkmcnt(2)
    s_barrier
    v_smfmac_f32_16x16x64_bf16 v[60:63], v[20:23], a[248:255], v1
    ds_read_b64_tr_b16 v[48:49], v5 offset:0
    ds_read_b64_tr_b16 v[50:51], v5 offset:768
    v_smfmac_f32_16x16x64_bf16 v[56:59], v[24:27], v[136:143], v1
    ds_read_b64_tr_b16 v[52:53], v5 offset:1536
    ds_read_b64_tr_b16 v[54:55], v5 offset:2304
    v_smfmac_f32_16x16x64_bf16 v[56:59], v[28:31], v[104:111], v1
    ds_read_b128 v[64:67], v3 offset:10496
    v_mov_b64 v[36:37], 0
    v_smfmac_f32_16x16x64_bf16 v[60:63], v[24:27], v[144:151], v1
    ds_read_b128 v[68:71], v3 offset:10480
    s_waitcnt lgkmcnt(4)
    v_mov_b64 v[38:39], 0
    v_mfma_f32_16x16x32_bf16 v[48:51], v[48:51], v[40:43], 0
    ds_read_b128 v[16:19], v0 offset:24576
    s_waitcnt lgkmcnt(3)
    v_add_f32 v56, v56, v57
    v_add_f32 v58, v58, v59
    v_mfma_f32_16x16x32_bf16 v[48:51], v[52:55], v[44:47], v[48:51]
    ds_read_b128 v[20:23], v0 offset:25600
    v_cvt_pk_bf16_f32 v56, v56, v58
    v_smfmac_f32_16x16x64_bf16 v[60:63], v[28:31], v[112:119], v1
    ds_read_b128 v[24:27], v0 offset:26624
    s_waitcnt lgkmcnt(4)
    v_mfma_f32_16x16x32_bf16 v[52:55], v[32:35], v[64:67], 0
    ds_read_b128 v[28:31], v0 offset:27648
    v_add_f32_dpp v48, v49, v48 quad_perm:[1,0,3,2] row_mask:0xf bank_mask:0xf
    v_add_f32_dpp v50, v51, v50 quad_perm:[1,0,3,2] row_mask:0xf bank_mask:0xf
    v_mfma_f32_16x16x32_bf16 v[72:75], v[72:75], v[64:67], 0
    s_waitcnt lgkmcnt(4)
    v_mul_f32 v48, s44, v48
    v_mul_f32 v50, s44, v50
    v_exp_f32 v48, v48
    v_exp_f32 v50, v50
    v_add_f32 v60, v60, v61
    v_cvt_pk_bf16_f32 v48, v48, v50
    v_cndmask_b32 v48, 0, v48, s[40:41]
    v_mfma_f32_16x16x32_bf16 v[72:75], v[76:79], v[68:71], v[72:75]
    ds_read_b128 v[64:67], v0 offset:22528
    v_mov_b32_dpp v49, v48 quad_perm:[1,0,3,2] row_mask:0xf bank_mask:0xf
    v_add_f32 v62, v62, v63
    v_cvt_pk_bf16_f32 v57, v60, v62
    v_mfma_f32_16x16x16_bf16 v[52:55], v[32:33], v[48:49], v[52:55]
    ds_read_b128 v[32:35], v3 offset:14592
    ds_read_b128 v[68:71], v0 offset:23552
    v_mov_b64 v[40:41], 0
    v_mfma_f32_16x16x16_bf16 v[72:75], v[56:57], v[48:49], v[72:75]
    v_mov_b64 v[42:43], 0
    v_mov_b64 v[44:45], 0
    v_mov_b64 v[46:47], 0
    v_mov_b64 v[60:61], 0
    v_rcp_f32_dpp v53, v52 quad_perm:[0,0,2,2] row_mask:0xf bank_mask:0xf
    v_mov_b64 v[62:63], 0
    v_max_u32 v52, v52, v53
    v_cmp_lt_u32 vcc, s17, v52
    v_mul_f32 v72, v72, v53
    v_mul_f32 v73, v73, v53
    v_mul_f32 v74, v74, v53
    v_mul_f32 v75, v75, v53
    v_cvt_pk_bf16_f32 v72, v72, v73
    v_cvt_pk_bf16_f32 v73, v74, v75
    ds_write_b64 v4, v[72:73] offset:6400
    v_mov_b32_dpp v76, v72 quad_perm:[0,0,2,2] row_mask:0xf bank_mask:0xf
    v_mov_b32_dpp v77, v73 quad_perm:[0,0,2,2] row_mask:0xf bank_mask:0xf
    v_mov_b32_dpp v78, v72 quad_perm:[1,1,3,3] row_mask:0xf bank_mask:0xf
    v_mov_b32_dpp v79, v73 quad_perm:[1,1,3,3] row_mask:0xf bank_mask:0xf
    s_cbranch_vccnz CF3_SLOW
CF3_FAST:
    s_nop 0
    v_smfmac_f32_16x16x64_bf16 v[40:43], v[76:79], v[8:15], v1
    s_waitcnt lgkmcnt(6)
    v_smfmac_f32_16x16x64_bf16 v[44:47], v[76:79], v[16:23], v1
    s_waitcnt lgkmcnt(0)
    s_barrier
    ds_read_b128 v[48:51], v32 offset:5632
    ds_read_b128 v[52:55], v32 offset:4864
    ds_read_b128 v[56:59], v32 offset:4096
    v_smfmac_f32_16x16x64_bf16 v[60:63], v[76:79], v[24:31], v1
    s_add_u32 s38, s38, 32768
    s_add_u32 s50, s50, 32768
    v_smfmac_f32_16x16x64_bf16 v[36:39], v[76:79], v[64:71], v1
    s_add_u32 s46, s46, 32768
    ds_read_b128 v[24:27], v0 offset:10240
    s_waitcnt lgkmcnt(3)
    v_lshrrev_b32 v32, 16, v1
    v_smfmac_f32_16x16x64_bf16 v[40:43], v[48:51], v[192:199], v1
    ds_read_b128 v[28:31], v0 offset:11264
    s_waitcnt lgkmcnt(3)
    v_smfmac_f32_16x16x64_bf16 v[40:43], v[52:55], v[208:215], v1
    ds_read_b128 v[72:75], v33 offset:4096
    s_waitcnt lgkmcnt(3)
    v_smfmac_f32_16x16x64_bf16 v[40:43], v[56:59], v[224:231], v1
    ds_read_b128 v[76:79], v33 offset:5632
    v_smfmac_f32_16x16x64_bf16 v[44:47], v[48:51], v[152:159], v1
    ds_read_b128 v[64:67], v0 offset:28672
    v_smfmac_f32_16x16x64_bf16 v[44:47], v[52:55], v[168:175], v1
    ds_read_b128 v[68:71], v0 offset:29696
    v_cvt_pk_bf16_f32 v40, v40, v41
    v_cvt_pk_bf16_f32 v41, v42, v43
    v_bfi_b32 v40, 1, s32, v40
    buffer_store_dwordx2 v[40:41], v34, s[4:7], s12 offen
    s_waitcnt lgkmcnt(4)
    v_smfmac_f32_16x16x64_bf16 v[44:47], v[56:59], v[24:31], v1
    v_mov_b64 v[40:41], 0
    v_smfmac_f32_16x16x64_bf16 v[60:63], v[48:51], v[160:167], v1
    ds_read_b128 v[24:27], v0 offset:14336
    v_mov_b64 v[42:43], 0
    v_smfmac_f32_16x16x64_bf16 v[60:63], v[52:55], v[176:183], v1
    ds_read_b128 v[28:31], v0 offset:15360
    v_cvt_pk_bf16_f32 v44, v44, v45
    v_smfmac_f32_16x16x64_bf16 v[60:63], v[56:59], v[184:191], v1
    s_waitcnt lgkmcnt(4)
    v_cvt_pk_bf16_f32 v45, v46, v47
    v_smfmac_f32_16x16x64_bf16 v[40:43], v[72:75], v[240:247], v1
    v_bfi_b32 v44, 1, s32, v44
    v_smfmac_f32_16x16x64_bf16 v[40:43], v[76:79], v[248:255], v1
    ds_read_b128 v[72:75], v0 offset:12288
    v_cvt_pk_bf16_f32 v46, v60, v61
    v_cvt_pk_bf16_f32 v47, v62, v63
    buffer_store_dwordx4 v[44:47], v32, s[4:7], s13 offen
    v_smfmac_f32_16x16x64_bf16 v[36:39], v[48:51], v[200:207], v1
    ds_read_b128 v[76:79], v0 offset:13312
    v_smfmac_f32_16x16x64_bf16 v[36:39], v[52:55], v[216:223], v1
    ds_read_b128 v[44:47], v3 offset:12544
    v_add_f32 v40, v40, v41
    v_smfmac_f32_16x16x64_bf16 v[36:39], v[56:59], v[232:239], v1
    v_add_f32 v42, v42, v43
    v_cvt_pk_bf16_f32 v40, v40, v42
    v_bfi_b32 v40, 1, s32, v40
    buffer_store_dword v40, v35, s[4:7], s15 offen
    s_nop 3
    v_cvt_pk_bf16_f32 v36, v36, v37
    v_cvt_pk_bf16_f32 v37, v38, v39
    v_bfi_b32 v36, 1, s32, v36
    buffer_store_dwordx2 v[36:37], v34, s[4:7], s14 offen
    ds_read_b128 v[32:35], v0 offset:30720
    ds_read_b128 v[36:39], v0 offset:31744
    s_add_u32 s48, s32, 1
    s_min_u32 s48, s48, 63
    s_waitcnt vmcnt(4)
    v_cmp_ge_u32 vcc, s48, v6
    v_mov_b64 v[40:41], 0
    v_mov_b64 v[42:43], 0
    v_mov_b64 v[52:53], 0
    v_mov_b64 v[54:55], 0
    v_mov_b64 v[56:57], 0
    v_mov_b64 v[58:59], 0
    s_and_b64 vcc, vcc, s[42:43]
    s_cbranch_scc1 CF3_QL
CF3_QC:
    s_waitcnt lgkmcnt(0)
    s_branch CF3_T
CF3_FB:
    s_add_u32 s29, s29, 1
    s_cmp_lt_u32 s29, 8
    s_cbranch_scc1 EX_55
    v_cmp_eq_u32 vcc, s30, v16
    v_cmp_eq_u32 s[48:49], s30, v17
    s_or_b64 vcc, vcc, s[48:49]
    v_cmp_eq_u32 s[48:49], s30, v18
    s_or_b64 vcc, vcc, s[48:49]
    v_cmp_eq_u32 s[48:49], s30, v19
    s_or_b64 vcc, vcc, s[48:49]
    s_cbranch_vccz CF3_CB
EX_55:
    s_add_u32 s31, s31, 1
    s_cmp_ge_u32 s31, 400000
    s_cbranch_scc1 FAIL
    s_waitcnt vmcnt(0)
    s_branch CF3_FF
CF3_RE:
    s_waitcnt vmcnt(0) lgkmcnt(0)
    v_mov_b64 v[40:41], 0
    v_mov_b64 v[42:43], 0
    v_mov_b64 v[44:45], 0
    v_mov_b64 v[46:47], 0
    s_nop 1
    v_mov_b64 v[48:49], 0
    v_mov_b64 v[50:51], 0
    v_mov_b64 v[52:53], 0
    v_mov_b64 v[54:55], 0
    v_mov_b64 v[56:57], 0
    v_mov_b64 v[58:59], 0
    v_mov_b64 v[60:61], 0
    v_mov_b64 v[62:63], 0
    s_add_u32 s31, s31, 1
    s_cmp_ge_u32 s31, 400000
    s_cbranch_scc1 FAIL
CF3_L0:
    buffer_load_dwordx4 v[8:11], v3, s[4:7], s19 offen offset:1024 sc1
    s_add_u32 s31, s31, 1
    s_cmp_ge_u32 s31, 400000
    s_cbranch_scc1 FAIL
    s_waitcnt vmcnt(0)
    v_cmp_eq_u32 vcc, s30, v8
    v_cmp_eq_u32 s[48:49], s30, v9
    s_or_b64 vcc, vcc, s[48:49]
    v_cmp_eq_u32 s[48:49], s30, v10
    s_or_b64 vcc, vcc, s[48:49]
    v_cmp_eq_u32 s[48:49], s30, v11
    s_or_b64 vcc, vcc, s[48:49]
    s_cbranch_vccnz CF3_L0
    ds_read_b128 v[32:35], v0 offset:12288
    ds_read_b128 v[36:39], v0 offset:13312
    s_waitcnt lgkmcnt(0)
    v_smfmac_f32_16x16x64_bf16 v[40:43], v[8:11], v[32:39], v1
    ds_read_b128 v[32:35], v0 offset:28672
    ds_read_b128 v[36:39], v0 offset:29696
    s_waitcnt lgkmcnt(0)
    v_smfmac_f32_16x16x64_bf16 v[48:51], v[8:11], v[32:39], v1
    ds_read_b128 v[32:35], v0 offset:14336
    ds_read_b128 v[36:39], v0 offset:15360
    s_waitcnt lgkmcnt(0)
    v_smfmac_f32_16x16x64_bf16 v[44:47], v[8:11], v[32:39], v1
    ds_read_b128 v[32:35], v0 offset:30720
    ds_read_b128 v[36:39], v0 offset:31744
    s_waitcnt lgkmcnt(0)
    v_smfmac_f32_16x16x64_bf16 v[52:55], v[8:11], v[32:39], v1
    v_smfmac_f32_16x16x64_bf16 v[56:59], v[8:11], a[216:223], v1
    v_smfmac_f32_16x16x64_bf16 v[60:63], v[8:11], a[224:231], v1
CF3_L1:
    buffer_load_dwordx4 v[12:15], v3, s[4:7], s19 offen offset:0 sc1
    s_add_u32 s31, s31, 1
    s_cmp_ge_u32 s31, 400000
    s_cbranch_scc1 FAIL
    s_waitcnt vmcnt(0)
    v_cmp_eq_u32 vcc, s30, v12
    v_cmp_eq_u32 s[48:49], s30, v13
    s_or_b64 vcc, vcc, s[48:49]
    v_cmp_eq_u32 s[48:49], s30, v14
    s_or_b64 vcc, vcc, s[48:49]
    v_cmp_eq_u32 s[48:49], s30, v15
    s_or_b64 vcc, vcc, s[48:49]
    s_cbranch_vccnz CF3_L1
    v_smfmac_f32_16x16x64_bf16 v[40:43], v[12:15], a[0:7], v1
    ds_read_b128 v[32:35], v0 offset:32768
    ds_read_b128 v[36:39], v0 offset:33792
    s_waitcnt lgkmcnt(0)
    v_smfmac_f32_16x16x64_bf16 v[48:51], v[12:15], v[32:39], v1
    v_smfmac_f32_16x16x64_bf16 v[44:47], v[12:15], a[8:15], v1
    ds_read_b128 v[32:35], v0 offset:34816
    ds_read_b128 v[36:39], v0 offset:35840
    s_waitcnt lgkmcnt(0)
    v_smfmac_f32_16x16x64_bf16 v[52:55], v[12:15], v[32:39], v1
    v_smfmac_f32_16x16x64_bf16 v[56:59], v[12:15], a[232:239], v1
    ds_read_b128 v[32:35], v0 offset:4096
    ds_read_b128 v[36:39], v0 offset:5120
    s_waitcnt lgkmcnt(0)
    v_smfmac_f32_16x16x64_bf16 v[60:63], v[12:15], v[32:39], v1
CF3_L2:
    buffer_load_dwordx4 v[16:19], v3, s[4:7], s34 offen offset:3072 sc1
    s_add_u32 s31, s31, 1
    s_cmp_ge_u32 s31, 400000
    s_cbranch_scc1 FAIL
    s_waitcnt vmcnt(0)
    v_cmp_eq_u32 vcc, s30, v16
    v_cmp_eq_u32 s[48:49], s30, v17
    s_or_b64 vcc, vcc, s[48:49]
    v_cmp_eq_u32 s[48:49], s30, v18
    s_or_b64 vcc, vcc, s[48:49]
    v_cmp_eq_u32 s[48:49], s30, v19
    s_or_b64 vcc, vcc, s[48:49]
    s_cbranch_vccnz CF3_L2
    v_smfmac_f32_16x16x64_bf16 v[40:43], v[16:19], a[16:23], v1
    v_smfmac_f32_16x16x64_bf16 v[48:51], v[16:19], a[120:127], v1
    v_smfmac_f32_16x16x64_bf16 v[44:47], v[16:19], a[24:31], v1
    v_smfmac_f32_16x16x64_bf16 v[52:55], v[16:19], a[128:135], v1
    ds_read_b128 v[32:35], v0 offset:16384
    ds_read_b128 v[36:39], v0 offset:17408
    s_waitcnt lgkmcnt(0)
    v_smfmac_f32_16x16x64_bf16 v[56:59], v[16:19], v[32:39], v1
    ds_read_b128 v[32:35], v0 offset:18432
    ds_read_b128 v[36:39], v0 offset:19456
    s_waitcnt lgkmcnt(0)
    v_smfmac_f32_16x16x64_bf16 v[60:63], v[16:19], v[32:39], v1
CF3_L3:
    buffer_load_dwordx4 v[20:23], v3, s[4:7], s34 offen offset:2048 sc1
    s_add_u32 s31, s31, 1
    s_cmp_ge_u32 s31, 400000
    s_cbranch_scc1 FAIL
    s_waitcnt vmcnt(0)
    v_cmp_eq_u32 vcc, s30, v20
    v_cmp_eq_u32 s[48:49], s30, v21
    s_or_b64 vcc, vcc, s[48:49]
    v_cmp_eq_u32 s[48:49], s30, v22
    s_or_b64 vcc, vcc, s[48:49]
    v_cmp_eq_u32 s[48:49], s30, v23
    s_or_b64 vcc, vcc, s[48:49]
    s_cbranch_vccnz CF3_L3
    v_smfmac_f32_16x16x64_bf16 v[40:43], v[20:23], a[32:39], v1
    v_smfmac_f32_16x16x64_bf16 v[48:51], v[20:23], a[136:143], v1
    v_smfmac_f32_16x16x64_bf16 v[44:47], v[20:23], a[40:47], v1
    v_smfmac_f32_16x16x64_bf16 v[52:55], v[20:23], a[144:151], v1
CF3_L4:
    buffer_load_dwordx4 v[8:11], v3, s[4:7], s34 offen offset:1024 sc1
    s_add_u32 s31, s31, 1
    s_cmp_ge_u32 s31, 400000
    s_cbranch_scc1 FAIL
    s_waitcnt vmcnt(0)
    v_cmp_eq_u32 vcc, s30, v8
    v_cmp_eq_u32 s[48:49], s30, v9
    s_or_b64 vcc, vcc, s[48:49]
    v_cmp_eq_u32 s[48:49], s30, v10
    s_or_b64 vcc, vcc, s[48:49]
    v_cmp_eq_u32 s[48:49], s30, v11
    s_or_b64 vcc, vcc, s[48:49]
    s_cbranch_vccnz CF3_L4
    v_smfmac_f32_16x16x64_bf16 v[40:43], v[8:11], a[48:55], v1
    v_smfmac_f32_16x16x64_bf16 v[44:47], v[8:11], a[56:63], v1
CF3_L5:
    buffer_load_dwordx4 v[12:15], v3, s[4:7], s34 offen offset:0 sc1
    s_add_u32 s31, s31, 1
    s_cmp_ge_u32 s31, 400000
    s_cbranch_scc1 FAIL
    s_waitcnt vmcnt(0)
    v_cmp_eq_u32 vcc, s30, v12
    v_cmp_eq_u32 s[48:49], s30, v13
    s_or_b64 vcc, vcc, s[48:49]
    v_cmp_eq_u32 s[48:49], s30, v14
    s_or_b64 vcc, vcc, s[48:49]
    v_cmp_eq_u32 s[48:49], s30, v15
    s_or_b64 vcc, vcc, s[48:49]
    s_cbranch_vccnz CF3_L5
    v_smfmac_f32_16x16x64_bf16 v[40:43], v[12:15], a[64:71], v1
    v_smfmac_f32_16x16x64_bf16 v[44:47], v[12:15], a[72:79], v1
CF3_L6:
    buffer_load_dwordx4 v[28:31], v3, s[4:7], s35 offen offset:0 sc1
    s_add_u32 s31, s31, 1
    s_cmp_ge_u32 s31, 400000
    s_cbranch_scc1 FAIL
    s_waitcnt vmcnt(0)
    v_cmp_eq_u32 vcc, s30, v28
    v_cmp_eq_u32 s[48:49], s30, v29
    s_or_b64 vcc, vcc, s[48:49]
    v_cmp_eq_u32 s[48:49], s30, v30
    s_or_b64 vcc, vcc, s[48:49]
    v_cmp_eq_u32 s[48:49], s30, v31
    s_or_b64 vcc, vcc, s[48:49]
    s_cbranch_vccnz CF3_L6
    ds_read_b128 v[32:35], v0 offset:0
    ds_read_b128 v[36:39], v0 offset:1024
    s_waitcnt lgkmcnt(0)
    v_smfmac_f32_16x16x64_bf16 v[40:43], v[28:31], v[32:39], v1
    v_smfmac_f32_16x16x64_bf16 v[44:47], v[28:31], a[80:87], v1
CF3_L8:
    buffer_load_dwordx4 v[24:27], v3, s[4:7], s35 offen offset:2048 sc1
    s_add_u32 s31, s31, 1
    s_cmp_ge_u32 s31, 400000
    s_cbranch_scc1 FAIL
    s_waitcnt vmcnt(0)
    v_cmp_eq_u32 vcc, s30, v24
    v_cmp_eq_u32 s[48:49], s30, v25
    s_or_b64 vcc, vcc, s[48:49]
    v_cmp_eq_u32 s[48:49], s30, v26
    s_or_b64 vcc, vcc, s[48:49]
    v_cmp_eq_u32 s[48:49], s30, v27
    s_or_b64 vcc, vcc, s[48:49]
    s_cbranch_vccnz CF3_L8
    v_smfmac_f32_16x16x64_bf16 v[40:43], v[24:27], a[104:111], v1
CF3_L7:
    buffer_load_dwordx4 v[16:19], v3, s[4:7], s35 offen offset:1024 sc1
    s_add_u32 s31, s31, 1
    s_cmp_ge_u32 s31, 400000
    s_cbranch_scc1 FAIL
    s_waitcnt vmcnt(0)
    v_cmp_eq_u32 vcc, s30, v16
    v_cmp_eq_u32 s[48:49], s30, v17
    s_or_b64 vcc, vcc, s[48:49]
    v_cmp_eq_u32 s[48:49], s30, v18
    s_or_b64 vcc, vcc, s[48:49]
    v_cmp_eq_u32 s[48:49], s30, v19
    s_or_b64 vcc, vcc, s[48:49]
    s_cbranch_vccnz CF3_L7
    v_smfmac_f32_16x16x64_bf16 v[40:43], v[16:19], a[88:95], v1
    v_smfmac_f32_16x16x64_bf16 v[44:47], v[24:27], a[112:119], v1
    v_smfmac_f32_16x16x64_bf16 v[44:47], v[16:19], a[96:103], v1
    ds_read_b128 v[32:35], v0 offset:2048
    ds_read_b128 v[36:39], v0 offset:3072
    s_waitcnt lgkmcnt(0)
    v_smfmac_f32_16x16x64_bf16 v[48:51], v[8:11], v[32:39], v1
    v_smfmac_f32_16x16x64_bf16 v[52:55], v[8:11], a[152:159], v1
    v_smfmac_f32_16x16x64_bf16 v[48:51], v[12:15], a[160:167], v1
    v_smfmac_f32_16x16x64_bf16 v[52:55], v[12:15], a[168:175], v1
    v_smfmac_f32_16x16x64_bf16 v[48:51], v[28:31], a[176:183], v1
    ds_read_b128 v[32:35], v0 offset:8192
    ds_read_b128 v[36:39], v0 offset:9216
    v_add_f32 v40, v40, v41
    v_add_f32 v42, v42, v43
    v_add_f32 v44, v44, v45
    v_add_f32 v46, v46, v47
    v_cvt_pk_bf16_f32 v40, v40, v44
    v_cvt_pk_bf16_f32 v41, v42, v46
    ds_write_b64 v4, v[40:41] offset:9472
    s_waitcnt lgkmcnt(0)
    s_branch CF3_RJ
CF3_SLOW:
    ds_read_b64_tr_b16 v[40:41], v5 offset:7168
    ds_read_b64_tr_b16 v[48:49], v5 offset:0
    ds_read_b64_tr_b16 v[42:43], v5 offset:7936
    ds_read_b64_tr_b16 v[50:51], v5 offset:768
    ds_read_b64_tr_b16 v[44:45], v5 offset:8704
    ds_read_b64_tr_b16 v[52:53], v5 offset:1536
    ds_read_b64_tr_b16 v[46:47], v5 offset:9472
    ds_read_b64_tr_b16 v[54:55], v5 offset:2304
    s_waitcnt vmcnt(0) lgkmcnt(0)
    v_and_b32 v64, 128, v3
    v_mad_u32_u24 v64, v64, 31, v3
    buffer_load_dwordx4 v[68:71], v64, s[4:7], s50 offen offset:1152 sc1
    buffer_load_dwordx4 v[76:79], v3, s[4:7], s46 offen offset:3072 sc1
    buffer_load_dwordx4 v[64:67], v64, s[4:7], s38 offen offset:1152 sc1
    buffer_load_dwordx4 v[72:75], v3, s[4:7], s46 offen offset:2048 sc1
    v_mfma_f32_16x16x32_bf16 v[48:51], v[48:51], v[40:43], 0
    v_mfma_f32_16x16x32_bf16 v[48:51], v[52:55], v[44:47], v[48:51]
    v_lshrrev_b32 v38, 2, v3
    v_and_b32 v38, 0xe0, v38
    v_and_b32 v39, 0xe0, v3
    s_nop 4
    v_add_f32_dpp v48, v49, v48 quad_perm:[1,0,3,2] row_mask:0xf bank_mask:0xf
    v_add_f32_dpp v50, v51, v50 quad_perm:[1,0,3,2] row_mask:0xf bank_mask:0xf
    v_mul_f32 v48, s44, v48
    v_mul_f32 v50, s44, v50
    v_mov_b64 v[32:33], s[20:21]
    v_mov_b64 v[34:35], s[20:21]
    s_waitcnt vmcnt(0)
    ds_read_b32 v2, v3 offset:13568
    v_mfma_f32_16x16x32_bf16 v[64:67], v[40:43], v[64:67], 0
    v_mfma_f32_16x16x32_bf16 v[64:67], v[44:47], v[68:71], v[64:67]
    v_max_f32 v37, v48, v50
    v_mov_b32 v36, v37
    s_nop 1
    v_permlane16_swap_b32 v36, v37
    v_max_f32 v37, v36, v37
    v_mov_b32 v36, v37
    s_nop 1
    v_permlane32_swap_b32 v36, v37
    v_max_f32 v37, v36, v37
    v_add_f32_dpp v64, v65, v64 row_ror:8 row_mask:0xf bank_mask:0xf
    v_add_f32_dpp v64, v66, v67 row_ror:8 row_mask:0xf bank_mask:0xc
    s_nop 1
    v_max_f32_dpp v36, v64, v64 quad_perm:[1,0,3,2] row_mask:0xf bank_mask:0xf
    s_nop 1
    v_max_f32_dpp v36, v36, v36 quad_perm:[2,3,0,1] row_mask:0xf bank_mask:0xf
    s_nop 1
    v_max_f32_dpp v36, v36, v36 row_half_mirror row_mask:0xf bank_mask:0xf
    ds_write_b32 v38, v36 offset:15628
    s_mov_b64 exec, s[40:41]
    ds_write_b32 v39, v37 offset:15632
    s_mov_b64 exec, -1
    s_waitcnt lgkmcnt(0)
    s_barrier
    ds_read_b128 v[40:43], v38 offset:15616
    ds_read_b32 v36, v38 offset:15632
    ds_read_b128 v[44:47], v39 offset:15616
    ds_read_b32 v37, v39 offset:15632
    s_waitcnt lgkmcnt(0)
    v_max3_f32 v36, v36, v40, v41
    v_max3_f32 v36, v36, v42, v43
    v_max3_f32 v37, v37, v44, v45
    v_max3_f32 v37, v37, v46, v47
    v_sub_f32 v64, v64, v36
    v_exp_f32 v64, v64
    v_sub_f32 v48, v48, v37
    v_exp_f32 v48, v48
    v_sub_f32 v50, v50, v37
    v_exp_f32 v50, v50
    v_cvt_pk_bf16_f32 v64, v64, v64
    ds_write_b16 v2, v64 offset:11016
    v_cvt_pk_bf16_f32 v48, v48, v50
    v_cndmask_b32 v48, 0, v48, s[40:41]
    s_nop 1
    v_mov_b32_dpp v49, v48 quad_perm:[1,0,3,2] row_mask:0xf bank_mask:0xf
    s_waitcnt lgkmcnt(0)
    s_barrier
    ds_read_b128 v[64:67], v3 offset:10496
    ds_read_b128 v[68:71], v3 offset:10480
    s_waitcnt lgkmcnt(0)
    v_mfma_f32_16x16x32_bf16 v[72:75], v[72:75], v[64:67], 0
    v_mfma_f32_16x16x32_bf16 v[72:75], v[76:79], v[68:71], v[72:75]
    v_mfma_f32_16x16x32_bf16 v[52:55], v[32:35], v[64:67], 0
    s_nop 5
    v_mfma_f32_16x16x16_bf16 v[52:55], v[32:33], v[48:49], v[52:55]
    v_mfma_f32_16x16x16_bf16 v[72:75], v[56:57], v[48:49], v[72:75]
    ds_read_b128 v[64:67], v0 offset:22528
    ds_read_b128 v[68:71], v0 offset:23552
    ds_read_b128 v[32:35], v3 offset:14592
    v_mov_b64 v[36:37], 0
    v_mov_b64 v[38:39], 0
    v_mov_b64 v[40:41], 0
    v_mov_b64 v[42:43], 0
    v_mov_b64 v[44:45], 0
    v_mov_b64 v[46:47], 0
    v_rcp_f32_dpp v53, v52 quad_perm:[0,0,2,2] row_mask:0xf bank_mask:0xf
    s_nop 0
    v_mul_f32 v72, v72, v53
    v_mul_f32 v73, v73, v53
    v_mul_f32 v74, v74, v53
    v_mul_f32 v75, v75, v53
    v_cvt_pk_bf16_f32 v72, v72, v73
    v_cvt_pk_bf16_f32 v73, v74, v75
    ds_write_b64 v4, v[72:73] offset:6400
    v_mov_b32_dpp v76, v72 quad_perm:[0,0,2,2] row_mask:0xf bank_mask:0xf
    v_mov_b32_dpp v77, v73 quad_perm:[0,0,2,2] row_mask:0xf bank_mask:0xf
    v_mov_b32_dpp v78, v72 quad_perm:[1,1,3,3] row_mask:0xf bank_mask:0xf
    v_mov_b32_dpp v79, v73 quad_perm:[1,1,3,3] row_mask:0xf bank_mask:0xf
    s_waitcnt lgkmcnt(0)
    s_branch CF3_FAST
CF3_SP:
    s_cmp_eq_u32 s32, 63
    s_cbranch_scc1 CF3_LAST
    s_add_u32 s18, s18, 1
    s_cmp_gt_u32 s18, 1
    s_cselect_b32 s18, 63, s18
    s_waitcnt vmcnt(0)
CF3_SQ:
    buffer_load_dwordx4 v[16:19], v3, s[4:7], s35 offen offset:2048 sc1
    s_add_u32 s31, s31, 1
    s_cmp_ge_u32 s31, 400000
    s_cbranch_scc1 FAIL
    s_waitcnt vmcnt(0)
    v_cmp_eq_u32 vcc, s30, v16
    v_cmp_eq_u32 s[48:49], s30, v17
    s_or_b64 vcc, vcc, s[48:49]
    v_cmp_eq_u32 s[48:49], s30, v18
    s_or_b64 vcc, vcc, s[48:49]
    v_cmp_eq_u32 s[48:49], s30, v19
    s_or_b64 vcc, vcc, s[48:49]
    s_cbranch_vccnz CF3_SQ
    buffer_load_dwordx4 v[16:19], v3, s[4:7], s34 offen offset:3072 sc1
    buffer_load_dwordx4 v[20:23], v3, s[4:7], s34 offen offset:2048 sc1
    s_branch CF3_A
CF3_QL:
    v_lshrrev_b32 v6, 2, v3
    buffer_load_dword v6, v6, s[4:7], s53 offen sc1
    s_add_u32 s31, s31, 1
    s_cmp_ge_u32 s31, 400000
    s_cbranch_scc1 FAIL
    s_waitcnt vmcnt(0)
    v_cmp_ge_u32 vcc, s48, v6
    s_nop 4
    s_and_b64 vcc, vcc, s[42:43]
    s_cbranch_scc1 CF3_QL
    s_branch CF3_QC
CF3_R1:
    buffer_load_dwordx4 v[48:51], v3, s[4:7], s51 offen offset:0 sc1
    s_add_u32 s31, s31, 1
    s_cmp_ge_u32 s31, 400000
    s_cbranch_scc1 FAIL
    s_waitcnt vmcnt(0)
    v_mfma_f32_16x16x32_bf16 v[60:63], v[44:47], v[48:51], 0
    v_bitop3_b32 v2, v48, v49, s32 bitop3:0x7e
    v_bitop3_b32 v6, v50, v51, s32 bitop3:0x7e
    v_bitop3_b32 v2, v2, v6, 1 bitop3:0xa8
    v_cmp_ne_u32 vcc, 0, v2
    v_mov_b64 v[48:49], 0
    v_mov_b64 v[50:51], 0
    s_nop 1
    v_add_f32_dpp v60, v60, v60 row_ror:8 row_mask:0xf bank_mask:0xf
    v_add_f32_dpp v61, v61, v61 row_ror:8 row_mask:0xf bank_mask:0xf
    s_nop 0
    v_add_f32_dpp v60, v60, v60 row_ror:4 row_mask:0xf bank_mask:0xf
    v_add_f32_dpp v61, v61, v61 row_ror:4 row_mask:0xf bank_mask:0xf
    s_nop 0
    v_add_f32_dpp v60, v60, v60 row_ror:2 row_mask:0xf bank_mask:0xf
    v_add_f32_dpp v61, v61, v61 row_ror:2 row_mask:0xf bank_mask:0xf
    v_cvt_pk_bf16_f32 v6, v60, v61
    s_cbranch_vccz CF3_RC
    s_branch CF3_R1
CF3_LAST:
    buffer_store_dword v6, v7, s[4:7], s39 offen sc1
    s_waitcnt vmcnt(0)
    s_branch C_END
CM0_IN:
    s_add_u32 s45, s38, 32768
    s_add_u32 s34, s19, 2048
    s_add_u32 s35, s19, 6144
    s_add_u32 s33, s19, s16
    buffer_load_dwordx4 v[8:11], v3, s[4:7], s33 offen offset:0 sc1
    buffer_load_dwordx4 v[12:15], v3, s[4:7], s33 offen offset:1024 sc1
    s_mov_b32 s29, 0
    s_mov_b32 m0, 4096
    s_mov_b32 s18, 1
CM0_FF:
    ds_read_b128 v[72:75], v0 offset:12288
    ds_read_b128 v[76:79], v0 offset:13312
    ds_read_b128 v[64:67], v0 offset:28672
    ds_read_b128 v[68:71], v0 offset:29696
    ds_read_b128 v[24:27], v0 offset:14336
    ds_read_b128 v[28:31], v0 offset:15360
    ds_read_b128 v[32:35], v0 offset:30720
    ds_read_b128 v[36:39], v0 offset:31744
    v_mov_b64 v[40:41], 0
    v_mov_b64 v[42:43], 0
    v_mov_b64 v[44:45], 0
    v_mov_b64 v[46:47], 0
    v_mov_b64 v[48:49], 0
    v_mov_b64 v[50:51], 0
    v_mov_b64 v[52:53], 0
    v_mov_b64 v[54:55], 0
    v_mov_b64 v[56:57], 0
    v_mov_b64 v[58:59], 0
    v_mov_b64 v[60:61], 0
    v_mov_b64 v[62:63], 0
    s_waitcnt vmcnt(0) lgkmcnt(0)
    buffer_load_dwordx4 v[16:19], v3, s[4:7], s34 offen offset:0 sc1
    buffer_load_dwordx4 v[20:23], v3, s[4:7], s34 offen offset:1024 sc1
    s_branch CM0_A
CM0_T:
    buffer_load_dwordx4 v[8:11], v3, s[4:7], s33 offen offset:0 sc1
    buffer_load_dwordx4 v[12:15], v3, s[4:7], s33 offen offset:1024 sc1
    s_waitcnt vmcnt(8)
    v_maximum3_f32 v2, v8, v9, v10
    v_maximum3_f32 v2, v2, v11, v12
    v_maximum3_f32 v2, v2, v13, v14
    v_cmp_u_f32 vcc, v2, v15
    s_cbranch_vccz CM0_FX
    buffer_load_dwordx4 v[8:11], v3, s[4:7], s33 offen offset:0 sc1
    buffer_load_dwordx4 v[12:15], v3, s[4:7], s33 offen offset:1024 sc1
    s_waitcnt vmcnt(8)
    v_maximum3_f32 v2, v8, v9, v10
    v_maximum3_f32 v2, v2, v11, v12
    v_maximum3_f32 v2, v2, v13, v14
    v_cmp_u_f32 vcc, v2, v15
    s_cbranch_vccz CM0_FX
CM0_FE:
    buffer_load_dwordx4 v[8:11], v3, s[4:7], s33 offen offset:0 sc1
    buffer_load_dwordx4 v[12:15], v3, s[4:7], s33 offen offset:1024 sc1
    s_waitcnt vmcnt(8)
    v_maximum3_f32 v2, v8, v9, v10
    v_maximum3_f32 v2, v2, v11, v12
    ds_write_b128 v3, v[8:11] offset:7168
    v_maximum3_f32 v2, v2, v13, v14
    v_cmp_u_f32 vcc, v2, v15
    ds_write_b128 v3, v[12:15] offset:8192
    s_cbranch_vccz CM0_CE
    buffer_load_dwordx4 v[8:11], v3, s[4:7], s33 offen offset:0 sc1
    buffer_load_dwordx4 v[12:15], v3, s[4:7], s33 offen offset:1024 sc1
    s_waitcnt vmcnt(8)
    v_maximum3_f32 v2, v8, v9, v10
    v_maximum3_f32 v2, v2, v11, v12
    ds_write_b128 v3, v[8:11] offset:7168
    v_maximum3_f32 v2, v2, v13, v14
    v_cmp_u_f32 vcc, v2, v15
    ds_write_b128 v3, v[12:15] offset:8192
    s_cbranch_vccz CM0_CE
    buffer_load_dwordx4 v[8:11], v3, s[4:7], s33 offen offset:0 sc1
    buffer_load_dwordx4 v[12:15], v3, s[4:7], s33 offen offset:1024 sc1
    s_waitcnt vmcnt(8)
    v_maximum3_f32 v2, v8, v9, v10
    v_maximum3_f32 v2, v2, v11, v12
    ds_write_b128 v3, v[8:11] offset:7168
    v_maximum3_f32 v2, v2, v13, v14
    v_cmp_u_f32 vcc, v2, v15
    ds_write_b128 v3, v[12:15] offset:8192
    s_cbranch_vccz CM0_CE
    buffer_load_dwordx4 v[8:11], v3, s[4:7], s33 offen offset:0 sc1
    buffer_load_dwordx4 v[12:15], v3, s[4:7], s33 offen offset:1024 sc1
    s_waitcnt vmcnt(8)
    v_maximum3_f32 v2, v8, v9, v10
    v_maximum3_f32 v2, v2, v11, v12
    ds_write_b128 v3, v[8:11] offset:7168
    v_maximum3_f32 v2, v2, v13, v14
    v_cmp_u_f32 vcc, v2, v15
    ds_write_b128 v3, v[12:15] offset:8192
    s_cbranch_vccz CM0_CE
    buffer_load_dwordx4 v[8:11], v3, s[4:7], s33 offen offset:0 sc1
    buffer_load_dwordx4 v[12:15], v3, s[4:7], s33 offen offset:1024 sc1
    s_waitcnt vmcnt(8)
    v_maximum3_f32 v2, v8, v9, v10
    v_maximum3_f32 v2, v2, v11, v12
    ds_write_b128 v3, v[8:11] offset:7168
    v_maximum3_f32 v2, v2, v13, v14
    v_cmp_u_f32 vcc, v2, v15
    ds_write_b128 v3, v[12:15] offset:8192
    s_cbranch_vccz CM0_CE
    buffer_load_dwordx4 v[8:11], v3, s[4:7], s33 offen offset:0 sc1
    buffer_load_dwordx4 v[12:15], v3, s[4:7], s33 offen offset:1024 sc1
    s_waitcnt vmcnt(8)
    v_maximum3_f32 v2, v8, v9, v10
    v_maximum3_f32 v2, v2, v11, v12
    ds_write_b128 v3, v[8:11] offset:7168
    v_maximum3_f32 v2, v2, v13, v14
    v_cmp_u_f32 vcc, v2, v15
    ds_write_b128 v3, v[12:15] offset:8192
    s_cbranch_vccz CM0_CE
    s_add_u32 s29, s29, 1
    s_cmp_lt_u32 s29, 8
    s_cbranch_scc1 EX_56
    v_cmp_eq_u32 vcc, s30, v8
    v_cmp_eq_u32 s[48:49], s30, v9
    s_or_b64 vcc, vcc, s[48:49]
    v_cmp_eq_u32 s[48:49], s30, v10
    s_or_b64 vcc, vcc, s[48:49]
    v_cmp_eq_u32 s[48:49], s30, v11
    s_or_b64 vcc, vcc, s[48:49]
    v_cmp_eq_u32 s[48:49], s30, v12
    s_or_b64 vcc, vcc, s[48:49]
    v_cmp_eq_u32 s[48:49], s30, v13
    s_or_b64 vcc, vcc, s[48:49]
    v_cmp_eq_u32 s[48:49], s30, v14
    s_or_b64 vcc, vcc, s[48:49]
    v_cmp_eq_u32 s[48:49], s30, v15
    s_or_b64 vcc, vcc, s[48:49]
    s_cbranch_vccz CM0_FX
EX_56:
    s_add_u32 s31, s31, 1
    s_cmp_ge_u32 s31, 400000
    s_cbranch_scc1 FAIL
    s_branch CM0_FE
CM0_FX:
    s_waitcnt vmcnt(8)
    v_maximum3_f32 v2, v8, v9, v10
    v_maximum3_f32 v2, v2, v11, v12
    ds_write_b128 v3, v[8:11] offset:7168
    v_maximum3_f32 v2, v2, v13, v14
    v_cmp_u_f32 vcc, v2, v15
    ds_write_b128 v3, v[12:15] offset:8192
CM0_CE:
    s_barrier
    buffer_load_dwordx4 v[16:19], v3, s[4:7], s34 offen offset:0 sc1
    v_mov_b64 v[48:49], 0
    v_mov_b64 v[50:51], 0
    v_mov_b64 v[52:53], 0
    v_mov_b64 v[54:55], 0
    v_mov_b64 v[56:57], 0
    v_mov_b64 v[58:59], 0
    v_mov_b64 v[40:41], 0
    v_mov_b64 v[42:43], 0
    s_waitcnt lgkmcnt(0)
    s_barrier
    buffer_load_dwordx4 v[20:23], v3, s[4:7], s34 offen offset:1024 sc1
    s_cmp_eq_u32 s32, 63
    s_cbranch_scc1 CM0_LAST
CM0_A:
    v_smfmac_f32_16x16x64_bf16 v[40:43], v[8:11], v[72:79], v1
    v_smfmac_f32_16x16x64_bf16 v[48:51], v[8:11], v[64:71], v1
    ds_read_b128 v[64:67], v0 offset:32768
    v_smfmac_f32_16x16x64_bf16 v[44:47], v[8:11], v[24:31], v1
    ds_read_b128 v[68:71], v0 offset:33792
    v_mov_b32 v2, s30
    v_smfmac_f32_16x16x64_bf16 v[52:55], v[8:11], v[32:39], v1
    buffer_store_dword v2, v7, s[4:7], s37 offen sc1
    ds_read_b128 v[24:27], v0 offset:34816
    v_smfmac_f32_16x16x64_bf16 v[56:59], v[8:11], a[216:223], v1
    ds_read_b128 v[28:31], v0 offset:35840
    v_smfmac_f32_16x16x64_bf16 v[60:63], v[8:11], a[224:231], v1
    ds_read_b128 v[32:35], v0 offset:4096
    v_smfmac_f32_16x16x64_bf16 v[40:43], v[12:15], a[0:7], v1
    ds_read_b128 v[36:39], v0 offset:5120
    s_waitcnt lgkmcnt(4)
    v_smfmac_f32_16x16x64_bf16 v[48:51], v[12:15], v[64:71], v1
    v_smfmac_f32_16x16x64_bf16 v[44:47], v[12:15], a[8:15], v1
    s_waitcnt lgkmcnt(2)
    v_smfmac_f32_16x16x64_bf16 v[52:55], v[12:15], v[24:31], v1
    buffer_load_dwordx4 v[72:75], v3, s[4:7], s46 offen offset:2048 sc1
    ds_read_b128 v[24:27], v0 offset:16384
    v_smfmac_f32_16x16x64_bf16 v[56:59], v[12:15], a[232:239], v1
    buffer_load_dwordx4 v[76:79], v3, s[4:7], s46 offen offset:3072 sc1
    ds_read_b128 v[28:31], v0 offset:17408
    s_waitcnt lgkmcnt(2)
    v_smfmac_f32_16x16x64_bf16 v[60:63], v[12:15], v[32:39], v1
    ds_read_b128 v[32:35], v0 offset:18432
    ds_read_b128 v[36:39], v0 offset:19456
    s_waitcnt vmcnt(4)
    v_smfmac_f32_16x16x64_bf16 v[40:43], v[16:19], a[16:23], v1
    ds_write_b128 v3, v[16:19] offset:0
    v_and_b32 v64, 128, v3
    v_smfmac_f32_16x16x64_bf16 v[48:51], v[16:19], a[120:127], v1
    v_mad_u32_u24 v64, v64, 31, v3
    v_smfmac_f32_16x16x64_bf16 v[44:47], v[16:19], a[24:31], v1
    buffer_load_dwordx4 v[68:71], v64, s[4:7], s50 offen offset:0 sc1
    v_maximum3_f32 v2, v16, v17, v18
    v_smfmac_f32_16x16x64_bf16 v[52:55], v[16:19], a[128:135], v1
    buffer_load_dwordx4 v[64:67], v64, s[4:7], s38 offen offset:0 sc1
    s_waitcnt lgkmcnt(3)
    v_cmp_u_f32 vcc, v2, v19
    v_smfmac_f32_16x16x64_bf16 v[56:59], v[16:19], v[24:31], v1
    s_waitcnt lgkmcnt(1)
    v_smfmac_f32_16x16x64_bf16 v[60:63], v[16:19], v[32:39], v1
    s_cbranch_vccnz CM0_FB
CM0_CB:
    s_waitcnt lgkmcnt(0)
    s_barrier
    s_waitcnt vmcnt(5)
    v_smfmac_f32_16x16x64_bf16 v[40:43], v[20:23], a[32:39], v1
    s_mov_b64 exec, s[22:23]
    buffer_store_dword v6, v7, s[4:7], s39 offen sc1
    s_mov_b64 exec, -1
    ds_read_b128 v[8:11], v3 offset:2048
    v_smfmac_f32_16x16x64_bf16 v[48:51], v[20:23], a[136:143], v1
    ds_read_b128 v[12:15], v3 offset:3072
    v_smfmac_f32_16x16x64_bf16 v[44:47], v[20:23], a[40:47], v1
    ds_read_b128 v[32:35], v0 offset:0
    s_mov_b32 s37, s36
    v_smfmac_f32_16x16x64_bf16 v[52:55], v[20:23], a[144:151], v1
    s_barrier
    ds_read_b128 v[36:39], v0 offset:1024
    s_waitcnt lgkmcnt(3)
    v_smfmac_f32_16x16x64_bf16 v[40:43], v[8:11], a[48:55], v1
    ds_read_b128 v[28:31], v3 offset:4096
    s_add_u32 s36, s36, 0x8000
    v_smfmac_f32_16x16x64_bf16 v[44:47], v[8:11], a[56:63], v1
    ds_read_b128 v[24:27], v3 offset:6144
    s_bitset0_b32 s36, 17
    s_waitcnt lgkmcnt(4)
    v_smfmac_f32_16x16x64_bf16 v[40:43], v[12:15], a[64:71], v1
    ds_read_b128 v[16:19], v3 offset:5120
    s_add_u32 s32, s32, 1
    v_smfmac_f32_16x16x64_bf16 v[44:47], v[12:15], a[72:79], v1
    ds_read_b32 v2, v3 offset:13568
    s_waitcnt lgkmcnt(3)
    v_smfmac_f32_16x16x64_bf16 v[40:43], v[28:31], v[32:39], v1
    ds_read_b128 v[32:35], v0 offset:2048
    s_add_u32 s39, s39, 9216
    v_smfmac_f32_16x16x64_bf16 v[44:47], v[28:31], a[80:87], v1
    ds_read_b128 v[36:39], v0 offset:3072
    s_mov_b32 s29, 0
    s_waitcnt lgkmcnt(4)
    v_smfmac_f32_16x16x64_bf16 v[40:43], v[24:27], a[104:111], v1
    s_waitcnt lgkmcnt(3)
    v_smfmac_f32_16x16x64_bf16 v[40:43], v[16:19], a[88:95], v1
    v_smfmac_f32_16x16x64_bf16 v[44:47], v[24:27], a[112:119], v1
    v_smfmac_f32_16x16x64_bf16 v[44:47], v[16:19], a[96:103], v1
    s_waitcnt lgkmcnt(0)
    v_add_f32 v40, v40, v41
    v_smfmac_f32_16x16x64_bf16 v[48:51], v[8:11], v[32:39], v1
    ds_read_b128 v[32:35], v0 offset:8192
    v_add_f32 v42, v42, v43
    v_smfmac_f32_16x16x64_bf16 v[52:55], v[8:11], a[152:159], v1
    ds_read_b128 v[36:39], v0 offset:9216
    v_add_f32 v44, v44, v45
    v_add_f32 v46, v46, v47
    v_cvt_pk_bf16_f32 v40, v40, v44
    v_cvt_pk_bf16_f32 v41, v42, v46
    v_smfmac_f32_16x16x64_bf16 v[48:51], v[12:15], a[160:167], v1
    ds_write_b64 v4, v[40:41] offset:7168
    v_cmp_u_f32 vcc, v40, v41
    v_smfmac_f32_16x16x64_bf16 v[52:55], v[12:15], a[168:175], v1
    v_smfmac_f32_16x16x64_bf16 v[48:51], v[28:31], a[176:183], v1
    s_cbranch_vccnz CM0_RE
CM0_RJ:
    v_smfmac_f32_16x16x64_bf16 v[52:55], v[28:31], a[184:191], v1
    s_add_u32 s19, s19, 0x8000
    s_waitcnt lgkmcnt(1)
    v_smfmac_f32_16x16x64_bf16 v[48:51], v[24:27], v[32:39], v1
    s_waitcnt lgkmcnt(0)
    s_barrier
    v_smfmac_f32_16x16x64_bf16 v[48:51], v[16:19], a[192:199], v1
    ds_read_b64_tr_b16 v[40:41], v5 offset:7168
    ds_read_b64_tr_b16 v[42:43], v5 offset:7936
    v_smfmac_f32_16x16x64_bf16 v[52:55], v[24:27], a[208:215], v1
    ds_read_b64_tr_b16 v[44:45], v5 offset:8704
    ds_read_b64_tr_b16 v[46:47], v5 offset:9472
    v_smfmac_f32_16x16x64_bf16 v[52:55], v[16:19], a[200:207], v1
    ds_read_b128 v[32:35], v0 offset:6144
    v_add_f32 v48, v48, v49
    v_smfmac_f32_16x16x64_bf16 v[56:59], v[8:11], v[80:87], v1
    ds_read_b128 v[36:39], v0 offset:7168
    s_waitcnt vmcnt(1) lgkmcnt(4)
    v_add_f32 v50, v50, v51
    v_mfma_f32_16x16x32_bf16 v[64:67], v[40:43], v[64:67], 0
    s_waitcnt lgkmcnt(2)
    v_add_f32 v52, v52, v53
    v_add_f32 v54, v54, v55
    v_mfma_f32_16x16x32_bf16 v[64:67], v[44:47], v[68:71], v[64:67]
    v_cvt_pk_bf16_f32 v48, v48, v52
    v_cvt_pk_bf16_f32 v49, v50, v54
    v_smfmac_f32_16x16x64_bf16 v[60:63], v[8:11], v[88:95], v1
    ds_write_b64 v4, v[48:49] offset:0
    s_bitset0_b32 s19, 17
    v_smfmac_f32_16x16x64_bf16 v[56:59], v[12:15], v[96:103], v1
    s_add_u32 s34, s19, 2048
    s_waitcnt lgkmcnt(1)
    v_add_f32_dpp v64, v65, v64 row_ror:8 row_mask:0xf bank_mask:0xf
    v_add_f32_dpp v64, v66, v67 row_ror:8 row_mask:0xf bank_mask:0xc
    v_exp_f32 v64, v64
    s_nop 0
    v_cvt_pk_bf16_f32 v64, v64, v64
    v_smfmac_f32_16x16x64_bf16 v[60:63], v[12:15], v[32:39], v1
    ds_write_b16 v2, v64 offset:10496
    v_smfmac_f32_16x16x64_bf16 v[56:59], v[16:19], v[120:127], v1
    ds_read_b128 v[8:11], v0 offset:20480
    s_add_u32 s35, s19, 6144
    v_mov_b64 v[32:33], s[20:21]
    v_smfmac_f32_16x16x64_bf16 v[60:63], v[16:19], v[128:135], v1
    ds_read_b128 v[12:15], v0 offset:21504
    s_add_u32 s33, s19, s16
    v_mov_b64 v[34:35], s[20:21]
    v_smfmac_f32_16x16x64_bf16 v[56:59], v[20:23], a[240:247], v1
    s_waitcnt lgkmcnt(2)
    s_barrier
    v_smfmac_f32_16x16x64_bf16 v[60:63], v[20:23], a[248:255], v1
    ds_read_b64_tr_b16 v[48:49], v5 offset:0
    ds_read_b64_tr_b16 v[50:51], v5 offset:768
    v_smfmac_f32_16x16x64_bf16 v[56:59], v[24:27], v[136:143], v1
    ds_read_b64_tr_b16 v[52:53], v5 offset:1536
    ds_read_b64_tr_b16 v[54:55], v5 offset:2304
    v_smfmac_f32_16x16x64_bf16 v[56:59], v[28:31], v[104:111], v1
    ds_read_b128 v[64:67], v3 offset:10496
    v_mov_b64 v[36:37], 0
    v_smfmac_f32_16x16x64_bf16 v[60:63], v[24:27], v[144:151], v1
    ds_read_b128 v[68:71], v3 offset:10480
    s_waitcnt lgkmcnt(4)
    v_mov_b64 v[38:39], 0
    v_mfma_f32_16x16x32_bf16 v[48:51], v[48:51], v[40:43], 0
    ds_read_b128 v[16:19], v0 offset:24576
    s_waitcnt lgkmcnt(3)
    v_add_f32 v56, v56, v57
    v_add_f32 v58, v58, v59
    v_mfma_f32_16x16x32_bf16 v[48:51], v[52:55], v[44:47], v[48:51]
    ds_read_b128 v[20:23], v0 offset:25600
    v_cvt_pk_bf16_f32 v56, v56, v58
    v_smfmac_f32_16x16x64_bf16 v[60:63], v[28:31], v[112:119], v1
    ds_read_b128 v[24:27], v0 offset:26624
    s_waitcnt lgkmcnt(4)
    v_mfma_f32_16x16x32_bf16 v[52:55], v[32:35], v[64:67], 0
    ds_read_b128 v[28:31], v0 offset:27648
    v_add_f32_dpp v48, v49, v48 quad_perm:[1,0,3,2] row_mask:0xf bank_mask:0xf
    v_add_f32_dpp v50, v51, v50 quad_perm:[1,0,3,2] row_mask:0xf bank_mask:0xf
    v_mfma_f32_16x16x32_bf16 v[72:75], v[72:75], v[64:67], 0
    s_waitcnt lgkmcnt(4)
    v_mul_f32 v48, s44, v48
    v_mul_f32 v50, s44, v50
    v_exp_f32 v48, v48
    v_exp_f32 v50, v50
    v_add_f32 v60, v60, v61
    v_cvt_pk_bf16_f32 v48, v48, v50
    v_cndmask_b32 v48, 0, v48, s[40:41]
    v_mfma_f32_16x16x32_bf16 v[72:75], v[76:79], v[68:71], v[72:75]
    ds_read_b128 v[64:67], v0 offset:22528
    v_mov_b32_dpp v49, v48 quad_perm:[1,0,3,2] row_mask:0xf bank_mask:0xf
    v_add_f32 v62, v62, v63
    v_cvt_pk_bf16_f32 v57, v60, v62
    v_mfma_f32_16x16x16_bf16 v[52:55], v[32:33], v[48:49], v[52:55]
    ds_read_b128 v[32:35], v3 offset:14592
    ds_read_b128 v[68:71], v0 offset:23552
    v_mov_b64 v[40:41], 0
    v_mfma_f32_16x16x16_bf16 v[72:75], v[56:57], v[48:49], v[72:75]
    v_mov_b64 v[42:43], 0
    v_mov_b64 v[44:45], 0
    v_mov_b64 v[46:47], 0
    v_mov_b64 v[60:61], 0
    v_rcp_f32_dpp v53, v52 quad_perm:[0,0,2,2] row_mask:0xf bank_mask:0xf
    v_mov_b64 v[62:63], 0
    v_max_u32 v52, v52, v53
    v_cmp_lt_u32 vcc, s17, v52
    v_mul_f32 v72, v72, v53
    v_mul_f32 v73, v73, v53
    v_mul_f32 v74, v74, v53
    v_mul_f32 v75, v75, v53
    v_cvt_pk_bf16_f32 v72, v72, v73
    v_cvt_pk_bf16_f32 v73, v74, v75
    ds_write_b64 v4, v[72:73] offset:4096
    v_mov_b32_dpp v76, v72 quad_perm:[0,0,2,2] row_mask:0xf bank_mask:0xf
    v_mov_b32_dpp v77, v73 quad_perm:[0,0,2,2] row_mask:0xf bank_mask:0xf
    v_mov_b32_dpp v78, v72 quad_perm:[1,1,3,3] row_mask:0xf bank_mask:0xf
    v_mov_b32_dpp v79, v73 quad_perm:[1,1,3,3] row_mask:0xf bank_mask:0xf
    s_cbranch_vccnz CM0_SLOW
CM0_FAST:
    s_nop 0
    v_smfmac_f32_16x16x64_bf16 v[40:43], v[76:79], v[8:15], v1
    s_waitcnt lgkmcnt(6)
    v_smfmac_f32_16x16x64_bf16 v[44:47], v[76:79], v[16:23], v1
    s_waitcnt lgkmcnt(0)
    s_barrier
    ds_read_b128 v[48:51], v32 offset:4864
    ds_read_b128 v[52:55], v32 offset:5632
    ds_read_b128 v[56:59], v32 offset:6400
    v_smfmac_f32_16x16x64_bf16 v[60:63], v[76:79], v[24:31], v1
    s_add_u32 s38, s38, 32768
    s_add_u32 s50, s50, 32768
    v_smfmac_f32_16x16x64_bf16 v[36:39], v[76:79], v[64:71], v1
    s_add_u32 s46, s46, 32768
    ds_read_b128 v[24:27], v0 offset:10240
    s_waitcnt lgkmcnt(3)
    v_lshrrev_b32 v32, 16, v1
    v_smfmac_f32_16x16x64_bf16 v[40:43], v[48:51], v[192:199], v1
    ds_read_b128 v[28:31], v0 offset:11264
    s_waitcnt lgkmcnt(3)
    v_smfmac_f32_16x16x64_bf16 v[40:43], v[52:55], v[208:215], v1
    ds_read_b128 v[72:75], v33 offset:4096
    s_waitcnt lgkmcnt(3)
    v_smfmac_f32_16x16x64_bf16 v[40:43], v[56:59], v[224:231], v1
    ds_read_b128 v[76:79], v33 offset:5632
    v_smfmac_f32_16x16x64_bf16 v[44:47], v[48:51], v[152:159], v1
    ds_read_b128 v[64:67], v0 offset:28672
    v_smfmac_f32_16x16x64_bf16 v[44:47], v[52:55], v[168:175], v1
    ds_read_b128 v[68:71], v0 offset:29696
    v_cvt_pk_bf16_f32 v40, v40, v41
    v_cvt_pk_bf16_f32 v41, v42, v43
    v_bfi_b32 v40, 1, s32, v40
    buffer_store_dwordx2 v[40:41], v34, s[4:7], s12 offen sc1
    s_waitcnt lgkmcnt(4)
    v_smfmac_f32_16x16x64_bf16 v[44:47], v[56:59], v[24:31], v1
    v_mov_b64 v[40:41], 0
    v_smfmac_f32_16x16x64_bf16 v[60:63], v[48:51], v[160:167], v1
    ds_read_b128 v[24:27], v0 offset:14336
    v_mov_b64 v[42:43], 0
    v_smfmac_f32_16x16x64_bf16 v[60:63], v[52:55], v[176:183], v1
    ds_read_b128 v[28:31], v0 offset:15360
    v_cvt_pk_bf16_f32 v44, v44, v45
    v_smfmac_f32_16x16x64_bf16 v[60:63], v[56:59], v[184:191], v1
    buffer_load_dwordx4 v[8:11], v3, s[4:7], s51 offen offset:0 sc1
    buffer_load_dwordx4 v[12:15], v3, s[4:7], s51 offen offset:1024 sc1
    s_waitcnt lgkmcnt(4)
    v_cvt_pk_bf16_f32 v45, v46, v47
    v_smfmac_f32_16x16x64_bf16 v[40:43], v[72:75], v[240:247], v1
    v_bfi_b32 v44, 1, s32, v44
    v_smfmac_f32_16x16x64_bf16 v[40:43], v[76:79], v[248:255], v1
    ds_read_b128 v[72:75], v0 offset:12288
    buffer_load_dwordx4 v[16:19], v3, s[4:7], s51 offen offset:0 sc1
    buffer_load_dwordx4 v[20:23], v3, s[4:7], s51 offen offset:1024 sc1
    v_cvt_pk_bf16_f32 v46, v60, v61
    v_cvt_pk_bf16_f32 v47, v62, v63
    buffer_store_dwordx4 v[44:47], v32, s[4:7], s13 offen sc1
    v_smfmac_f32_16x16x64_bf16 v[36:39], v[48:51], v[200:207], v1
    ds_read_b128 v[76:79], v0 offset:13312
    v_smfmac_f32_16x16x64_bf16 v[36:39], v[52:55], v[216:223], v1
    ds_read_b128 v[44:47], v3 offset:11520
    buffer_load_dwordx4 v[48:51], v3, s[4:7], s51 offen offset:0 sc1
    buffer_load_dwordx4 v[52:55], v3, s[4:7], s51 offen offset:1024 sc1
    v_add_f32 v40, v40, v41
    v_smfmac_f32_16x16x64_bf16 v[36:39], v[56:59], v[232:239], v1
    v_add_f32 v42, v42, v43
    v_cvt_pk_bf16_f32 v40, v40, v42
    v_bfi_b32 v40, 1, s32, v40
    buffer_store_dword v40, v35, s[4:7], s15 offen sc1
    s_nop 3
    v_cvt_pk_bf16_f32 v36, v36, v37
    v_cvt_pk_bf16_f32 v37, v38, v39
    v_bfi_b32 v36, 1, s32, v36
    buffer_store_dwordx2 v[36:37], v34, s[4:7], s14 offen sc1
    buffer_load_dwordx4 v[40:43], v3, s[4:7], s51 offen offset:0 sc1
    buffer_load_dwordx4 v[56:59], v3, s[4:7], s51 offen offset:1024 sc1
    s_waitcnt lgkmcnt(0)
CM0_R0:
    s_waitcnt vmcnt(10)
    v_mfma_f32_16x16x32_bf16 v[60:63], v[44:47], v[8:11], 0
    v_bitop3_b32 v2, v8, v10, s32 bitop3:0x7e
    s_waitcnt vmcnt(9)
    v_mfma_f32_16x16x32_bf16 v[60:63], v[44:47], v[12:15], v[60:63]
    v_bitop3_b32 v6, v12, v14, s32 bitop3:0x7e
    v_bitop3_b32 v2, v2, v6, 1 bitop3:0xa8
    v_cmp_ne_u32 vcc, 0, v2
    v_mov_b64 v[8:9], s[96:97]
    v_mov_b64 v[10:11], s[96:97]
    v_mov_b64 v[12:13], s[96:97]
    v_mov_b64 v[14:15], s[96:97]
    s_nop 0
    v_add_f32_dpp v60, v60, v60 row_ror:8 row_mask:0xf bank_mask:0xf
    v_add_f32_dpp v61, v61, v61 row_ror:8 row_mask:0xf bank_mask:0xf
    s_cbranch_vccz CM0_RC
CM0_R1:
    s_waitcnt vmcnt(8)
    v_mfma_f32_16x16x32_bf16 v[60:63], v[44:47], v[16:19], 0
    v_bitop3_b32 v2, v16, v18, s32 bitop3:0x7e
    s_waitcnt vmcnt(7)
    v_mfma_f32_16x16x32_bf16 v[60:63], v[44:47], v[20:23], v[60:63]
    v_bitop3_b32 v6, v20, v22, s32 bitop3:0x7e
    v_bitop3_b32 v2, v2, v6, 1 bitop3:0xa8
    v_cmp_ne_u32 vcc, 0, v2
    s_nop 4
    v_add_f32_dpp v60, v60, v60 row_ror:8 row_mask:0xf bank_mask:0xf
    v_add_f32_dpp v61, v61, v61 row_ror:8 row_mask:0xf bank_mask:0xf
    s_cbranch_vccz CM0_RC
CM0_R2:
    buffer_load_dwordx4 v[16:19], v3, s[4:7], s51 offen offset:0 sc1
    buffer_load_dwordx4 v[20:23], v3, s[4:7], s51 offen offset:1024 sc1
    s_waitcnt vmcnt(7)
    v_mfma_f32_16x16x32_bf16 v[60:63], v[44:47], v[48:51], 0
    v_bitop3_b32 v2, v48, v50, s32 bitop3:0x7e
    s_waitcnt vmcnt(6)
    v_mfma_f32_16x16x32_bf16 v[60:63], v[44:47], v[52:55], v[60:63]
    v_bitop3_b32 v6, v52, v54, s32 bitop3:0x7e
    v_bitop3_b32 v2, v2, v6, 1 bitop3:0xa8
    v_cmp_ne_u32 vcc, 0, v2
    s_nop 4
    v_add_f32_dpp v60, v60, v60 row_ror:8 row_mask:0xf bank_mask:0xf
    v_add_f32_dpp v61, v61, v61 row_ror:8 row_mask:0xf bank_mask:0xf
    s_cbranch_vccnz CM0_R3
CM0_RC:
    s_barrier
    s_nop 0
    v_add_f32_dpp v60, v60, v60 row_ror:4 row_mask:0xf bank_mask:0xf
    v_add_f32_dpp v61, v61, v61 row_ror:4 row_mask:0xf bank_mask:0xf
    v_cvt_pk_bf16_f32 v6, v60, v61
    buffer_store_dword v6, v7, s[4:7], s36 offen sc1
    buffer_load_dwordx4 v[8:11], v3, s[4:7], s33 offen offset:0 sc1
    buffer_load_dwordx4 v[12:15], v3, s[4:7], s33 offen offset:1024 sc1
    s_barrier
    ds_read_b128 v[32:35], v0 offset:30720
    ds_read_b128 v[36:39], v0 offset:31744
    v_mov_b64 v[44:45], 0
    v_mov_b64 v[46:47], 0
    v_mov_b64 v[60:61], 0
    v_mov_b64 v[62:63], 0
    s_branch CM0_T
CM0_FB:
    s_add_u32 s29, s29, 1
    s_cmp_lt_u32 s29, 8
    s_cbranch_scc1 EX_57
    v_cmp_eq_u32 vcc, s30, v16
    v_cmp_eq_u32 s[48:49], s30, v17
    s_or_b64 vcc, vcc, s[48:49]
    v_cmp_eq_u32 s[48:49], s30, v18
    s_or_b64 vcc, vcc, s[48:49]
    v_cmp_eq_u32 s[48:49], s30, v19
    s_or_b64 vcc, vcc, s[48:49]
    s_cbranch_vccz CM0_CB
EX_57:
    s_add_u32 s31, s31, 1
    s_cmp_ge_u32 s31, 400000
    s_cbranch_scc1 FAIL
    s_waitcnt vmcnt(0)
    s_branch CM0_FF
CM0_RE:
    s_waitcnt vmcnt(0) lgkmcnt(0)
    v_mov_b64 v[40:41], 0
    v_mov_b64 v[42:43], 0
    v_mov_b64 v[44:45], 0
    v_mov_b64 v[46:47], 0
    s_nop 1
    v_mov_b64 v[48:49], 0
    v_mov_b64 v[50:51], 0
    v_mov_b64 v[52:53], 0
    v_mov_b64 v[54:55], 0
    v_mov_b64 v[56:57], 0
    v_mov_b64 v[58:59], 0
    v_mov_b64 v[60:61], 0
    v_mov_b64 v[62:63], 0
    s_add_u32 s31, s31, 1
    s_cmp_ge_u32 s31, 400000
    s_cbranch_scc1 FAIL
CM0_L0:
    buffer_load_dwordx4 v[8:11], v3, s[4:7], s33 offen offset:0 sc1
    s_add_u32 s31, s31, 1
    s_cmp_ge_u32 s31, 400000
    s_cbranch_scc1 FAIL
    s_waitcnt vmcnt(0)
    v_cmp_eq_u32 vcc, s30, v8
    v_cmp_eq_u32 s[48:49], s30, v9
    s_or_b64 vcc, vcc, s[48:49]
    v_cmp_eq_u32 s[48:49], s30, v10
    s_or_b64 vcc, vcc, s[48:49]
    v_cmp_eq_u32 s[48:49], s30, v11
    s_or_b64 vcc, vcc, s[48:49]
    s_cbranch_vccnz CM0_L0
    ds_read_b128 v[32:35], v0 offset:12288
    ds_read_b128 v[36:39], v0 offset:13312
    s_waitcnt lgkmcnt(0)
    v_smfmac_f32_16x16x64_bf16 v[40:43], v[8:11], v[32:39], v1
    ds_read_b128 v[32:35], v0 offset:28672
    ds_read_b128 v[36:39], v0 offset:29696
    s_waitcnt lgkmcnt(0)
    v_smfmac_f32_16x16x64_bf16 v[48:51], v[8:11], v[32:39], v1
    ds_read_b128 v[32:35], v0 offset:14336
    ds_read_b128 v[36:39], v0 offset:15360
    s_waitcnt lgkmcnt(0)
    v_smfmac_f32_16x16x64_bf16 v[44:47], v[8:11], v[32:39], v1
    ds_read_b128 v[32:35], v0 offset:30720
    ds_read_b128 v[36:39], v0 offset:31744
    s_waitcnt lgkmcnt(0)
    v_smfmac_f32_16x16x64_bf16 v[52:55], v[8:11], v[32:39], v1
    v_smfmac_f32_16x16x64_bf16 v[56:59], v[8:11], a[216:223], v1
    v_smfmac_f32_16x16x64_bf16 v[60:63], v[8:11], a[224:231], v1
CM0_L1:
    buffer_load_dwordx4 v[12:15], v3, s[4:7], s33 offen offset:1024 sc1
    s_add_u32 s31, s31, 1
    s_cmp_ge_u32 s31, 400000
    s_cbranch_scc1 FAIL
    s_waitcnt vmcnt(0)
    v_cmp_eq_u32 vcc, s30, v12
    v_cmp_eq_u32 s[48:49], s30, v13
    s_or_b64 vcc, vcc, s[48:49]
    v_cmp_eq_u32 s[48:49], s30, v14
    s_or_b64 vcc, vcc, s[48:49]
    v_cmp_eq_u32 s[48:49], s30, v15
    s_or_b64 vcc, vcc, s[48:49]
    s_cbranch_vccnz CM0_L1
    v_smfmac_f32_16x16x64_bf16 v[40:43], v[12:15], a[0:7], v1
    ds_read_b128 v[32:35], v0 offset:32768
    ds_read_b128 v[36:39], v0 offset:33792
    s_waitcnt lgkmcnt(0)
    v_smfmac_f32_16x16x64_bf16 v[48:51], v[12:15], v[32:39], v1
    v_smfmac_f32_16x16x64_bf16 v[44:47], v[12:15], a[8:15], v1
    ds_read_b128 v[32:35], v0 offset:34816
    ds_read_b128 v[36:39], v0 offset:35840
    s_waitcnt lgkmcnt(0)
    v_smfmac_f32_16x16x64_bf16 v[52:55], v[12:15], v[32:39], v1
    v_smfmac_f32_16x16x64_bf16 v[56:59], v[12:15], a[232:239], v1
    ds_read_b128 v[32:35], v0 offset:4096
    ds_read_b128 v[36:39], v0 offset:5120
    s_waitcnt lgkmcnt(0)
    v_smfmac_f32_16x16x64_bf16 v[60:63], v[12:15], v[32:39], v1
CM0_L2:
    buffer_load_dwordx4 v[16:19], v3, s[4:7], s34 offen offset:0 sc1
    s_add_u32 s31, s31, 1
    s_cmp_ge_u32 s31, 400000
    s_cbranch_scc1 FAIL
    s_waitcnt vmcnt(0)
    v_cmp_eq_u32 vcc, s30, v16
    v_cmp_eq_u32 s[48:49], s30, v17
    s_or_b64 vcc, vcc, s[48:49]
    v_cmp_eq_u32 s[48:49], s30, v18
    s_or_b64 vcc, vcc, s[48:49]
    v_cmp_eq_u32 s[48:49], s30, v19
    s_or_b64 vcc, vcc, s[48:49]
    s_cbranch_vccnz CM0_L2
    v_smfmac_f32_16x16x64_bf16 v[40:43], v[16:19], a[16:23], v1
    v_smfmac_f32_16x16x64_bf16 v[48:51], v[16:19], a[120:127], v1
    v_smfmac_f32_16x16x64_bf16 v[44:47], v[16:19], a[24:31], v1
    v_smfmac_f32_16x16x64_bf16 v[52:55], v[16:19], a[128:135], v1
    ds_read_b128 v[32:35], v0 offset:16384
    ds_read_b128 v[36:39], v0 offset:17408
    s_waitcnt lgkmcnt(0)
    v_smfmac_f32_16x16x64_bf16 v[56:59], v[16:19], v[32:39], v1
    ds_read_b128 v[32:35], v0 offset:18432
    ds_read_b128 v[36:39], v0 offset:19456
    s_waitcnt lgkmcnt(0)
    v_smfmac_f32_16x16x64_bf16 v[60:63], v[16:19], v[32:39], v1
CM0_L3:
    buffer_load_dwordx4 v[20:23], v3, s[4:7], s34 offen offset:1024 sc1
    s_add_u32 s31, s31, 1
    s_cmp_ge_u32 s31, 400000
    s_cbranch_scc1 FAIL
    s_waitcnt vmcnt(0)
    v_cmp_eq_u32 vcc, s30, v20
    v_cmp_eq_u32 s[48:49], s30, v21
    s_or_b64 vcc, vcc, s[48:49]
    v_cmp_eq_u32 s[48:49], s30, v22
    s_or_b64 vcc, vcc, s[48:49]
    v_cmp_eq_u32 s[48:49], s30, v23
    s_or_b64 vcc, vcc, s[48:49]
    s_cbranch_vccnz CM0_L3
    v_smfmac_f32_16x16x64_bf16 v[40:43], v[20:23], a[32:39], v1
    v_smfmac_f32_16x16x64_bf16 v[48:51], v[20:23], a[136:143], v1
    v_smfmac_f32_16x16x64_bf16 v[44:47], v[20:23], a[40:47], v1
    v_smfmac_f32_16x16x64_bf16 v[52:55], v[20:23], a[144:151], v1
CM0_L4:
    buffer_load_dwordx4 v[8:11], v3, s[4:7], s34 offen offset:2048 sc1
    s_add_u32 s31, s31, 1
    s_cmp_ge_u32 s31, 400000
    s_cbranch_scc1 FAIL
    s_waitcnt vmcnt(0)
    v_cmp_eq_u32 vcc, s30, v8
    v_cmp_eq_u32 s[48:49], s30, v9
    s_or_b64 vcc, vcc, s[48:49]
    v_cmp_eq_u32 s[48:49], s30, v10
    s_or_b64 vcc, vcc, s[48:49]
    v_cmp_eq_u32 s[48:49], s30, v11
    s_or_b64 vcc, vcc, s[48:49]
    s_cbranch_vccnz CM0_L4
    v_smfmac_f32_16x16x64_bf16 v[40:43], v[8:11], a[48:55], v1
    v_smfmac_f32_16x16x64_bf16 v[44:47], v[8:11], a[56:63], v1
CM0_L5:
    buffer_load_dwordx4 v[12:15], v3, s[4:7], s34 offen offset:3072 sc1
    s_add_u32 s31, s31, 1
    s_cmp_ge_u32 s31, 400000
    s_cbranch_scc1 FAIL
    s_waitcnt vmcnt(0)
    v_cmp_eq_u32 vcc, s30, v12
    v_cmp_eq_u32 s[48:49], s30, v13
    s_or_b64 vcc, vcc, s[48:49]
    v_cmp_eq_u32 s[48:49], s30, v14
    s_or_b64 vcc, vcc, s[48:49]
    v_cmp_eq_u32 s[48:49], s30, v15
    s_or_b64 vcc, vcc, s[48:49]
    s_cbranch_vccnz CM0_L5
    v_smfmac_f32_16x16x64_bf16 v[40:43], v[12:15], a[64:71], v1
    v_smfmac_f32_16x16x64_bf16 v[44:47], v[12:15], a[72:79], v1
CM0_L6:
    buffer_load_dwordx4 v[28:31], v3, s[4:7], s35 offen offset:0 sc1
    s_add_u32 s31, s31, 1
    s_cmp_ge_u32 s31, 400000
    s_cbranch_scc1 FAIL
    s_waitcnt vmcnt(0)
    v_cmp_eq_u32 vcc, s30, v28
    v_cmp_eq_u32 s[48:49], s30, v29
    s_or_b64 vcc, vcc, s[48:49]
    v_cmp_eq_u32 s[48:49], s30, v30
    s_or_b64 vcc, vcc, s[48:49]
    v_cmp_eq_u32 s[48:49], s30, v31
    s_or_b64 vcc, vcc, s[48:49]
    s_cbranch_vccnz CM0_L6
    ds_read_b128 v[32:35], v0 offset:0
    ds_read_b128 v[36:39], v0 offset:1024
    s_waitcnt lgkmcnt(0)
    v_smfmac_f32_16x16x64_bf16 v[40:43], v[28:31], v[32:39], v1
    v_smfmac_f32_16x16x64_bf16 v[44:47], v[28:31], a[80:87], v1
CM0_L8:
    buffer_load_dwordx4 v[24:27], v3, s[4:7], s35 offen offset:2048 sc1
    s_add_u32 s31, s31, 1
    s_cmp_ge_u32 s31, 400000
    s_cbranch_scc1 FAIL
    s_waitcnt vmcnt(0)
    v_cmp_eq_u32 vcc, s30, v24
    v_cmp_eq_u32 s[48:49], s30, v25
    s_or_b64 vcc, vcc, s[48:49]
    v_cmp_eq_u32 s[48:49], s30, v26
    s_or_b64 vcc, vcc, s[48:49]
    v_cmp_eq_u32 s[48:49], s30, v27
    s_or_b64 vcc, vcc, s[48:49]
    s_cbranch_vccnz CM0_L8
    v_smfmac_f32_16x16x64_bf16 v[40:43], v[24:27], a[104:111], v1
CM0_L7:
    buffer_load_dwordx4 v[16:19], v3, s[4:7], s35 offen offset:1024 sc1
    s_add_u32 s31, s31, 1
    s_cmp_ge_u32 s31, 400000
    s_cbranch_scc1 FAIL
    s_waitcnt vmcnt(0)
    v_cmp_eq_u32 vcc, s30, v16
    v_cmp_eq_u32 s[48:49], s30, v17
    s_or_b64 vcc, vcc, s[48:49]
    v_cmp_eq_u32 s[48:49], s30, v18
    s_or_b64 vcc, vcc, s[48:49]
    v_cmp_eq_u32 s[48:49], s30, v19
    s_or_b64 vcc, vcc, s[48:49]
    s_cbranch_vccnz CM0_L7
    v_smfmac_f32_16x16x64_bf16 v[40:43], v[16:19], a[88:95], v1
    v_smfmac_f32_16x16x64_bf16 v[44:47], v[24:27], a[112:119], v1
    v_smfmac_f32_16x16x64_bf16 v[44:47], v[16:19], a[96:103], v1
    ds_read_b128 v[32:35], v0 offset:2048
    ds_read_b128 v[36:39], v0 offset:3072
    s_waitcnt lgkmcnt(0)
    v_smfmac_f32_16x16x64_bf16 v[48:51], v[8:11], v[32:39], v1
    v_smfmac_f32_16x16x64_bf16 v[52:55], v[8:11], a[152:159], v1
    v_smfmac_f32_16x16x64_bf16 v[48:51], v[12:15], a[160:167], v1
    v_smfmac_f32_16x16x64_bf16 v[52:55], v[12:15], a[168:175], v1
    v_smfmac_f32_16x16x64_bf16 v[48:51], v[28:31], a[176:183], v1
    ds_read_b128 v[32:35], v0 offset:8192
    ds_read_b128 v[36:39], v0 offset:9216
    v_add_f32 v40, v40, v41
    v_add_f32 v42, v42, v43
    v_add_f32 v44, v44, v45
    v_add_f32 v46, v46, v47
    v_cvt_pk_bf16_f32 v40, v40, v44
    v_cvt_pk_bf16_f32 v41, v42, v46
    ds_write_b64 v4, v[40:41] offset:7168
    s_waitcnt lgkmcnt(0)
    s_branch CM0_RJ
CM0_SLOW:
    ds_read_b64_tr_b16 v[40:41], v5 offset:7168
    ds_read_b64_tr_b16 v[48:49], v5 offset:0
    ds_read_b64_tr_b16 v[42:43], v5 offset:7936
    ds_read_b64_tr_b16 v[50:51], v5 offset:768
    ds_read_b64_tr_b16 v[44:45], v5 offset:8704
    ds_read_b64_tr_b16 v[52:53], v5 offset:1536
    ds_read_b64_tr_b16 v[46:47], v5 offset:9472
    ds_read_b64_tr_b16 v[54:55], v5 offset:2304
    s_waitcnt vmcnt(0) lgkmcnt(0)
    v_and_b32 v64, 128, v3
    v_mad_u32_u24 v64, v64, 31, v3
    buffer_load_dwordx4 v[68:71], v64, s[4:7], s50 offen offset:0 sc1
    buffer_load_dwordx4 v[76:79], v3, s[4:7], s46 offen offset:3072 sc1
    buffer_load_dwordx4 v[64:67], v64, s[4:7], s38 offen offset:0 sc1
    buffer_load_dwordx4 v[72:75], v3, s[4:7], s46 offen offset:2048 sc1
    v_mfma_f32_16x16x32_bf16 v[48:51], v[48:51], v[40:43], 0
    v_mfma_f32_16x16x32_bf16 v[48:51], v[52:55], v[44:47], v[48:51]
    v_lshrrev_b32 v38, 2, v3
    v_and_b32 v38, 0xe0, v38
    v_and_b32 v39, 0xe0, v3
    s_nop 4
    v_add_f32_dpp v48, v49, v48 quad_perm:[1,0,3,2] row_mask:0xf bank_mask:0xf
    v_add_f32_dpp v50, v51, v50 quad_perm:[1,0,3,2] row_mask:0xf bank_mask:0xf
    v_mul_f32 v48, s44, v48
    v_mul_f32 v50, s44, v50
    v_mov_b64 v[32:33], s[20:21]
    v_mov_b64 v[34:35], s[20:21]
    s_waitcnt vmcnt(0)
    ds_read_b32 v2, v3 offset:13568
    v_mfma_f32_16x16x32_bf16 v[64:67], v[40:43], v[64:67], 0
    v_mfma_f32_16x16x32_bf16 v[64:67], v[44:47], v[68:71], v[64:67]
    v_max_f32 v37, v48, v50
    v_mov_b32 v36, v37
    s_nop 1
    v_permlane16_swap_b32 v36, v37
    v_max_f32 v37, v36, v37
    v_mov_b32 v36, v37
    s_nop 1
    v_permlane32_swap_b32 v36, v37
    v_max_f32 v37, v36, v37
    v_add_f32_dpp v64, v65, v64 row_ror:8 row_mask:0xf bank_mask:0xf
    v_add_f32_dpp v64, v66, v67 row_ror:8 row_mask:0xf bank_mask:0xc
    s_nop 1
    v_max_f32_dpp v36, v64, v64 quad_perm:[1,0,3,2] row_mask:0xf bank_mask:0xf
    s_nop 1
    v_max_f32_dpp v36, v36, v36 quad_perm:[2,3,0,1] row_mask:0xf bank_mask:0xf
    s_nop 1
    v_max_f32_dpp v36, v36, v36 row_half_mirror row_mask:0xf bank_mask:0xf
    ds_write_b32 v38, v36 offset:15616
    s_mov_b64 exec, s[40:41]
    ds_write_b32 v39, v37 offset:15632
    s_mov_b64 exec, -1
    s_waitcnt lgkmcnt(0)
    s_barrier
    ds_read_b128 v[40:43], v38 offset:15616
    ds_read_b32 v36, v38 offset:15632
    ds_read_b128 v[44:47], v39 offset:15616
    ds_read_b32 v37, v39 offset:15632
    s_waitcnt lgkmcnt(0)
    v_max3_f32 v36, v36, v40, v41
    v_max3_f32 v36, v36, v42, v43
    v_max3_f32 v37, v37, v44, v45
    v_max3_f32 v37, v37, v46, v47
    v_sub_f32 v64, v64, v36
    v_exp_f32 v64, v64
    v_sub_f32 v48, v48, v37
    v_exp_f32 v48, v48
    v_sub_f32 v50, v50, v37
    v_exp_f32 v50, v50
    v_cvt_pk_bf16_f32 v64, v64, v64
    ds_write_b16 v2, v64 offset:10496
    v_cvt_pk_bf16_f32 v48, v48, v50
    v_cndmask_b32 v48, 0, v48, s[40:41]
    s_nop 1
    v_mov_b32_dpp v49, v48 quad_perm:[1,0,3,2] row_mask:0xf bank_mask:0xf
    s_waitcnt lgkmcnt(0)
    s_barrier
    ds_read_b128 v[64:67], v3 offset:10496
    ds_read_b128 v[68:71], v3 offset:10480
    s_waitcnt lgkmcnt(0)
    v_mfma_f32_16x16x32_bf16 v[72:75], v[72:75], v[64:67], 0
    v_mfma_f32_16x16x32_bf16 v[72:75], v[76:79], v[68:71], v[72:75]
    v_mfma_f32_16x16x32_bf16 v[52:55], v[32:35], v[64:67], 0
    s_nop 5
    v_mfma_f32_16x16x16_bf16 v[52:55], v[32:33], v[48:49], v[52:55]
    v_mfma_f32_16x16x16_bf16 v[72:75], v[56:57], v[48:49], v[72:75]
    ds_read_b128 v[64:67], v0 offset:22528
    ds_read_b128 v[68:71], v0 offset:23552
    ds_read_b128 v[32:35], v3 offset:14592
    v_mov_b64 v[36:37], 0
    v_mov_b64 v[38:39], 0
    v_mov_b64 v[40:41], 0
    v_mov_b64 v[42:43], 0
    v_mov_b64 v[44:45], 0
    v_mov_b64 v[46:47], 0
    v_rcp_f32_dpp v53, v52 quad_perm:[0,0,2,2] row_mask:0xf bank_mask:0xf
    s_nop 0
    v_mul_f32 v72, v72, v53
    v_mul_f32 v73, v73, v53
    v_mul_f32 v74, v74, v53
    v_mul_f32 v75, v75, v53
    v_cvt_pk_bf16_f32 v72, v72, v73
    v_cvt_pk_bf16_f32 v73, v74, v75
    ds_write_b64 v4, v[72:73] offset:4096
    v_mov_b32_dpp v76, v72 quad_perm:[0,0,2,2] row_mask:0xf bank_mask:0xf
    v_mov_b32_dpp v77, v73 quad_perm:[0,0,2,2] row_mask:0xf bank_mask:0xf
    v_mov_b32_dpp v78, v72 quad_perm:[1,1,3,3] row_mask:0xf bank_mask:0xf
    v_mov_b32_dpp v79, v73 quad_perm:[1,1,3,3] row_mask:0xf bank_mask:0xf
    s_waitcnt lgkmcnt(0)
    s_branch CM0_FAST
CM0_R3:
    buffer_load_dwordx4 v[48:51], v3, s[4:7], s51 offen offset:0 sc1
    buffer_load_dwordx4 v[52:55], v3, s[4:7], s51 offen offset:1024 sc1
    s_waitcnt vmcnt(5)
    v_mfma_f32_16x16x32_bf16 v[60:63], v[44:47], v[40:43], 0
    v_bitop3_b32 v2, v40, v42, s32 bitop3:0x7e
    s_waitcnt vmcnt(4)
    v_mfma_f32_16x16x32_bf16 v[60:63], v[44:47], v[56:59], v[60:63]
    v_bitop3_b32 v6, v56, v58, s32 bitop3:0x7e
    v_bitop3_b32 v2, v2, v6, 1 bitop3:0xa8
    v_cmp_ne_u32 vcc, 0, v2
    s_nop 4
    v_add_f32_dpp v60, v60, v60 row_ror:8 row_mask:0xf bank_mask:0xf
    v_add_f32_dpp v61, v61, v61 row_ror:8 row_mask:0xf bank_mask:0xf
    s_cbranch_vccz CM0_RC
CM0_R4:
    buffer_load_dwordx4 v[40:43], v3, s[4:7], s51 offen offset:0 sc1
    buffer_load_dwordx4 v[56:59], v3, s[4:7], s51 offen offset:1024 sc1
    s_waitcnt vmcnt(5)
    v_mfma_f32_16x16x32_bf16 v[60:63], v[44:47], v[16:19], 0
    v_bitop3_b32 v2, v16, v18, s32 bitop3:0x7e
    s_waitcnt vmcnt(4)
    v_mfma_f32_16x16x32_bf16 v[60:63], v[44:47], v[20:23], v[60:63]
    v_bitop3_b32 v6, v20, v22, s32 bitop3:0x7e
    v_bitop3_b32 v2, v2, v6, 1 bitop3:0xa8
    v_cmp_ne_u32 vcc, 0, v2
    s_nop 4
    v_add_f32_dpp v60, v60, v60 row_ror:8 row_mask:0xf bank_mask:0xf
    v_add_f32_dpp v61, v61, v61 row_ror:8 row_mask:0xf bank_mask:0xf
    s_cbranch_vccz CM0_RC
CM0_R5:
    buffer_load_dwordx4 v[16:19], v3, s[4:7], s51 offen offset:0 sc1
    buffer_load_dwordx4 v[20:23], v3, s[4:7], s51 offen offset:1024 sc1
    s_waitcnt vmcnt(5)
    v_mfma_f32_16x16x32_bf16 v[60:63], v[44:47], v[48:51], 0
    v_bitop3_b32 v2, v48, v50, s32 bitop3:0x7e
    s_waitcnt vmcnt(4)
    v_mfma_f32_16x16x32_bf16 v[60:63], v[44:47], v[52:55], v[60:63]
    v_bitop3_b32 v6, v52, v54, s32 bitop3:0x7e
    v_bitop3_b32 v2, v2, v6, 1 bitop3:0xa8
    v_cmp_ne_u32 vcc, 0, v2
    s_nop 4
    v_add_f32_dpp v60, v60, v60 row_ror:8 row_mask:0xf bank_mask:0xf
    v_add_f32_dpp v61, v61, v61 row_ror:8 row_mask:0xf bank_mask:0xf
    s_cbranch_vccz CM0_RC
CM0_R6:
    buffer_load_dwordx4 v[48:51], v3, s[4:7], s51 offen offset:0 sc1
    buffer_load_dwordx4 v[52:55], v3, s[4:7], s51 offen offset:1024 sc1
    s_waitcnt vmcnt(5)
    v_mfma_f32_16x16x32_bf16 v[60:63], v[44:47], v[40:43], 0
    v_bitop3_b32 v2, v40, v42, s32 bitop3:0x7e
    s_waitcnt vmcnt(4)
    v_mfma_f32_16x16x32_bf16 v[60:63], v[44:47], v[56:59], v[60:63]
    v_bitop3_b32 v6, v56, v58, s32 bitop3:0x7e
    v_bitop3_b32 v2, v2, v6, 1 bitop3:0xa8
    v_cmp_ne_u32 vcc, 0, v2
    s_nop 4
    v_add_f32_dpp v60, v60, v60 row_ror:8 row_mask:0xf bank_mask:0xf
    v_add_f32_dpp v61, v61, v61 row_ror:8 row_mask:0xf bank_mask:0xf
    s_cbranch_vccz CM0_RC
    s_add_u32 s31, s31, 1
    s_cmp_ge_u32 s31, 400000
    s_cbranch_scc1 FAIL
    s_branch CM0_R4
CM0_RB:
    s_barrier
    s_branch CM0_RC
CM0_LAST:
    s_mov_b64 exec, s[22:23]
    buffer_store_dword v6, v7, s[4:7], s39 offen sc1
    s_mov_b64 exec, -1
    s_waitcnt vmcnt(0)
    s_branch C_END
CM1_IN:
    s_add_u32 s45, s38, 32768
    s_add_u32 s34, s19, 2048
    s_add_u32 s35, s19, 6144
    buffer_load_dwordx4 v[8:11], v3, s[4:7], s19 offen offset:1024 sc1
    buffer_load_dwordx4 v[12:15], v3, s[4:7], s19 offen offset:0 sc1
    s_mov_b32 s29, 0
    s_mov_b32 m0, 4096
    s_mov_b32 s18, 1
CM1_FF:
    ds_read_b128 v[72:75], v0 offset:12288
    ds_read_b128 v[76:79], v0 offset:13312
    ds_read_b128 v[64:67], v0 offset:28672
    ds_read_b128 v[68:71], v0 offset:29696
    ds_read_b128 v[24:27], v0 offset:14336
    ds_read_b128 v[28:31], v0 offset:15360
    ds_read_b128 v[32:35], v0 offset:30720
    ds_read_b128 v[36:39], v0 offset:31744
    v_mov_b64 v[40:41], 0
    v_mov_b64 v[42:43], 0
    v_mov_b64 v[44:45], 0
    v_mov_b64 v[46:47], 0
    v_mov_b64 v[48:49], 0
    v_mov_b64 v[50:51], 0
    v_mov_b64 v[52:53], 0
    v_mov_b64 v[54:55], 0
    v_mov_b64 v[56:57], 0
    v_mov_b64 v[58:59], 0
    v_mov_b64 v[60:61], 0
    v_mov_b64 v[62:63], 0
    s_waitcnt vmcnt(0) lgkmcnt(0)
    buffer_load_dwordx4 v[16:19], v3, s[4:7], s34 offen offset:1024 sc1
    buffer_load_dwordx4 v[20:23], v3, s[4:7], s34 offen offset:0 sc1
    s_branch CM1_A
CM1_T:
    s_barrier
    buffer_load_dwordx4 v[48:51], v3, s[4:7], s51 offen offset:0 sc1
    buffer_load_dwordx4 v[52:55], v3, s[4:7], s51 offen offset:1024 sc1
    buffer_load_dwordx4 v[40:43], v3, s[4:7], s51 offen offset:2048 sc1
    buffer_load_dwordx4 v[56:59], v3, s[4:7], s51 offen offset:3072 sc1
    s_barrier
    s_waitcnt vmcnt(3)
    v_mfma_f32_16x16x32_bf16 v[60:63], v[44:47], v[48:51], 0
    s_waitcnt vmcnt(2)
    v_mfma_f32_16x16x32_bf16 v[60:63], v[44:47], v[52:55], v[60:63]
    v_bitop3_b32 v2, v48, v52, s32 bitop3:0x7e
    s_waitcnt vmcnt(1)
    v_mfma_f32_16x16x32_bf16 v[60:63], v[44:47], v[40:43], v[60:63]
    s_waitcnt vmcnt(0)
    v_mfma_f32_16x16x32_bf16 v[60:63], v[44:47], v[56:59], v[60:63]
    v_bitop3_b32 v6, v40, v56, s32 bitop3:0x7e
    v_bitop3_b32 v2, v2, v6, 1 bitop3:0xa8
    v_cmp_ne_u32 vcc, 0, v2
    v_mov_b64 v[48:49], 0
    v_mov_b64 v[50:51], 0
    v_mov_b64 v[52:53], 0
    v_mov_b64 v[54:55], 0
    s_nop 0
    v_add_f32_dpp v60, v60, v60 row_ror:8 row_mask:0xf bank_mask:0xf
    v_add_f32_dpp v61, v61, v61 row_ror:8 row_mask:0xf bank_mask:0xf
    v_cvt_pk_bf16_f32 v6, v60, v61
    s_cbranch_vccnz CM1_R1
CM1_RC:
    buffer_store_dword v6, v7, s[4:7], s36 offen sc1
    v_mov_b64 v[44:45], 0
    v_mov_b64 v[46:47], 0
    v_mov_b64 v[60:61], 0
    v_mov_b64 v[62:63], 0
    v_mov_b64 v[40:41], 0
    v_mov_b64 v[42:43], 0
    v_mov_b64 v[56:57], 0
    v_mov_b64 v[58:59], 0
    s_barrier
    buffer_load_dwordx4 v[16:19], v3, s[4:7], s34 offen offset:1024 sc1
    s_barrier
    ds_read_b128 v[8:11], v3 offset:8192
    ds_read_b128 v[12:15], v3 offset:7168
    buffer_load_dwordx4 v[20:23], v3, s[4:7], s34 offen offset:0 sc1
    s_cmp_eq_u32 s32, s18
    s_cbranch_scc1 CM1_SP
CM1_A:
    s_waitcnt lgkmcnt(1)
    v_smfmac_f32_16x16x64_bf16 v[40:43], v[8:11], v[72:79], v1
    v_smfmac_f32_16x16x64_bf16 v[48:51], v[8:11], v[64:71], v1
    ds_read_b128 v[64:67], v0 offset:32768
    v_smfmac_f32_16x16x64_bf16 v[44:47], v[8:11], v[24:31], v1
    ds_read_b128 v[68:71], v0 offset:33792
    v_mov_b32 v2, s30
    v_smfmac_f32_16x16x64_bf16 v[52:55], v[8:11], v[32:39], v1
    buffer_store_dword v2, v7, s[4:7], s37 offen sc1
    ds_read_b128 v[24:27], v0 offset:34816
    v_smfmac_f32_16x16x64_bf16 v[56:59], v[8:11], a[216:223], v1
    ds_read_b128 v[28:31], v0 offset:35840
    v_smfmac_f32_16x16x64_bf16 v[60:63], v[8:11], a[224:231], v1
    buffer_load_dwordx4 v3, s[4:7], s35 offen offset:0 sc1 lds
    ds_read_b128 v[32:35], v0 offset:4096
    s_waitcnt lgkmcnt(5)
    v_smfmac_f32_16x16x64_bf16 v[40:43], v[12:15], a[0:7], v1
    ds_read_b128 v[36:39], v0 offset:5120
    s_waitcnt lgkmcnt(4)
    v_smfmac_f32_16x16x64_bf16 v[48:51], v[12:15], v[64:71], v1
    v_smfmac_f32_16x16x64_bf16 v[44:47], v[12:15], a[8:15], v1
    s_waitcnt lgkmcnt(2)
    v_smfmac_f32_16x16x64_bf16 v[52:55], v[12:15], v[24:31], v1
    buffer_load_dwordx4 v[72:75], v3, s[4:7], s46 offen offset:2048 sc1
    ds_read_b128 v[24:27], v0 offset:16384
    v_smfmac_f32_16x16x64_bf16 v[56:59], v[12:15], a[232:239], v1
    buffer_load_dwordx4 v[76:79], v3, s[4:7], s46 offen offset:3072 sc1
    ds_read_b128 v[28:31], v0 offset:17408
    s_waitcnt lgkmcnt(2)
    v_smfmac_f32_16x16x64_bf16 v[60:63], v[12:15], v[32:39], v1
    ds_read_b128 v[32:35], v0 offset:18432
    ds_read_b128 v[36:39], v0 offset:19456
    s_waitcnt vmcnt(5)
    v_smfmac_f32_16x16x64_bf16 v[40:43], v[16:19], a[16:23], v1
    ds_write_b128 v3, v[16:19] offset:1024
    v_and_b32 v64, 128, v3
    v_smfmac_f32_16x16x64_bf16 v[48:51], v[16:19], a[120:127], v1
    v_mad_u32_u24 v64, v64, 31, v3
    v_smfmac_f32_16x16x64_bf16 v[44:47], v[16:19], a[24:31], v1
    buffer_load_dwordx4 v[68:71], v64, s[4:7], s50 offen offset:128 sc1
    v_maximum3_f32 v2, v16, v17, v18
    v_smfmac_f32_16x16x64_bf16 v[52:55], v[16:19], a[128:135], v1
    buffer_load_dwordx4 v[64:67], v64, s[4:7], s38 offen offset:128 sc1
    s_waitcnt lgkmcnt(3)
    v_cmp_u_f32 vcc, v2, v19
    v_smfmac_f32_16x16x64_bf16 v[56:59], v[16:19], v[24:31], v1
    s_waitcnt lgkmcnt(1)
    v_smfmac_f32_16x16x64_bf16 v[60:63], v[16:19], v[32:39], v1
    s_cbranch_vccnz CM1_FB
CM1_CB:
    s_waitcnt lgkmcnt(0)
    s_barrier
    s_waitcnt vmcnt(6)
    v_smfmac_f32_16x16x64_bf16 v[40:43], v[20:23], a[32:39], v1
    buffer_store_dword v6, v7, s[4:7], s39 offen sc1
    ds_read_b128 v[8:11], v3 offset:3072
    v_lshlrev_b32 v6, 3, v3
    v_smfmac_f32_16x16x64_bf16 v[48:51], v[20:23], a[136:143], v1
    buffer_load_dword v6, v6, s[4:7], s45 offen sc1
    ds_read_b128 v[12:15], v3 offset:2048
    v_smfmac_f32_16x16x64_bf16 v[44:47], v[20:23], a[40:47], v1
    ds_read_b128 v[32:35], v0 offset:0
    s_mov_b32 s37, s36
    v_smfmac_f32_16x16x64_bf16 v[52:55], v[20:23], a[144:151], v1
    s_waitcnt vmcnt(6)
    s_barrier
    ds_read_b128 v[36:39], v0 offset:1024
    s_waitcnt lgkmcnt(3)
    v_smfmac_f32_16x16x64_bf16 v[40:43], v[8:11], a[48:55], v1
    ds_read_b128 v[28:31], v3 offset:4096
    s_add_u32 s36, s36, 0x8000
    v_smfmac_f32_16x16x64_bf16 v[44:47], v[8:11], a[56:63], v1
    ds_read_b128 v[24:27], v3 offset:6144
    s_bitset0_b32 s36, 17
    s_waitcnt lgkmcnt(4)
    v_smfmac_f32_16x16x64_bf16 v[40:43], v[12:15], a[64:71], v1
    ds_read_b128 v[16:19], v3 offset:5120
    s_add_u32 s32, s32, 1
    v_smfmac_f32_16x16x64_bf16 v[44:47], v[12:15], a[72:79], v1
    ds_read_b32 v2, v3 offset:13568
    s_waitcnt lgkmcnt(3)
    v_smfmac_f32_16x16x64_bf16 v[40:43], v[28:31], v[32:39], v1
    ds_read_b128 v[32:35], v0 offset:2048
    s_add_u32 s39, s39, 9216
    v_smfmac_f32_16x16x64_bf16 v[44:47], v[28:31], a[80:87], v1
    ds_read_b128 v[36:39], v0 offset:3072
    s_mov_b32 s29, 0
    s_waitcnt lgkmcnt(4)
    v_smfmac_f32_16x16x64_bf16 v[40:43], v[24:27], a[104:111], v1
    s_add_u32 s45, s45, 32768
    s_waitcnt lgkmcnt(3)
    v_smfmac_f32_16x16x64_bf16 v[40:43], v[16:19], a[88:95], v1
    v_smfmac_f32_16x16x64_bf16 v[44:47], v[24:27], a[112:119], v1
    v_smfmac_f32_16x16x64_bf16 v[44:47], v[16:19], a[96:103], v1
    s_waitcnt lgkmcnt(0)
    v_add_f32 v40, v40, v41
    v_smfmac_f32_16x16x64_bf16 v[48:51], v[8:11], v[32:39], v1
    ds_read_b128 v[32:35], v0 offset:8192
    v_add_f32 v42, v42, v43
    v_smfmac_f32_16x16x64_bf16 v[52:55], v[8:11], a[152:159], v1
    ds_read_b128 v[36:39], v0 offset:9216
    v_add_f32 v44, v44, v45
    v_add_f32 v46, v46, v47
    v_cvt_pk_bf16_f32 v40, v40, v44
    v_cvt_pk_bf16_f32 v41, v42, v46
    v_smfmac_f32_16x16x64_bf16 v[48:51], v[12:15], a[160:167], v1
    ds_write_b64 v4, v[40:41] offset:7936
    v_cmp_u_f32 vcc, v40, v41
    v_smfmac_f32_16x16x64_bf16 v[52:55], v[12:15], a[168:175], v1
    v_smfmac_f32_16x16x64_bf16 v[48:51], v[28:31], a[176:183], v1
    s_cbranch_vccnz CM1_RE
CM1_RJ:
    v_smfmac_f32_16x16x64_bf16 v[52:55], v[28:31], a[184:191], v1
    s_add_u32 s19, s19, 0x8000
    s_waitcnt lgkmcnt(1)
    v_smfmac_f32_16x16x64_bf16 v[48:51], v[24:27], v[32:39], v1
    s_waitcnt lgkmcnt(0)
    s_barrier
    v_smfmac_f32_16x16x64_bf16 v[48:51], v[16:19], a[192:199], v1
    ds_read_b64_tr_b16 v[40:41], v5 offset:7168
    ds_read_b64_tr_b16 v[42:43], v5 offset:7936
    v_smfmac_f32_16x16x64_bf16 v[52:55], v[24:27], a[208:215], v1
    ds_read_b64_tr_b16 v[44:45], v5 offset:8704
    ds_read_b64_tr_b16 v[46:47], v5 offset:9472
    v_smfmac_f32_16x16x64_bf16 v[52:55], v[16:19], a[200:207], v1
    ds_read_b128 v[32:35], v0 offset:6144
    v_add_f32 v48, v48, v49
    v_smfmac_f32_16x16x64_bf16 v[56:59], v[8:11], v[80:87], v1
    ds_read_b128 v[36:39], v0 offset:7168
    s_waitcnt vmcnt(2) lgkmcnt(4)
    v_add_f32 v50, v50, v51
    v_mfma_f32_16x16x32_bf16 v[64:67], v[40:43], v[64:67], 0
    s_waitcnt lgkmcnt(2)
    v_add_f32 v52, v52, v53
    v_add_f32 v54, v54, v55
    v_mfma_f32_16x16x32_bf16 v[64:67], v[44:47], v[68:71], v[64:67]
    v_cvt_pk_bf16_f32 v48, v48, v52
    v_cvt_pk_bf16_f32 v49, v50, v54
    v_smfmac_f32_16x16x64_bf16 v[60:63], v[8:11], v[88:95], v1
    ds_write_b64 v4, v[48:49] offset:768
    s_bitset0_b32 s19, 17
    v_smfmac_f32_16x16x64_bf16 v[56:59], v[12:15], v[96:103], v1
    s_add_u32 s34, s19, 2048
    s_waitcnt lgkmcnt(1)
    v_add_f32_dpp v64, v65, v64 row_ror:8 row_mask:0xf bank_mask:0xf
    v_add_f32_dpp v64, v66, v67 row_ror:8 row_mask:0xf bank_mask:0xc
    v_exp_f32 v64, v64
    s_nop 0
    v_cvt_pk_bf16_f32 v64, v64, v64
    v_smfmac_f32_16x16x64_bf16 v[60:63], v[12:15], v[32:39], v1
    ds_write_b16 v2, v64 offset:11008
    v_smfmac_f32_16x16x64_bf16 v[56:59], v[16:19], v[120:127], v1
    ds_read_b128 v[8:11], v0 offset:20480
    s_add_u32 s35, s19, 6144
    v_mov_b64 v[32:33], s[20:21]
    v_smfmac_f32_16x16x64_bf16 v[60:63], v[16:19], v[128:135], v1
    ds_read_b128 v[12:15], v0 offset:21504
    v_mov_b64 v[34:35], s[20:21]
    v_smfmac_f32_16x16x64_bf16 v[56:59], v[20:23], a[240:247], v1
    s_waitcnt lgkmcnt(2)
    s_barrier
    v_smfmac_f32_16x16x64_bf16 v[60:63], v[20:23], a[248:255], v1
    ds_read_b64_tr_b16 v[48:49], v5 offset:0
    ds_read_b64_tr_b16 v[50:51], v5 offset:768
    v_smfmac_f32_16x16x64_bf16 v[56:59], v[24:27], v[136:143], v1
    ds_read_b64_tr_b16 v[52:53], v5 offset:1536
    ds_read_b64_tr_b16 v[54:55], v5 offset:2304
    v_smfmac_f32_16x16x64_bf16 v[56:59], v[28:31], v[104:111], v1
    ds_read_b128 v[64:67], v3 offset:10496
    v_mov_b64 v[36:37], 0
    v_smfmac_f32_16x16x64_bf16 v[60:63], v[24:27], v[144:151], v1
    ds_read_b128 v[68:71], v3 offset:10480
    s_waitcnt lgkmcnt(4)
    v_mov_b64 v[38:39], 0
    v_mfma_f32_16x16x32_bf16 v[48:51], v[48:51], v[40:43], 0
    ds_read_b128 v[16:19], v0 offset:24576
    s_waitcnt lgkmcnt(3)
    v_add_f32 v56, v56, v57
    v_add_f32 v58, v58, v59
    v_mfma_f32_16x16x32_bf16 v[48:51], v[52:55], v[44:47], v[48:51]
    ds_read_b128 v[20:23], v0 offset:25600
    v_cvt_pk_bf16_f32 v56, v56, v58
    v_smfmac_f32_16x16x64_bf16 v[60:63], v[28:31], v[112:119], v1
    ds_read_b128 v[24:27], v0 offset:26624
    s_waitcnt lgkmcnt(4)
    v_mfma_f32_16x16x32_bf16 v[52:55], v[32:35], v[64:67], 0
    ds_read_b128 v[28:31], v0 offset:27648
    v_add_f32_dpp v48, v49, v48 quad_perm:[1,0,3,2] row_mask:0xf bank_mask:0xf
    v_add_f32_dpp v50, v51, v50 quad_perm:[1,0,3,2] row_mask:0xf bank_mask:0xf
    v_mfma_f32_16x16x32_bf16 v[72:75], v[72:75], v[64:67], 0
    s_waitcnt lgkmcnt(4)
    v_mul_f32 v48, s44, v48
    v_mul_f32 v50, s44, v50
    v_exp_f32 v48, v48
    v_exp_f32 v50, v50
    v_add_f32 v60, v60, v61
    v_cvt_pk_bf16_f32 v48, v48, v50
    v_cndmask_b32 v48, 0, v48, s[40:41]
    v_mfma_f32_16x16x32_bf16 v[72:75], v[76:79], v[68:71], v[72:75]
    ds_read_b128 v[64:67], v0 offset:22528
    v_mov_b32_dpp v49, v48 quad_perm:[1,0,3,2] row_mask:0xf bank_mask:0xf
    v_add_f32 v62, v62, v63
    v_cvt_pk_bf16_f32 v57, v60, v62
    v_mfma_f32_16x16x16_bf16 v[52:55], v[32:33], v[48:49], v[52:55]
    ds_read_b128 v[32:35], v3 offset:14592
    ds_read_b128 v[68:71], v0 offset:23552
    v_mov_b64 v[40:41], 0
    v_mfma_f32_16x16x16_bf16 v[72:75], v[56:57], v[48:49], v[72:75]
    v_mov_b64 v[42:43], 0
    v_mov_b64 v[44:45], 0
    v_mov_b64 v[46:47], 0
    v_mov_b64 v[60:61], 0
    v_rcp_f32_dpp v53, v52 quad_perm:[0,0,2,2] row_mask:0xf bank_mask:0xf
    v_mov_b64 v[62:63], 0
    v_max_u32 v52, v52, v53
    v_cmp_lt_u32 vcc, s17, v52
    v_mul_f32 v72, v72, v53
    v_mul_f32 v73, v73, v53
    v_mul_f32 v74, v74, v53
    v_mul_f32 v75, v75, v53
    v_cvt_pk_bf16_f32 v72, v72, v73
    v_cvt_pk_bf16_f32 v73, v74, v75
    ds_write_b64 v4, v[72:73] offset:4864
    v_mov_b32_dpp v76, v72 quad_perm:[0,0,2,2] row_mask:0xf bank_mask:0xf
    v_mov_b32_dpp v77, v73 quad_perm:[0,0,2,2] row_mask:0xf bank_mask:0xf
    v_mov_b32_dpp v78, v72 quad_perm:[1,1,3,3] row_mask:0xf bank_mask:0xf
    v_mov_b32_dpp v79, v73 quad_perm:[1,1,3,3] row_mask:0xf bank_mask:0xf
    s_cbranch_vccnz CM1_SLOW
CM1_FAST:
    s_nop 0
    v_smfmac_f32_16x16x64_bf16 v[40:43], v[76:79], v[8:15], v1
    s_waitcnt lgkmcnt(6)
    v_smfmac_f32_16x16x64_bf16 v[44:47], v[76:79], v[16:23], v1
    s_waitcnt lgkmcnt(0)
    s_barrier
    ds_read_b128 v[48:51], v32 offset:4096
    ds_read_b128 v[52:55], v32 offset:6400
    ds_read_b128 v[56:59], v32 offset:5632
    v_smfmac_f32_16x16x64_bf16 v[60:63], v[76:79], v[24:31], v1
    s_add_u32 s38, s38, 32768
    s_add_u32 s50, s50, 32768
    v_smfmac_f32_16x16x64_bf16 v[36:39], v[76:79], v[64:71], v1
    s_add_u32 s46, s46, 32768
    ds_read_b128 v[24:27], v0 offset:10240
    s_waitcnt lgkmcnt(3)
    v_lshrrev_b32 v32, 16, v1
    v_smfmac_f32_16x16x64_bf16 v[40:43], v[48:51], v[192:199], v1
    ds_read_b128 v[28:31], v0 offset:11264
    s_waitcnt lgkmcnt(3)
    v_smfmac_f32_16x16x64_bf16 v[40:43], v[52:55], v[208:215], v1
    ds_read_b128 v[72:75], v33 offset:4096
    s_waitcnt lgkmcnt(3)
    v_smfmac_f32_16x16x64_bf16 v[40:43], v[56:59], v[224:231], v1
    ds_read_b128 v[76:79], v33 offset:5632
    v_smfmac_f32_16x16x64_bf16 v[44:47], v[48:51], v[152:159], v1
    ds_read_b128 v[64:67], v0 offset:28672
    v_smfmac_f32_16x16x64_bf16 v[44:47], v[52:55], v[168:175], v1
    ds_read_b128 v[68:71], v0 offset:29696
    v_cvt_pk_bf16_f32 v40, v40, v41
    v_cvt_pk_bf16_f32 v41, v42, v43
    v_bfi_b32 v40, 1, s32, v40
    buffer_store_dwordx2 v[40:41], v34, s[4:7], s12 offen sc1
    s_waitcnt lgkmcnt(4)
    v_smfmac_f32_16x16x64_bf16 v[44:47], v[56:59], v[24:31], v1
    v_mov_b64 v[40:41], 0
    v_smfmac_f32_16x16x64_bf16 v[60:63], v[48:51], v[160:167], v1
    ds_read_b128 v[24:27], v0 offset:14336
    v_mov_b64 v[42:43], 0
    v_smfmac_f32_16x16x64_bf16 v[60:63], v[52:55], v[176:183], v1
    ds_read_b128 v[28:31], v0 offset:15360
    v_cvt_pk_bf16_f32 v44, v44, v45
    v_smfmac_f32_16x16x64_bf16 v[60:63], v[56:59], v[184:191], v1
    s_waitcnt lgkmcnt(4)
    v_cvt_pk_bf16_f32 v45, v46, v47
    v_smfmac_f32_16x16x64_bf16 v[40:43], v[72:75], v[240:247], v1
    v_bfi_b32 v44, 1, s32, v44
    v_smfmac_f32_16x16x64_bf16 v[40:43], v[76:79], v[248:255], v1
    ds_read_b128 v[72:75], v0 offset:12288
    v_cvt_pk_bf16_f32 v46, v60, v61
    v_cvt_pk_bf16_f32 v47, v62, v63
    buffer_store_dwordx4 v[44:47], v32, s[4:7], s13 offen sc1
    v_smfmac_f32_16x16x64_bf16 v[36:39], v[48:51], v[200:207], v1
    ds_read_b128 v[76:79], v0 offset:13312
    v_smfmac_f32_16x16x64_bf16 v[36:39], v[52:55], v[216:223], v1
    ds_read_b128 v[44:47], v3 offset:11520
    v_add_f32 v40, v40, v41
    v_smfmac_f32_16x16x64_bf16 v[36:39], v[56:59], v[232:239], v1
    v_add_f32 v42, v42, v43
    v_cvt_pk_bf16_f32 v40, v40, v42
    v_bfi_b32 v40, 1, s32, v40
    buffer_store_dword v40, v35, s[4:7], s15 offen sc1
    s_nop 3
    v_cvt_pk_bf16_f32 v36, v36, v37
    v_cvt_pk_bf16_f32 v37, v38, v39
    v_bfi_b32 v36, 1, s32, v36
    buffer_store_dwordx2 v[36:37], v34, s[4:7], s14 offen sc1
    ds_read_b128 v[32:35], v0 offset:30720
    ds_read_b128 v[36:39], v0 offset:31744
    s_waitcnt lgkmcnt(0)
    s_branch CM1_T
CM1_FB:
    s_add_u32 s29, s29, 1
    s_cmp_lt_u32 s29, 8
    s_cbranch_scc1 EX_58
    v_cmp_eq_u32 vcc, s30, v16
    v_cmp_eq_u32 s[48:49], s30, v17
    s_or_b64 vcc, vcc, s[48:49]
    v_cmp_eq_u32 s[48:49], s30, v18
    s_or_b64 vcc, vcc, s[48:49]
    v_cmp_eq_u32 s[48:49], s30, v19
    s_or_b64 vcc, vcc, s[48:49]
    s_cbranch_vccz CM1_CB
EX_58:
    s_add_u32 s31, s31, 1
    s_cmp_ge_u32 s31, 400000
    s_cbranch_scc1 FAIL
    s_waitcnt vmcnt(0)
    s_branch CM1_FF
CM1_RE:
    s_waitcnt vmcnt(0) lgkmcnt(0)
    v_mov_b64 v[40:41], 0
    v_mov_b64 v[42:43], 0
    v_mov_b64 v[44:45], 0
    v_mov_b64 v[46:47], 0
    s_nop 1
    v_mov_b64 v[48:49], 0
    v_mov_b64 v[50:51], 0
    v_mov_b64 v[52:53], 0
    v_mov_b64 v[54:55], 0
    v_mov_b64 v[56:57], 0
    v_mov_b64 v[58:59], 0
    v_mov_b64 v[60:61], 0
    v_mov_b64 v[62:63], 0
    s_add_u32 s31, s31, 1
    s_cmp_ge_u32 s31, 400000
    s_cbranch_scc1 FAIL
CM1_L0:
    buffer_load_dwordx4 v[8:11], v3, s[4:7], s19 offen offset:1024 sc1
    s_add_u32 s31, s31, 1
    s_cmp_ge_u32 s31, 400000
    s_cbranch_scc1 FAIL
    s_waitcnt vmcnt(0)
    v_cmp_eq_u32 vcc, s30, v8
    v_cmp_eq_u32 s[48:49], s30, v9
    s_or_b64 vcc, vcc, s[48:49]
    v_cmp_eq_u32 s[48:49], s30, v10
    s_or_b64 vcc, vcc, s[48:49]
    v_cmp_eq_u32 s[48:49], s30, v11
    s_or_b64 vcc, vcc, s[48:49]
    s_cbranch_vccnz CM1_L0
    ds_read_b128 v[32:35], v0 offset:12288
    ds_read_b128 v[36:39], v0 offset:13312
    s_waitcnt lgkmcnt(0)
    v_smfmac_f32_16x16x64_bf16 v[40:43], v[8:11], v[32:39], v1
    ds_read_b128 v[32:35], v0 offset:28672
    ds_read_b128 v[36:39], v0 offset:29696
    s_waitcnt lgkmcnt(0)
    v_smfmac_f32_16x16x64_bf16 v[48:51], v[8:11], v[32:39], v1
    ds_read_b128 v[32:35], v0 offset:14336
    ds_read_b128 v[36:39], v0 offset:15360
    s_waitcnt lgkmcnt(0)
    v_smfmac_f32_16x16x64_bf16 v[44:47], v[8:11], v[32:39], v1
    ds_read_b128 v[32:35], v0 offset:30720
    ds_read_b128 v[36:39], v0 offset:31744
    s_waitcnt lgkmcnt(0)
    v_smfmac_f32_16x16x64_bf16 v[52:55], v[8:11], v[32:39], v1
    v_smfmac_f32_16x16x64_bf16 v[56:59], v[8:11], a[216:223], v1
    v_smfmac_f32_16x16x64_bf16 v[60:63], v[8:11], a[224:231], v1
CM1_L1:
    buffer_load_dwordx4 v[12:15], v3, s[4:7], s19 offen offset:0 sc1
    s_add_u32 s31, s31, 1
    s_cmp_ge_u32 s31, 400000
    s_cbranch_scc1 FAIL
    s_waitcnt vmcnt(0)
    v_cmp_eq_u32 vcc, s30, v12
    v_cmp_eq_u32 s[48:49], s30, v13
    s_or_b64 vcc, vcc, s[48:49]
    v_cmp_eq_u32 s[48:49], s30, v14
    s_or_b64 vcc, vcc, s[48:49]
    v_cmp_eq_u32 s[48:49], s30, v15
    s_or_b64 vcc, vcc, s[48:49]
    s_cbranch_vccnz CM1_L1
    v_smfmac_f32_16x16x64_bf16 v[40:43], v[12:15], a[0:7], v1
    ds_read_b128 v[32:35], v0 offset:32768
    ds_read_b128 v[36:39], v0 offset:33792
    s_waitcnt lgkmcnt(0)
    v_smfmac_f32_16x16x64_bf16 v[48:51], v[12:15], v[32:39], v1
    v_smfmac_f32_16x16x64_bf16 v[44:47], v[12:15], a[8:15], v1
    ds_read_b128 v[32:35], v0 offset:34816
    ds_read_b128 v[36:39], v0 offset:35840
    s_waitcnt lgkmcnt(0)
    v_smfmac_f32_16x16x64_bf16 v[52:55], v[12:15], v[32:39], v1
    v_smfmac_f32_16x16x64_bf16 v[56:59], v[12:15], a[232:239], v1
    ds_read_b128 v[32:35], v0 offset:4096
    ds_read_b128 v[36:39], v0 offset:5120
    s_waitcnt lgkmcnt(0)
    v_smfmac_f32_16x16x64_bf16 v[60:63], v[12:15], v[32:39], v1
CM1_L2:
    buffer_load_dwordx4 v[16:19], v3, s[4:7], s34 offen offset:1024 sc1
    s_add_u32 s31, s31, 1
    s_cmp_ge_u32 s31, 400000
    s_cbranch_scc1 FAIL
    s_waitcnt vmcnt(0)
    v_cmp_eq_u32 vcc, s30, v16
    v_cmp_eq_u32 s[48:49], s30, v17
    s_or_b64 vcc, vcc, s[48:49]
    v_cmp_eq_u32 s[48:49], s30, v18
    s_or_b64 vcc, vcc, s[48:49]
    v_cmp_eq_u32 s[48:49], s30, v19
    s_or_b64 vcc, vcc, s[48:49]
    s_cbranch_vccnz CM1_L2
    v_smfmac_f32_16x16x64_bf16 v[40:43], v[16:19], a[16:23], v1
    v_smfmac_f32_16x16x64_bf16 v[48:51], v[16:19], a[120:127], v1
    v_smfmac_f32_16x16x64_bf16 v[44:47], v[16:19], a[24:31], v1
    v_smfmac_f32_16x16x64_bf16 v[52:55], v[16:19], a[128:135], v1
    ds_read_b128 v[32:35], v0 offset:16384
    ds_read_b128 v[36:39], v0 offset:17408
    s_waitcnt lgkmcnt(0)
    v_smfmac_f32_16x16x64_bf16 v[56:59], v[16:19], v[32:39], v1
    ds_read_b128 v[32:35], v0 offset:18432
    ds_read_b128 v[36:39], v0 offset:19456
    s_waitcnt lgkmcnt(0)
    v_smfmac_f32_16x16x64_bf16 v[60:63], v[16:19], v[32:39], v1
CM1_L3:
    buffer_load_dwordx4 v[20:23], v3, s[4:7], s34 offen offset:0 sc1
    s_add_u32 s31, s31, 1
    s_cmp_ge_u32 s31, 400000
    s_cbranch_scc1 FAIL
    s_waitcnt vmcnt(0)
    v_cmp_eq_u32 vcc, s30, v20
    v_cmp_eq_u32 s[48:49], s30, v21
    s_or_b64 vcc, vcc, s[48:49]
    v_cmp_eq_u32 s[48:49], s30, v22
    s_or_b64 vcc, vcc, s[48:49]
    v_cmp_eq_u32 s[48:49], s30, v23
    s_or_b64 vcc, vcc, s[48:49]
    s_cbranch_vccnz CM1_L3
    v_smfmac_f32_16x16x64_bf16 v[40:43], v[20:23], a[32:39], v1
    v_smfmac_f32_16x16x64_bf16 v[48:51], v[20:23], a[136:143], v1
    v_smfmac_f32_16x16x64_bf16 v[44:47], v[20:23], a[40:47], v1
    v_smfmac_f32_16x16x64_bf16 v[52:55], v[20:23], a[144:151], v1
CM1_L4:
    buffer_load_dwordx4 v[8:11], v3, s[4:7], s34 offen offset:3072 sc1
    s_add_u32 s31, s31, 1
    s_cmp_ge_u32 s31, 400000
    s_cbranch_scc1 FAIL
    s_waitcnt vmcnt(0)
    v_cmp_eq_u32 vcc, s30, v8
    v_cmp_eq_u32 s[48:49], s30, v9
    s_or_b64 vcc, vcc, s[48:49]
    v_cmp_eq_u32 s[48:49], s30, v10
    s_or_b64 vcc, vcc, s[48:49]
    v_cmp_eq_u32 s[48:49], s30, v11
    s_or_b64 vcc, vcc, s[48:49]
    s_cbranch_vccnz CM1_L4
    v_smfmac_f32_16x16x64_bf16 v[40:43], v[8:11], a[48:55], v1
    v_smfmac_f32_16x16x64_bf16 v[44:47], v[8:11], a[56:63], v1
CM1_L5:
    buffer_load_dwordx4 v[12:15], v3, s[4:7], s34 offen offset:2048 sc1
    s_add_u32 s31, s31, 1
    s_cmp_ge_u32 s31, 400000
    s_cbranch_scc1 FAIL
    s_waitcnt vmcnt(0)
    v_cmp_eq_u32 vcc, s30, v12
    v_cmp_eq_u32 s[48:49], s30, v13
    s_or_b64 vcc, vcc, s[48:49]
    v_cmp_eq_u32 s[48:49], s30, v14
    s_or_b64 vcc, vcc, s[48:49]
    v_cmp_eq_u32 s[48:49], s30, v15
    s_or_b64 vcc, vcc, s[48:49]
    s_cbranch_vccnz CM1_L5
    v_smfmac_f32_16x16x64_bf16 v[40:43], v[12:15], a[64:71], v1
    v_smfmac_f32_16x16x64_bf16 v[44:47], v[12:15], a[72:79], v1
CM1_L6:
    buffer_load_dwordx4 v[28:31], v3, s[4:7], s35 offen offset:0 sc1
    s_add_u32 s31, s31, 1
    s_cmp_ge_u32 s31, 400000
    s_cbranch_scc1 FAIL
    s_waitcnt vmcnt(0)
    v_cmp_eq_u32 vcc, s30, v28
    v_cmp_eq_u32 s[48:49], s30, v29
    s_or_b64 vcc, vcc, s[48:49]
    v_cmp_eq_u32 s[48:49], s30, v30
    s_or_b64 vcc, vcc, s[48:49]
    v_cmp_eq_u32 s[48:49], s30, v31
    s_or_b64 vcc, vcc, s[48:49]
    s_cbranch_vccnz CM1_L6
    ds_read_b128 v[32:35], v0 offset:0
    ds_read_b128 v[36:39], v0 offset:1024
    s_waitcnt lgkmcnt(0)
    v_smfmac_f32_16x16x64_bf16 v[40:43], v[28:31], v[32:39], v1
    v_smfmac_f32_16x16x64_bf16 v[44:47], v[28:31], a[80:87], v1
CM1_L8:
    buffer_load_dwordx4 v[24:27], v3, s[4:7], s35 offen offset:2048 sc1
    s_add_u32 s31, s31, 1
    s_cmp_ge_u32 s31, 400000
    s_cbranch_scc1 FAIL
    s_waitcnt vmcnt(0)
    v_cmp_eq_u32 vcc, s30, v24
    v_cmp_eq_u32 s[48:49], s30, v25
    s_or_b64 vcc, vcc, s[48:49]
    v_cmp_eq_u32 s[48:49], s30, v26
    s_or_b64 vcc, vcc, s[48:49]
    v_cmp_eq_u32 s[48:49], s30, v27
    s_or_b64 vcc, vcc, s[48:49]
    s_cbranch_vccnz CM1_L8
    v_smfmac_f32_16x16x64_bf16 v[40:43], v[24:27], a[104:111], v1
CM1_L7:
    buffer_load_dwordx4 v[16:19], v3, s[4:7], s35 offen offset:1024 sc1
    s_add_u32 s31, s31, 1
    s_cmp_ge_u32 s31, 400000
    s_cbranch_scc1 FAIL
    s_waitcnt vmcnt(0)
    v_cmp_eq_u32 vcc, s30, v16
    v_cmp_eq_u32 s[48:49], s30, v17
    s_or_b64 vcc, vcc, s[48:49]
    v_cmp_eq_u32 s[48:49], s30, v18
    s_or_b64 vcc, vcc, s[48:49]
    v_cmp_eq_u32 s[48:49], s30, v19
    s_or_b64 vcc, vcc, s[48:49]
    s_cbranch_vccnz CM1_L7
    v_smfmac_f32_16x16x64_bf16 v[40:43], v[16:19], a[88:95], v1
    v_smfmac_f32_16x16x64_bf16 v[44:47], v[24:27], a[112:119], v1
    v_smfmac_f32_16x16x64_bf16 v[44:47], v[16:19], a[96:103], v1
    ds_read_b128 v[32:35], v0 offset:2048
    ds_read_b128 v[36:39], v0 offset:3072
    s_waitcnt lgkmcnt(0)
    v_smfmac_f32_16x16x64_bf16 v[48:51], v[8:11], v[32:39], v1
    v_smfmac_f32_16x16x64_bf16 v[52:55], v[8:11], a[152:159], v1
    v_smfmac_f32_16x16x64_bf16 v[48:51], v[12:15], a[160:167], v1
    v_smfmac_f32_16x16x64_bf16 v[52:55], v[12:15], a[168:175], v1
    v_smfmac_f32_16x16x64_bf16 v[48:51], v[28:31], a[176:183], v1
    ds_read_b128 v[32:35], v0 offset:8192
    ds_read_b128 v[36:39], v0 offset:9216
    v_add_f32 v40, v40, v41
    v_add_f32 v42, v42, v43
    v_add_f32 v44, v44, v45
    v_add_f32 v46, v46, v47
    v_cvt_pk_bf16_f32 v40, v40, v44
    v_cvt_pk_bf16_f32 v41, v42, v46
    ds_write_b64 v4, v[40:41] offset:7936
    s_waitcnt lgkmcnt(0)
    s_branch CM1_RJ
CM1_SLOW:
    ds_read_b64_tr_b16 v[40:41], v5 offset:7168
    ds_read_b64_tr_b16 v[48:49], v5 offset:0
    ds_read_b64_tr_b16 v[42:43], v5 offset:7936
    ds_read_b64_tr_b16 v[50:51], v5 offset:768
    ds_read_b64_tr_b16 v[44:45], v5 offset:8704
    ds_read_b64_tr_b16 v[52:53], v5 offset:1536
    ds_read_b64_tr_b16 v[46:47], v5 offset:9472
    ds_read_b64_tr_b16 v[54:55], v5 offset:2304
    s_waitcnt vmcnt(0) lgkmcnt(0)
    v_and_b32 v64, 128, v3
    v_mad_u32_u24 v64, v64, 31, v3
    buffer_load_dwordx4 v[68:71], v64, s[4:7], s50 offen offset:128 sc1
    buffer_load_dwordx4 v[76:79], v3, s[4:7], s46 offen offset:3072 sc1
    buffer_load_dwordx4 v[64:67], v64, s[4:7], s38 offen offset:128 sc1
    buffer_load_dwordx4 v[72:75], v3, s[4:7], s46 offen offset:2048 sc1
    v_mfma_f32_16x16x32_bf16 v[48:51], v[48:51], v[40:43], 0
    v_mfma_f32_16x16x32_bf16 v[48:51], v[52:55], v[44:47], v[48:51]
    v_lshrrev_b32 v38, 2, v3
    v_and_b32 v38, 0xe0, v38
    v_and_b32 v39, 0xe0, v3
    s_nop 4
    v_add_f32_dpp v48, v49, v48 quad_perm:[1,0,3,2] row_mask:0xf bank_mask:0xf
    v_add_f32_dpp v50, v51, v50 quad_perm:[1,0,3,2] row_mask:0xf bank_mask:0xf
    v_mul_f32 v48, s44, v48
    v_mul_f32 v50, s44, v50
    v_mov_b64 v[32:33], s[20:21]
    v_mov_b64 v[34:35], s[20:21]
    s_waitcnt vmcnt(0)
    ds_read_b32 v2, v3 offset:13568
    v_mfma_f32_16x16x32_bf16 v[64:67], v[40:43], v[64:67], 0
    v_mfma_f32_16x16x32_bf16 v[64:67], v[44:47], v[68:71], v[64:67]
    v_max_f32 v37, v48, v50
    v_mov_b32 v36, v37
    s_nop 1
    v_permlane16_swap_b32 v36, v37
    v_max_f32 v37, v36, v37
    v_mov_b32 v36, v37
    s_nop 1
    v_permlane32_swap_b32 v36, v37
    v_max_f32 v37, v36, v37
    v_add_f32_dpp v64, v65, v64 row_ror:8 row_mask:0xf bank_mask:0xf
    v_add_f32_dpp v64, v66, v67 row_ror:8 row_mask:0xf bank_mask:0xc
    s_nop 1
    v_max_f32_dpp v36, v64, v64 quad_perm:[1,0,3,2] row_mask:0xf bank_mask:0xf
    s_nop 1
    v_max_f32_dpp v36, v36, v36 quad_perm:[2,3,0,1] row_mask:0xf bank_mask:0xf
    s_nop 1
    v_max_f32_dpp v36, v36, v36 row_half_mirror row_mask:0xf bank_mask:0xf
    ds_write_b32 v38, v36 offset:15620
    s_mov_b64 exec, s[40:41]
    ds_write_b32 v39, v37 offset:15632
    s_mov_b64 exec, -1
    s_waitcnt lgkmcnt(0)
    s_barrier
    ds_read_b128 v[40:43], v38 offset:15616
    ds_read_b32 v36, v38 offset:15632
    ds_read_b128 v[44:47], v39 offset:15616
    ds_read_b32 v37, v39 offset:15632
    s_waitcnt lgkmcnt(0)
    v_max3_f32 v36, v36, v40, v41
    v_max3_f32 v36, v36, v42, v43
    v_max3_f32 v37, v37, v44, v45
    v_max3_f32 v37, v37, v46, v47
    v_sub_f32 v64, v64, v36
    v_exp_f32 v64, v64
    v_sub_f32 v48, v48, v37
    v_exp_f32 v48, v48
    v_sub_f32 v50, v50, v37
    v_exp_f32 v50, v50
    v_cvt_pk_bf16_f32 v64, v64, v64
    ds_write_b16 v2, v64 offset:11008
    v_cvt_pk_bf16_f32 v48, v48, v50
    v_cndmask_b32 v48, 0, v48, s[40:41]
    s_nop 1
    v_mov_b32_dpp v49, v48 quad_perm:[1,0,3,2] row_mask:0xf bank_mask:0xf
    s_waitcnt lgkmcnt(0)
    s_barrier
    ds_read_b128 v[64:67], v3 offset:10496
    ds_read_b128 v[68:71], v3 offset:10480
    s_waitcnt lgkmcnt(0)
    v_mfma_f32_16x16x32_bf16 v[72:75], v[72:75], v[64:67], 0
    v_mfma_f32_16x16x32_bf16 v[72:75], v[76:79], v[68:71], v[72:75]
    v_mfma_f32_16x16x32_bf16 v[52:55], v[32:35], v[64:67], 0
    s_nop 5
    v_mfma_f32_16x16x16_bf16 v[52:55], v[32:33], v[48:49], v[52:55]
    v_mfma_f32_16x16x16_bf16 v[72:75], v[56:57], v[48:49], v[72:75]
    ds_read_b128 v[64:67], v0 offset:22528
    ds_read_b128 v[68:71], v0 offset:23552
    ds_read_b128 v[32:35], v3 offset:14592
    v_mov_b64 v[36:37], 0
    v_mov_b64 v[38:39], 0
    v_mov_b64 v[40:41], 0
    v_mov_b64 v[42:43], 0
    v_mov_b64 v[44:45], 0
    v_mov_b64 v[46:47], 0
    v_rcp_f32_dpp v53, v52 quad_perm:[0,0,2,2] row_mask:0xf bank_mask:0xf
    s_nop 0
    v_mul_f32 v72, v72, v53
    v_mul_f32 v73, v73, v53
    v_mul_f32 v74, v74, v53
    v_mul_f32 v75, v75, v53
    v_cvt_pk_bf16_f32 v72, v72, v73
    v_cvt_pk_bf16_f32 v73, v74, v75
    ds_write_b64 v4, v[72:73] offset:4864
    v_mov_b32_dpp v76, v72 quad_perm:[0,0,2,2] row_mask:0xf bank_mask:0xf
    v_mov_b32_dpp v77, v73 quad_perm:[0,0,2,2] row_mask:0xf bank_mask:0xf
    v_mov_b32_dpp v78, v72 quad_perm:[1,1,3,3] row_mask:0xf bank_mask:0xf
    v_mov_b32_dpp v79, v73 quad_perm:[1,1,3,3] row_mask:0xf bank_mask:0xf
    s_waitcnt lgkmcnt(0)
    s_branch CM1_FAST
CM1_SP:
    s_cmp_eq_u32 s32, 63
    s_cbranch_scc1 CM1_LAST
    s_add_u32 s18, s18, 1
    s_cmp_gt_u32 s18, 1
    s_cselect_b32 s18, 63, s18
    s_waitcnt vmcnt(0)
CM1_SQ:
    buffer_load_dwordx4 v[16:19], v3, s[4:7], s35 offen offset:0 sc1
    s_add_u32 s31, s31, 1
    s_cmp_ge_u32 s31, 400000
    s_cbranch_scc1 FAIL
    s_waitcnt vmcnt(0)
    v_cmp_eq_u32 vcc, s30, v16
    v_cmp_eq_u32 s[48:49], s30, v17
    s_or_b64 vcc, vcc, s[48:49]
    v_cmp_eq_u32 s[48:49], s30, v18
    s_or_b64 vcc, vcc, s[48:49]
    v_cmp_eq_u32 s[48:49], s30, v19
    s_or_b64 vcc, vcc, s[48:49]
    s_cbranch_vccnz CM1_SQ
    buffer_load_dwordx4 v[16:19], v3, s[4:7], s34 offen offset:1024 sc1
    buffer_load_dwordx4 v[20:23], v3, s[4:7], s34 offen offset:0 sc1
    s_branch CM1_A
CM1_R1:
    buffer_load_dwordx4 v[48:51], v3, s[4:7], s51 offen offset:0 sc1
    buffer_load_dwordx4 v[52:55], v3, s[4:7], s51 offen offset:1024 sc1
    buffer_load_dwordx4 v[40:43], v3, s[4:7], s51 offen offset:2048 sc1
    buffer_load_dwordx4 v[56:59], v3, s[4:7], s51 offen offset:3072 sc1
    s_add_u32 s31, s31, 1
    s_cmp_ge_u32 s31, 400000
    s_cbranch_scc1 FAIL
    s_waitcnt vmcnt(3)
    v_mfma_f32_16x16x32_bf16 v[60:63], v[44:47], v[48:51], 0
    s_waitcnt vmcnt(2)
    v_mfma_f32_16x16x32_bf16 v[60:63], v[44:47], v[52:55], v[60:63]
    v_bitop3_b32 v2, v48, v52, s32 bitop3:0x7e
    s_waitcnt vmcnt(1)
    v_mfma_f32_16x16x32_bf16 v[60:63], v[44:47], v[40:43], v[60:63]
    s_waitcnt vmcnt(0)
    v_mfma_f32_16x16x32_bf16 v[60:63], v[44:47], v[56:59], v[60:63]
    v_bitop3_b32 v6, v40, v56, s32 bitop3:0x7e
    v_bitop3_b32 v2, v2, v6, 1 bitop3:0xa8
    v_cmp_ne_u32 vcc, 0, v2
    v_mov_b64 v[48:49], 0
    v_mov_b64 v[50:51], 0
    v_mov_b64 v[52:53], 0
    v_mov_b64 v[54:55], 0
    s_nop 0
    v_add_f32_dpp v60, v60, v60 row_ror:8 row_mask:0xf bank_mask:0xf
    v_add_f32_dpp v61, v61, v61 row_ror:8 row_mask:0xf bank_mask:0xf
    v_cvt_pk_bf16_f32 v6, v60, v61
    s_cbranch_vccz CM1_RC
    s_branch CM1_R1
CM1_LAST:
    buffer_store_dword v6, v7, s[4:7], s39 offen sc1
    s_waitcnt vmcnt(0)
    s_branch C_END
CM2_IN:
    s_add_u32 s45, s38, 40960
    s_add_u32 s34, s19, 2048
    s_add_u32 s35, s19, 6144
    buffer_load_dwordx4 v[8:11], v3, s[4:7], s19 offen offset:0 sc1
    buffer_load_dwordx4 v[12:15], v3, s[4:7], s19 offen offset:1024 sc1
    s_mov_b32 s29, 0
    s_mov_b32 m0, 4096
    s_mov_b32 s18, 1
CM2_FF:
    ds_read_b128 v[72:75], v0 offset:12288
    ds_read_b128 v[76:79], v0 offset:13312
    ds_read_b128 v[64:67], v0 offset:28672
    ds_read_b128 v[68:71], v0 offset:29696
    ds_read_b128 v[24:27], v0 offset:14336
    ds_read_b128 v[28:31], v0 offset:15360
    ds_read_b128 v[32:35], v0 offset:30720
    ds_read_b128 v[36:39], v0 offset:31744
    v_mov_b64 v[40:41], 0
    v_mov_b64 v[42:43], 0
    v_mov_b64 v[44:45], 0
    v_mov_b64 v[46:47], 0
    v_mov_b64 v[48:49], 0
    v_mov_b64 v[50:51], 0
    v_mov_b64 v[52:53], 0
    v_mov_b64 v[54:55], 0
    v_mov_b64 v[56:57], 0
    v_mov_b64 v[58:59], 0
    v_mov_b64 v[60:61], 0
    v_mov_b64 v[62:63], 0
    s_waitcnt vmcnt(0) lgkmcnt(0)
    buffer_load_dwordx4 v[16:19], v3, s[4:7], s34 offen offset:2048 sc1
    buffer_load_dwordx4 v[20:23], v3, s[4:7], s34 offen offset:3072 sc1
    s_branch CM2_A
CM2_T:
    s_barrier
    s_barrier
    buffer_load_dwordx4 v[48:51], v3, s[4:7], s51 offen offset:0 sc1
    buffer_load_dwordx4 v[52:55], v3, s[4:7], s51 offen offset:1024 sc1
    s_waitcnt vmcnt(1)
    v_mfma_f32_16x16x32_bf16 v[60:63], v[44:47], v[48:51], 0
    v_bitop3_b32 v2, v48, v50, s32 bitop3:0x7e
    s_waitcnt vmcnt(0)
    v_mfma_f32_16x16x32_bf16 v[60:63], v[44:47], v[52:55], v[60:63]
    v_bitop3_b32 v6, v52, v54, s32 bitop3:0x7e
    v_bitop3_b32 v2, v2, v6, 1 bitop3:0xa8
    v_cmp_ne_u32 vcc, 0, v2
    v_mov_b64 v[48:49], 0
    v_mov_b64 v[50:51], 0
    v_mov_b64 v[52:53], 0
    v_mov_b64 v[54:55], 0
    s_nop 0
    v_add_f32_dpp v60, v60, v60 row_ror:8 row_mask:0xf bank_mask:0xf
    v_add_f32_dpp v61, v61, v61 row_ror:8 row_mask:0xf bank_mask:0xf
    s_nop 0
    v_add_f32_dpp v60, v60, v60 row_ror:4 row_mask:0xf bank_mask:0xf
    v_add_f32_dpp v61, v61, v61 row_ror:4 row_mask:0xf bank_mask:0xf
    v_cvt_pk_bf16_f32 v6, v60, v61
    s_cbranch_vccnz CM2_R1
CM2_RC:
    buffer_store_dword v6, v7, s[4:7], s36 offen sc1
    v_mov_b64 v[44:45], 0
    v_mov_b64 v[46:47], 0
    v_mov_b64 v[60:61], 0
    v_mov_b64 v[62:63], 0
    s_barrier
    buffer_load_dwordx4 v[16:19], v3, s[4:7], s34 offen offset:2048 sc1
    s_barrier
    ds_read_b128 v[8:11], v3 offset:7168
    ds_read_b128 v[12:15], v3 offset:8192
    buffer_load_dwordx4 v[20:23], v3, s[4:7], s34 offen offset:3072 sc1
    s_cmp_eq_u32 s32, s18
    s_cbranch_scc1 CM2_SP
CM2_A:
    s_waitcnt lgkmcnt(1)
    v_smfmac_f32_16x16x64_bf16 v[40:43], v[8:11], v[72:79], v1
    v_smfmac_f32_16x16x64_bf16 v[48:51], v[8:11], v[64:71], v1
    ds_read_b128 v[64:67], v0 offset:32768
    v_smfmac_f32_16x16x64_bf16 v[44:47], v[8:11], v[24:31], v1
    ds_read_b128 v[68:71], v0 offset:33792
    v_mov_b32 v2, s30
    v_smfmac_f32_16x16x64_bf16 v[52:55], v[8:11], v[32:39], v1
    buffer_store_dword v2, v7, s[4:7], s37 offen sc1
    ds_read_b128 v[24:27], v0 offset:34816
    v_smfmac_f32_16x16x64_bf16 v[56:59], v[8:11], a[216:223], v1
    ds_read_b128 v[28:31], v0 offset:35840
    v_smfmac_f32_16x16x64_bf16 v[60:63], v[8:11], a[224:231], v1
    buffer_load_dwordx4 v3, s[4:7], s35 offen offset:1024 sc1 lds
    ds_read_b128 v[32:35], v0 offset:4096
    s_waitcnt lgkmcnt(5)
    v_smfmac_f32_16x16x64_bf16 v[40:43], v[12:15], a[0:7], v1
    ds_read_b128 v[36:39], v0 offset:5120
    s_waitcnt lgkmcnt(4)
    v_smfmac_f32_16x16x64_bf16 v[48:51], v[12:15], v[64:71], v1
    v_smfmac_f32_16x16x64_bf16 v[44:47], v[12:15], a[8:15], v1
    s_waitcnt lgkmcnt(2)
    v_smfmac_f32_16x16x64_bf16 v[52:55], v[12:15], v[24:31], v1
    buffer_load_dwordx4 v[72:75], v3, s[4:7], s46 offen offset:2048 sc1
    ds_read_b128 v[24:27], v0 offset:16384
    v_smfmac_f32_16x16x64_bf16 v[56:59], v[12:15], a[232:239], v1
    buffer_load_dwordx4 v[76:79], v3, s[4:7], s46 offen offset:3072 sc1
    ds_read_b128 v[28:31], v0 offset:17408
    s_waitcnt lgkmcnt(2)
    v_smfmac_f32_16x16x64_bf16 v[60:63], v[12:15], v[32:39], v1
    ds_read_b128 v[32:35], v0 offset:18432
    ds_read_b128 v[36:39], v0 offset:19456
    s_waitcnt vmcnt(5)
    v_smfmac_f32_16x16x64_bf16 v[40:43], v[16:19], a[16:23], v1
    ds_write_b128 v3, v[16:19] offset:2048
    v_and_b32 v64, 128, v3
    v_smfmac_f32_16x16x64_bf16 v[48:51], v[16:19], a[120:127], v1
    v_mad_u32_u24 v64, v64, 31, v3
    v_smfmac_f32_16x16x64_bf16 v[44:47], v[16:19], a[24:31], v1
    buffer_load_dwordx4 v[68:71], v64, s[4:7], s50 offen offset:1024 sc1
    v_maximum3_f32 v2, v16, v17, v18
    v_smfmac_f32_16x16x64_bf16 v[52:55], v[16:19], a[128:135], v1
    buffer_load_dwordx4 v[64:67], v64, s[4:7], s38 offen offset:1024 sc1
    s_waitcnt lgkmcnt(3)
    v_cmp_u_f32 vcc, v2, v19
    v_smfmac_f32_16x16x64_bf16 v[56:59], v[16:19], v[24:31], v1
    s_waitcnt lgkmcnt(1)
    v_smfmac_f32_16x16x64_bf16 v[60:63], v[16:19], v[32:39], v1
    s_cbranch_vccnz CM2_FB
CM2_CB:
    s_waitcnt lgkmcnt(0)
    s_barrier
    s_waitcnt vmcnt(6)
    v_smfmac_f32_16x16x64_bf16 v[40:43], v[20:23], a[32:39], v1
    buffer_store_dword v6, v7, s[4:7], s39 offen sc1
    ds_read_b128 v[8:11], v3 offset:0
    v_lshlrev_b32 v6, 3, v3
    v_smfmac_f32_16x16x64_bf16 v[48:51], v[20:23], a[136:143], v1
    buffer_load_dword v6, v6, s[4:7], s45 offen sc1
    ds_read_b128 v[12:15], v3 offset:1024
    v_smfmac_f32_16x16x64_bf16 v[44:47], v[20:23], a[40:47], v1
    ds_read_b128 v[32:35], v0 offset:0
    s_mov_b32 s37, s36
    v_smfmac_f32_16x16x64_bf16 v[52:55], v[20:23], a[144:151], v1
    s_waitcnt vmcnt(6)
    s_barrier
    ds_read_b128 v[36:39], v0 offset:1024
    s_waitcnt lgkmcnt(3)
    v_smfmac_f32_16x16x64_bf16 v[40:43], v[8:11], a[48:55], v1
    ds_read_b128 v[28:31], v3 offset:4096
    s_add_u32 s36, s36, 0x8000
    v_smfmac_f32_16x16x64_bf16 v[44:47], v[8:11], a[56:63], v1
    ds_read_b128 v[24:27], v3 offset:6144
    s_bitset0_b32 s36, 17
    s_waitcnt lgkmcnt(4)
    v_smfmac_f32_16x16x64_bf16 v[40:43], v[12:15], a[64:71], v1
    ds_read_b128 v[16:19], v3 offset:5120
    s_add_u32 s32, s32, 1
    v_smfmac_f32_16x16x64_bf16 v[44:47], v[12:15], a[72:79], v1
    ds_read_b32 v2, v3 offset:13568
    s_waitcnt lgkmcnt(3)
    v_smfmac_f32_16x16x64_bf16 v[40:43], v[28:31], v[32:39], v1
    ds_read_b128 v[32:35], v0 offset:2048
    s_add_u32 s39, s39, 9216
    v_smfmac_f32_16x16x64_bf16 v[44:47], v[28:31], a[80:87], v1
    ds_read_b128 v[36:39], v0 offset:3072
    s_mov_b32 s29, 0
    s_waitcnt lgkmcnt(4)
    v_smfmac_f32_16x16x64_bf16 v[40:43], v[24:27], a[104:111], v1
    s_add_u32 s45, s45, 32768
    s_waitcnt lgkmcnt(3)
    v_smfmac_f32_16x16x64_bf16 v[40:43], v[16:19], a[88:95], v1
    v_smfmac_f32_16x16x64_bf16 v[44:47], v[24:27], a[112:119], v1
    v_smfmac_f32_16x16x64_bf16 v[44:47], v[16:19], a[96:103], v1
    s_waitcnt lgkmcnt(0)
    v_add_f32 v40, v40, v41
    v_smfmac_f32_16x16x64_bf16 v[48:51], v[8:11], v[32:39], v1
    ds_read_b128 v[32:35], v0 offset:8192
    v_add_f32 v42, v42, v43
    v_smfmac_f32_16x16x64_bf16 v[52:55], v[8:11], a[152:159], v1
    ds_read_b128 v[36:39], v0 offset:9216
    v_add_f32 v44, v44, v45
    v_add_f32 v46, v46, v47
    v_cvt_pk_bf16_f32 v40, v40, v44
    v_cvt_pk_bf16_f32 v41, v42, v46
    v_smfmac_f32_16x16x64_bf16 v[48:51], v[12:15], a[160:167], v1
    ds_write_b64 v4, v[40:41] offset:8704
    v_cmp_u_f32 vcc, v40, v41
    v_smfmac_f32_16x16x64_bf16 v[52:55], v[12:15], a[168:175], v1
    v_smfmac_f32_16x16x64_bf16 v[48:51], v[28:31], a[176:183], v1
    s_cbranch_vccnz CM2_RE
CM2_RJ:
    v_smfmac_f32_16x16x64_bf16 v[52:55], v[28:31], a[184:191], v1
    s_add_u32 s19, s19, 0x8000
    s_waitcnt lgkmcnt(1)
    v_smfmac_f32_16x16x64_bf16 v[48:51], v[24:27], v[32:39], v1
    s_waitcnt lgkmcnt(0)
    s_barrier
    v_smfmac_f32_16x16x64_bf16 v[48:51], v[16:19], a[192:199], v1
    ds_read_b64_tr_b16 v[40:41], v5 offset:7168
    ds_read_b64_tr_b16 v[42:43], v5 offset:7936
    v_smfmac_f32_16x16x64_bf16 v[52:55], v[24:27], a[208:215], v1
    ds_read_b64_tr_b16 v[44:45], v5 offset:8704
    ds_read_b64_tr_b16 v[46:47], v5 offset:9472
    v_smfmac_f32_16x16x64_bf16 v[52:55], v[16:19], a[200:207], v1
    ds_read_b128 v[32:35], v0 offset:6144
    v_add_f32 v48, v48, v49
    v_smfmac_f32_16x16x64_bf16 v[56:59], v[8:11], v[80:87], v1
    ds_read_b128 v[36:39], v0 offset:7168
    s_waitcnt vmcnt(2) lgkmcnt(4)
    v_add_f32 v50, v50, v51
    v_mfma_f32_16x16x32_bf16 v[64:67], v[40:43], v[64:67], 0
    s_waitcnt lgkmcnt(2)
    v_add_f32 v52, v52, v53
    v_add_f32 v54, v54, v55
    v_mfma_f32_16x16x32_bf16 v[64:67], v[44:47], v[68:71], v[64:67]
    v_cvt_pk_bf16_f32 v48, v48, v52
    v_cvt_pk_bf16_f32 v49, v50, v54
    v_smfmac_f32_16x16x64_bf16 v[60:63], v[8:11], v[88:95], v1
    ds_write_b64 v4, v[48:49] offset:1536
    s_bitset0_b32 s19, 17
    v_smfmac_f32_16x16x64_bf16 v[56:59], v[12:15], v[96:103], v1
    s_add_u32 s34, s19, 2048
    s_waitcnt lgkmcnt(1)
    v_add_f32_dpp v64, v65, v64 row_ror:8 row_mask:0xf bank_mask:0xf
    v_add_f32_dpp v64, v66, v67 row_ror:8 row_mask:0xf bank_mask:0xc
    v_exp_f32 v64, v64
    s_nop 0
    v_cvt_pk_bf16_f32 v64, v64, v64
    v_smfmac_f32_16x16x64_bf16 v[60:63], v[12:15], v[32:39], v1
    ds_write_b16 v2, v64 offset:10504
    v_smfmac_f32_16x16x64_bf16 v[56:59], v[16:19], v[120:127], v1
    ds_read_b128 v[8:11], v0 offset:20480
    s_add_u32 s35, s19, 6144
    v_mov_b64 v[32:33], s[20:21]
    v_smfmac_f32_16x16x64_bf16 v[60:63], v[16:19], v[128:135], v1
    ds_read_b128 v[12:15], v0 offset:21504
    v_mov_b64 v[34:35], s[20:21]
    v_smfmac_f32_16x16x64_bf16 v[56:59], v[20:23], a[240:247], v1
    s_waitcnt lgkmcnt(2)
    s_barrier
    v_smfmac_f32_16x16x64_bf16 v[60:63], v[20:23], a[248:255], v1
    ds_read_b64_tr_b16 v[48:49], v5 offset:0
    ds_read_b64_tr_b16 v[50:51], v5 offset:768
    v_smfmac_f32_16x16x64_bf16 v[56:59], v[24:27], v[136:143], v1
    ds_read_b64_tr_b16 v[52:53], v5 offset:1536
    ds_read_b64_tr_b16 v[54:55], v5 offset:2304
    v_smfmac_f32_16x16x64_bf16 v[56:59], v[28:31], v[104:111], v1
    ds_read_b128 v[64:67], v3 offset:10496
    v_mov_b64 v[36:37], 0
    v_smfmac_f32_16x16x64_bf16 v[60:63], v[24:27], v[144:151], v1
    ds_read_b128 v[68:71], v3 offset:10480
    s_waitcnt lgkmcnt(4)
    v_mov_b64 v[38:39], 0
    v_mfma_f32_16x16x32_bf16 v[48:51], v[48:51], v[40:43], 0
    ds_read_b128 v[16:19], v0 offset:24576
    s_waitcnt lgkmcnt(3)
    v_add_f32 v56, v56, v57
    v_add_f32 v58, v58, v59
    v_mfma_f32_16x16x32_bf16 v[48:51], v[52:55], v[44:47], v[48:51]
    ds_read_b128 v[20:23], v0 offset:25600
    v_cvt_pk_bf16_f32 v56, v56, v58
    v_smfmac_f32_16x16x64_bf16 v[60:63], v[28:31], v[112:119], v1
    ds_read_b128 v[24:27], v0 offset:26624
    s_waitcnt lgkmcnt(4)
    v_mfma_f32_16x16x32_bf16 v[52:55], v[32:35], v[64:67], 0
    ds_read_b128 v[28:31], v0 offset:27648
    v_add_f32_dpp v48, v49, v48 quad_perm:[1,0,3,2] row_mask:0xf bank_mask:0xf
    v_add_f32_dpp v50, v51, v50 quad_perm:[1,0,3,2] row_mask:0xf bank_mask:0xf
    v_mfma_f32_16x16x32_bf16 v[72:75], v[72:75], v[64:67], 0
    s_waitcnt lgkmcnt(4)
    v_mul_f32 v48, s44, v48
    v_mul_f32 v50, s44, v50
    v_exp_f32 v48, v48
    v_exp_f32 v50, v50
    v_add_f32 v60, v60, v61
    v_cvt_pk_bf16_f32 v48, v48, v50
    v_cndmask_b32 v48, 0, v48, s[40:41]
    v_mfma_f32_16x16x32_bf16 v[72:75], v[76:79], v[68:71], v[72:75]
    ds_read_b128 v[64:67], v0 offset:22528
    v_mov_b32_dpp v49, v48 quad_perm:[1,0,3,2] row_mask:0xf bank_mask:0xf
    v_add_f32 v62, v62, v63
    v_cvt_pk_bf16_f32 v57, v60, v62
    v_mfma_f32_16x16x16_bf16 v[52:55], v[32:33], v[48:49], v[52:55]
    ds_read_b128 v[32:35], v3 offset:14592
    ds_read_b128 v[68:71], v0 offset:23552
    v_mov_b64 v[40:41], 0
    v_mfma_f32_16x16x16_bf16 v[72:75], v[56:57], v[48:49], v[72:75]
    v_mov_b64 v[42:43], 0
    v_mov_b64 v[44:45], 0
    v_mov_b64 v[46:47], 0
    v_mov_b64 v[60:61], 0
    v_rcp_f32_dpp v53, v52 quad_perm:[0,0,2,2] row_mask:0xf bank_mask:0xf
    v_mov_b64 v[62:63], 0
    v_max_u32 v52, v52, v53
    v_cmp_lt_u32 vcc, s17, v52
    v_mul_f32 v72, v72, v53
    v_mul_f32 v73, v73, v53
    v_mul_f32 v74, v74, v53
    v_mul_f32 v75, v75, v53
    v_cvt_pk_bf16_f32 v72, v72, v73
    v_cvt_pk_bf16_f32 v73, v74, v75
    ds_write_b64 v4, v[72:73] offset:5632
    v_mov_b32_dpp v76, v72 quad_perm:[0,0,2,2] row_mask:0xf bank_mask:0xf
    v_mov_b32_dpp v77, v73 quad_perm:[0,0,2,2] row_mask:0xf bank_mask:0xf
    v_mov_b32_dpp v78, v72 quad_perm:[1,1,3,3] row_mask:0xf bank_mask:0xf
    v_mov_b32_dpp v79, v73 quad_perm:[1,1,3,3] row_mask:0xf bank_mask:0xf
    s_cbranch_vccnz CM2_SLOW
CM2_FAST:
    s_nop 0
    v_smfmac_f32_16x16x64_bf16 v[40:43], v[76:79], v[8:15], v1
    s_waitcnt lgkmcnt(6)
    v_smfmac_f32_16x16x64_bf16 v[44:47], v[76:79], v[16:23], v1
    s_waitcnt lgkmcnt(0)
    s_barrier
    ds_read_b128 v[48:51], v32 offset:6400
    ds_read_b128 v[52:55], v32 offset:4096
    ds_read_b128 v[56:59], v32 offset:4864
    v_smfmac_f32_16x16x64_bf16 v[60:63], v[76:79], v[24:31], v1
    s_add_u32 s38, s38, 32768
    s_add_u32 s50, s50, 32768
    v_smfmac_f32_16x16x64_bf16 v[36:39], v[76:79], v[64:71], v1
    s_add_u32 s46, s46, 32768
    ds_read_b128 v[24:27], v0 offset:10240
    s_waitcnt lgkmcnt(3)
    v_lshrrev_b32 v32, 16, v1
    v_smfmac_f32_16x16x64_bf16 v[40:43], v[48:51], v[192:199], v1
    ds_read_b128 v[28:31], v0 offset:11264
    s_waitcnt lgkmcnt(3)
    v_smfmac_f32_16x16x64_bf16 v[40:43], v[52:55], v[208:215], v1
    ds_read_b128 v[72:75], v33 offset:4096
    s_waitcnt lgkmcnt(3)
    v_smfmac_f32_16x16x64_bf16 v[40:43], v[56:59], v[224:231], v1
    ds_read_b128 v[76:79], v33 offset:5632
    v_smfmac_f32_16x16x64_bf16 v[44:47], v[48:51], v[152:159], v1
    ds_read_b128 v[64:67], v0 offset:28672
    v_smfmac_f32_16x16x64_bf16 v[44:47], v[52:55], v[168:175], v1
    ds_read_b128 v[68:71], v0 offset:29696
    v_cvt_pk_bf16_f32 v40, v40, v41
    v_cvt_pk_bf16_f32 v41, v42, v43
    v_bfi_b32 v40, 1, s32, v40
    buffer_store_dwordx2 v[40:41], v34, s[4:7], s12 offen sc1
    s_waitcnt lgkmcnt(4)
    v_smfmac_f32_16x16x64_bf16 v[44:47], v[56:59], v[24:31], v1
    v_mov_b64 v[40:41], 0
    v_smfmac_f32_16x16x64_bf16 v[60:63], v[48:51], v[160:167], v1
    ds_read_b128 v[24:27], v0 offset:14336
    v_mov_b64 v[42:43], 0
    v_smfmac_f32_16x16x64_bf16 v[60:63], v[52:55], v[176:183], v1
    ds_read_b128 v[28:31], v0 offset:15360
    v_cvt_pk_bf16_f32 v44, v44, v45
    v_smfmac_f32_16x16x64_bf16 v[60:63], v[56:59], v[184:191], v1
    s_waitcnt lgkmcnt(4)
    v_cvt_pk_bf16_f32 v45, v46, v47
    v_smfmac_f32_16x16x64_bf16 v[40:43], v[72:75], v[240:247], v1
    v_bfi_b32 v44, 1, s32, v44
    v_smfmac_f32_16x16x64_bf16 v[40:43], v[76:79], v[248:255], v1
    ds_read_b128 v[72:75], v0 offset:12288
    v_cvt_pk_bf16_f32 v46, v60, v61
    v_cvt_pk_bf16_f32 v47, v62, v63
    buffer_store_dwordx4 v[44:47], v32, s[4:7], s13 offen sc1
    v_smfmac_f32_16x16x64_bf16 v[36:39], v[48:51], v[200:207], v1
    ds_read_b128 v[76:79], v0 offset:13312
    v_smfmac_f32_16x16x64_bf16 v[36:39], v[52:55], v[216:223], v1
    ds_read_b128 v[44:47], v3 offset:11520
    v_add_f32 v40, v40, v41
    v_smfmac_f32_16x16x64_bf16 v[36:39], v[56:59], v[232:239], v1
    v_add_f32 v42, v42, v43
    v_cvt_pk_bf16_f32 v40, v40, v42
    v_bfi_b32 v40, 1, s32, v40
    buffer_store_dword v40, v35, s[4:7], s15 offen sc1
    s_nop 3
    v_cvt_pk_bf16_f32 v36, v36, v37
    v_cvt_pk_bf16_f32 v37, v38, v39
    v_bfi_b32 v36, 1, s32, v36
    buffer_store_dwordx2 v[36:37], v34, s[4:7], s14 offen sc1
    ds_read_b128 v[32:35], v0 offset:30720
    ds_read_b128 v[36:39], v0 offset:31744
    v_mov_b64 v[40:41], 0
    v_mov_b64 v[42:43], 0
    v_mov_b64 v[56:57], 0
    v_mov_b64 v[58:59], 0
    s_waitcnt lgkmcnt(0)
    s_branch CM2_T
CM2_FB:
    s_add_u32 s29, s29, 1
    s_cmp_lt_u32 s29, 8
    s_cbranch_scc1 EX_59
    v_cmp_eq_u32 vcc, s30, v16
    v_cmp_eq_u32 s[48:49], s30, v17
    s_or_b64 vcc, vcc, s[48:49]
    v_cmp_eq_u32 s[48:49], s30, v18
    s_or_b64 vcc, vcc, s[48:49]
    v_cmp_eq_u32 s[48:49], s30, v19
    s_or_b64 vcc, vcc, s[48:49]
    s_cbranch_vccz CM2_CB
EX_59:
    s_add_u32 s31, s31, 1
    s_cmp_ge_u32 s31, 400000
    s_cbranch_scc1 FAIL
    s_waitcnt vmcnt(0)
    s_branch CM2_FF
CM2_RE:
    s_waitcnt vmcnt(0) lgkmcnt(0)
    v_mov_b64 v[40:41], 0
    v_mov_b64 v[42:43], 0
    v_mov_b64 v[44:45], 0
    v_mov_b64 v[46:47], 0
    s_nop 1
    v_mov_b64 v[48:49], 0
    v_mov_b64 v[50:51], 0
    v_mov_b64 v[52:53], 0
    v_mov_b64 v[54:55], 0
    v_mov_b64 v[56:57], 0
    v_mov_b64 v[58:59], 0
    v_mov_b64 v[60:61], 0
    v_mov_b64 v[62:63], 0
    s_add_u32 s31, s31, 1
    s_cmp_ge_u32 s31, 400000
    s_cbranch_scc1 FAIL
CM2_L0:
    buffer_load_dwordx4 v[8:11], v3, s[4:7], s19 offen offset:0 sc1
    s_add_u32 s31, s31, 1
    s_cmp_ge_u32 s31, 400000
    s_cbranch_scc1 FAIL
    s_waitcnt vmcnt(0)
    v_cmp_eq_u32 vcc, s30, v8
    v_cmp_eq_u32 s[48:49], s30, v9
    s_or_b64 vcc, vcc, s[48:49]
    v_cmp_eq_u32 s[48:49], s30, v10
    s_or_b64 vcc, vcc, s[48:49]
    v_cmp_eq_u32 s[48:49], s30, v11
    s_or_b64 vcc, vcc, s[48:49]
    s_cbranch_vccnz CM2_L0
    ds_read_b128 v[32:35], v0 offset:12288
    ds_read_b128 v[36:39], v0 offset:13312
    s_waitcnt lgkmcnt(0)
    v_smfmac_f32_16x16x64_bf16 v[40:43], v[8:11], v[32:39], v1
    ds_read_b128 v[32:35], v0 offset:28672
    ds_read_b128 v[36:39], v0 offset:29696
    s_waitcnt lgkmcnt(0)
    v_smfmac_f32_16x16x64_bf16 v[48:51], v[8:11], v[32:39], v1
    ds_read_b128 v[32:35], v0 offset:14336
    ds_read_b128 v[36:39], v0 offset:15360
    s_waitcnt lgkmcnt(0)
    v_smfmac_f32_16x16x64_bf16 v[44:47], v[8:11], v[32:39], v1
    ds_read_b128 v[32:35], v0 offset:30720
    ds_read_b128 v[36:39], v0 offset:31744
    s_waitcnt lgkmcnt(0)
    v_smfmac_f32_16x16x64_bf16 v[52:55], v[8:11], v[32:39], v1
    v_smfmac_f32_16x16x64_bf16 v[56:59], v[8:11], a[216:223], v1
    v_smfmac_f32_16x16x64_bf16 v[60:63], v[8:11], a[224:231], v1
CM2_L1:
    buffer_load_dwordx4 v[12:15], v3, s[4:7], s19 offen offset:1024 sc1
    s_add_u32 s31, s31, 1
    s_cmp_ge_u32 s31, 400000
    s_cbranch_scc1 FAIL
    s_waitcnt vmcnt(0)
    v_cmp_eq_u32 vcc, s30, v12
    v_cmp_eq_u32 s[48:49], s30, v13
    s_or_b64 vcc, vcc, s[48:49]
    v_cmp_eq_u32 s[48:49], s30, v14
    s_or_b64 vcc, vcc, s[48:49]
    v_cmp_eq_u32 s[48:49], s30, v15
    s_or_b64 vcc, vcc, s[48:49]
    s_cbranch_vccnz CM2_L1
    v_smfmac_f32_16x16x64_bf16 v[40:43], v[12:15], a[0:7], v1
    ds_read_b128 v[32:35], v0 offset:32768
    ds_read_b128 v[36:39], v0 offset:33792
    s_waitcnt lgkmcnt(0)
    v_smfmac_f32_16x16x64_bf16 v[48:51], v[12:15], v[32:39], v1
    v_smfmac_f32_16x16x64_bf16 v[44:47], v[12:15], a[8:15], v1
    ds_read_b128 v[32:35], v0 offset:34816
    ds_read_b128 v[36:39], v0 offset:35840
    s_waitcnt lgkmcnt(0)
    v_smfmac_f32_16x16x64_bf16 v[52:55], v[12:15], v[32:39], v1
    v_smfmac_f32_16x16x64_bf16 v[56:59], v[12:15], a[232:239], v1
    ds_read_b128 v[32:35], v0 offset:4096
    ds_read_b128 v[36:39], v0 offset:5120
    s_waitcnt lgkmcnt(0)
    v_smfmac_f32_16x16x64_bf16 v[60:63], v[12:15], v[32:39], v1
CM2_L2:
    buffer_load_dwordx4 v[16:19], v3, s[4:7], s34 offen offset:2048 sc1
    s_add_u32 s31, s31, 1
    s_cmp_ge_u32 s31, 400000
    s_cbranch_scc1 FAIL
    s_waitcnt vmcnt(0)
    v_cmp_eq_u32 vcc, s30, v16
    v_cmp_eq_u32 s[48:49], s30, v17
    s_or_b64 vcc, vcc, s[48:49]
    v_cmp_eq_u32 s[48:49], s30, v18
    s_or_b64 vcc, vcc, s[48:49]
    v_cmp_eq_u32 s[48:49], s30, v19
    s_or_b64 vcc, vcc, s[48:49]
    s_cbranch_vccnz CM2_L2
    v_smfmac_f32_16x16x64_bf16 v[40:43], v[16:19], a[16:23], v1
    v_smfmac_f32_16x16x64_bf16 v[48:51], v[16:19], a[120:127], v1
    v_smfmac_f32_16x16x64_bf16 v[44:47], v[16:19], a[24:31], v1
    v_smfmac_f32_16x16x64_bf16 v[52:55], v[16:19], a[128:135], v1
    ds_read_b128 v[32:35], v0 offset:16384
    ds_read_b128 v[36:39], v0 offset:17408
    s_waitcnt lgkmcnt(0)
    v_smfmac_f32_16x16x64_bf16 v[56:59], v[16:19], v[32:39], v1
    ds_read_b128 v[32:35], v0 offset:18432
    ds_read_b128 v[36:39], v0 offset:19456
    s_waitcnt lgkmcnt(0)
    v_smfmac_f32_16x16x64_bf16 v[60:63], v[16:19], v[32:39], v1
CM2_L3:
    buffer_load_dwordx4 v[20:23], v3, s[4:7], s34 offen offset:3072 sc1
    s_add_u32 s31, s31, 1
    s_cmp_ge_u32 s31, 400000
    s_cbranch_scc1 FAIL
    s_waitcnt vmcnt(0)
    v_cmp_eq_u32 vcc, s30, v20
    v_cmp_eq_u32 s[48:49], s30, v21
    s_or_b64 vcc, vcc, s[48:49]
    v_cmp_eq_u32 s[48:49], s30, v22
    s_or_b64 vcc, vcc, s[48:49]
    v_cmp_eq_u32 s[48:49], s30, v23
    s_or_b64 vcc, vcc, s[48:49]
    s_cbranch_vccnz CM2_L3
    v_smfmac_f32_16x16x64_bf16 v[40:43], v[20:23], a[32:39], v1
    v_smfmac_f32_16x16x64_bf16 v[48:51], v[20:23], a[136:143], v1
    v_smfmac_f32_16x16x64_bf16 v[44:47], v[20:23], a[40:47], v1
    v_smfmac_f32_16x16x64_bf16 v[52:55], v[20:23], a[144:151], v1
CM2_L4:
    buffer_load_dwordx4 v[8:11], v3, s[4:7], s34 offen offset:0 sc1
    s_add_u32 s31, s31, 1
    s_cmp_ge_u32 s31, 400000
    s_cbranch_scc1 FAIL
    s_waitcnt vmcnt(0)
    v_cmp_eq_u32 vcc, s30, v8
    v_cmp_eq_u32 s[48:49], s30, v9
    s_or_b64 vcc, vcc, s[48:49]
    v_cmp_eq_u32 s[48:49], s30, v10
    s_or_b64 vcc, vcc, s[48:49]
    v_cmp_eq_u32 s[48:49], s30, v11
    s_or_b64 vcc, vcc, s[48:49]
    s_cbranch_vccnz CM2_L4
    v_smfmac_f32_16x16x64_bf16 v[40:43], v[8:11], a[48:55], v1
    v_smfmac_f32_16x16x64_bf16 v[44:47], v[8:11], a[56:63], v1
CM2_L5:
    buffer_load_dwordx4 v[12:15], v3, s[4:7], s34 offen offset:1024 sc1
    s_add_u32 s31, s31, 1
    s_cmp_ge_u32 s31, 400000
    s_cbranch_scc1 FAIL
    s_waitcnt vmcnt(0)
    v_cmp_eq_u32 vcc, s30, v12
    v_cmp_eq_u32 s[48:49], s30, v13
    s_or_b64 vcc, vcc, s[48:49]
    v_cmp_eq_u32 s[48:49], s30, v14
    s_or_b64 vcc, vcc, s[48:49]
    v_cmp_eq_u32 s[48:49], s30, v15
    s_or_b64 vcc, vcc, s[48:49]
    s_cbranch_vccnz CM2_L5
    v_smfmac_f32_16x16x64_bf16 v[40:43], v[12:15], a[64:71], v1
    v_smfmac_f32_16x16x64_bf16 v[44:47], v[12:15], a[72:79], v1
CM2_L6:
    buffer_load_dwordx4 v[28:31], v3, s[4:7], s35 offen offset:0 sc1
    s_add_u32 s31, s31, 1
    s_cmp_ge_u32 s31, 400000
    s_cbranch_scc1 FAIL
    s_waitcnt vmcnt(0)
    v_cmp_eq_u32 vcc, s30, v28
    v_cmp_eq_u32 s[48:49], s30, v29
    s_or_b64 vcc, vcc, s[48:49]
    v_cmp_eq_u32 s[48:49], s30, v30
    s_or_b64 vcc, vcc, s[48:49]
    v_cmp_eq_u32 s[48:49], s30, v31
    s_or_b64 vcc, vcc, s[48:49]
    s_cbranch_vccnz CM2_L6
    ds_read_b128 v[32:35], v0 offset:0
    ds_read_b128 v[36:39], v0 offset:1024
    s_waitcnt lgkmcnt(0)
    v_smfmac_f32_16x16x64_bf16 v[40:43], v[28:31], v[32:39], v1
    v_smfmac_f32_16x16x64_bf16 v[44:47], v[28:31], a[80:87], v1
CM2_L8:
    buffer_load_dwordx4 v[24:27], v3, s[4:7], s35 offen offset:2048 sc1
    s_add_u32 s31, s31, 1
    s_cmp_ge_u32 s31, 400000
    s_cbranch_scc1 FAIL
    s_waitcnt vmcnt(0)
    v_cmp_eq_u32 vcc, s30, v24
    v_cmp_eq_u32 s[48:49], s30, v25
    s_or_b64 vcc, vcc, s[48:49]
    v_cmp_eq_u32 s[48:49], s30, v26
    s_or_b64 vcc, vcc, s[48:49]
    v_cmp_eq_u32 s[48:49], s30, v27
    s_or_b64 vcc, vcc, s[48:49]
    s_cbranch_vccnz CM2_L8
    v_smfmac_f32_16x16x64_bf16 v[40:43], v[24:27], a[104:111], v1
CM2_L7:
    buffer_load_dwordx4 v[16:19], v3, s[4:7], s35 offen offset:1024 sc1
    s_add_u32 s31, s31, 1
    s_cmp_ge_u32 s31, 400000
    s_cbranch_scc1 FAIL
    s_waitcnt vmcnt(0)
    v_cmp_eq_u32 vcc, s30, v16
    v_cmp_eq_u32 s[48:49], s30, v17
    s_or_b64 vcc, vcc, s[48:49]
    v_cmp_eq_u32 s[48:49], s30, v18
    s_or_b64 vcc, vcc, s[48:49]
    v_cmp_eq_u32 s[48:49], s30, v19
    s_or_b64 vcc, vcc, s[48:49]
    s_cbranch_vccnz CM2_L7
    v_smfmac_f32_16x16x64_bf16 v[40:43], v[16:19], a[88:95], v1
    v_smfmac_f32_16x16x64_bf16 v[44:47], v[24:27], a[112:119], v1
    v_smfmac_f32_16x16x64_bf16 v[44:47], v[16:19], a[96:103], v1
    ds_read_b128 v[32:35], v0 offset:2048
    ds_read_b128 v[36:39], v0 offset:3072
    s_waitcnt lgkmcnt(0)
    v_smfmac_f32_16x16x64_bf16 v[48:51], v[8:11], v[32:39], v1
    v_smfmac_f32_16x16x64_bf16 v[52:55], v[8:11], a[152:159], v1
    v_smfmac_f32_16x16x64_bf16 v[48:51], v[12:15], a[160:167], v1
    v_smfmac_f32_16x16x64_bf16 v[52:55], v[12:15], a[168:175], v1
    v_smfmac_f32_16x16x64_bf16 v[48:51], v[28:31], a[176:183], v1
    ds_read_b128 v[32:35], v0 offset:8192
    ds_read_b128 v[36:39], v0 offset:9216
    v_add_f32 v40, v40, v41
    v_add_f32 v42, v42, v43
    v_add_f32 v44, v44, v45
    v_add_f32 v46, v46, v47
    v_cvt_pk_bf16_f32 v40, v40, v44
    v_cvt_pk_bf16_f32 v41, v42, v46
    ds_write_b64 v4, v[40:41] offset:8704
    s_waitcnt lgkmcnt(0)
    s_branch CM2_RJ
CM2_SLOW:
    ds_read_b64_tr_b16 v[40:41], v5 offset:7168
    ds_read_b64_tr_b16 v[48:49], v5 offset:0
    ds_read_b64_tr_b16 v[42:43], v5 offset:7936
    ds_read_b64_tr_b16 v[50:51], v5 offset:768
    ds_read_b64_tr_b16 v[44:45], v5 offset:8704
    ds_read_b64_tr_b16 v[52:53], v5 offset:1536
    ds_read_b64_tr_b16 v[46:47], v5 offset:9472
    ds_read_b64_tr_b16 v[54:55], v5 offset:2304
    s_waitcnt vmcnt(0) lgkmcnt(0)
    v_and_b32 v64, 128, v3
    v_mad_u32_u24 v64, v64, 31, v3
    buffer_load_dwordx4 v[68:71], v64, s[4:7], s50 offen offset:1024 sc1
    buffer_load_dwordx4 v[76:79], v3, s[4:7], s46 offen offset:3072 sc1
    buffer_load_dwordx4 v[64:67], v64, s[4:7], s38 offen offset:1024 sc1
    buffer_load_dwordx4 v[72:75], v3, s[4:7], s46 offen offset:2048 sc1
    v_mfma_f32_16x16x32_bf16 v[48:51], v[48:51], v[40:43], 0
    v_mfma_f32_16x16x32_bf16 v[48:51], v[52:55], v[44:47], v[48:51]
    v_lshrrev_b32 v38, 2, v3
    v_and_b32 v38, 0xe0, v38
    v_and_b32 v39, 0xe0, v3
    s_nop 4
    v_add_f32_dpp v48, v49, v48 quad_perm:[1,0,3,2] row_mask:0xf bank_mask:0xf
    v_add_f32_dpp v50, v51, v50 quad_perm:[1,0,3,2] row_mask:0xf bank_mask:0xf
    v_mul_f32 v48, s44, v48
    v_mul_f32 v50, s44, v50
    v_mov_b64 v[32:33], s[20:21]
    v_mov_b64 v[34:35], s[20:21]
    s_waitcnt vmcnt(0)
    ds_read_b32 v2, v3 offset:13568
    v_mfma_f32_16x16x32_bf16 v[64:67], v[40:43], v[64:67], 0
    v_mfma_f32_16x16x32_bf16 v[64:67], v[44:47], v[68:71], v[64:67]
    v_max_f32 v37, v48, v50
    v_mov_b32 v36, v37
    s_nop 1
    v_permlane16_swap_b32 v36, v37
    v_max_f32 v37, v36, v37
    v_mov_b32 v36, v37
    s_nop 1
    v_permlane32_swap_b32 v36, v37
    v_max_f32 v37, v36, v37
    v_add_f32_dpp v64, v65, v64 row_ror:8 row_mask:0xf bank_mask:0xf
    v_add_f32_dpp v64, v66, v67 row_ror:8 row_mask:0xf bank_mask:0xc
    s_nop 1
    v_max_f32_dpp v36, v64, v64 quad_perm:[1,0,3,2] row_mask:0xf bank_mask:0xf
    s_nop 1
    v_max_f32_dpp v36, v36, v36 quad_perm:[2,3,0,1] row_mask:0xf bank_mask:0xf
    s_nop 1
    v_max_f32_dpp v36, v36, v36 row_half_mirror row_mask:0xf bank_mask:0xf
    ds_write_b32 v38, v36 offset:15624
    s_mov_b64 exec, s[40:41]
    ds_write_b32 v39, v37 offset:15632
    s_mov_b64 exec, -1
    s_waitcnt lgkmcnt(0)
    s_barrier
    ds_read_b128 v[40:43], v38 offset:15616
    ds_read_b32 v36, v38 offset:15632
    ds_read_b128 v[44:47], v39 offset:15616
    ds_read_b32 v37, v39 offset:15632
    s_waitcnt lgkmcnt(0)
    v_max3_f32 v36, v36, v40, v41
    v_max3_f32 v36, v36, v42, v43
    v_max3_f32 v37, v37, v44, v45
    v_max3_f32 v37, v37, v46, v47
    v_sub_f32 v64, v64, v36
    v_exp_f32 v64, v64
    v_sub_f32 v48, v48, v37
    v_exp_f32 v48, v48
    v_sub_f32 v50, v50, v37
    v_exp_f32 v50, v50
    v_cvt_pk_bf16_f32 v64, v64, v64
    ds_write_b16 v2, v64 offset:10504
    v_cvt_pk_bf16_f32 v48, v48, v50
    v_cndmask_b32 v48, 0, v48, s[40:41]
    s_nop 1
    v_mov_b32_dpp v49, v48 quad_perm:[1,0,3,2] row_mask:0xf bank_mask:0xf
    s_waitcnt lgkmcnt(0)
    s_barrier
    ds_read_b128 v[64:67], v3 offset:10496
    ds_read_b128 v[68:71], v3 offset:10480
    s_waitcnt lgkmcnt(0)
    v_mfma_f32_16x16x32_bf16 v[72:75], v[72:75], v[64:67], 0
    v_mfma_f32_16x16x32_bf16 v[72:75], v[76:79], v[68:71], v[72:75]
    v_mfma_f32_16x16x32_bf16 v[52:55], v[32:35], v[64:67], 0
    s_nop 5
    v_mfma_f32_16x16x16_bf16 v[52:55], v[32:33], v[48:49], v[52:55]
    v_mfma_f32_16x16x16_bf16 v[72:75], v[56:57], v[48:49], v[72:75]
    ds_read_b128 v[64:67], v0 offset:22528
    ds_read_b128 v[68:71], v0 offset:23552
    ds_read_b128 v[32:35], v3 offset:14592
    v_mov_b64 v[36:37], 0
    v_mov_b64 v[38:39], 0
    v_mov_b64 v[40:41], 0
    v_mov_b64 v[42:43], 0
    v_mov_b64 v[44:45], 0
    v_mov_b64 v[46:47], 0
    v_rcp_f32_dpp v53, v52 quad_perm:[0,0,2,2] row_mask:0xf bank_mask:0xf
    s_nop 0
    v_mul_f32 v72, v72, v53
    v_mul_f32 v73, v73, v53
    v_mul_f32 v74, v74, v53
    v_mul_f32 v75, v75, v53
    v_cvt_pk_bf16_f32 v72, v72, v73
    v_cvt_pk_bf16_f32 v73, v74, v75
    ds_write_b64 v4, v[72:73] offset:5632
    v_mov_b32_dpp v76, v72 quad_perm:[0,0,2,2] row_mask:0xf bank_mask:0xf
    v_mov_b32_dpp v77, v73 quad_perm:[0,0,2,2] row_mask:0xf bank_mask:0xf
    v_mov_b32_dpp v78, v72 quad_perm:[1,1,3,3] row_mask:0xf bank_mask:0xf
    v_mov_b32_dpp v79, v73 quad_perm:[1,1,3,3] row_mask:0xf bank_mask:0xf
    s_waitcnt lgkmcnt(0)
    s_branch CM2_FAST
CM2_SP:
    s_cmp_eq_u32 s32, 63
    s_cbranch_scc1 CM2_LAST
    s_add_u32 s18, s18, 1
    s_cmp_gt_u32 s18, 1
    s_cselect_b32 s18, 63, s18
    s_waitcnt vmcnt(0)
CM2_SQ:
    buffer_load_dwordx4 v[16:19], v3, s[4:7], s35 offen offset:1024 sc1
    s_add_u32 s31, s31, 1
    s_cmp_ge_u32 s31, 400000
    s_cbranch_scc1 FAIL
    s_waitcnt vmcnt(0)
    v_cmp_eq_u32 vcc, s30, v16
    v_cmp_eq_u32 s[48:49], s30, v17
    s_or_b64 vcc, vcc, s[48:49]
    v_cmp_eq_u32 s[48:49], s30, v18
    s_or_b64 vcc, vcc, s[48:49]
    v_cmp_eq_u32 s[48:49], s30, v19
    s_or_b64 vcc, vcc, s[48:49]
    s_cbranch_vccnz CM2_SQ
    buffer_load_dwordx4 v[16:19], v3, s[4:7], s34 offen offset:2048 sc1
    buffer_load_dwordx4 v[20:23], v3, s[4:7], s34 offen offset:3072 sc1
    s_branch CM2_A
CM2_R1:
    buffer_load_dwordx4 v[48:51], v3, s[4:7], s51 offen offset:0 sc1
    buffer_load_dwordx4 v[52:55], v3, s[4:7], s51 offen offset:1024 sc1
    s_add_u32 s31, s31, 1
    s_cmp_ge_u32 s31, 400000
    s_cbranch_scc1 FAIL
    s_waitcnt vmcnt(1)
    v_mfma_f32_16x16x32_bf16 v[60:63], v[44:47], v[48:51], 0
    v_bitop3_b32 v2, v48, v50, s32 bitop3:0x7e
    s_waitcnt vmcnt(0)
    v_mfma_f32_16x16x32_bf16 v[60:63], v[44:47], v[52:55], v[60:63]
    v_bitop3_b32 v6, v52, v54, s32 bitop3:0x7e
    v_bitop3_b32 v2, v2, v6, 1 bitop3:0xa8
    v_cmp_ne_u32 vcc, 0, v2
    v_mov_b64 v[48:49], 0
    v_mov_b64 v[50:51], 0
    v_mov_b64 v[52:53], 0
    v_mov_b64 v[54:55], 0
    s_nop 0
    v_add_f32_dpp v60, v60, v60 row_ror:8 row_mask:0xf bank_mask:0xf
    v_add_f32_dpp v61, v61, v61 row_ror:8 row_mask:0xf bank_mask:0xf
    s_nop 0
    v_add_f32_dpp v60, v60, v60 row_ror:4 row_mask:0xf bank_mask:0xf
    v_add_f32_dpp v61, v61, v61 row_ror:4 row_mask:0xf bank_mask:0xf
    v_cvt_pk_bf16_f32 v6, v60, v61
    s_cbranch_vccz CM2_RC
    s_branch CM2_R1
CM2_LAST:
    buffer_store_dword v6, v7, s[4:7], s39 offen sc1
    s_waitcnt vmcnt(0)
    s_branch C_END
CM3_IN:
    s_add_u32 s45, s38, 32768
    s_add_u32 s34, s19, 2048
    s_add_u32 s35, s19, 6144
    buffer_load_dwordx4 v[8:11], v3, s[4:7], s19 offen offset:1024 sc1
    buffer_load_dwordx4 v[12:15], v3, s[4:7], s19 offen offset:0 sc1
    s_mov_b32 s29, 0
    s_mov_b32 m0, 4096
    s_mov_b32 s18, 1
CM3_FF:
    ds_read_b128 v[72:75], v0 offset:12288
    ds_read_b128 v[76:79], v0 offset:13312
    ds_read_b128 v[64:67], v0 offset:28672
    ds_read_b128 v[68:71], v0 offset:29696
    ds_read_b128 v[24:27], v0 offset:14336
    ds_read_b128 v[28:31], v0 offset:15360
    ds_read_b128 v[32:35], v0 offset:30720
    ds_read_b128 v[36:39], v0 offset:31744
    v_mov_b64 v[40:41], 0
    v_mov_b64 v[42:43], 0
    v_mov_b64 v[44:45], 0
    v_mov_b64 v[46:47], 0
    v_mov_b64 v[48:49], 0
    v_mov_b64 v[50:51], 0
    v_mov_b64 v[52:53], 0
    v_mov_b64 v[54:55], 0
    v_mov_b64 v[56:57], 0
    v_mov_b64 v[58:59], 0
    v_mov_b64 v[60:61], 0
    v_mov_b64 v[62:63], 0
    s_waitcnt vmcnt(0) lgkmcnt(0)
    buffer_load_dwordx4 v[16:19], v3, s[4:7], s34 offen offset:3072 sc1
    buffer_load_dwordx4 v[20:23], v3, s[4:7], s34 offen offset:2048 sc1
    s_branch CM3_A
CM3_T:
    s_barrier
    s_barrier
    buffer_load_dwordx4 v[48:51], v3, s[4:7], s51 offen offset:0 sc1
    s_waitcnt vmcnt(0)
    v_mfma_f32_16x16x32_bf16 v[60:63], v[44:47], v[48:51], 0
    v_bitop3_b32 v2, v48, v49, s32 bitop3:0x7e
    v_bitop3_b32 v6, v50, v51, s32 bitop3:0x7e
    v_bitop3_b32 v2, v2, v6, 1 bitop3:0xa8
    v_cmp_ne_u32 vcc, 0, v2
    v_mov_b64 v[48:49], 0
    v_mov_b64 v[50:51], 0
    s_nop 1
    v_add_f32_dpp v60, v60, v60 row_ror:8 row_mask:0xf bank_mask:0xf
    v_add_f32_dpp v61, v61, v61 row_ror:8 row_mask:0xf bank_mask:0xf
    s_nop 0
    v_add_f32_dpp v60, v60, v60 row_ror:4 row_mask:0xf bank_mask:0xf
    v_add_f32_dpp v61, v61, v61 row_ror:4 row_mask:0xf bank_mask:0xf
    s_nop 0
    v_add_f32_dpp v60, v60, v60 row_ror:2 row_mask:0xf bank_mask:0xf
    v_add_f32_dpp v61, v61, v61 row_ror:2 row_mask:0xf bank_mask:0xf
    v_cvt_pk_bf16_f32 v6, v60, v61
    s_cbranch_vccnz CM3_R1
CM3_RC:
    buffer_store_dword v6, v7, s[4:7], s36 offen sc1
    v_mov_b64 v[44:45], 0
    v_mov_b64 v[46:47], 0
    v_mov_b64 v[60:61], 0
    v_mov_b64 v[62:63], 0
    s_barrier
    buffer_load_dwordx4 v[16:19], v3, s[4:7], s34 offen offset:3072 sc1
    s_barrier
    ds_read_b128 v[8:11], v3 offset:8192
    ds_read_b128 v[12:15], v3 offset:7168
    buffer_load_dwordx4 v[20:23], v3, s[4:7], s34 offen offset:2048 sc1
    s_cmp_eq_u32 s32, s18
    s_cbranch_scc1 CM3_SP
CM3_A:
    s_waitcnt lgkmcnt(1)
    v_smfmac_f32_16x16x64_bf16 v[40:43], v[8:11], v[72:79], v1
    v_smfmac_f32_16x16x64_bf16 v[48:51], v[8:11], v[64:71], v1
    ds_read_b128 v[64:67], v0 offset:32768
    v_smfmac_f32_16x16x64_bf16 v[44:47], v[8:11], v[24:31], v1
    ds_read_b128 v[68:71], v0 offset:33792
    v_mov_b32 v2, s30
    v_smfmac_f32_16x16x64_bf16 v[52:55], v[8:11], v[32:39], v1
    buffer_store_dword v2, v7, s[4:7], s37 offen sc1
    ds_read_b128 v[24:27], v0 offset:34816
    v_smfmac_f32_16x16x64_bf16 v[56:59], v[8:11], a[216:223], v1
    ds_read_b128 v[28:31], v0 offset:35840
    v_smfmac_f32_16x16x64_bf16 v[60:63], v[8:11], a[224:231], v1
    buffer_load_dwordx4 v3, s[4:7], s35 offen offset:2048 sc1 lds
    ds_read_b128 v[32:35], v0 offset:4096
    s_waitcnt lgkmcnt(5)
    v_smfmac_f32_16x16x64_bf16 v[40:43], v[12:15], a[0:7], v1
    ds_read_b128 v[36:39], v0 offset:5120
    s_waitcnt lgkmcnt(4)
    v_smfmac_f32_16x16x64_bf16 v[48:51], v[12:15], v[64:71], v1
    v_smfmac_f32_16x16x64_bf16 v[44:47], v[12:15], a[8:15], v1
    s_waitcnt lgkmcnt(2)
    v_smfmac_f32_16x16x64_bf16 v[52:55], v[12:15], v[24:31], v1
    buffer_load_dwordx4 v[72:75], v3, s[4:7], s46 offen offset:2048 sc1
    ds_read_b128 v[24:27], v0 offset:16384
    v_smfmac_f32_16x16x64_bf16 v[56:59], v[12:15], a[232:239], v1
    buffer_load_dwordx4 v[76:79], v3, s[4:7], s46 offen offset:3072 sc1
    ds_read_b128 v[28:31], v0 offset:17408
    s_waitcnt lgkmcnt(2)
    v_smfmac_f32_16x16x64_bf16 v[60:63], v[12:15], v[32:39], v1
    ds_read_b128 v[32:35], v0 offset:18432
    ds_read_b128 v[36:39], v0 offset:19456
    s_waitcnt vmcnt(5)
    v_smfmac_f32_16x16x64_bf16 v[40:43], v[16:19], a[16:23], v1
    ds_write_b128 v3, v[16:19] offset:3072
    v_and_b32 v64, 128, v3
    v_smfmac_f32_16x16x64_bf16 v[48:51], v[16:19], a[120:127], v1
    v_mad_u32_u24 v64, v64, 31, v3
    v_smfmac_f32_16x16x64_bf16 v[44:47], v[16:19], a[24:31], v1
    buffer_load_dwordx4 v[68:71], v64, s[4:7], s50 offen offset:1152 sc1
    v_maximum3_f32 v2, v16, v17, v18
    v_smfmac_f32_16x16x64_bf16 v[52:55], v[16:19], a[128:135], v1
    buffer_load_dwordx4 v[64:67], v64, s[4:7], s38 offen offset:1152 sc1
    s_waitcnt lgkmcnt(3)
    v_cmp_u_f32 vcc, v2, v19
    v_smfmac_f32_16x16x64_bf16 v[56:59], v[16:19], v[24:31], v1
    s_waitcnt lgkmcnt(1)
    v_smfmac_f32_16x16x64_bf16 v[60:63], v[16:19], v[32:39], v1
    s_cbranch_vccnz CM3_FB
CM3_CB:
    s_waitcnt lgkmcnt(0)
    s_barrier
    s_waitcnt vmcnt(6)
    v_smfmac_f32_16x16x64_bf16 v[40:43], v[20:23], a[32:39], v1
    buffer_store_dword v6, v7, s[4:7], s39 offen sc1
    ds_read_b128 v[8:11], v3 offset:1024
    v_lshrrev_b32 v6, 2, v3
    v_smfmac_f32_16x16x64_bf16 v[48:51], v[20:23], a[136:143], v1
    buffer_load_dword v6, v6, s[4:7], s53 offen sc1
    ds_read_b128 v[12:15], v3 offset:0
    v_smfmac_f32_16x16x64_bf16 v[44:47], v[20:23], a[40:47], v1
    ds_read_b128 v[32:35], v0 offset:0
    s_mov_b32 s37, s36
    v_smfmac_f32_16x16x64_bf16 v[52:55], v[20:23], a[144:151], v1
    s_waitcnt vmcnt(6)
    s_barrier
    ds_read_b128 v[36:39], v0 offset:1024
    s_waitcnt lgkmcnt(3)
    v_smfmac_f32_16x16x64_bf16 v[40:43], v[8:11], a[48:55], v1
    ds_read_b128 v[28:31], v3 offset:4096
    s_add_u32 s36, s36, 0x8000
    v_smfmac_f32_16x16x64_bf16 v[44:47], v[8:11], a[56:63], v1
    ds_read_b128 v[24:27], v3 offset:6144
    s_bitset0_b32 s36, 17
    s_waitcnt lgkmcnt(4)
    v_smfmac_f32_16x16x64_bf16 v[40:43], v[12:15], a[64:71], v1
    ds_read_b128 v[16:19], v3 offset:5120
    s_add_u32 s32, s32, 1
    v_smfmac_f32_16x16x64_bf16 v[44:47], v[12:15], a[72:79], v1
    ds_read_b32 v2, v3 offset:13568
    s_waitcnt lgkmcnt(3)
    v_smfmac_f32_16x16x64_bf16 v[40:43], v[28:31], v[32:39], v1
    ds_read_b128 v[32:35], v0 offset:2048
    s_add_u32 s39, s39, 9216
    v_smfmac_f32_16x16x64_bf16 v[44:47], v[28:31], a[80:87], v1
    ds_read_b128 v[36:39], v0 offset:3072
    s_mov_b32 s29, 0
    s_waitcnt lgkmcnt(4)
    v_smfmac_f32_16x16x64_bf16 v[40:43], v[24:27], a[104:111], v1
    s_waitcnt lgkmcnt(3)
    v_smfmac_f32_16x16x64_bf16 v[40:43], v[16:19], a[88:95], v1
    v_smfmac_f32_16x16x64_bf16 v[44:47], v[24:27], a[112:119], v1
    v_smfmac_f32_16x16x64_bf16 v[44:47], v[16:19], a[96:103], v1
    s_waitcnt lgkmcnt(0)
    v_add_f32 v40, v40, v41
    v_smfmac_f32_16x16x64_bf16 v[48:51], v[8:11], v[32:39], v1
    ds_read_b128 v[32:35], v0 offset:8192
    v_add_f32 v42, v42, v43
    v_smfmac_f32_16x16x64_bf16 v[52:55], v[8:11], a[152:159], v1
    ds_read_b128 v[36:39], v0 offset:9216
    v_add_f32 v44, v44, v45
    v_add_f32 v46, v46, v47
    v_cvt_pk_bf16_f32 v40, v40, v44
    v_cvt_pk_bf16_f32 v41, v42, v46
    v_smfmac_f32_16x16x64_bf16 v[48:51], v[12:15], a[160:167], v1
    ds_write_b64 v4, v[40:41] offset:9472
    v_cmp_u_f32 vcc, v40, v41
    v_smfmac_f32_16x16x64_bf16 v[52:55], v[12:15], a[168:175], v1
    v_smfmac_f32_16x16x64_bf16 v[48:51], v[28:31], a[176:183], v1
    s_cbranch_vccnz CM3_RE
CM3_RJ:
    v_smfmac_f32_16x16x64_bf16 v[52:55], v[28:31], a[184:191], v1
    s_add_u32 s19, s19, 0x8000
    s_waitcnt lgkmcnt(1)
    v_smfmac_f32_16x16x64_bf16 v[48:51], v[24:27], v[32:39], v1
    s_waitcnt lgkmcnt(0)
    s_barrier
    v_smfmac_f32_16x16x64_bf16 v[48:51], v[16:19], a[192:199], v1
    ds_read_b64_tr_b16 v[40:41], v5 offset:7168
    ds_read_b64_tr_b16 v[42:43], v5 offset:7936
    v_smfmac_f32_16x16x64_bf16 v[52:55], v[24:27], a[208:215], v1
    ds_read_b64_tr_b16 v[44:45], v5 offset:8704
    ds_read_b64_tr_b16 v[46:47], v5 offset:9472
    v_smfmac_f32_16x16x64_bf16 v[52:55], v[16:19], a[200:207], v1
    ds_read_b128 v[32:35], v0 offset:6144
    v_add_f32 v48, v48, v49
    v_smfmac_f32_16x16x64_bf16 v[56:59], v[8:11], v[80:87], v1
    ds_read_b128 v[36:39], v0 offset:7168
    s_waitcnt vmcnt(2) lgkmcnt(4)
    v_add_f32 v50, v50, v51
    v_mfma_f32_16x16x32_bf16 v[64:67], v[40:43], v[64:67], 0
    s_waitcnt lgkmcnt(2)
    v_add_f32 v52, v52, v53
    v_add_f32 v54, v54, v55
    v_mfma_f32_16x16x32_bf16 v[64:67], v[44:47], v[68:71], v[64:67]
    v_cvt_pk_bf16_f32 v48, v48, v52
    v_cvt_pk_bf16_f32 v49, v50, v54
    v_smfmac_f32_16x16x64_bf16 v[60:63], v[8:11], v[88:95], v1
    ds_write_b64 v4, v[48:49] offset:2304
    s_bitset0_b32 s19, 17
    v_smfmac_f32_16x16x64_bf16 v[56:59], v[12:15], v[96:103], v1
    s_add_u32 s34, s19, 2048
    s_waitcnt lgkmcnt(1)
    v_add_f32_dpp v64, v65, v64 row_ror:8 row_mask:0xf bank_mask:0xf
    v_add_f32_dpp v64, v66, v67 row_ror:8 row_mask:0xf bank_mask:0xc
    v_exp_f32 v64, v64
    s_nop 0
    v_cvt_pk_bf16_f32 v64, v64, v64
    v_smfmac_f32_16x16x64_bf16 v[60:63], v[12:15], v[32:39], v1
    ds_write_b16 v2, v64 offset:11016
    v_smfmac_f32_16x16x64_bf16 v[56:59], v[16:19], v[120:127], v1
    ds_read_b128 v[8:11], v0 offset:20480
    s_add_u32 s35, s19, 6144
    v_mov_b64 v[32:33], s[20:21]
    v_smfmac_f32_16x16x64_bf16 v[60:63], v[16:19], v[128:135], v1
    ds_read_b128 v[12:15], v0 offset:21504
    v_mov_b64 v[34:35], s[20:21]
    v_smfmac_f32_16x16x64_bf16 v[56:59], v[20:23], a[240:247], v1
    s_waitcnt lgkmcnt(2)
    s_barrier
    v_smfmac_f32_16x16x64_bf16 v[60:63], v[20:23], a[248:255], v1
    ds_read_b64_tr_b16 v[48:49], v5 offset:0
    ds_read_b64_tr_b16 v[50:51], v5 offset:768
    v_smfmac_f32_16x16x64_bf16 v[56:59], v[24:27], v[136:143], v1
    ds_read_b64_tr_b16 v[52:53], v5 offset:1536
    ds_read_b64_tr_b16 v[54:55], v5 offset:2304
    v_smfmac_f32_16x16x64_bf16 v[56:59], v[28:31], v[104:111], v1
    ds_read_b128 v[64:67], v3 offset:10496
    v_mov_b64 v[36:37], 0
    v_smfmac_f32_16x16x64_bf16 v[60:63], v[24:27], v[144:151], v1
    ds_read_b128 v[68:71], v3 offset:10480
    s_waitcnt lgkmcnt(4)
    v_mov_b64 v[38:39], 0
    v_mfma_f32_16x16x32_bf16 v[48:51], v[48:51], v[40:43], 0
    ds_read_b128 v[16:19], v0 offset:24576
    s_waitcnt lgkmcnt(3)
    v_add_f32 v56, v56, v57
    v_add_f32 v58, v58, v59
    v_mfma_f32_16x16x32_bf16 v[48:51], v[52:55], v[44:47], v[48:51]
    ds_read_b128 v[20:23], v0 offset:25600
    v_cvt_pk_bf16_f32 v56, v56, v58
    v_smfmac_f32_16x16x64_bf16 v[60:63], v[28:31], v[112:119], v1
    ds_read_b128 v[24:27], v0 offset:26624
    s_waitcnt lgkmcnt(4)
    v_mfma_f32_16x16x32_bf16 v[52:55], v[32:35], v[64:67], 0
    ds_read_b128 v[28:31], v0 offset:27648
    v_add_f32_dpp v48, v49, v48 quad_perm:[1,0,3,2] row_mask:0xf bank_mask:0xf
    v_add_f32_dpp v50, v51, v50 quad_perm:[1,0,3,2] row_mask:0xf bank_mask:0xf
    v_mfma_f32_16x16x32_bf16 v[72:75], v[72:75], v[64:67], 0
    s_waitcnt lgkmcnt(4)
    v_mul_f32 v48, s44, v48
    v_mul_f32 v50, s44, v50
    v_exp_f32 v48, v48
    v_exp_f32 v50, v50
    v_add_f32 v60, v60, v61
    v_cvt_pk_bf16_f32 v48, v48, v50
    v_cndmask_b32 v48, 0, v48, s[40:41]
    v_mfma_f32_16x16x32_bf16 v[72:75], v[76:79], v[68:71], v[72:75]
    ds_read_b128 v[64:67], v0 offset:22528
    v_mov_b32_dpp v49, v48 quad_perm:[1,0,3,2] row_mask:0xf bank_mask:0xf
    v_add_f32 v62, v62, v63
    v_cvt_pk_bf16_f32 v57, v60, v62
    v_mfma_f32_16x16x16_bf16 v[52:55], v[32:33], v[48:49], v[52:55]
    ds_read_b128 v[32:35], v3 offset:14592
    ds_read_b128 v[68:71], v0 offset:23552
    v_mov_b64 v[40:41], 0
    v_mfma_f32_16x16x16_bf16 v[72:75], v[56:57], v[48:49], v[72:75]
    v_mov_b64 v[42:43], 0
    v_mov_b64 v[44:45], 0
    v_mov_b64 v[46:47], 0
    v_mov_b64 v[60:61], 0
    v_rcp_f32_dpp v53, v52 quad_perm:[0,0,2,2] row_mask:0xf bank_mask:0xf
    v_mov_b64 v[62:63], 0
    v_max_u32 v52, v52, v53
    v_cmp_lt_u32 vcc, s17, v52
    v_mul_f32 v72, v72, v53
    v_mul_f32 v73, v73, v53
    v_mul_f32 v74, v74, v53
    v_mul_f32 v75, v75, v53
    v_cvt_pk_bf16_f32 v72, v72, v73
    v_cvt_pk_bf16_f32 v73, v74, v75
    ds_write_b64 v4, v[72:73] offset:6400
    v_mov_b32_dpp v76, v72 quad_perm:[0,0,2,2] row_mask:0xf bank_mask:0xf
    v_mov_b32_dpp v77, v73 quad_perm:[0,0,2,2] row_mask:0xf bank_mask:0xf
    v_mov_b32_dpp v78, v72 quad_perm:[1,1,3,3] row_mask:0xf bank_mask:0xf
    v_mov_b32_dpp v79, v73 quad_perm:[1,1,3,3] row_mask:0xf bank_mask:0xf
    s_cbranch_vccnz CM3_SLOW
CM3_FAST:
    s_nop 0
    v_smfmac_f32_16x16x64_bf16 v[40:43], v[76:79], v[8:15], v1
    s_waitcnt lgkmcnt(6)
    v_smfmac_f32_16x16x64_bf16 v[44:47], v[76:79], v[16:23], v1
    s_waitcnt lgkmcnt(0)
    s_barrier
    ds_read_b128 v[48:51], v32 offset:5632
    ds_read_b128 v[52:55], v32 offset:4864
    ds_read_b128 v[56:59], v32 offset:4096
    v_smfmac_f32_16x16x64_bf16 v[60:63], v[76:79], v[24:31], v1
    s_add_u32 s38, s38, 32768
    s_add_u32 s50, s50, 32768
    v_smfmac_f32_16x16x64_bf16 v[36:39], v[76:79], v[64:71], v1
    s_add_u32 s46, s46, 32768
    ds_read_b128 v[24:27], v0 offset:10240
    s_waitcnt lgkmcnt(3)
    v_lshrrev_b32 v32, 16, v1
    v_smfmac_f32_16x16x64_bf16 v[40:43], v[48:51], v[192:199], v1
    ds_read_b128 v[28:31], v0 offset:11264
    s_waitcnt lgkmcnt(3)
    v_smfmac_f32_16x16x64_bf16 v[40:43], v[52:55], v[208:215], v1
    ds_read_b128 v[72:75], v33 offset:4096
    s_waitcnt lgkmcnt(3)
    v_smfmac_f32_16x16x64_bf16 v[40:43], v[56:59], v[224:231], v1
    ds_read_b128 v[76:79], v33 offset:5632
    v_smfmac_f32_16x16x64_bf16 v[44:47], v[48:51], v[152:159], v1
    ds_read_b128 v[64:67], v0 offset:28672
    v_smfmac_f32_16x16x64_bf16 v[44:47], v[52:55], v[168:175], v1
    ds_read_b128 v[68:71], v0 offset:29696
    v_cvt_pk_bf16_f32 v40, v40, v41
    v_cvt_pk_bf16_f32 v41, v42, v43
    v_bfi_b32 v40, 1, s32, v40
    buffer_store_dwordx2 v[40:41], v34, s[4:7], s12 offen sc1
    s_waitcnt lgkmcnt(4)
    v_smfmac_f32_16x16x64_bf16 v[44:47], v[56:59], v[24:31], v1
    v_mov_b64 v[40:41], 0
    v_smfmac_f32_16x16x64_bf16 v[60:63], v[48:51], v[160:167], v1
    ds_read_b128 v[24:27], v0 offset:14336
    v_mov_b64 v[42:43], 0
    v_smfmac_f32_16x16x64_bf16 v[60:63], v[52:55], v[176:183], v1
    ds_read_b128 v[28:31], v0 offset:15360
    v_cvt_pk_bf16_f32 v44, v44, v45
    v_smfmac_f32_16x16x64_bf16 v[60:63], v[56:59], v[184:191], v1
    s_waitcnt lgkmcnt(4)
    v_cvt_pk_bf16_f32 v45, v46, v47
    v_smfmac_f32_16x16x64_bf16 v[40:43], v[72:75], v[240:247], v1
    v_bfi_b32 v44, 1, s32, v44
    v_smfmac_f32_16x16x64_bf16 v[40:43], v[76:79], v[248:255], v1
    ds_read_b128 v[72:75], v0 offset:12288
    v_cvt_pk_bf16_f32 v46, v60, v61
    v_cvt_pk_bf16_f32 v47, v62, v63
    buffer_store_dwordx4 v[44:47], v32, s[4:7], s13 offen sc1
    v_smfmac_f32_16x16x64_bf16 v[36:39], v[48:51], v[200:207], v1
    ds_read_b128 v[76:79], v0 offset:13312
    v_smfmac_f32_16x16x64_bf16 v[36:39], v[52:55], v[216:223], v1
    ds_read_b128 v[44:47], v3 offset:12544
    v_add_f32 v40, v40, v41
    v_smfmac_f32_16x16x64_bf16 v[36:39], v[56:59], v[232:239], v1
    v_add_f32 v42, v42, v43
    v_cvt_pk_bf16_f32 v40, v40, v42
    v_bfi_b32 v40, 1, s32, v40
    buffer_store_dword v40, v35, s[4:7], s15 offen sc1
    s_nop 3
    v_cvt_pk_bf16_f32 v36, v36, v37
    v_cvt_pk_bf16_f32 v37, v38, v39
    v_bfi_b32 v36, 1, s32, v36
    buffer_store_dwordx2 v[36:37], v34, s[4:7], s14 offen sc1
    ds_read_b128 v[32:35], v0 offset:30720
    ds_read_b128 v[36:39], v0 offset:31744
    s_add_u32 s48, s32, 1
    s_min_u32 s48, s48, 63
    s_waitcnt vmcnt(4)
    v_cmp_ge_u32 vcc, s48, v6
    v_mov_b64 v[40:41], 0
    v_mov_b64 v[42:43], 0
    v_mov_b64 v[52:53], 0
    v_mov_b64 v[54:55], 0
    v_mov_b64 v[56:57], 0
    v_mov_b64 v[58:59], 0
    s_and_b64 vcc, vcc, s[42:43]
    s_cbranch_scc1 CM3_QL
CM3_QC:
    s_waitcnt lgkmcnt(0)
    s_branch CM3_T
CM3_FB:
    s_add_u32 s29, s29, 1
    s_cmp_lt_u32 s29, 8
    s_cbranch_scc1 EX_60
    v_cmp_eq_u32 vcc, s30, v16
    v_cmp_eq_u32 s[48:49], s30, v17
    s_or_b64 vcc, vcc, s[48:49]
    v_cmp_eq_u32 s[48:49], s30, v18
    s_or_b64 vcc, vcc, s[48:49]
    v_cmp_eq_u32 s[48:49], s30, v19
    s_or_b64 vcc, vcc, s[48:49]
    s_cbranch_vccz CM3_CB
EX_60:
    s_add_u32 s31, s31, 1
    s_cmp_ge_u32 s31, 400000
    s_cbranch_scc1 FAIL
    s_waitcnt vmcnt(0)
    s_branch CM3_FF
CM3_RE:
    s_waitcnt vmcnt(0) lgkmcnt(0)
    v_mov_b64 v[40:41], 0
    v_mov_b64 v[42:43], 0
    v_mov_b64 v[44:45], 0
    v_mov_b64 v[46:47], 0
    s_nop 1
    v_mov_b64 v[48:49], 0
    v_mov_b64 v[50:51], 0
    v_mov_b64 v[52:53], 0
    v_mov_b64 v[54:55], 0
    v_mov_b64 v[56:57], 0
    v_mov_b64 v[58:59], 0
    v_mov_b64 v[60:61], 0
    v_mov_b64 v[62:63], 0
    s_add_u32 s31, s31, 1
    s_cmp_ge_u32 s31, 400000
    s_cbranch_scc1 FAIL
CM3_L0:
    buffer_load_dwordx4 v[8:11], v3, s[4:7], s19 offen offset:1024 sc1
    s_add_u32 s31, s31, 1
    s_cmp_ge_u32 s31, 400000
    s_cbranch_scc1 FAIL
    s_waitcnt vmcnt(0)
    v_cmp_eq_u32 vcc, s30, v8
    v_cmp_eq_u32 s[48:49], s30, v9
    s_or_b64 vcc, vcc, s[48:49]
    v_cmp_eq_u32 s[48:49], s30, v10
    s_or_b64 vcc, vcc, s[48:49]
    v_cmp_eq_u32 s[48:49], s30, v11
    s_or_b64 vcc, vcc, s[48:49]
    s_cbranch_vccnz CM3_L0
    ds_read_b128 v[32:35], v0 offset:12288
    ds_read_b128 v[36:39], v0 offset:13312
    s_waitcnt lgkmcnt(0)
    v_smfmac_f32_16x16x64_bf16 v[40:43], v[8:11], v[32:39], v1
    ds_read_b128 v[32:35], v0 offset:28672
    ds_read_b128 v[36:39], v0 offset:29696
    s_waitcnt lgkmcnt(0)
    v_smfmac_f32_16x16x64_bf16 v[48:51], v[8:11], v[32:39], v1
    ds_read_b128 v[32:35], v0 offset:14336
    ds_read_b128 v[36:39], v0 offset:15360
    s_waitcnt lgkmcnt(0)
    v_smfmac_f32_16x16x64_bf16 v[44:47], v[8:11], v[32:39], v1
    ds_read_b128 v[32:35], v0 offset:30720
    ds_read_b128 v[36:39], v0 offset:31744
    s_waitcnt lgkmcnt(0)
    v_smfmac_f32_16x16x64_bf16 v[52:55], v[8:11], v[32:39], v1
    v_smfmac_f32_16x16x64_bf16 v[56:59], v[8:11], a[216:223], v1
    v_smfmac_f32_16x16x64_bf16 v[60:63], v[8:11], a[224:231], v1
CM3_L1:
    buffer_load_dwordx4 v[12:15], v3, s[4:7], s19 offen offset:0 sc1
    s_add_u32 s31, s31, 1
    s_cmp_ge_u32 s31, 400000
    s_cbranch_scc1 FAIL
    s_waitcnt vmcnt(0)
    v_cmp_eq_u32 vcc, s30, v12
    v_cmp_eq_u32 s[48:49], s30, v13
    s_or_b64 vcc, vcc, s[48:49]
    v_cmp_eq_u32 s[48:49], s30, v14
    s_or_b64 vcc, vcc, s[48:49]
    v_cmp_eq_u32 s[48:49], s30, v15
    s_or_b64 vcc, vcc, s[48:49]
    s_cbranch_vccnz CM3_L1
    v_smfmac_f32_16x16x64_bf16 v[40:43], v[12:15], a[0:7], v1
    ds_read_b128 v[32:35], v0 offset:32768
    ds_read_b128 v[36:39], v0 offset:33792
    s_waitcnt lgkmcnt(0)
    v_smfmac_f32_16x16x64_bf16 v[48:51], v[12:15], v[32:39], v1
    v_smfmac_f32_16x16x64_bf16 v[44:47], v[12:15], a[8:15], v1
    ds_read_b128 v[32:35], v0 offset:34816
    ds_read_b128 v[36:39], v0 offset:35840
    s_waitcnt lgkmcnt(0)
    v_smfmac_f32_16x16x64_bf16 v[52:55], v[12:15], v[32:39], v1
    v_smfmac_f32_16x16x64_bf16 v[56:59], v[12:15], a[232:239], v1
    ds_read_b128 v[32:35], v0 offset:4096
    ds_read_b128 v[36:39], v0 offset:5120
    s_waitcnt lgkmcnt(0)
    v_smfmac_f32_16x16x64_bf16 v[60:63], v[12:15], v[32:39], v1
CM3_L2:
    buffer_load_dwordx4 v[16:19], v3, s[4:7], s34 offen offset:3072 sc1
    s_add_u32 s31, s31, 1
    s_cmp_ge_u32 s31, 400000
    s_cbranch_scc1 FAIL
    s_waitcnt vmcnt(0)
    v_cmp_eq_u32 vcc, s30, v16
    v_cmp_eq_u32 s[48:49], s30, v17
    s_or_b64 vcc, vcc, s[48:49]
    v_cmp_eq_u32 s[48:49], s30, v18
    s_or_b64 vcc, vcc, s[48:49]
    v_cmp_eq_u32 s[48:49], s30, v19
    s_or_b64 vcc, vcc, s[48:49]
    s_cbranch_vccnz CM3_L2
    v_smfmac_f32_16x16x64_bf16 v[40:43], v[16:19], a[16:23], v1
    v_smfmac_f32_16x16x64_bf16 v[48:51], v[16:19], a[120:127], v1
    v_smfmac_f32_16x16x64_bf16 v[44:47], v[16:19], a[24:31], v1
    v_smfmac_f32_16x16x64_bf16 v[52:55], v[16:19], a[128:135], v1
    ds_read_b128 v[32:35], v0 offset:16384
    ds_read_b128 v[36:39], v0 offset:17408
    s_waitcnt lgkmcnt(0)
    v_smfmac_f32_16x16x64_bf16 v[56:59], v[16:19], v[32:39], v1
    ds_read_b128 v[32:35], v0 offset:18432
    ds_read_b128 v[36:39], v0 offset:19456
    s_waitcnt lgkmcnt(0)
    v_smfmac_f32_16x16x64_bf16 v[60:63], v[16:19], v[32:39], v1
CM3_L3:
    buffer_load_dwordx4 v[20:23], v3, s[4:7], s34 offen offset:2048 sc1
    s_add_u32 s31, s31, 1
    s_cmp_ge_u32 s31, 400000
    s_cbranch_scc1 FAIL
    s_waitcnt vmcnt(0)
    v_cmp_eq_u32 vcc, s30, v20
    v_cmp_eq_u32 s[48:49], s30, v21
    s_or_b64 vcc, vcc, s[48:49]
    v_cmp_eq_u32 s[48:49], s30, v22
    s_or_b64 vcc, vcc, s[48:49]
    v_cmp_eq_u32 s[48:49], s30, v23
    s_or_b64 vcc, vcc, s[48:49]
    s_cbranch_vccnz CM3_L3
    v_smfmac_f32_16x16x64_bf16 v[40:43], v[20:23], a[32:39], v1
    v_smfmac_f32_16x16x64_bf16 v[48:51], v[20:23], a[136:143], v1
    v_smfmac_f32_16x16x64_bf16 v[44:47], v[20:23], a[40:47], v1
    v_smfmac_f32_16x16x64_bf16 v[52:55], v[20:23], a[144:151], v1
CM3_L4:
    buffer_load_dwordx4 v[8:11], v3, s[4:7], s34 offen offset:1024 sc1
    s_add_u32 s31, s31, 1
    s_cmp_ge_u32 s31, 400000
    s_cbranch_scc1 FAIL
    s_waitcnt vmcnt(0)
    v_cmp_eq_u32 vcc, s30, v8
    v_cmp_eq_u32 s[48:49], s30, v9
    s_or_b64 vcc, vcc, s[48:49]
    v_cmp_eq_u32 s[48:49], s30, v10
    s_or_b64 vcc, vcc, s[48:49]
    v_cmp_eq_u32 s[48:49], s30, v11
    s_or_b64 vcc, vcc, s[48:49]
    s_cbranch_vccnz CM3_L4
    v_smfmac_f32_16x16x64_bf16 v[40:43], v[8:11], a[48:55], v1
    v_smfmac_f32_16x16x64_bf16 v[44:47], v[8:11], a[56:63], v1
CM3_L5:
    buffer_load_dwordx4 v[12:15], v3, s[4:7], s34 offen offset:0 sc1
    s_add_u32 s31, s31, 1
    s_cmp_ge_u32 s31, 400000
    s_cbranch_scc1 FAIL
    s_waitcnt vmcnt(0)
    v_cmp_eq_u32 vcc, s30, v12
    v_cmp_eq_u32 s[48:49], s30, v13
    s_or_b64 vcc, vcc, s[48:49]
    v_cmp_eq_u32 s[48:49], s30, v14
    s_or_b64 vcc, vcc, s[48:49]
    v_cmp_eq_u32 s[48:49], s30, v15
    s_or_b64 vcc, vcc, s[48:49]
    s_cbranch_vccnz CM3_L5
    v_smfmac_f32_16x16x64_bf16 v[40:43], v[12:15], a[64:71], v1
    v_smfmac_f32_16x16x64_bf16 v[44:47], v[12:15], a[72:79], v1
CM3_L6:
    buffer_load_dwordx4 v[28:31], v3, s[4:7], s35 offen offset:0 sc1
    s_add_u32 s31, s31, 1
    s_cmp_ge_u32 s31, 400000
    s_cbranch_scc1 FAIL
    s_waitcnt vmcnt(0)
    v_cmp_eq_u32 vcc, s30, v28
    v_cmp_eq_u32 s[48:49], s30, v29
    s_or_b64 vcc, vcc, s[48:49]
    v_cmp_eq_u32 s[48:49], s30, v30
    s_or_b64 vcc, vcc, s[48:49]
    v_cmp_eq_u32 s[48:49], s30, v31
    s_or_b64 vcc, vcc, s[48:49]
    s_cbranch_vccnz CM3_L6
    ds_read_b128 v[32:35], v0 offset:0
    ds_read_b128 v[36:39], v0 offset:1024
    s_waitcnt lgkmcnt(0)
    v_smfmac_f32_16x16x64_bf16 v[40:43], v[28:31], v[32:39], v1
    v_smfmac_f32_16x16x64_bf16 v[44:47], v[28:31], a[80:87], v1
CM3_L8:
    buffer_load_dwordx4 v[24:27], v3, s[4:7], s35 offen offset:2048 sc1
    s_add_u32 s31, s31, 1
    s_cmp_ge_u32 s31, 400000
    s_cbranch_scc1 FAIL
    s_waitcnt vmcnt(0)
    v_cmp_eq_u32 vcc, s30, v24
    v_cmp_eq_u32 s[48:49], s30, v25
    s_or_b64 vcc, vcc, s[48:49]
    v_cmp_eq_u32 s[48:49], s30, v26
    s_or_b64 vcc, vcc, s[48:49]
    v_cmp_eq_u32 s[48:49], s30, v27
    s_or_b64 vcc, vcc, s[48:49]
    s_cbranch_vccnz CM3_L8
    v_smfmac_f32_16x16x64_bf16 v[40:43], v[24:27], a[104:111], v1
CM3_L7:
    buffer_load_dwordx4 v[16:19], v3, s[4:7], s35 offen offset:1024 sc1
    s_add_u32 s31, s31, 1
    s_cmp_ge_u32 s31, 400000
    s_cbranch_scc1 FAIL
    s_waitcnt vmcnt(0)
    v_cmp_eq_u32 vcc, s30, v16
    v_cmp_eq_u32 s[48:49], s30, v17
    s_or_b64 vcc, vcc, s[48:49]
    v_cmp_eq_u32 s[48:49], s30, v18
    s_or_b64 vcc, vcc, s[48:49]
    v_cmp_eq_u32 s[48:49], s30, v19
    s_or_b64 vcc, vcc, s[48:49]
    s_cbranch_vccnz CM3_L7
    v_smfmac_f32_16x16x64_bf16 v[40:43], v[16:19], a[88:95], v1
    v_smfmac_f32_16x16x64_bf16 v[44:47], v[24:27], a[112:119], v1
    v_smfmac_f32_16x16x64_bf16 v[44:47], v[16:19], a[96:103], v1
    ds_read_b128 v[32:35], v0 offset:2048
    ds_read_b128 v[36:39], v0 offset:3072
    s_waitcnt lgkmcnt(0)
    v_smfmac_f32_16x16x64_bf16 v[48:51], v[8:11], v[32:39], v1
    v_smfmac_f32_16x16x64_bf16 v[52:55], v[8:11], a[152:159], v1
    v_smfmac_f32_16x16x64_bf16 v[48:51], v[12:15], a[160:167], v1
    v_smfmac_f32_16x16x64_bf16 v[52:55], v[12:15], a[168:175], v1
    v_smfmac_f32_16x16x64_bf16 v[48:51], v[28:31], a[176:183], v1
    ds_read_b128 v[32:35], v0 offset:8192
    ds_read_b128 v[36:39], v0 offset:9216
    v_add_f32 v40, v40, v41
    v_add_f32 v42, v42, v43
    v_add_f32 v44, v44, v45
    v_add_f32 v46, v46, v47
    v_cvt_pk_bf16_f32 v40, v40, v44
    v_cvt_pk_bf16_f32 v41, v42, v46
    ds_write_b64 v4, v[40:41] offset:9472
    s_waitcnt lgkmcnt(0)
    s_branch CM3_RJ
CM3_SLOW:
    ds_read_b64_tr_b16 v[40:41], v5 offset:7168
    ds_read_b64_tr_b16 v[48:49], v5 offset:0
    ds_read_b64_tr_b16 v[42:43], v5 offset:7936
    ds_read_b64_tr_b16 v[50:51], v5 offset:768
    ds_read_b64_tr_b16 v[44:45], v5 offset:8704
    ds_read_b64_tr_b16 v[52:53], v5 offset:1536
    ds_read_b64_tr_b16 v[46:47], v5 offset:9472
    ds_read_b64_tr_b16 v[54:55], v5 offset:2304
    s_waitcnt vmcnt(0) lgkmcnt(0)
    v_and_b32 v64, 128, v3
    v_mad_u32_u24 v64, v64, 31, v3
    buffer_load_dwordx4 v[68:71], v64, s[4:7], s50 offen offset:1152 sc1
    buffer_load_dwordx4 v[76:79], v3, s[4:7], s46 offen offset:3072 sc1
    buffer_load_dwordx4 v[64:67], v64, s[4:7], s38 offen offset:1152 sc1
    buffer_load_dwordx4 v[72:75], v3, s[4:7], s46 offen offset:2048 sc1
    v_mfma_f32_16x16x32_bf16 v[48:51], v[48:51], v[40:43], 0
    v_mfma_f32_16x16x32_bf16 v[48:51], v[52:55], v[44:47], v[48:51]
    v_lshrrev_b32 v38, 2, v3
    v_and_b32 v38, 0xe0, v38
    v_and_b32 v39, 0xe0, v3
    s_nop 4
    v_add_f32_dpp v48, v49, v48 quad_perm:[1,0,3,2] row_mask:0xf bank_mask:0xf
    v_add_f32_dpp v50, v51, v50 quad_perm:[1,0,3,2] row_mask:0xf bank_mask:0xf
    v_mul_f32 v48, s44, v48
    v_mul_f32 v50, s44, v50
    v_mov_b64 v[32:33], s[20:21]
    v_mov_b64 v[34:35], s[20:21]
    s_waitcnt vmcnt(0)
    ds_read_b32 v2, v3 offset:13568
    v_mfma_f32_16x16x32_bf16 v[64:67], v[40:43], v[64:67], 0
    v_mfma_f32_16x16x32_bf16 v[64:67], v[44:47], v[68:71], v[64:67]
    v_max_f32 v37, v48, v50
    v_mov_b32 v36, v37
    s_nop 1
    v_permlane16_swap_b32 v36, v37
    v_max_f32 v37, v36, v37
    v_mov_b32 v36, v37
    s_nop 1
    v_permlane32_swap_b32 v36, v37
    v_max_f32 v37, v36, v37
    v_add_f32_dpp v64, v65, v64 row_ror:8 row_mask:0xf bank_mask:0xf
    v_add_f32_dpp v64, v66, v67 row_ror:8 row_mask:0xf bank_mask:0xc
    s_nop 1
    v_max_f32_dpp v36, v64, v64 quad_perm:[1,0,3,2] row_mask:0xf bank_mask:0xf
    s_nop 1
    v_max_f32_dpp v36, v36, v36 quad_perm:[2,3,0,1] row_mask:0xf bank_mask:0xf
    s_nop 1
    v_max_f32_dpp v36, v36, v36 row_half_mirror row_mask:0xf bank_mask:0xf
    ds_write_b32 v38, v36 offset:15628
    s_mov_b64 exec, s[40:41]
    ds_write_b32 v39, v37 offset:15632
    s_mov_b64 exec, -1
    s_waitcnt lgkmcnt(0)
    s_barrier
    ds_read_b128 v[40:43], v38 offset:15616
    ds_read_b32 v36, v38 offset:15632
    ds_read_b128 v[44:47], v39 offset:15616
    ds_read_b32 v37, v39 offset:15632
    s_waitcnt lgkmcnt(0)
    v_max3_f32 v36, v36, v40, v41
    v_max3_f32 v36, v36, v42, v43
    v_max3_f32 v37, v37, v44, v45
    v_max3_f32 v37, v37, v46, v47
    v_sub_f32 v64, v64, v36
    v_exp_f32 v64, v64
    v_sub_f32 v48, v48, v37
    v_exp_f32 v48, v48
    v_sub_f32 v50, v50, v37
    v_exp_f32 v50, v50
    v_cvt_pk_bf16_f32 v64, v64, v64
    ds_write_b16 v2, v64 offset:11016
    v_cvt_pk_bf16_f32 v48, v48, v50
    v_cndmask_b32 v48, 0, v48, s[40:41]
    s_nop 1
    v_mov_b32_dpp v49, v48 quad_perm:[1,0,3,2] row_mask:0xf bank_mask:0xf
    s_waitcnt lgkmcnt(0)
    s_barrier
    ds_read_b128 v[64:67], v3 offset:10496
    ds_read_b128 v[68:71], v3 offset:10480
    s_waitcnt lgkmcnt(0)
    v_mfma_f32_16x16x32_bf16 v[72:75], v[72:75], v[64:67], 0
    v_mfma_f32_16x16x32_bf16 v[72:75], v[76:79], v[68:71], v[72:75]
    v_mfma_f32_16x16x32_bf16 v[52:55], v[32:35], v[64:67], 0
    s_nop 5
    v_mfma_f32_16x16x16_bf16 v[52:55], v[32:33], v[48:49], v[52:55]
    v_mfma_f32_16x16x16_bf16 v[72:75], v[56:57], v[48:49], v[72:75]
    ds_read_b128 v[64:67], v0 offset:22528
    ds_read_b128 v[68:71], v0 offset:23552
    ds_read_b128 v[32:35], v3 offset:14592
    v_mov_b64 v[36:37], 0
    v_mov_b64 v[38:39], 0
    v_mov_b64 v[40:41], 0
    v_mov_b64 v[42:43], 0
    v_mov_b64 v[44:45], 0
    v_mov_b64 v[46:47], 0
    v_rcp_f32_dpp v53, v52 quad_perm:[0,0,2,2] row_mask:0xf bank_mask:0xf
    s_nop 0
    v_mul_f32 v72, v72, v53
    v_mul_f32 v73, v73, v53
    v_mul_f32 v74, v74, v53
    v_mul_f32 v75, v75, v53
    v_cvt_pk_bf16_f32 v72, v72, v73
    v_cvt_pk_bf16_f32 v73, v74, v75
    ds_write_b64 v4, v[72:73] offset:6400
    v_mov_b32_dpp v76, v72 quad_perm:[0,0,2,2] row_mask:0xf bank_mask:0xf
    v_mov_b32_dpp v77, v73 quad_perm:[0,0,2,2] row_mask:0xf bank_mask:0xf
    v_mov_b32_dpp v78, v72 quad_perm:[1,1,3,3] row_mask:0xf bank_mask:0xf
    v_mov_b32_dpp v79, v73 quad_perm:[1,1,3,3] row_mask:0xf bank_mask:0xf
    s_waitcnt lgkmcnt(0)
    s_branch CM3_FAST
CM3_SP:
    s_cmp_eq_u32 s32, 63
    s_cbranch_scc1 CM3_LAST
    s_add_u32 s18, s18, 1
    s_cmp_gt_u32 s18, 1
    s_cselect_b32 s18, 63, s18
    s_waitcnt vmcnt(0)
CM3_SQ:
    buffer_load_dwordx4 v[16:19], v3, s[4:7], s35 offen offset:2048 sc1
    s_add_u32 s31, s31, 1
    s_cmp_ge_u32 s31, 400000
    s_cbranch_scc1 FAIL
    s_waitcnt vmcnt(0)
    v_cmp_eq_u32 vcc, s30, v16
    v_cmp_eq_u32 s[48:49], s30, v17
    s_or_b64 vcc, vcc, s[48:49]
    v_cmp_eq_u32 s[48:49], s30, v18
    s_or_b64 vcc, vcc, s[48:49]
    v_cmp_eq_u32 s[48:49], s30, v19
    s_or_b64 vcc, vcc, s[48:49]
    s_cbranch_vccnz CM3_SQ
    buffer_load_dwordx4 v[16:19], v3, s[4:7], s34 offen offset:3072 sc1
    buffer_load_dwordx4 v[20:23], v3, s[4:7], s34 offen offset:2048 sc1
    s_branch CM3_A
CM3_QL:
    v_lshrrev_b32 v6, 2, v3
    buffer_load_dword v6, v6, s[4:7], s53 offen sc1
    s_add_u32 s31, s31, 1
    s_cmp_ge_u32 s31, 400000
    s_cbranch_scc1 FAIL
    s_waitcnt vmcnt(0)
    v_cmp_ge_u32 vcc, s48, v6
    s_nop 4
    s_and_b64 vcc, vcc, s[42:43]
    s_cbranch_scc1 CM3_QL
    s_branch CM3_QC
CM3_R1:
    buffer_load_dwordx4 v[48:51], v3, s[4:7], s51 offen offset:0 sc1
    s_add_u32 s31, s31, 1
    s_cmp_ge_u32 s31, 400000
    s_cbranch_scc1 FAIL
    s_waitcnt vmcnt(0)
    v_mfma_f32_16x16x32_bf16 v[60:63], v[44:47], v[48:51], 0
    v_bitop3_b32 v2, v48, v49, s32 bitop3:0x7e
    v_bitop3_b32 v6, v50, v51, s32 bitop3:0x7e
    v_bitop3_b32 v2, v2, v6, 1 bitop3:0xa8
    v_cmp_ne_u32 vcc, 0, v2
    v_mov_b64 v[48:49], 0
    v_mov_b64 v[50:51], 0
    s_nop 1
    v_add_f32_dpp v60, v60, v60 row_ror:8 row_mask:0xf bank_mask:0xf
    v_add_f32_dpp v61, v61, v61 row_ror:8 row_mask:0xf bank_mask:0xf
    s_nop 0
    v_add_f32_dpp v60, v60, v60 row_ror:4 row_mask:0xf bank_mask:0xf
    v_add_f32_dpp v61, v61, v61 row_ror:4 row_mask:0xf bank_mask:0xf
    s_nop 0
    v_add_f32_dpp v60, v60, v60 row_ror:2 row_mask:0xf bank_mask:0xf
    v_add_f32_dpp v61, v61, v61 row_ror:2 row_mask:0xf bank_mask:0xf
    v_cvt_pk_bf16_f32 v6, v60, v61
    s_cbranch_vccz CM3_RC
    s_branch CM3_R1
CM3_LAST:
    buffer_store_dword v6, v7, s[4:7], s39 offen sc1
    s_waitcnt vmcnt(0)
    s_branch C_END
C_END:
    s_endpgm
FAIL:
    s_mov_b64 exec, 1
    v_mov_b32 v3, 44
    v_mov_b32 v4, s27
    buffer_store_dword v4, v3, s[8:11], 0 offen sc1
EXIT:
    s_endpgm
.section .rodata,"a"
.p2align 6
.amdhsa_kernel sequential_preLN__memory_aug_recurrent_mem_tr__swiglu_ffn__prompt_kernel
  .amdhsa_next_free_vgpr 512
  .amdhsa_next_free_sgpr 102
  .amdhsa_accum_offset 256
  .amdhsa_group_segment_fixed_size 0
  .amdhsa_kernarg_size 112
  .amdhsa_user_sgpr_count 2
  .amdhsa_user_sgpr_kernarg_segment_ptr 1
  .amdhsa_system_sgpr_workgroup_id_x 1
.end_amdhsa_kernel
```
